```python
import torch

def _softmax(x, axis=-1):
    return torch.softmax(x, dim=axis)

def _gelu(x):
    return torch.nn.functional.gelu(x, approximate='tanh')

def _silu(x):
    return torch.nn.functional.silu(x)

def _sigmoid(x):
    return torch.sigmoid(x)

def _layernorm(x, axis=-1, eps=1e-05):
    m = x.mean(dim=axis, keepdim=True)
    v = x.var(dim=axis, keepdim=True, unbiased=False)
    return (x - m) / torch.sqrt(v + eps)

def _scatter_add(tgt, idx, src, axis=0):
    return tgt.clone().index_add_(axis, idx, src)

def _segment_sum(src, seg, n):
    out = torch.zeros((n,) + src.shape[1:], dtype=src.dtype)
    return out.index_add_(0, seg, src)

def _pad(x, pw):
    flat = tuple((v for pair in reversed(pw) for v in pair))
    return torch.nn.functional.pad(x, flat)
kernel_name = 'adaLN_cond__gqa_block_cached__glu_gated_glu__prompt'

def setup_inputs():

    _w = lambda a: (lambda t: t.to(torch.bfloat16) if t.is_floating_point() else t)(torch.as_tensor(a))

    def _A_setup():
        B, Sq, D = (1, 2048, 1024)
        Hq, Hkv, Sk, Dh = (32, 4, 2048, 128)
        assert Hq % Hkv == 0, (Hq, Hkv)
        return {'x': _w((lambda *s: torch.randn(*s, dtype=torch.bfloat16) * 0.05)(B, Sq, D)), 'k_cache': _w((lambda *s: torch.randn(*s, dtype=torch.bfloat16) * 3.2)(B, Hkv, Sk, Dh)), 'v_cache': _w((lambda *s: torch.randn(*s, dtype=torch.bfloat16) * 0.4)(B, Hkv, Sk, Dh)), 'wq': _w((lambda *s: torch.randn(*s, dtype=torch.bfloat16) * 3.2)(D, Hq * Dh) * D ** (-0.5)), 'wo': _w((lambda *s: torch.randn(*s, dtype=torch.bfloat16) * 0.4)(Hq * Dh, D) * (Hq * Dh) ** (-0.5))}
    _A_in = _A_setup()

    def _B_setup():
        B, S, D, F = (1, 2048, 1024, 3584)
        return {'x': _w((lambda *s: torch.randn(*s, dtype=torch.bfloat16) * 0.05)(B, S, D)), 'w_gate': _w((lambda *s: torch.randn(*s, dtype=torch.bfloat16) * 0.05)(D, F)), 'w_up': _w((lambda *s: torch.randn(*s, dtype=torch.bfloat16) * 0.05)(D, F)), 'w_down': _w((lambda *s: torch.randn(*s, dtype=torch.bfloat16) * 0.05)(F, D))}
    _B_in = _B_setup()
    return {'A_x': _A_in['x'], 'A_k_cache': _A_in['k_cache'], 'A_v_cache': _A_in['v_cache'], 'A_wq': _A_in['wq'], 'A_wo': _A_in['wo'], 'B_x': _B_in['x'], 'B_w_gate': _B_in['w_gate'], 'B_w_up': _B_in['w_up'], 'B_w_down': _B_in['w_down'], 'c': _w((lambda *s: torch.randn(*s, dtype=torch.bfloat16) * 0.1)(1, 1024) * 8.0), 'w_mod': _w((lambda *s: torch.randn(*s, dtype=torch.bfloat16) * 0.1)(1024, 6 * 1024) * 1024 ** (-0.5) * 8.0)}

def reference(A_x, A_k_cache, A_v_cache, A_wq, A_wo, B_x, B_w_gate, B_w_up, B_w_down, c, w_mod):

    def _A_ref(x, k_cache, v_cache, wq, wo):
        B, Sq, D = x.shape
        Hq, Dh = (32, 128)
        Hkv = k_cache.shape[1]
        rep = Hq // Hkv
        q = (lambda x, *d: x.permute(*d))((x @ wq).reshape(B, Sq, Hq, Dh), 0, 2, 1, 3)
        k = (lambda x, n, axis: torch.repeat_interleave(x, n, dim=axis))(k_cache, rep, axis=1)
        v = (lambda x, n, axis: torch.repeat_interleave(x, n, dim=axis))(v_cache, rep, axis=1)
        scores = torch.einsum('bhqd,bhkd->bhqk', q, k) * Dh ** (-0.5)
        p = _softmax(scores, axis=-1)
        o = torch.einsum('bhqk,bhkd->bhqd', p, v)
        return (lambda x, *d: x.permute(*d))(o, 0, 2, 1, 3).reshape(B, Sq, Hq * Dh) @ wo

    def _B_ref(x, w_gate, w_up, w_down):
        g = torch.einsum('bsd,df->bsf', x, w_gate)
        u = torch.einsum('bsd,df->bsf', x, w_up)
        h = _sigmoid(g) * u
        return torch.einsum('bsf,fd->bsd', h, w_down)
    x = A_x
    mod = (_silu(c) @ w_mod).reshape(c.shape[0], 6, 1, -1)
    sa, ca, ga, sb, cb, gb = (mod[:, 0].clone(), mod[:, 1].clone(), mod[:, 2].clone(), mod[:, 3].clone(), mod[:, 4].clone(), mod[:, 5].clone())
    h = _layernorm(x, axis=-1) * (1 + ca) + sa
    x = x + ga * _A_ref(h, A_k_cache, A_v_cache, A_wq, A_wo)
    h = _layernorm(x, axis=-1) * (1 + cb) + sb
    x = x + gb * _B_ref(h, B_w_gate, B_w_up, B_w_down)
    return x
```

```asm
; @launch kernel=k0_prep_kernel grid=(512,1,1) block=(512,1,1) lds=34816
; @launch kernel=k_main_kernel grid=(256,1,1) block=(256,1,1) lds=163840
.amdgcn_target "amdgcn-amd-amdhsa--gfx950"
.text
.globl k0_prep_kernel
.p2align 8
.type k0_prep_kernel,@function
k0_prep_kernel:
s_cmp_ge_u32 s2, 512
s_cbranch_scc1 L_k0_end
s_load_dwordx2 s[4:5], s[0:1], 72
s_load_dwordx2 s[6:7], s[0:1], 80
s_load_dwordx2 s[8:9], s[0:1], 8
s_load_dwordx2 s[10:11], s[0:1], 16
s_load_dwordx2 s[12:13], s[0:1], 104
v_lshrrev_b32 v1, 6, v0
s_nop 0
v_readfirstlane_b32 s36, v1
v_lshrrev_b32 v4, 3, v0
v_and_b32 v5, 7, v0
s_mov_b32 s38, 49152
v_mul_lo_u32 v2, v4, s38
v_lshl_add_u32 v2, v5, 4, v2
v_lshlrev_b32 v6, 3, v4
s_lshr_b32 s37, s2, 2
s_lshl_b32 s39, s37, 7
s_and_b32 s38, s2, 3
s_mul_i32 s40, s38, 3145728
s_add_u32 s39, s39, s40
s_lshl_b32 s41, s38, 9
s_load_dwordx2 s[42:43], s[0:1], 0
s_waitcnt lgkmcnt(0)
s_cmp_ge_u32 s2, 384
s_cbranch_scc1 L_k0_kv
s_mov_b32 s16, s4
s_and_b32 s17, s5, 0xffff
s_mov_b32 s18, 0x800
s_mov_b32 s19, 0x20000
s_mov_b32 s20, s6
s_and_b32 s21, s7, 0xffff
s_mov_b32 s22, 0xc00000
s_mov_b32 s23, 0x20000
buffer_load_dwordx4 v[28:31], v2, s[20:23], s39 offen nt
s_add_u32 s39, s39, 12288
buffer_load_dwordx4 v[32:35], v2, s[20:23], s39 offen nt
s_add_u32 s39, s39, 12288
buffer_load_dwordx4 v[36:39], v2, s[20:23], s39 offen nt
s_add_u32 s39, s39, 12288
buffer_load_dwordx4 v[40:43], v2, s[20:23], s39 offen nt
buffer_load_dwordx2 v[8:9], v6, s[16:19], s41 offen
s_mov_b32 s32, s12
s_and_b32 s33, s13, 0xffff
s_mov_b32 s34, 0x10000000
s_mov_b32 s35, 0x20000
s_cmp_ge_u32 s2, 11
s_cbranch_scc1 L_k0_nofl
s_lshl_b32 s37, s2, 16
s_add_u32 s37, s37, 56688640
v_lshlrev_b32 v44, 7, v0
v_mov_b32 v45, 0
buffer_store_dword v45, v44, s[32:35], s37 offen
L_k0_nofl:
s_waitcnt vmcnt(0)
v_lshlrev_b32 v12, 16, v8
v_and_b32 v13, 0xffff0000, v8
v_lshlrev_b32 v14, 16, v9
v_and_b32 v15, 0xffff0000, v9
v_mul_f32 v16, 0xbfb8aa3b, v12
v_mul_f32 v17, 0xbfb8aa3b, v13
v_mul_f32 v18, 0xbfb8aa3b, v14
v_mul_f32 v19, 0xbfb8aa3b, v15
v_exp_f32 v16, v16
v_exp_f32 v17, v17
v_exp_f32 v18, v18
v_exp_f32 v19, v19
s_nop 0
v_add_f32 v16, 1.0, v16
v_add_f32 v17, 1.0, v17
v_add_f32 v18, 1.0, v18
v_add_f32 v19, 1.0, v19
v_rcp_f32 v16, v16
v_rcp_f32 v17, v17
v_rcp_f32 v18, v18
v_rcp_f32 v19, v19
s_nop 0
v_mul_f32 v16, v16, v12
v_mul_f32 v17, v17, v13
v_mul_f32 v18, v18, v14
v_mul_f32 v19, v19, v15
v_cvt_pk_bf16_f32 v16, v16, v17
v_lshlrev_b32 v12, 16, v16
v_and_b32 v13, 0xffff0000, v16
v_cvt_pk_bf16_f32 v18, v18, v19
v_lshlrev_b32 v14, 16, v18
v_and_b32 v15, 0xffff0000, v18
v_lshlrev_b32 v46, 16, v28
v_and_b32 v47, 0xffff0000, v28
v_mul_f32 v20, v46, v12
v_mul_f32 v21, v47, v12
v_lshlrev_b32 v46, 16, v29
v_and_b32 v47, 0xffff0000, v29
v_mul_f32 v22, v46, v12
v_mul_f32 v23, v47, v12
v_lshlrev_b32 v46, 16, v30
v_and_b32 v47, 0xffff0000, v30
v_mul_f32 v24, v46, v12
v_mul_f32 v25, v47, v12
v_lshlrev_b32 v46, 16, v31
v_and_b32 v47, 0xffff0000, v31
v_mul_f32 v26, v46, v12
v_mul_f32 v27, v47, v12
v_lshlrev_b32 v46, 16, v32
v_and_b32 v47, 0xffff0000, v32
v_fmac_f32 v20, v46, v13
v_fmac_f32 v21, v47, v13
v_lshlrev_b32 v46, 16, v33
v_and_b32 v47, 0xffff0000, v33
v_fmac_f32 v22, v46, v13
v_fmac_f32 v23, v47, v13
v_lshlrev_b32 v46, 16, v34
v_and_b32 v47, 0xffff0000, v34
v_fmac_f32 v24, v46, v13
v_fmac_f32 v25, v47, v13
v_lshlrev_b32 v46, 16, v35
v_and_b32 v47, 0xffff0000, v35
v_fmac_f32 v26, v46, v13
v_fmac_f32 v27, v47, v13
v_lshlrev_b32 v46, 16, v36
v_and_b32 v47, 0xffff0000, v36
v_fmac_f32 v20, v46, v14
v_fmac_f32 v21, v47, v14
v_lshlrev_b32 v46, 16, v37
v_and_b32 v47, 0xffff0000, v37
v_fmac_f32 v22, v46, v14
v_fmac_f32 v23, v47, v14
v_lshlrev_b32 v46, 16, v38
v_and_b32 v47, 0xffff0000, v38
v_fmac_f32 v24, v46, v14
v_fmac_f32 v25, v47, v14
v_lshlrev_b32 v46, 16, v39
v_and_b32 v47, 0xffff0000, v39
v_fmac_f32 v26, v46, v14
v_fmac_f32 v27, v47, v14
v_lshlrev_b32 v46, 16, v40
v_and_b32 v47, 0xffff0000, v40
v_fmac_f32 v20, v46, v15
v_fmac_f32 v21, v47, v15
v_lshlrev_b32 v46, 16, v41
v_and_b32 v47, 0xffff0000, v41
v_fmac_f32 v22, v46, v15
v_fmac_f32 v23, v47, v15
v_lshlrev_b32 v46, 16, v42
v_and_b32 v47, 0xffff0000, v42
v_fmac_f32 v24, v46, v15
v_fmac_f32 v25, v47, v15
v_lshlrev_b32 v46, 16, v43
v_and_b32 v47, 0xffff0000, v43
v_fmac_f32 v26, v46, v15
v_fmac_f32 v27, v47, v15
v_add_f32_dpp v20, v20, v20 row_ror:8 row_mask:0xf bank_mask:0xf
v_add_f32_dpp v21, v21, v21 row_ror:8 row_mask:0xf bank_mask:0xf
v_add_f32_dpp v22, v22, v22 row_ror:8 row_mask:0xf bank_mask:0xf
v_add_f32_dpp v23, v23, v23 row_ror:8 row_mask:0xf bank_mask:0xf
v_add_f32_dpp v24, v24, v24 row_ror:8 row_mask:0xf bank_mask:0xf
v_add_f32_dpp v25, v25, v25 row_ror:8 row_mask:0xf bank_mask:0xf
v_add_f32_dpp v26, v26, v26 row_ror:8 row_mask:0xf bank_mask:0xf
v_add_f32_dpp v27, v27, v27 row_ror:8 row_mask:0xf bank_mask:0xf
v_mov_b32 v28, v20
v_mov_b32 v29, v21
v_mov_b32 v30, v22
v_mov_b32 v31, v23
v_mov_b32 v32, v24
v_mov_b32 v33, v25
v_mov_b32 v34, v26
v_mov_b32 v35, v27
v_permlane16_swap_b32 v20, v28
v_permlane16_swap_b32 v21, v29
v_permlane16_swap_b32 v22, v30
v_permlane16_swap_b32 v23, v31
v_permlane16_swap_b32 v24, v32
v_permlane16_swap_b32 v25, v33
v_permlane16_swap_b32 v26, v34
v_permlane16_swap_b32 v27, v35
v_add_f32 v20, v20, v28
v_add_f32 v21, v21, v29
v_add_f32 v22, v22, v30
v_add_f32 v23, v23, v31
v_add_f32 v24, v24, v32
v_add_f32 v25, v25, v33
v_add_f32 v26, v26, v34
v_add_f32 v27, v27, v35
v_mov_b32 v28, v20
v_mov_b32 v29, v21
v_mov_b32 v30, v22
v_mov_b32 v31, v23
v_mov_b32 v32, v24
v_mov_b32 v33, v25
v_mov_b32 v34, v26
v_mov_b32 v35, v27
v_permlane32_swap_b32 v20, v28
v_permlane32_swap_b32 v21, v29
v_permlane32_swap_b32 v22, v30
v_permlane32_swap_b32 v23, v31
v_permlane32_swap_b32 v24, v32
v_permlane32_swap_b32 v25, v33
v_permlane32_swap_b32 v26, v34
v_permlane32_swap_b32 v27, v35
v_add_f32 v20, v20, v28
v_add_f32 v21, v21, v29
v_add_f32 v22, v22, v30
v_add_f32 v23, v23, v31
v_add_f32 v24, v24, v32
v_add_f32 v25, v25, v33
v_add_f32 v26, v26, v34
v_add_f32 v27, v27, v35
v_and_b32 v44, 7, v0
v_lshlrev_b32 v44, 5, v44
s_lshl_b32 s37, s36, 8
v_add_u32 v44, s37, v44
ds_write_b128 v44, v[20:23]
ds_write_b128 v44, v[24:27] offset:16
s_waitcnt lgkmcnt(0)
s_barrier
s_cmp_lg_u32 s36, 0
s_cbranch_scc1 L_k0_end
v_lshlrev_b32 v44, 2, v0
ds_read_b32 v20, v44 offset:0
ds_read_b32 v21, v44 offset:256
ds_read_b32 v22, v44 offset:512
ds_read_b32 v23, v44 offset:768
ds_read_b32 v24, v44 offset:1024
ds_read_b32 v25, v44 offset:1280
ds_read_b32 v26, v44 offset:1536
ds_read_b32 v27, v44 offset:1792
s_waitcnt lgkmcnt(0)
v_add_f32 v20, v20, v21
v_add_f32 v20, v20, v22
v_add_f32 v20, v20, v23
v_add_f32 v20, v20, v24
v_add_f32 v20, v20, v25
v_add_f32 v20, v20, v26
v_add_f32 v20, v20, v27
s_lshr_b32 s37, s2, 2
s_lshl_b32 s39, s37, 8
s_and_b32 s38, s2, 3
s_mul_i32 s38, s38, 24576
s_add_u32 s39, s39, s38
s_add_u32 s39, s39, 71368704
buffer_store_dword v20, v44, s[32:35], s39 offen
s_endpgm
L_k0_kv:
s_mov_b32 s24, s8
s_and_b32 s25, s9, 0xffff
s_mov_b32 s26, 0x200000
s_mov_b32 s27, 0x20000
s_mov_b32 s28, s10
s_and_b32 s29, s11, 0xffff
s_mov_b32 s30, 0x200000
s_mov_b32 s31, 0x20000
s_mov_b32 s32, s12
s_and_b32 s33, s13, 0xffff
s_mov_b32 s34, 0x10000000
s_mov_b32 s35, 0x20000
v_and_b32 v2, 63, v0
v_lshlrev_b32 v3, 4, v2
s_sub_u32 s39, s2, 384
s_lshl_b32 s39, s39, 14
s_and_b32 s48, s36, 3
s_lshl_b32 s40, s36, 12
s_mov_b32 m0, s40
s_lshl_b32 s40, s48, 12
s_add_u32 s40, s40, s39
s_cmp_ge_u32 s36, 4
s_cbranch_scc1 L_k0_v
v_lshrrev_b32 v22, 4, v2
v_add_u32 v22, 0, v22
v_and_b32 v23, 15, v2
v_xor_b32 v23, v23, v22
v_lshrrev_b32 v22, 4, v2
v_lshlrev_b32 v22, 8, v22
v_lshl_add_u32 v24, v23, 4, v22
v_lshrrev_b32 v22, 4, v2
v_add_u32 v22, 4, v22
v_and_b32 v23, 15, v2
v_xor_b32 v23, v23, v22
v_lshrrev_b32 v22, 4, v2
v_lshlrev_b32 v22, 8, v22
v_lshl_add_u32 v25, v23, 4, v22
v_lshrrev_b32 v22, 4, v2
v_add_u32 v22, 8, v22
v_and_b32 v23, 15, v2
v_xor_b32 v23, v23, v22
v_lshrrev_b32 v22, 4, v2
v_lshlrev_b32 v22, 8, v22
v_lshl_add_u32 v26, v23, 4, v22
v_lshrrev_b32 v22, 4, v2
v_add_u32 v22, 12, v22
v_and_b32 v23, 15, v2
v_xor_b32 v23, v23, v22
v_lshrrev_b32 v22, 4, v2
v_lshlrev_b32 v22, 8, v22
v_lshl_add_u32 v27, v23, 4, v22
buffer_load_dwordx4 v24, s[24:27], s40 offen offset:0 nt lds
buffer_load_dwordx4 v25, s[24:27], s40 offen offset:1024 nt lds
buffer_load_dwordx4 v26, s[24:27], s40 offen offset:2048 nt lds
buffer_load_dwordx4 v27, s[24:27], s40 offen offset:3072 nt lds
v_and_b32 v22, 15, v2
v_lshrrev_b32 v23, 5, v2
v_xor_b32 v23, v23, v22
v_lshlrev_b32 v20, 8, v22
v_bfe_u32 v22, v2, 4, 1
v_lshl_add_u32 v20, v22, 3, v20
s_lshl_b32 s37, s48, 12
v_add_u32 v20, s37, v20
v_xor_b32 v22, 0, v23
v_lshl_add_u32 v28, v22, 4, v20
v_xor_b32 v22, 2, v23
v_lshl_add_u32 v29, v22, 4, v20
v_xor_b32 v22, 4, v23
v_lshl_add_u32 v30, v22, 4, v20
v_xor_b32 v22, 6, v23
v_lshl_add_u32 v31, v22, 4, v20
v_xor_b32 v22, 8, v23
v_lshl_add_u32 v32, v22, 4, v20
v_xor_b32 v22, 10, v23
v_lshl_add_u32 v33, v22, 4, v20
v_xor_b32 v22, 12, v23
v_lshl_add_u32 v34, v22, 4, v20
v_xor_b32 v22, 14, v23
v_lshl_add_u32 v35, v22, 4, v20
s_waitcnt vmcnt(0)
ds_read_b64 v[4:5], v28
ds_read_b64 v[6:7], v29
ds_read_b64 v[8:9], v30
ds_read_b64 v[10:11], v31
ds_read_b64 v[12:13], v32
ds_read_b64 v[14:15], v33
ds_read_b64 v[16:17], v34
ds_read_b64 v[18:19], v35
s_add_u32 s41, s40, 65536
s_waitcnt lgkmcnt(6)
buffer_store_dwordx4 v[4:7], v3, s[32:35], s41 offen offset:0
s_waitcnt lgkmcnt(4)
buffer_store_dwordx4 v[8:11], v3, s[32:35], s41 offen offset:1024
s_waitcnt lgkmcnt(2)
buffer_store_dwordx4 v[12:15], v3, s[32:35], s41 offen offset:2048
s_waitcnt lgkmcnt(0)
buffer_store_dwordx4 v[16:19], v3, s[32:35], s41 offen offset:3072
s_barrier
s_endpgm
L_k0_v:
buffer_load_dwordx4 v3, s[28:31], s40 offen offset:0 nt lds
buffer_load_dwordx4 v3, s[28:31], s40 offen offset:1024 nt lds
buffer_load_dwordx4 v3, s[28:31], s40 offen offset:2048 nt lds
buffer_load_dwordx4 v3, s[28:31], s40 offen offset:3072 nt lds
v_lshrrev_b32 v20, 2, v2
v_lshlrev_b32 v20, 8, v20
v_and_b32 v22, 3, v2
v_lshl_add_u32 v20, v22, 3, v20
s_lshr_b32 s41, s48, 1
s_lshl_b32 s41, s41, 13
s_and_b32 s37, s48, 1
s_lshl_b32 s37, s37, 7
s_add_u32 s41, s41, s37
s_add_u32 s41, s41, 16384
v_add_u32 v20, s41, v20
s_waitcnt vmcnt(0)
s_barrier
ds_read_b64_tr_b16 v[4:5], v20 offset:0
ds_read_b64_tr_b16 v[6:7], v20 offset:4096
ds_read_b64_tr_b16 v[8:9], v20 offset:32
ds_read_b64_tr_b16 v[10:11], v20 offset:4128
ds_read_b64_tr_b16 v[12:13], v20 offset:64
ds_read_b64_tr_b16 v[14:15], v20 offset:4160
ds_read_b64_tr_b16 v[16:17], v20 offset:96
ds_read_b64_tr_b16 v[18:19], v20 offset:4192
s_add_u32 s40, s40, 2162688
s_waitcnt lgkmcnt(6)
buffer_store_dwordx4 v[4:7], v3, s[32:35], s40 offen offset:0
s_waitcnt lgkmcnt(4)
buffer_store_dwordx4 v[8:11], v3, s[32:35], s40 offen offset:1024
s_waitcnt lgkmcnt(2)
buffer_store_dwordx4 v[12:15], v3, s[32:35], s40 offen offset:2048
s_waitcnt lgkmcnt(0)
buffer_store_dwordx4 v[16:19], v3, s[32:35], s40 offen offset:3072
s_mov_b32 s38, 0x7fff7fff
v_and_b32 v20, s38, v4
v_and_b32 v22, s38, v5
v_pk_max_u16 v20, v20, v22
v_and_b32 v22, s38, v6
v_pk_max_u16 v20, v20, v22
v_and_b32 v22, s38, v7
v_pk_max_u16 v20, v20, v22
v_and_b32 v22, s38, v8
v_pk_max_u16 v20, v20, v22
v_and_b32 v22, s38, v9
v_pk_max_u16 v20, v20, v22
v_and_b32 v22, s38, v10
v_pk_max_u16 v20, v20, v22
v_and_b32 v22, s38, v11
v_pk_max_u16 v20, v20, v22
v_and_b32 v22, s38, v12
v_pk_max_u16 v20, v20, v22
v_and_b32 v22, s38, v13
v_pk_max_u16 v20, v20, v22
v_and_b32 v22, s38, v14
v_pk_max_u16 v20, v20, v22
v_and_b32 v22, s38, v15
v_pk_max_u16 v20, v20, v22
v_and_b32 v22, s38, v16
v_pk_max_u16 v20, v20, v22
v_and_b32 v22, s38, v17
v_pk_max_u16 v20, v20, v22
v_and_b32 v22, s38, v18
v_pk_max_u16 v20, v20, v22
v_and_b32 v22, s38, v19
v_pk_max_u16 v20, v20, v22
v_lshrrev_b32 v22, 16, v20
v_and_b32 v20, 0xffff, v20
v_max_u32 v20, v20, v22
s_nop 1
v_max_u32_dpp v20, v20, v20 row_ror:8 row_mask:0xf bank_mask:0xf
s_nop 1
v_max_u32_dpp v20, v20, v20 row_ror:4 row_mask:0xf bank_mask:0xf
s_nop 1
v_max_u32_dpp v20, v20, v20 row_ror:2 row_mask:0xf bank_mask:0xf
s_nop 1
v_max_u32_dpp v20, v20, v20 row_ror:1 row_mask:0xf bank_mask:0xf
v_mov_b32 v22, v20
s_nop 1
v_permlane32_swap_b32 v20, v22
v_max_u32 v20, v20, v22
v_mov_b32 v22, v20
s_nop 1
v_permlane16_swap_b32 v20, v22
v_max_u32 v20, v20, v22
s_sub_u32 s37, s2, 384
s_lshl_b32 s37, s37, 2
s_add_u32 s37, s37, s48
s_lshl_b32 s37, s37, 2
s_add_u32 s37, s37, 70025216
v_mov_b32 v22, 0
buffer_store_dword v20, v22, s[32:35], s37 offen
L_k0_end:
s_endpgm
.section .rodata,"a"
.p2align 6
.amdhsa_kernel k0_prep_kernel
  .amdhsa_next_free_vgpr 64
  .amdhsa_next_free_sgpr 102
  .amdhsa_accum_offset 64
  .amdhsa_group_segment_fixed_size 0
  .amdhsa_kernarg_size 112
  .amdhsa_user_sgpr_count 2
  .amdhsa_user_sgpr_kernarg_segment_ptr 1
  .amdhsa_system_sgpr_workgroup_id_x 1
.end_amdhsa_kernel
.text
.globl k_main_kernel
.p2align 8
.type k_main_kernel,@function
k_main_kernel:
s_cmp_ge_u32 s2, 256
s_cbranch_scc1 L_main_end
s_load_dwordx2 s[4:5], s[0:1], 24
s_load_dwordx2 s[8:9], s[0:1], 104
s_load_dwordx2 s[12:13], s[0:1], 0
s_load_dwordx2 s[16:17], s[0:1], 32
s_load_dwordx2 s[18:19], s[0:1], 48
s_load_dwordx2 s[20:21], s[0:1], 56
s_load_dwordx2 s[22:23], s[0:1], 64
v_lshrrev_b32 v2, 6, v0
v_and_b32 v1, 63, v0
v_readfirstlane_b32 s30, v2
v_lshlrev_b32 v2, 4, v1
s_and_b32 s34, s2, 7
s_lshr_b32 s35, s2, 3
s_lshr_b32 s32, s34, 1
s_lshl_b32 s31, s32, 3
s_and_b32 s33, s35, 7
s_add_u32 s31, s31, s33
s_and_b32 s33, s34, 1
s_lshl_b32 s33, s33, 2
s_lshr_b32 s35, s35, 3
s_add_u32 s33, s33, s35
s_lshl_b32 s36, s33, 4
s_lshl_b32 s34, s30, 2
s_add_u32 s36, s36, s34
s_waitcnt lgkmcnt(0)
s_and_b32 s5, s5, 0xffff
s_mov_b32 s6, 0x800000
s_mov_b32 s7, 0x20000
s_and_b32 s9, s9, 0xffff
s_mov_b32 s10, 0x10000000
s_mov_b32 s11, 0x20000
s_and_b32 s13, s13, 0xffff
s_mov_b32 s14, 0x400000
s_mov_b32 s15, 0x20000
s_mov_b32 s24, s16
s_and_b32 s25, s17, 0xffff
s_mov_b32 s26, 0x800000
s_mov_b32 s27, 0x20000
s_lshl_b32 s28, s2, 2
s_add_u32 s28, s28, s30
s_lshl_b32 s28, s28, 13
s_mov_b32 s29, 0
s_lshl_b32 s37, s30, 12
s_add_u32 s37, s37, 98304
s_lshl_b32 s38, s31, 8
s_lshl_b32 s39, s36, 15
s_add_u32 s39, s39, 4259840
s_lshl_b32 s47, s32, 19
s_and_b32 s34, s30, 1
s_lshl_b32 s34, s34, 13
s_add_u32 s47, s47, s34
s_cmp_lt_u32 s30, 2
s_cselect_b32 s34, 0, 2080768
s_add_u32 s47, s47, s34
s_add_u32 s47, s47, 65536
s_mov_b32 s45, 0
s_mov_b32 s41, s47
s_lshl_b32 s43, s30, 13
s_lshl_b32 s49, s32, 9
s_add_u32 s49, s49, 70025216
v_lshlrev_b32 v252, 3, v1
buffer_load_dwordx2 v[4:5], v252, s[8:11], s49 offen
s_lshr_b32 s50, s31, 1
s_lshl_b32 s54, s33, 4
s_add_u32 s50, s50, s54
s_and_b32 s51, s31, 1
s_lshl_b32 s54, s30, 2
s_add_u32 s54, s54, 0
v_xor_b32 v160, s54, v1
v_lshlrev_b32 v160, 4, v160
s_lshl_b32 s54, s30, 2
s_add_u32 s54, s54, 1
v_xor_b32 v161, s54, v1
v_lshlrev_b32 v161, 4, v161
s_lshl_b32 s54, s30, 2
s_add_u32 s54, s54, 2
v_xor_b32 v162, s54, v1
v_lshlrev_b32 v162, 4, v162
s_lshl_b32 s54, s30, 2
s_add_u32 s54, s54, 3
v_xor_b32 v163, s54, v1
v_lshlrev_b32 v163, 4, v163
s_lshl_b32 s52, s50, 15
s_lshl_b32 s53, s30, 13
s_add_u32 s52, s52, s53
s_add_u32 s53, s53, 0
s_mov_b32 m0, s53
s_nop 0
buffer_load_dwordx4 v160, s[12:15], s52 offen offset:0 nt lds
buffer_load_dwordx4 v160, s[12:15], s52 offen offset:1024 nt lds
s_add_u32 s52, s52, 2048
s_add_u32 s53, s53, 2048
s_mov_b32 m0, s53
s_nop 0
buffer_load_dwordx4 v161, s[12:15], s52 offen offset:0 nt lds
buffer_load_dwordx4 v161, s[12:15], s52 offen offset:1024 nt lds
s_add_u32 s52, s52, 2048
s_add_u32 s53, s53, 2048
s_mov_b32 m0, s53
s_nop 0
buffer_load_dwordx4 v162, s[12:15], s52 offen offset:0 nt lds
buffer_load_dwordx4 v162, s[12:15], s52 offen offset:1024 nt lds
s_add_u32 s52, s52, 2048
s_add_u32 s53, s53, 2048
s_mov_b32 m0, s53
s_nop 0
buffer_load_dwordx4 v163, s[12:15], s52 offen offset:0 nt lds
buffer_load_dwordx4 v163, s[12:15], s52 offen offset:1024 nt lds
v_and_b32 v144, 15, v1
v_lshrrev_b32 v145, 5, v1
v_xor_b32 v145, v145, v144
v_lshlrev_b32 v146, 11, v144
v_bfe_u32 v144, v1, 4, 1
v_lshl_add_u32 v146, v144, 3, v146
s_lshl_b32 s54, s30, 8
s_lshl_b32 s55, s51, 10
s_add_u32 s54, s54, s55
s_add_u32 s54, s54, 0
v_add_u32 v146, s54, v146
v_xor_b32 v144, 0, v145
v_lshl_add_u32 v152, v144, 4, v146
v_xor_b32 v164, 1024, v152
v_xor_b32 v144, 2, v145
v_lshl_add_u32 v153, v144, 4, v146
v_xor_b32 v165, 1024, v153
v_xor_b32 v144, 4, v145
v_lshl_add_u32 v154, v144, 4, v146
v_xor_b32 v166, 1024, v154
v_xor_b32 v144, 6, v145
v_lshl_add_u32 v155, v144, 4, v146
v_xor_b32 v167, 1024, v155
v_xor_b32 v144, 8, v145
v_lshl_add_u32 v156, v144, 4, v146
v_xor_b32 v168, 1024, v156
v_xor_b32 v144, 10, v145
v_lshl_add_u32 v157, v144, 4, v146
v_xor_b32 v169, 1024, v157
v_xor_b32 v144, 12, v145
v_lshl_add_u32 v158, v144, 4, v146
v_xor_b32 v170, 1024, v158
v_xor_b32 v144, 14, v145
v_lshl_add_u32 v159, v144, 4, v146
v_xor_b32 v171, 1024, v159
v_and_b32 v147, 127, v0
v_lshlrev_b32 v147, 4, v147
s_cmp_ge_u32 s30, 2
s_cselect_b32 s54, 4096, 0
s_lshl_b32 s55, s51, 11
s_add_u32 s54, s54, s55
s_add_u32 s54, s54, 71368704
buffer_load_dwordx4 v[108:111], v147, s[8:11], s54 offen
s_add_u32 s54, s54, 24576
buffer_load_dwordx4 v[112:115], v147, s[8:11], s54 offen
s_add_u32 s54, s54, 24576
buffer_load_dwordx4 v[116:119], v147, s[8:11], s54 offen
s_add_u32 s54, s54, 24576
buffer_load_dwordx4 v[120:123], v147, s[8:11], s54 offen
v_add_u32 v204, 0, v2
v_add_u32 v205, 32768, v2
v_add_u32 v206, 65536, v2
v_add_u32 v207, 98304, v2
s_lshl_b32 s34, s30, 17
v_lshrrev_b32 v6, 4, v1
v_add_u32 v6, 0, v6
v_and_b32 v7, 7, v6
v_lshlrev_b32 v7, 1, v7
v_and_b32 v208, 15, v1
v_xor_b32 v7, v7, v208
v_lshlrev_b32 v6, 13, v6
v_lshl_add_u32 v6, v7, 4, v6
v_add_u32 v208, s34, v6
v_lshrrev_b32 v6, 4, v1
v_add_u32 v6, 4, v6
v_and_b32 v7, 7, v6
v_lshlrev_b32 v7, 1, v7
v_and_b32 v209, 15, v1
v_xor_b32 v7, v7, v209
v_lshlrev_b32 v6, 13, v6
v_lshl_add_u32 v6, v7, 4, v6
v_add_u32 v209, s34, v6
v_lshrrev_b32 v6, 4, v1
v_add_u32 v6, 8, v6
v_and_b32 v7, 7, v6
v_lshlrev_b32 v7, 1, v7
v_and_b32 v210, 15, v1
v_xor_b32 v7, v7, v210
v_lshlrev_b32 v6, 13, v6
v_lshl_add_u32 v6, v7, 4, v6
v_add_u32 v210, s34, v6
v_lshrrev_b32 v6, 4, v1
v_add_u32 v6, 12, v6
v_and_b32 v7, 7, v6
v_lshlrev_b32 v7, 1, v7
v_and_b32 v211, 15, v1
v_xor_b32 v7, v7, v211
v_lshlrev_b32 v6, 13, v6
v_lshl_add_u32 v6, v7, 4, v6
v_add_u32 v211, s34, v6
v_bfe_u32 v6, v1, 1, 1
v_add_u32 v6, 0, v6
v_bfe_u32 v7, v1, 2, 3
v_lshlrev_b32 v7, 1, v7
v_xor_b32 v6, v6, v7
v_lshrrev_b32 v7, 2, v1
v_lshlrev_b32 v7, 8, v7
v_lshl_add_u32 v6, v6, 4, v7
v_and_b32 v7, 1, v1
v_lshl_add_u32 v6, v7, 3, v6
v_add_u32 v212, 98304, v6
v_bfe_u32 v6, v1, 1, 1
v_add_u32 v6, 2, v6
v_bfe_u32 v7, v1, 2, 3
v_lshlrev_b32 v7, 1, v7
v_xor_b32 v6, v6, v7
v_lshrrev_b32 v7, 2, v1
v_lshlrev_b32 v7, 8, v7
v_lshl_add_u32 v6, v6, 4, v7
v_and_b32 v7, 1, v1
v_lshl_add_u32 v6, v7, 3, v6
v_add_u32 v213, 98304, v6
v_bfe_u32 v6, v1, 1, 1
v_add_u32 v6, 4, v6
v_bfe_u32 v7, v1, 2, 3
v_lshlrev_b32 v7, 1, v7
v_xor_b32 v6, v6, v7
v_lshrrev_b32 v7, 2, v1
v_lshlrev_b32 v7, 8, v7
v_lshl_add_u32 v6, v6, 4, v7
v_and_b32 v7, 1, v1
v_lshl_add_u32 v6, v7, 3, v6
v_add_u32 v214, 98304, v6
v_bfe_u32 v6, v1, 1, 1
v_add_u32 v6, 6, v6
v_bfe_u32 v7, v1, 2, 3
v_lshlrev_b32 v7, 1, v7
v_xor_b32 v6, v6, v7
v_lshrrev_b32 v7, 2, v1
v_lshlrev_b32 v7, 8, v7
v_lshl_add_u32 v6, v6, 4, v7
v_and_b32 v7, 1, v1
v_lshl_add_u32 v6, v7, 3, v6
v_add_u32 v215, 98304, v6
v_bfe_u32 v6, v1, 1, 1
v_add_u32 v6, 8, v6
v_bfe_u32 v7, v1, 2, 3
v_lshlrev_b32 v7, 1, v7
v_xor_b32 v6, v6, v7
v_lshrrev_b32 v7, 2, v1
v_lshlrev_b32 v7, 8, v7
v_lshl_add_u32 v6, v6, 4, v7
v_and_b32 v7, 1, v1
v_lshl_add_u32 v6, v7, 3, v6
v_add_u32 v216, 98304, v6
v_bfe_u32 v6, v1, 1, 1
v_add_u32 v6, 10, v6
v_bfe_u32 v7, v1, 2, 3
v_lshlrev_b32 v7, 1, v7
v_xor_b32 v6, v6, v7
v_lshrrev_b32 v7, 2, v1
v_lshlrev_b32 v7, 8, v7
v_lshl_add_u32 v6, v6, 4, v7
v_and_b32 v7, 1, v1
v_lshl_add_u32 v6, v7, 3, v6
v_add_u32 v217, 98304, v6
v_bfe_u32 v6, v1, 1, 1
v_add_u32 v6, 12, v6
v_bfe_u32 v7, v1, 2, 3
v_lshlrev_b32 v7, 1, v7
v_xor_b32 v6, v6, v7
v_lshrrev_b32 v7, 2, v1
v_lshlrev_b32 v7, 8, v7
v_lshl_add_u32 v6, v6, 4, v7
v_and_b32 v7, 1, v1
v_lshl_add_u32 v6, v7, 3, v6
v_add_u32 v218, 98304, v6
v_bfe_u32 v6, v1, 1, 1
v_add_u32 v6, 14, v6
v_bfe_u32 v7, v1, 2, 3
v_lshlrev_b32 v7, 1, v7
v_xor_b32 v6, v6, v7
v_lshrrev_b32 v7, 2, v1
v_lshlrev_b32 v7, 8, v7
v_lshl_add_u32 v6, v6, 4, v7
v_and_b32 v7, 1, v1
v_lshl_add_u32 v6, v7, 3, v6
v_add_u32 v219, 98304, v6
s_waitcnt vmcnt(4)
s_barrier
ds_read_b64 v[12:13], v152
ds_read_b64 v[14:15], v153
ds_read_b64 v[16:17], v154
ds_read_b64 v[18:19], v155
ds_read_b64 v[20:21], v156
ds_read_b64 v[22:23], v157
ds_read_b64 v[24:25], v158
ds_read_b64 v[26:27], v159
ds_read_b64 v[28:29], v164
ds_read_b64 v[30:31], v165
ds_read_b64 v[32:33], v166
ds_read_b64 v[34:35], v167
ds_read_b64 v[36:37], v168
ds_read_b64 v[38:39], v169
ds_read_b64 v[40:41], v170
ds_read_b64 v[42:43], v171
s_waitcnt lgkmcnt(0)
v_lshlrev_b32 v44, 16, v12
v_and_b32 v45, 0xffff0000, v12
v_lshlrev_b32 v46, 16, v13
v_and_b32 v47, 0xffff0000, v13
v_lshlrev_b32 v48, 16, v14
v_and_b32 v49, 0xffff0000, v14
v_lshlrev_b32 v50, 16, v15
v_and_b32 v51, 0xffff0000, v15
v_lshlrev_b32 v52, 16, v16
v_and_b32 v53, 0xffff0000, v16
v_lshlrev_b32 v54, 16, v17
v_and_b32 v55, 0xffff0000, v17
v_lshlrev_b32 v56, 16, v18
v_and_b32 v57, 0xffff0000, v18
v_lshlrev_b32 v58, 16, v19
v_and_b32 v59, 0xffff0000, v19
v_lshlrev_b32 v60, 16, v20
v_and_b32 v61, 0xffff0000, v20
v_lshlrev_b32 v62, 16, v21
v_and_b32 v63, 0xffff0000, v21
v_lshlrev_b32 v64, 16, v22
v_and_b32 v65, 0xffff0000, v22
v_lshlrev_b32 v66, 16, v23
v_and_b32 v67, 0xffff0000, v23
v_lshlrev_b32 v68, 16, v24
v_and_b32 v69, 0xffff0000, v24
v_lshlrev_b32 v70, 16, v25
v_and_b32 v71, 0xffff0000, v25
v_lshlrev_b32 v72, 16, v26
v_and_b32 v73, 0xffff0000, v26
v_lshlrev_b32 v74, 16, v27
v_and_b32 v75, 0xffff0000, v27
v_lshlrev_b32 v76, 16, v28
v_and_b32 v77, 0xffff0000, v28
v_lshlrev_b32 v78, 16, v29
v_and_b32 v79, 0xffff0000, v29
v_lshlrev_b32 v80, 16, v30
v_and_b32 v81, 0xffff0000, v30
v_lshlrev_b32 v82, 16, v31
v_and_b32 v83, 0xffff0000, v31
v_lshlrev_b32 v84, 16, v32
v_and_b32 v85, 0xffff0000, v32
v_lshlrev_b32 v86, 16, v33
v_and_b32 v87, 0xffff0000, v33
v_lshlrev_b32 v88, 16, v34
v_and_b32 v89, 0xffff0000, v34
v_lshlrev_b32 v90, 16, v35
v_and_b32 v91, 0xffff0000, v35
v_lshlrev_b32 v92, 16, v36
v_and_b32 v93, 0xffff0000, v36
v_lshlrev_b32 v94, 16, v37
v_and_b32 v95, 0xffff0000, v37
v_lshlrev_b32 v96, 16, v38
v_and_b32 v97, 0xffff0000, v38
v_lshlrev_b32 v98, 16, v39
v_and_b32 v99, 0xffff0000, v39
v_lshlrev_b32 v100, 16, v40
v_and_b32 v101, 0xffff0000, v40
v_lshlrev_b32 v102, 16, v41
v_and_b32 v103, 0xffff0000, v41
v_lshlrev_b32 v104, 16, v42
v_and_b32 v105, 0xffff0000, v42
v_lshlrev_b32 v106, 16, v43
v_and_b32 v107, 0xffff0000, v43
v_pk_add_f32 v[124:125], v[44:45], v[46:47]
v_pk_add_f32 v[126:127], v[48:49], v[50:51]
v_pk_add_f32 v[124:125], v[124:125], v[52:53]
v_pk_add_f32 v[126:127], v[126:127], v[54:55]
v_pk_add_f32 v[124:125], v[124:125], v[56:57]
v_pk_add_f32 v[126:127], v[126:127], v[58:59]
v_pk_add_f32 v[124:125], v[124:125], v[60:61]
v_pk_add_f32 v[126:127], v[126:127], v[62:63]
v_pk_add_f32 v[124:125], v[124:125], v[64:65]
v_pk_add_f32 v[126:127], v[126:127], v[66:67]
v_pk_add_f32 v[124:125], v[124:125], v[68:69]
v_pk_add_f32 v[126:127], v[126:127], v[70:71]
v_pk_add_f32 v[124:125], v[124:125], v[72:73]
v_pk_add_f32 v[126:127], v[126:127], v[74:75]
v_pk_add_f32 v[124:125], v[124:125], v[76:77]
v_pk_add_f32 v[126:127], v[126:127], v[78:79]
v_pk_add_f32 v[124:125], v[124:125], v[80:81]
v_pk_add_f32 v[126:127], v[126:127], v[82:83]
v_pk_add_f32 v[124:125], v[124:125], v[84:85]
v_pk_add_f32 v[126:127], v[126:127], v[86:87]
v_pk_add_f32 v[124:125], v[124:125], v[88:89]
v_pk_add_f32 v[126:127], v[126:127], v[90:91]
v_pk_add_f32 v[124:125], v[124:125], v[92:93]
v_pk_add_f32 v[126:127], v[126:127], v[94:95]
v_pk_add_f32 v[124:125], v[124:125], v[96:97]
v_pk_add_f32 v[126:127], v[126:127], v[98:99]
v_pk_add_f32 v[124:125], v[124:125], v[100:101]
v_pk_add_f32 v[126:127], v[126:127], v[102:103]
v_pk_add_f32 v[124:125], v[124:125], v[104:105]
v_pk_add_f32 v[126:127], v[126:127], v[106:107]
v_pk_add_f32 v[124:125], v[124:125], v[126:127]
v_add_f32 v148, v124, v125
v_mov_b32 v144, v148
s_nop 1
v_permlane32_swap_b32 v148, v144
v_add_f32 v148, v148, v144
v_mov_b32 v144, v148
s_nop 1
v_permlane16_swap_b32 v148, v144
v_add_f32 v148, v148, v144
v_and_b32 v145, 15, v1
v_lshlrev_b32 v145, 4, v145
v_add_u32 v145, 155648, v145
s_lshl_b32 s53, s30, 2
v_add_u32 v144, s53, v145
ds_write_b32 v144, v148
s_waitcnt vmcnt(0)
v_add_f32 v108, v108, v112
v_add_f32 v116, v116, v120
v_add_f32 v108, v108, v116
v_add_f32 v109, v109, v113
v_add_f32 v117, v117, v121
v_add_f32 v109, v109, v117
v_add_f32 v110, v110, v114
v_add_f32 v118, v118, v122
v_add_f32 v110, v110, v118
v_add_f32 v111, v111, v115
v_add_f32 v119, v119, v123
v_add_f32 v111, v111, v119
v_cvt_pk_bf16_f32 v112, v108, v109
v_cvt_pk_bf16_f32 v113, v110, v111
v_lshlrev_b32 v108, 16, v112
v_and_b32 v109, 0xffff0000, v112
v_lshlrev_b32 v110, 16, v113
v_and_b32 v111, 0xffff0000, v113
s_cmp_ge_u32 s30, 2
s_cbranch_scc1 L_l1_isc
v_mul_f32 v108, 0x3e0293ee, v108
v_mul_f32 v109, 0x3e0293ee, v109
v_mul_f32 v110, 0x3e0293ee, v110
v_mul_f32 v111, 0x3e0293ee, v111
s_branch L_l1_modd
L_l1_isc:
v_add_f32 v108, 1.0, v108
v_add_f32 v109, 1.0, v109
v_add_f32 v110, 1.0, v110
v_add_f32 v111, 1.0, v111
v_cvt_pk_bf16_f32 v112, v108, v109
v_cvt_pk_bf16_f32 v113, v110, v111
v_lshlrev_b32 v108, 16, v112
v_and_b32 v109, 0xffff0000, v112
v_lshlrev_b32 v110, 16, v113
v_and_b32 v111, 0xffff0000, v113
L_l1_modd:
v_lshlrev_b32 v147, 4, v0
v_add_u32 v147, 156160, v147
ds_write_b128 v147, v[108:111]
s_waitcnt lgkmcnt(0)
s_barrier
ds_read_b128 v[124:127], v145
s_waitcnt lgkmcnt(0)
v_add_f32 v124, v124, v125
v_add_f32 v126, v126, v127
v_add_f32 v124, v124, v126
v_mul_f32 v150, 0x3a800000, v124
v_sub_f32 v124, 0, v150
v_sub_f32 v125, 0, v150
v_pk_add_f32 v[44:45], v[44:45], v[124:125]
v_pk_add_f32 v[46:47], v[46:47], v[124:125]
v_pk_add_f32 v[48:49], v[48:49], v[124:125]
v_pk_add_f32 v[50:51], v[50:51], v[124:125]
v_pk_add_f32 v[52:53], v[52:53], v[124:125]
v_pk_add_f32 v[54:55], v[54:55], v[124:125]
v_pk_add_f32 v[56:57], v[56:57], v[124:125]
v_pk_add_f32 v[58:59], v[58:59], v[124:125]
v_pk_add_f32 v[60:61], v[60:61], v[124:125]
v_pk_add_f32 v[62:63], v[62:63], v[124:125]
v_pk_add_f32 v[64:65], v[64:65], v[124:125]
v_pk_add_f32 v[66:67], v[66:67], v[124:125]
v_pk_add_f32 v[68:69], v[68:69], v[124:125]
v_pk_add_f32 v[70:71], v[70:71], v[124:125]
v_pk_add_f32 v[72:73], v[72:73], v[124:125]
v_pk_add_f32 v[74:75], v[74:75], v[124:125]
v_pk_add_f32 v[76:77], v[76:77], v[124:125]
v_pk_add_f32 v[78:79], v[78:79], v[124:125]
v_pk_add_f32 v[80:81], v[80:81], v[124:125]
v_pk_add_f32 v[82:83], v[82:83], v[124:125]
v_pk_add_f32 v[84:85], v[84:85], v[124:125]
v_pk_add_f32 v[86:87], v[86:87], v[124:125]
v_pk_add_f32 v[88:89], v[88:89], v[124:125]
v_pk_add_f32 v[90:91], v[90:91], v[124:125]
v_pk_add_f32 v[92:93], v[92:93], v[124:125]
v_pk_add_f32 v[94:95], v[94:95], v[124:125]
v_pk_add_f32 v[96:97], v[96:97], v[124:125]
v_pk_add_f32 v[98:99], v[98:99], v[124:125]
v_pk_add_f32 v[100:101], v[100:101], v[124:125]
v_pk_add_f32 v[102:103], v[102:103], v[124:125]
v_pk_add_f32 v[104:105], v[104:105], v[124:125]
v_pk_add_f32 v[106:107], v[106:107], v[124:125]
v_pk_mul_f32 v[128:129], v[44:45], v[44:45]
v_pk_mul_f32 v[130:131], v[46:47], v[46:47]
v_pk_fma_f32 v[128:129], v[48:49], v[48:49], v[128:129]
v_pk_fma_f32 v[130:131], v[50:51], v[50:51], v[130:131]
v_pk_fma_f32 v[128:129], v[52:53], v[52:53], v[128:129]
v_pk_fma_f32 v[130:131], v[54:55], v[54:55], v[130:131]
v_pk_fma_f32 v[128:129], v[56:57], v[56:57], v[128:129]
v_pk_fma_f32 v[130:131], v[58:59], v[58:59], v[130:131]
v_pk_fma_f32 v[128:129], v[60:61], v[60:61], v[128:129]
v_pk_fma_f32 v[130:131], v[62:63], v[62:63], v[130:131]
v_pk_fma_f32 v[128:129], v[64:65], v[64:65], v[128:129]
v_pk_fma_f32 v[130:131], v[66:67], v[66:67], v[130:131]
v_pk_fma_f32 v[128:129], v[68:69], v[68:69], v[128:129]
v_pk_fma_f32 v[130:131], v[70:71], v[70:71], v[130:131]
v_pk_fma_f32 v[128:129], v[72:73], v[72:73], v[128:129]
v_pk_fma_f32 v[130:131], v[74:75], v[74:75], v[130:131]
v_pk_fma_f32 v[128:129], v[76:77], v[76:77], v[128:129]
v_pk_fma_f32 v[130:131], v[78:79], v[78:79], v[130:131]
v_pk_fma_f32 v[128:129], v[80:81], v[80:81], v[128:129]
v_pk_fma_f32 v[130:131], v[82:83], v[82:83], v[130:131]
v_pk_fma_f32 v[128:129], v[84:85], v[84:85], v[128:129]
v_pk_fma_f32 v[130:131], v[86:87], v[86:87], v[130:131]
v_pk_fma_f32 v[128:129], v[88:89], v[88:89], v[128:129]
v_pk_fma_f32 v[130:131], v[90:91], v[90:91], v[130:131]
v_pk_fma_f32 v[128:129], v[92:93], v[92:93], v[128:129]
v_pk_fma_f32 v[130:131], v[94:95], v[94:95], v[130:131]
v_pk_fma_f32 v[128:129], v[96:97], v[96:97], v[128:129]
v_pk_fma_f32 v[130:131], v[98:99], v[98:99], v[130:131]
v_pk_fma_f32 v[128:129], v[100:101], v[100:101], v[128:129]
v_pk_fma_f32 v[130:131], v[102:103], v[102:103], v[130:131]
v_pk_fma_f32 v[128:129], v[104:105], v[104:105], v[128:129]
v_pk_fma_f32 v[130:131], v[106:107], v[106:107], v[130:131]
v_pk_add_f32 v[128:129], v[128:129], v[130:131]
v_add_f32 v148, v128, v129
v_mov_b32 v144, v148
s_nop 1
v_permlane32_swap_b32 v148, v144
v_add_f32 v148, v148, v144
v_mov_b32 v144, v148
s_nop 1
v_permlane16_swap_b32 v148, v144
v_add_f32 v148, v148, v144
v_add_u32 v144, s53, v145
ds_write_b32 v144, v148 offset:256
s_waitcnt lgkmcnt(0)
s_barrier
ds_read_b128 v[124:127], v145 offset:256
v_lshrrev_b32 v147, 4, v1
v_lshlrev_b32 v147, 4, v147
s_lshl_b32 s54, s30, 9
s_add_u32 s54, s54, 156160
v_add_u32 v147, s54, v147
s_lshl_b32 s52, s50, 15
s_lshl_b32 s53, s30, 12
s_add_u32 s52, s52, s53
s_lshl_b32 s53, s51, 14
s_add_u32 s52, s52, s53
s_add_u32 s52, s52, 4259840
s_add_u32 s54, s52, 48234496
buffer_store_dwordx4 v[12:15], v2, s[8:11], s54 offen offset:0 sc1
buffer_store_dwordx4 v[16:19], v2, s[8:11], s54 offen offset:1024 sc1
buffer_store_dwordx4 v[20:23], v2, s[8:11], s54 offen offset:2048 sc1
buffer_store_dwordx4 v[24:27], v2, s[8:11], s54 offen offset:3072 sc1
ds_read_b128 v[128:131], v147 offset:0
ds_read_b128 v[132:135], v147 offset:2048
ds_read_b128 v[136:139], v147 offset:64
ds_read_b128 v[140:143], v147 offset:2112
ds_read_b128 v[108:111], v147 offset:128
ds_read_b128 v[112:115], v147 offset:2176
ds_read_b128 v[116:119], v147 offset:192
ds_read_b128 v[120:123], v147 offset:2240
s_waitcnt lgkmcnt(8)
v_add_f32 v124, v124, v125
v_add_f32 v126, v126, v127
v_add_f32 v124, v124, v126
v_mov_b32 v144, 0x3727c5ac
v_fmac_f32 v144, 0x3a800000, v124
v_rsq_f32 v151, v144
s_nop 0
v_mul_f32 v151, 0x3e0293ee, v151
v_mov_b32 v126, v151
v_mov_b32 v127, v151
v_pk_mul_f32 v[44:45], v[44:45], v[126:127]
v_pk_mul_f32 v[46:47], v[46:47], v[126:127]
v_pk_mul_f32 v[48:49], v[48:49], v[126:127]
v_pk_mul_f32 v[50:51], v[50:51], v[126:127]
v_pk_mul_f32 v[52:53], v[52:53], v[126:127]
v_pk_mul_f32 v[54:55], v[54:55], v[126:127]
v_pk_mul_f32 v[56:57], v[56:57], v[126:127]
v_pk_mul_f32 v[58:59], v[58:59], v[126:127]
v_pk_mul_f32 v[60:61], v[60:61], v[126:127]
v_pk_mul_f32 v[62:63], v[62:63], v[126:127]
v_pk_mul_f32 v[64:65], v[64:65], v[126:127]
v_pk_mul_f32 v[66:67], v[66:67], v[126:127]
v_pk_mul_f32 v[68:69], v[68:69], v[126:127]
v_pk_mul_f32 v[70:71], v[70:71], v[126:127]
v_pk_mul_f32 v[72:73], v[72:73], v[126:127]
v_pk_mul_f32 v[74:75], v[74:75], v[126:127]
s_waitcnt lgkmcnt(4)
v_pk_fma_f32 v[128:129], v[44:45], v[132:133], v[128:129]
v_pk_fma_f32 v[130:131], v[46:47], v[134:135], v[130:131]
v_pk_fma_f32 v[136:137], v[48:49], v[140:141], v[136:137]
v_pk_fma_f32 v[138:139], v[50:51], v[142:143], v[138:139]
v_cvt_pk_bf16_f32 v12, v128, v129
v_cvt_pk_bf16_f32 v13, v130, v131
v_cvt_pk_bf16_f32 v14, v136, v137
v_cvt_pk_bf16_f32 v15, v138, v139
ds_read_b128 v[128:131], v147 offset:256
ds_read_b128 v[132:135], v147 offset:2304
ds_read_b128 v[136:139], v147 offset:320
ds_read_b128 v[140:143], v147 offset:2368
buffer_store_dwordx4 v[12:15], v2, s[8:11], s52 offen offset:0 sc1
s_waitcnt lgkmcnt(4)
v_pk_fma_f32 v[108:109], v[52:53], v[112:113], v[108:109]
v_pk_fma_f32 v[110:111], v[54:55], v[114:115], v[110:111]
v_pk_fma_f32 v[116:117], v[56:57], v[120:121], v[116:117]
v_pk_fma_f32 v[118:119], v[58:59], v[122:123], v[118:119]
v_cvt_pk_bf16_f32 v16, v108, v109
v_cvt_pk_bf16_f32 v17, v110, v111
v_cvt_pk_bf16_f32 v18, v116, v117
v_cvt_pk_bf16_f32 v19, v118, v119
ds_read_b128 v[108:111], v147 offset:384
ds_read_b128 v[112:115], v147 offset:2432
ds_read_b128 v[116:119], v147 offset:448
ds_read_b128 v[120:123], v147 offset:2496
buffer_store_dwordx4 v[16:19], v2, s[8:11], s52 offen offset:1024 sc1
s_waitcnt lgkmcnt(4)
v_pk_fma_f32 v[128:129], v[60:61], v[132:133], v[128:129]
v_pk_fma_f32 v[130:131], v[62:63], v[134:135], v[130:131]
v_pk_fma_f32 v[136:137], v[64:65], v[140:141], v[136:137]
v_pk_fma_f32 v[138:139], v[66:67], v[142:143], v[138:139]
v_cvt_pk_bf16_f32 v20, v128, v129
v_cvt_pk_bf16_f32 v21, v130, v131
v_cvt_pk_bf16_f32 v22, v136, v137
v_cvt_pk_bf16_f32 v23, v138, v139
buffer_store_dwordx4 v[20:23], v2, s[8:11], s52 offen offset:2048 sc1
s_waitcnt lgkmcnt(0)
v_pk_fma_f32 v[108:109], v[68:69], v[112:113], v[108:109]
v_pk_fma_f32 v[110:111], v[70:71], v[114:115], v[110:111]
v_pk_fma_f32 v[116:117], v[72:73], v[120:121], v[116:117]
v_pk_fma_f32 v[118:119], v[74:75], v[122:123], v[118:119]
v_cvt_pk_bf16_f32 v24, v108, v109
v_cvt_pk_bf16_f32 v25, v110, v111
v_cvt_pk_bf16_f32 v26, v116, v117
v_cvt_pk_bf16_f32 v27, v118, v119
buffer_store_dwordx4 v[24:27], v2, s[8:11], s52 offen offset:3072 sc1
s_waitcnt vmcnt(0)
s_barrier
s_lshl_b32 s54, s33, 5
s_add_u32 s55, s54, s31
s_lshl_b32 s55, s55, 7
s_add_u32 s55, s55, 56950784
s_cmp_lg_u32 s30, 0
s_cbranch_scc1 L_l1_pub
v_mov_b32 v144, 0
v_mov_b32 v145, 1
s_mov_b64 exec, 1
buffer_store_dword v145, v144, s[8:11], s55 offen sc1
s_mov_b64 exec, -1
L_l1_pub:
s_add_u32 m0, s37, 0
s_nop 0
buffer_load_dwordx4 v208, s[4:7], s38 offen lds
s_add_u32 m0, s37, 1024
s_nop 0
buffer_load_dwordx4 v209, s[4:7], s38 offen lds
s_add_u32 m0, s37, 2048
s_nop 0
buffer_load_dwordx4 v210, s[4:7], s38 offen lds
s_add_u32 m0, s37, 3072
s_nop 0
buffer_load_dwordx4 v211, s[4:7], s38 offen lds
s_add_u32 s38, s38, 524288
s_add_u32 m0, s37, 16384
s_nop 0
buffer_load_dwordx4 v208, s[4:7], s38 offen lds
s_add_u32 m0, s37, 17408
s_nop 0
buffer_load_dwordx4 v209, s[4:7], s38 offen lds
s_add_u32 m0, s37, 18432
s_nop 0
buffer_load_dwordx4 v210, s[4:7], s38 offen lds
s_add_u32 m0, s37, 19456
s_nop 0
buffer_load_dwordx4 v211, s[4:7], s38 offen lds
s_add_u32 s38, s38, 524288
v_mov_b32 v76, 0
v_mov_b32 v77, 0
v_mov_b32 v78, 0
v_mov_b32 v79, 0
v_mov_b32 v80, 0
v_mov_b32 v81, 0
v_mov_b32 v82, 0
v_mov_b32 v83, 0
v_mov_b32 v84, 0
v_mov_b32 v85, 0
v_mov_b32 v86, 0
v_mov_b32 v87, 0
v_mov_b32 v88, 0
v_mov_b32 v89, 0
v_mov_b32 v90, 0
v_mov_b32 v91, 0
v_mov_b32 v92, 0
v_mov_b32 v93, 0
v_mov_b32 v94, 0
v_mov_b32 v95, 0
v_mov_b32 v96, 0
v_mov_b32 v97, 0
v_mov_b32 v98, 0
v_mov_b32 v99, 0
v_mov_b32 v100, 0
v_mov_b32 v101, 0
v_mov_b32 v102, 0
v_mov_b32 v103, 0
v_mov_b32 v104, 0
v_mov_b32 v105, 0
v_mov_b32 v106, 0
v_mov_b32 v107, 0
v_mov_b32 v108, 0
v_mov_b32 v109, 0
v_mov_b32 v110, 0
v_mov_b32 v111, 0
v_mov_b32 v112, 0
v_mov_b32 v113, 0
v_mov_b32 v114, 0
v_mov_b32 v115, 0
v_mov_b32 v116, 0
v_mov_b32 v117, 0
v_mov_b32 v118, 0
v_mov_b32 v119, 0
v_mov_b32 v120, 0
v_mov_b32 v121, 0
v_mov_b32 v122, 0
v_mov_b32 v123, 0
v_mov_b32 v124, 0
v_mov_b32 v125, 0
v_mov_b32 v126, 0
v_mov_b32 v127, 0
v_mov_b32 v128, 0
v_mov_b32 v129, 0
v_mov_b32 v130, 0
v_mov_b32 v131, 0
v_mov_b32 v132, 0
v_mov_b32 v133, 0
v_mov_b32 v134, 0
v_mov_b32 v135, 0
v_mov_b32 v136, 0
v_mov_b32 v137, 0
v_mov_b32 v138, 0
v_mov_b32 v139, 0
v_mov_b32 v140, 0
v_mov_b32 v141, 0
v_mov_b32 v142, 0
v_mov_b32 v143, 0
v_mov_b32 v144, 0
v_mov_b32 v145, 0
v_mov_b32 v146, 0
v_mov_b32 v147, 0
v_mov_b32 v148, 0
v_mov_b32 v149, 0
v_mov_b32 v150, 0
v_mov_b32 v151, 0
v_mov_b32 v152, 0
v_mov_b32 v153, 0
v_mov_b32 v154, 0
v_mov_b32 v155, 0
v_mov_b32 v156, 0
v_mov_b32 v157, 0
v_mov_b32 v158, 0
v_mov_b32 v159, 0
v_mov_b32 v160, 0
v_mov_b32 v161, 0
v_mov_b32 v162, 0
v_mov_b32 v163, 0
v_mov_b32 v164, 0
v_mov_b32 v165, 0
v_mov_b32 v166, 0
v_mov_b32 v167, 0
v_mov_b32 v168, 0
v_mov_b32 v169, 0
v_mov_b32 v170, 0
v_mov_b32 v171, 0
v_mov_b32 v172, 0
v_mov_b32 v173, 0
v_mov_b32 v174, 0
v_mov_b32 v175, 0
v_mov_b32 v176, 0
v_mov_b32 v177, 0
v_mov_b32 v178, 0
v_mov_b32 v179, 0
v_mov_b32 v180, 0
v_mov_b32 v181, 0
v_mov_b32 v182, 0
v_mov_b32 v183, 0
v_mov_b32 v184, 0
v_mov_b32 v185, 0
v_mov_b32 v186, 0
v_mov_b32 v187, 0
v_mov_b32 v188, 0
v_mov_b32 v189, 0
v_mov_b32 v190, 0
v_mov_b32 v191, 0
v_mov_b32 v192, 0
v_mov_b32 v193, 0
v_mov_b32 v194, 0
v_mov_b32 v195, 0
v_mov_b32 v196, 0
v_mov_b32 v197, 0
v_mov_b32 v198, 0
v_mov_b32 v199, 0
v_mov_b32 v200, 0
v_mov_b32 v201, 0
v_mov_b32 v202, 0
v_mov_b32 v203, 0
v_accvgpr_write_b32 a0, 0
v_accvgpr_write_b32 a1, 0
v_accvgpr_write_b32 a2, 0
v_accvgpr_write_b32 a3, 0
v_accvgpr_write_b32 a4, 0
v_accvgpr_write_b32 a5, 0
v_accvgpr_write_b32 a6, 0
v_accvgpr_write_b32 a7, 0
v_accvgpr_write_b32 a8, 0
v_accvgpr_write_b32 a9, 0
v_accvgpr_write_b32 a10, 0
v_accvgpr_write_b32 a11, 0
v_accvgpr_write_b32 a12, 0
v_accvgpr_write_b32 a13, 0
v_accvgpr_write_b32 a14, 0
v_accvgpr_write_b32 a15, 0
v_accvgpr_write_b32 a16, 0
v_accvgpr_write_b32 a17, 0
v_accvgpr_write_b32 a18, 0
v_accvgpr_write_b32 a19, 0
v_accvgpr_write_b32 a20, 0
v_accvgpr_write_b32 a21, 0
v_accvgpr_write_b32 a22, 0
v_accvgpr_write_b32 a23, 0
v_accvgpr_write_b32 a24, 0
v_accvgpr_write_b32 a25, 0
v_accvgpr_write_b32 a26, 0
v_accvgpr_write_b32 a27, 0
v_accvgpr_write_b32 a28, 0
v_accvgpr_write_b32 a29, 0
v_accvgpr_write_b32 a30, 0
v_accvgpr_write_b32 a31, 0
v_accvgpr_write_b32 a32, 0
v_accvgpr_write_b32 a33, 0
v_accvgpr_write_b32 a34, 0
v_accvgpr_write_b32 a35, 0
v_accvgpr_write_b32 a36, 0
v_accvgpr_write_b32 a37, 0
v_accvgpr_write_b32 a38, 0
v_accvgpr_write_b32 a39, 0
v_accvgpr_write_b32 a40, 0
v_accvgpr_write_b32 a41, 0
v_accvgpr_write_b32 a42, 0
v_accvgpr_write_b32 a43, 0
v_accvgpr_write_b32 a44, 0
v_accvgpr_write_b32 a45, 0
v_accvgpr_write_b32 a46, 0
v_accvgpr_write_b32 a47, 0
v_accvgpr_write_b32 a48, 0
v_accvgpr_write_b32 a49, 0
v_accvgpr_write_b32 a50, 0
v_accvgpr_write_b32 a51, 0
v_accvgpr_write_b32 a52, 0
v_accvgpr_write_b32 a53, 0
v_accvgpr_write_b32 a54, 0
v_accvgpr_write_b32 a55, 0
v_accvgpr_write_b32 a56, 0
v_accvgpr_write_b32 a57, 0
v_accvgpr_write_b32 a58, 0
v_accvgpr_write_b32 a59, 0
v_accvgpr_write_b32 a60, 0
v_accvgpr_write_b32 a61, 0
v_accvgpr_write_b32 a62, 0
v_accvgpr_write_b32 a63, 0
v_accvgpr_write_b32 a64, 0
v_accvgpr_write_b32 a65, 0
v_accvgpr_write_b32 a66, 0
v_accvgpr_write_b32 a67, 0
v_accvgpr_write_b32 a68, 0
v_accvgpr_write_b32 a69, 0
v_accvgpr_write_b32 a70, 0
v_accvgpr_write_b32 a71, 0
v_accvgpr_write_b32 a72, 0
v_accvgpr_write_b32 a73, 0
v_accvgpr_write_b32 a74, 0
v_accvgpr_write_b32 a75, 0
v_accvgpr_write_b32 a76, 0
v_accvgpr_write_b32 a77, 0
v_accvgpr_write_b32 a78, 0
v_accvgpr_write_b32 a79, 0
v_accvgpr_write_b32 a80, 0
v_accvgpr_write_b32 a81, 0
v_accvgpr_write_b32 a82, 0
v_accvgpr_write_b32 a83, 0
v_accvgpr_write_b32 a84, 0
v_accvgpr_write_b32 a85, 0
v_accvgpr_write_b32 a86, 0
v_accvgpr_write_b32 a87, 0
v_accvgpr_write_b32 a88, 0
v_accvgpr_write_b32 a89, 0
v_accvgpr_write_b32 a90, 0
v_accvgpr_write_b32 a91, 0
v_accvgpr_write_b32 a92, 0
v_accvgpr_write_b32 a93, 0
v_accvgpr_write_b32 a94, 0
v_accvgpr_write_b32 a95, 0
v_accvgpr_write_b32 a96, 0
v_accvgpr_write_b32 a97, 0
v_accvgpr_write_b32 a98, 0
v_accvgpr_write_b32 a99, 0
v_accvgpr_write_b32 a100, 0
v_accvgpr_write_b32 a101, 0
v_accvgpr_write_b32 a102, 0
v_accvgpr_write_b32 a103, 0
v_accvgpr_write_b32 a104, 0
v_accvgpr_write_b32 a105, 0
v_accvgpr_write_b32 a106, 0
v_accvgpr_write_b32 a107, 0
v_accvgpr_write_b32 a108, 0
v_accvgpr_write_b32 a109, 0
v_accvgpr_write_b32 a110, 0
v_accvgpr_write_b32 a111, 0
v_accvgpr_write_b32 a112, 0
v_accvgpr_write_b32 a113, 0
v_accvgpr_write_b32 a114, 0
v_accvgpr_write_b32 a115, 0
v_accvgpr_write_b32 a116, 0
v_accvgpr_write_b32 a117, 0
v_accvgpr_write_b32 a118, 0
v_accvgpr_write_b32 a119, 0
v_accvgpr_write_b32 a120, 0
v_accvgpr_write_b32 a121, 0
v_accvgpr_write_b32 a122, 0
v_accvgpr_write_b32 a123, 0
v_accvgpr_write_b32 a124, 0
v_accvgpr_write_b32 a125, 0
v_accvgpr_write_b32 a126, 0
v_accvgpr_write_b32 a127, 0
s_lshl_b32 s55, s30, 3
s_add_u32 s54, s54, s55
s_lshl_b32 s54, s54, 7
s_add_u32 s54, s54, 56950784
v_and_b32 v6, 7, v1
v_lshlrev_b32 v6, 7, v6
s_nop 0
s_mov_b32 s55, 0x200000
L_l1w_aw:
buffer_load_dword v7, v6, s[8:11], s54 offen sc1
s_waitcnt vmcnt(0)
v_cmp_eq_u32 vcc, 0, v7
s_sub_u32 s55, s55, 1
s_cmp_eq_u32 s55, 0
s_cbranch_scc1 L_l1w_awd
s_cmp_lg_u64 vcc, 0
s_cbranch_scc1 L_l1w_aw
L_l1w_awd:
buffer_load_dwordx4 a[128:131], v204, s[8:11], s39 offen offset:0 sc1
s_nop 0
buffer_load_dwordx4 a[132:135], v205, s[8:11], s39 offen offset:0 sc1
buffer_load_dwordx4 a[136:139], v206, s[8:11], s39 offen offset:0 sc1
buffer_load_dwordx4 a[140:143], v207, s[8:11], s39 offen offset:0 sc1
buffer_load_dwordx4 a[144:147], v204, s[8:11], s39 offen offset:1024 sc1
buffer_load_dwordx4 a[148:151], v205, s[8:11], s39 offen offset:1024 sc1
buffer_load_dwordx4 a[152:155], v206, s[8:11], s39 offen offset:1024 sc1
buffer_load_dwordx4 a[156:159], v207, s[8:11], s39 offen offset:1024 sc1
buffer_load_dwordx4 a[160:163], v204, s[8:11], s39 offen offset:2048 sc1
buffer_load_dwordx4 a[164:167], v205, s[8:11], s39 offen offset:2048 sc1
buffer_load_dwordx4 a[168:171], v206, s[8:11], s39 offen offset:2048 sc1
buffer_load_dwordx4 a[172:175], v207, s[8:11], s39 offen offset:2048 sc1
buffer_load_dwordx4 a[176:179], v204, s[8:11], s39 offen offset:3072 sc1
buffer_load_dwordx4 a[180:183], v205, s[8:11], s39 offen offset:3072 sc1
buffer_load_dwordx4 a[184:187], v206, s[8:11], s39 offen offset:3072 sc1
buffer_load_dwordx4 a[188:191], v207, s[8:11], s39 offen offset:3072 sc1
s_add_u32 s39, s39, 4096
buffer_load_dwordx4 a[192:195], v204, s[8:11], s39 offen offset:0 sc1
buffer_load_dwordx4 a[196:199], v205, s[8:11], s39 offen offset:0 sc1
buffer_load_dwordx4 a[200:203], v206, s[8:11], s39 offen offset:0 sc1
buffer_load_dwordx4 a[204:207], v207, s[8:11], s39 offen offset:0 sc1
buffer_load_dwordx4 a[208:211], v204, s[8:11], s39 offen offset:1024 sc1
buffer_load_dwordx4 a[212:215], v205, s[8:11], s39 offen offset:1024 sc1
buffer_load_dwordx4 a[216:219], v206, s[8:11], s39 offen offset:1024 sc1
buffer_load_dwordx4 a[220:223], v207, s[8:11], s39 offen offset:1024 sc1
s_waitcnt lgkmcnt(0)
s_barrier
ds_read_b64_tr_b16 v[220:221], v212 offset:0
ds_read_b64_tr_b16 v[222:223], v212 offset:4096
ds_read_b64_tr_b16 v[224:225], v212 offset:8192
ds_read_b64_tr_b16 v[226:227], v212 offset:12288
ds_read_b64_tr_b16 v[228:229], v213 offset:0
ds_read_b64_tr_b16 v[230:231], v213 offset:4096
ds_read_b64_tr_b16 v[232:233], v213 offset:8192
ds_read_b64_tr_b16 v[234:235], v213 offset:12288
s_waitcnt vmcnt(16) lgkmcnt(4)
s_mov_b32 s40, 3
L_qp_loop:
v_mfma_f32_16x16x32_bf16 v[76:79], v[220:223], a[128:131], v[76:79]
ds_read_b64_tr_b16 v[236:237], v214 offset:0
v_mfma_f32_16x16x32_bf16 v[76:79], v[224:227], a[144:147], v[76:79]
ds_read_b64_tr_b16 v[238:239], v214 offset:4096
v_mfma_f32_16x16x32_bf16 v[80:83], v[224:227], a[148:151], v[80:83]
ds_read_b64_tr_b16 v[240:241], v214 offset:8192
v_mfma_f32_16x16x32_bf16 v[80:83], v[220:223], a[132:135], v[80:83]
ds_read_b64_tr_b16 v[242:243], v214 offset:12288
v_mfma_f32_16x16x32_bf16 v[84:87], v[220:223], a[136:139], v[84:87]
s_add_u32 m0, s37, 32768
v_mfma_f32_16x16x32_bf16 v[84:87], v[224:227], a[152:155], v[84:87]
buffer_load_dwordx4 v208, s[4:7], s38 offen lds
v_mfma_f32_16x16x32_bf16 v[88:91], v[224:227], a[156:159], v[88:91]
v_mfma_f32_16x16x32_bf16 v[88:91], v[220:223], a[140:143], v[88:91]
s_waitcnt lgkmcnt(4)
buffer_load_dwordx4 a[224:227], v204, s[8:11], s39 offen offset:2048 sc1
v_mfma_f32_16x16x32_bf16 v[104:107], v[228:231], a[140:143], v[104:107]
ds_read_b64_tr_b16 v[244:245], v215 offset:0
v_mfma_f32_16x16x32_bf16 v[104:107], v[232:235], a[156:159], v[104:107]
ds_read_b64_tr_b16 v[246:247], v215 offset:4096
v_mfma_f32_16x16x32_bf16 v[100:103], v[232:235], a[152:155], v[100:103]
ds_read_b64_tr_b16 v[248:249], v215 offset:8192
v_mfma_f32_16x16x32_bf16 v[100:103], v[228:231], a[136:139], v[100:103]
ds_read_b64_tr_b16 v[250:251], v215 offset:12288
v_mfma_f32_16x16x32_bf16 v[96:99], v[228:231], a[132:135], v[96:99]
s_add_u32 m0, s37, 33792
v_mfma_f32_16x16x32_bf16 v[96:99], v[232:235], a[148:151], v[96:99]
buffer_load_dwordx4 v209, s[4:7], s38 offen lds
v_mfma_f32_16x16x32_bf16 v[92:95], v[232:235], a[144:147], v[92:95]
v_mfma_f32_16x16x32_bf16 v[92:95], v[228:231], a[128:131], v[92:95]
s_waitcnt lgkmcnt(4)
buffer_load_dwordx4 a[228:231], v205, s[8:11], s39 offen offset:2048 sc1
v_mfma_f32_16x16x32_bf16 v[108:111], v[236:239], a[128:131], v[108:111]
ds_read_b64_tr_b16 v[220:221], v216 offset:0
v_mfma_f32_16x16x32_bf16 v[108:111], v[240:243], a[144:147], v[108:111]
ds_read_b64_tr_b16 v[222:223], v216 offset:4096
v_mfma_f32_16x16x32_bf16 v[112:115], v[240:243], a[148:151], v[112:115]
ds_read_b64_tr_b16 v[224:225], v216 offset:8192
v_mfma_f32_16x16x32_bf16 v[112:115], v[236:239], a[132:135], v[112:115]
ds_read_b64_tr_b16 v[226:227], v216 offset:12288
v_mfma_f32_16x16x32_bf16 v[116:119], v[236:239], a[136:139], v[116:119]
v_mfma_f32_16x16x32_bf16 v[116:119], v[240:243], a[152:155], v[116:119]
v_mfma_f32_16x16x32_bf16 v[120:123], v[240:243], a[156:159], v[120:123]
v_mfma_f32_16x16x32_bf16 v[120:123], v[236:239], a[140:143], v[120:123]
s_waitcnt lgkmcnt(4)
buffer_load_dwordx4 a[232:235], v206, s[8:11], s39 offen offset:2048 sc1
v_mfma_f32_16x16x32_bf16 v[136:139], v[244:247], a[140:143], v[136:139]
ds_read_b64_tr_b16 v[228:229], v217 offset:0
v_mfma_f32_16x16x32_bf16 v[136:139], v[248:251], a[156:159], v[136:139]
ds_read_b64_tr_b16 v[230:231], v217 offset:4096
v_mfma_f32_16x16x32_bf16 v[132:135], v[248:251], a[152:155], v[132:135]
ds_read_b64_tr_b16 v[232:233], v217 offset:8192
v_mfma_f32_16x16x32_bf16 v[132:135], v[244:247], a[136:139], v[132:135]
ds_read_b64_tr_b16 v[234:235], v217 offset:12288
v_mfma_f32_16x16x32_bf16 v[128:131], v[244:247], a[132:135], v[128:131]
s_add_u32 m0, s37, 34816
v_mfma_f32_16x16x32_bf16 v[128:131], v[248:251], a[148:151], v[128:131]
buffer_load_dwordx4 v210, s[4:7], s38 offen lds
v_mfma_f32_16x16x32_bf16 v[124:127], v[248:251], a[144:147], v[124:127]
v_mfma_f32_16x16x32_bf16 v[124:127], v[244:247], a[128:131], v[124:127]
s_waitcnt lgkmcnt(4)
buffer_load_dwordx4 a[236:239], v207, s[8:11], s39 offen offset:2048 sc1
v_mfma_f32_16x16x32_bf16 v[140:143], v[220:223], a[128:131], v[140:143]
ds_read_b64_tr_b16 v[236:237], v218 offset:0
v_mfma_f32_16x16x32_bf16 v[140:143], v[224:227], a[144:147], v[140:143]
ds_read_b64_tr_b16 v[238:239], v218 offset:4096
v_mfma_f32_16x16x32_bf16 v[144:147], v[224:227], a[148:151], v[144:147]
ds_read_b64_tr_b16 v[240:241], v218 offset:8192
v_mfma_f32_16x16x32_bf16 v[144:147], v[220:223], a[132:135], v[144:147]
ds_read_b64_tr_b16 v[242:243], v218 offset:12288
v_mfma_f32_16x16x32_bf16 v[148:151], v[220:223], a[136:139], v[148:151]
s_add_u32 m0, s37, 35840
v_mfma_f32_16x16x32_bf16 v[148:151], v[224:227], a[152:155], v[148:151]
buffer_load_dwordx4 v211, s[4:7], s38 offen lds
s_add_u32 s38, s38, 524288
v_mfma_f32_16x16x32_bf16 v[152:155], v[224:227], a[156:159], v[152:155]
v_mfma_f32_16x16x32_bf16 v[152:155], v[220:223], a[140:143], v[152:155]
s_waitcnt lgkmcnt(4)
buffer_load_dwordx4 a[240:243], v204, s[8:11], s39 offen offset:3072 sc1
v_mfma_f32_16x16x32_bf16 v[168:171], v[228:231], a[140:143], v[168:171]
ds_read_b64_tr_b16 v[244:245], v219 offset:0
v_mfma_f32_16x16x32_bf16 v[168:171], v[232:235], a[156:159], v[168:171]
ds_read_b64_tr_b16 v[246:247], v219 offset:4096
v_mfma_f32_16x16x32_bf16 v[164:167], v[232:235], a[152:155], v[164:167]
ds_read_b64_tr_b16 v[248:249], v219 offset:8192
v_mfma_f32_16x16x32_bf16 v[164:167], v[228:231], a[136:139], v[164:167]
ds_read_b64_tr_b16 v[250:251], v219 offset:12288
v_mfma_f32_16x16x32_bf16 v[160:163], v[228:231], a[132:135], v[160:163]
v_mfma_f32_16x16x32_bf16 v[160:163], v[232:235], a[148:151], v[160:163]
v_mfma_f32_16x16x32_bf16 v[156:159], v[232:235], a[144:147], v[156:159]
v_mfma_f32_16x16x32_bf16 v[156:159], v[228:231], a[128:131], v[156:159]
s_waitcnt lgkmcnt(4)
buffer_load_dwordx4 a[244:247], v205, s[8:11], s39 offen offset:3072 sc1
v_mfma_f32_16x16x32_bf16 v[172:175], v[236:239], a[128:131], v[172:175]
s_waitcnt vmcnt(14)
s_barrier
ds_read_b64_tr_b16 v[220:221], v212 offset:16384
v_mfma_f32_16x16x32_bf16 v[172:175], v[240:243], a[144:147], v[172:175]
ds_read_b64_tr_b16 v[222:223], v212 offset:20480
v_mfma_f32_16x16x32_bf16 v[176:179], v[240:243], a[148:151], v[176:179]
ds_read_b64_tr_b16 v[224:225], v212 offset:24576
v_mfma_f32_16x16x32_bf16 v[176:179], v[236:239], a[132:135], v[176:179]
ds_read_b64_tr_b16 v[226:227], v212 offset:28672
v_mfma_f32_16x16x32_bf16 v[180:183], v[236:239], a[136:139], v[180:183]
v_mfma_f32_16x16x32_bf16 v[180:183], v[240:243], a[152:155], v[180:183]
v_mfma_f32_16x16x32_bf16 v[184:187], v[240:243], a[156:159], v[184:187]
v_mfma_f32_16x16x32_bf16 v[184:187], v[236:239], a[140:143], v[184:187]
s_waitcnt lgkmcnt(4)
buffer_load_dwordx4 a[248:251], v206, s[8:11], s39 offen offset:3072 sc1
v_mfma_f32_16x16x32_bf16 v[200:203], v[244:247], a[140:143], v[200:203]
ds_read_b64_tr_b16 v[228:229], v213 offset:16384
v_mfma_f32_16x16x32_bf16 v[200:203], v[248:251], a[156:159], v[200:203]
ds_read_b64_tr_b16 v[230:231], v213 offset:20480
v_mfma_f32_16x16x32_bf16 v[196:199], v[248:251], a[152:155], v[196:199]
ds_read_b64_tr_b16 v[232:233], v213 offset:24576
v_mfma_f32_16x16x32_bf16 v[196:199], v[244:247], a[136:139], v[196:199]
ds_read_b64_tr_b16 v[234:235], v213 offset:28672
v_mfma_f32_16x16x32_bf16 v[192:195], v[244:247], a[132:135], v[192:195]
v_mfma_f32_16x16x32_bf16 v[192:195], v[248:251], a[148:151], v[192:195]
v_mfma_f32_16x16x32_bf16 v[188:191], v[248:251], a[144:147], v[188:191]
v_mfma_f32_16x16x32_bf16 v[188:191], v[244:247], a[128:131], v[188:191]
s_waitcnt vmcnt(19) lgkmcnt(4)
buffer_load_dwordx4 a[252:255], v207, s[8:11], s39 offen offset:3072 sc1
s_add_u32 s39, s39, 4096
v_mfma_f32_16x16x32_bf16 v[76:79], v[220:223], a[160:163], v[76:79]
ds_read_b64_tr_b16 v[236:237], v214 offset:16384
v_mfma_f32_16x16x32_bf16 v[76:79], v[224:227], a[176:179], v[76:79]
ds_read_b64_tr_b16 v[238:239], v214 offset:20480
v_mfma_f32_16x16x32_bf16 v[80:83], v[224:227], a[180:183], v[80:83]
ds_read_b64_tr_b16 v[240:241], v214 offset:24576
v_mfma_f32_16x16x32_bf16 v[80:83], v[220:223], a[164:167], v[80:83]
ds_read_b64_tr_b16 v[242:243], v214 offset:28672
v_mfma_f32_16x16x32_bf16 v[84:87], v[220:223], a[168:171], v[84:87]
s_add_u32 m0, s37, 49152
v_mfma_f32_16x16x32_bf16 v[84:87], v[224:227], a[184:187], v[84:87]
buffer_load_dwordx4 v208, s[4:7], s38 offen lds
v_mfma_f32_16x16x32_bf16 v[88:91], v[224:227], a[188:191], v[88:91]
v_mfma_f32_16x16x32_bf16 v[88:91], v[220:223], a[172:175], v[88:91]
s_waitcnt lgkmcnt(4)
buffer_load_dwordx4 a[128:131], v204, s[8:11], s39 offen offset:0 sc1
v_mfma_f32_16x16x32_bf16 v[104:107], v[228:231], a[172:175], v[104:107]
ds_read_b64_tr_b16 v[244:245], v215 offset:16384
v_mfma_f32_16x16x32_bf16 v[104:107], v[232:235], a[188:191], v[104:107]
ds_read_b64_tr_b16 v[246:247], v215 offset:20480
v_mfma_f32_16x16x32_bf16 v[100:103], v[232:235], a[184:187], v[100:103]
ds_read_b64_tr_b16 v[248:249], v215 offset:24576
v_mfma_f32_16x16x32_bf16 v[100:103], v[228:231], a[168:171], v[100:103]
ds_read_b64_tr_b16 v[250:251], v215 offset:28672
v_mfma_f32_16x16x32_bf16 v[96:99], v[228:231], a[164:167], v[96:99]
s_add_u32 m0, s37, 50176
v_mfma_f32_16x16x32_bf16 v[96:99], v[232:235], a[180:183], v[96:99]
buffer_load_dwordx4 v209, s[4:7], s38 offen lds
v_mfma_f32_16x16x32_bf16 v[92:95], v[232:235], a[176:179], v[92:95]
v_mfma_f32_16x16x32_bf16 v[92:95], v[228:231], a[160:163], v[92:95]
s_waitcnt lgkmcnt(4)
buffer_load_dwordx4 a[132:135], v205, s[8:11], s39 offen offset:0 sc1
v_mfma_f32_16x16x32_bf16 v[108:111], v[236:239], a[160:163], v[108:111]
ds_read_b64_tr_b16 v[220:221], v216 offset:16384
v_mfma_f32_16x16x32_bf16 v[108:111], v[240:243], a[176:179], v[108:111]
ds_read_b64_tr_b16 v[222:223], v216 offset:20480
v_mfma_f32_16x16x32_bf16 v[112:115], v[240:243], a[180:183], v[112:115]
ds_read_b64_tr_b16 v[224:225], v216 offset:24576
v_mfma_f32_16x16x32_bf16 v[112:115], v[236:239], a[164:167], v[112:115]
ds_read_b64_tr_b16 v[226:227], v216 offset:28672
v_mfma_f32_16x16x32_bf16 v[116:119], v[236:239], a[168:171], v[116:119]
v_mfma_f32_16x16x32_bf16 v[116:119], v[240:243], a[184:187], v[116:119]
v_mfma_f32_16x16x32_bf16 v[120:123], v[240:243], a[188:191], v[120:123]
v_mfma_f32_16x16x32_bf16 v[120:123], v[236:239], a[172:175], v[120:123]
s_waitcnt lgkmcnt(4)
buffer_load_dwordx4 a[136:139], v206, s[8:11], s39 offen offset:0 sc1
v_mfma_f32_16x16x32_bf16 v[136:139], v[244:247], a[172:175], v[136:139]
ds_read_b64_tr_b16 v[228:229], v217 offset:16384
v_mfma_f32_16x16x32_bf16 v[136:139], v[248:251], a[188:191], v[136:139]
ds_read_b64_tr_b16 v[230:231], v217 offset:20480
v_mfma_f32_16x16x32_bf16 v[132:135], v[248:251], a[184:187], v[132:135]
ds_read_b64_tr_b16 v[232:233], v217 offset:24576
v_mfma_f32_16x16x32_bf16 v[132:135], v[244:247], a[168:171], v[132:135]
ds_read_b64_tr_b16 v[234:235], v217 offset:28672
v_mfma_f32_16x16x32_bf16 v[128:131], v[244:247], a[164:167], v[128:131]
s_add_u32 m0, s37, 51200
v_mfma_f32_16x16x32_bf16 v[128:131], v[248:251], a[180:183], v[128:131]
buffer_load_dwordx4 v210, s[4:7], s38 offen lds
v_mfma_f32_16x16x32_bf16 v[124:127], v[248:251], a[176:179], v[124:127]
v_mfma_f32_16x16x32_bf16 v[124:127], v[244:247], a[160:163], v[124:127]
s_waitcnt lgkmcnt(4)
buffer_load_dwordx4 a[140:143], v207, s[8:11], s39 offen offset:0 sc1
v_mfma_f32_16x16x32_bf16 v[140:143], v[220:223], a[160:163], v[140:143]
ds_read_b64_tr_b16 v[236:237], v218 offset:16384
v_mfma_f32_16x16x32_bf16 v[140:143], v[224:227], a[176:179], v[140:143]
ds_read_b64_tr_b16 v[238:239], v218 offset:20480
v_mfma_f32_16x16x32_bf16 v[144:147], v[224:227], a[180:183], v[144:147]
ds_read_b64_tr_b16 v[240:241], v218 offset:24576
v_mfma_f32_16x16x32_bf16 v[144:147], v[220:223], a[164:167], v[144:147]
ds_read_b64_tr_b16 v[242:243], v218 offset:28672
v_mfma_f32_16x16x32_bf16 v[148:151], v[220:223], a[168:171], v[148:151]
s_add_u32 m0, s37, 52224
v_mfma_f32_16x16x32_bf16 v[148:151], v[224:227], a[184:187], v[148:151]
buffer_load_dwordx4 v211, s[4:7], s38 offen lds
s_add_u32 s38, s38, 524288
v_mfma_f32_16x16x32_bf16 v[152:155], v[224:227], a[188:191], v[152:155]
v_mfma_f32_16x16x32_bf16 v[152:155], v[220:223], a[172:175], v[152:155]
s_waitcnt lgkmcnt(4)
buffer_load_dwordx4 a[144:147], v204, s[8:11], s39 offen offset:1024 sc1
v_mfma_f32_16x16x32_bf16 v[168:171], v[228:231], a[172:175], v[168:171]
ds_read_b64_tr_b16 v[244:245], v219 offset:16384
v_mfma_f32_16x16x32_bf16 v[168:171], v[232:235], a[188:191], v[168:171]
ds_read_b64_tr_b16 v[246:247], v219 offset:20480
v_mfma_f32_16x16x32_bf16 v[164:167], v[232:235], a[184:187], v[164:167]
ds_read_b64_tr_b16 v[248:249], v219 offset:24576
v_mfma_f32_16x16x32_bf16 v[164:167], v[228:231], a[168:171], v[164:167]
ds_read_b64_tr_b16 v[250:251], v219 offset:28672
v_mfma_f32_16x16x32_bf16 v[160:163], v[228:231], a[164:167], v[160:163]
v_mfma_f32_16x16x32_bf16 v[160:163], v[232:235], a[180:183], v[160:163]
v_mfma_f32_16x16x32_bf16 v[156:159], v[232:235], a[176:179], v[156:159]
v_mfma_f32_16x16x32_bf16 v[156:159], v[228:231], a[160:163], v[156:159]
s_waitcnt lgkmcnt(4)
buffer_load_dwordx4 a[148:151], v205, s[8:11], s39 offen offset:1024 sc1
v_mfma_f32_16x16x32_bf16 v[172:175], v[236:239], a[160:163], v[172:175]
s_waitcnt vmcnt(14)
s_barrier
ds_read_b64_tr_b16 v[220:221], v212 offset:32768
v_mfma_f32_16x16x32_bf16 v[172:175], v[240:243], a[176:179], v[172:175]
ds_read_b64_tr_b16 v[222:223], v212 offset:36864
v_mfma_f32_16x16x32_bf16 v[176:179], v[240:243], a[180:183], v[176:179]
ds_read_b64_tr_b16 v[224:225], v212 offset:40960
v_mfma_f32_16x16x32_bf16 v[176:179], v[236:239], a[164:167], v[176:179]
ds_read_b64_tr_b16 v[226:227], v212 offset:45056
v_mfma_f32_16x16x32_bf16 v[180:183], v[236:239], a[168:171], v[180:183]
v_mfma_f32_16x16x32_bf16 v[180:183], v[240:243], a[184:187], v[180:183]
v_mfma_f32_16x16x32_bf16 v[184:187], v[240:243], a[188:191], v[184:187]
v_mfma_f32_16x16x32_bf16 v[184:187], v[236:239], a[172:175], v[184:187]
s_waitcnt lgkmcnt(4)
buffer_load_dwordx4 a[152:155], v206, s[8:11], s39 offen offset:1024 sc1
v_mfma_f32_16x16x32_bf16 v[200:203], v[244:247], a[172:175], v[200:203]
ds_read_b64_tr_b16 v[228:229], v213 offset:32768
v_mfma_f32_16x16x32_bf16 v[200:203], v[248:251], a[188:191], v[200:203]
ds_read_b64_tr_b16 v[230:231], v213 offset:36864
v_mfma_f32_16x16x32_bf16 v[196:199], v[248:251], a[184:187], v[196:199]
ds_read_b64_tr_b16 v[232:233], v213 offset:40960
v_mfma_f32_16x16x32_bf16 v[196:199], v[244:247], a[168:171], v[196:199]
ds_read_b64_tr_b16 v[234:235], v213 offset:45056
v_mfma_f32_16x16x32_bf16 v[192:195], v[244:247], a[164:167], v[192:195]
v_mfma_f32_16x16x32_bf16 v[192:195], v[248:251], a[180:183], v[192:195]
v_mfma_f32_16x16x32_bf16 v[188:191], v[248:251], a[176:179], v[188:191]
v_mfma_f32_16x16x32_bf16 v[188:191], v[244:247], a[160:163], v[188:191]
s_waitcnt lgkmcnt(4)
buffer_load_dwordx4 a[156:159], v207, s[8:11], s39 offen offset:1024 sc1
v_mfma_f32_16x16x32_bf16 v[76:79], v[220:223], a[192:195], v[76:79]
ds_read_b64_tr_b16 v[236:237], v214 offset:32768
v_mfma_f32_16x16x32_bf16 v[76:79], v[224:227], a[208:211], v[76:79]
ds_read_b64_tr_b16 v[238:239], v214 offset:36864
v_mfma_f32_16x16x32_bf16 v[80:83], v[224:227], a[212:215], v[80:83]
ds_read_b64_tr_b16 v[240:241], v214 offset:40960
v_mfma_f32_16x16x32_bf16 v[80:83], v[220:223], a[196:199], v[80:83]
ds_read_b64_tr_b16 v[242:243], v214 offset:45056
v_mfma_f32_16x16x32_bf16 v[84:87], v[220:223], a[200:203], v[84:87]
s_add_u32 m0, s37, 0
v_mfma_f32_16x16x32_bf16 v[84:87], v[224:227], a[216:219], v[84:87]
buffer_load_dwordx4 v208, s[4:7], s38 offen lds
v_mfma_f32_16x16x32_bf16 v[88:91], v[224:227], a[220:223], v[88:91]
v_mfma_f32_16x16x32_bf16 v[88:91], v[220:223], a[204:207], v[88:91]
s_waitcnt lgkmcnt(4)
buffer_load_dwordx4 a[160:163], v204, s[8:11], s39 offen offset:2048 sc1
v_mfma_f32_16x16x32_bf16 v[104:107], v[228:231], a[204:207], v[104:107]
ds_read_b64_tr_b16 v[244:245], v215 offset:32768
v_mfma_f32_16x16x32_bf16 v[104:107], v[232:235], a[220:223], v[104:107]
ds_read_b64_tr_b16 v[246:247], v215 offset:36864
v_mfma_f32_16x16x32_bf16 v[100:103], v[232:235], a[216:219], v[100:103]
ds_read_b64_tr_b16 v[248:249], v215 offset:40960
v_mfma_f32_16x16x32_bf16 v[100:103], v[228:231], a[200:203], v[100:103]
ds_read_b64_tr_b16 v[250:251], v215 offset:45056
v_mfma_f32_16x16x32_bf16 v[96:99], v[228:231], a[196:199], v[96:99]
s_add_u32 m0, s37, 1024
v_mfma_f32_16x16x32_bf16 v[96:99], v[232:235], a[212:215], v[96:99]
buffer_load_dwordx4 v209, s[4:7], s38 offen lds
v_mfma_f32_16x16x32_bf16 v[92:95], v[232:235], a[208:211], v[92:95]
v_mfma_f32_16x16x32_bf16 v[92:95], v[228:231], a[192:195], v[92:95]
s_waitcnt lgkmcnt(4)
buffer_load_dwordx4 a[164:167], v205, s[8:11], s39 offen offset:2048 sc1
v_mfma_f32_16x16x32_bf16 v[108:111], v[236:239], a[192:195], v[108:111]
ds_read_b64_tr_b16 v[220:221], v216 offset:32768
v_mfma_f32_16x16x32_bf16 v[108:111], v[240:243], a[208:211], v[108:111]
ds_read_b64_tr_b16 v[222:223], v216 offset:36864
v_mfma_f32_16x16x32_bf16 v[112:115], v[240:243], a[212:215], v[112:115]
ds_read_b64_tr_b16 v[224:225], v216 offset:40960
v_mfma_f32_16x16x32_bf16 v[112:115], v[236:239], a[196:199], v[112:115]
ds_read_b64_tr_b16 v[226:227], v216 offset:45056
v_mfma_f32_16x16x32_bf16 v[116:119], v[236:239], a[200:203], v[116:119]
v_mfma_f32_16x16x32_bf16 v[116:119], v[240:243], a[216:219], v[116:119]
v_mfma_f32_16x16x32_bf16 v[120:123], v[240:243], a[220:223], v[120:123]
v_mfma_f32_16x16x32_bf16 v[120:123], v[236:239], a[204:207], v[120:123]
s_waitcnt lgkmcnt(4)
buffer_load_dwordx4 a[168:171], v206, s[8:11], s39 offen offset:2048 sc1
v_mfma_f32_16x16x32_bf16 v[136:139], v[244:247], a[204:207], v[136:139]
ds_read_b64_tr_b16 v[228:229], v217 offset:32768
v_mfma_f32_16x16x32_bf16 v[136:139], v[248:251], a[220:223], v[136:139]
ds_read_b64_tr_b16 v[230:231], v217 offset:36864
v_mfma_f32_16x16x32_bf16 v[132:135], v[248:251], a[216:219], v[132:135]
ds_read_b64_tr_b16 v[232:233], v217 offset:40960
v_mfma_f32_16x16x32_bf16 v[132:135], v[244:247], a[200:203], v[132:135]
ds_read_b64_tr_b16 v[234:235], v217 offset:45056
v_mfma_f32_16x16x32_bf16 v[128:131], v[244:247], a[196:199], v[128:131]
s_add_u32 m0, s37, 2048
v_mfma_f32_16x16x32_bf16 v[128:131], v[248:251], a[212:215], v[128:131]
buffer_load_dwordx4 v210, s[4:7], s38 offen lds
v_mfma_f32_16x16x32_bf16 v[124:127], v[248:251], a[208:211], v[124:127]
v_mfma_f32_16x16x32_bf16 v[124:127], v[244:247], a[192:195], v[124:127]
s_waitcnt lgkmcnt(4)
buffer_load_dwordx4 a[172:175], v207, s[8:11], s39 offen offset:2048 sc1
v_mfma_f32_16x16x32_bf16 v[140:143], v[220:223], a[192:195], v[140:143]
ds_read_b64_tr_b16 v[236:237], v218 offset:32768
v_mfma_f32_16x16x32_bf16 v[140:143], v[224:227], a[208:211], v[140:143]
ds_read_b64_tr_b16 v[238:239], v218 offset:36864
v_mfma_f32_16x16x32_bf16 v[144:147], v[224:227], a[212:215], v[144:147]
ds_read_b64_tr_b16 v[240:241], v218 offset:40960
v_mfma_f32_16x16x32_bf16 v[144:147], v[220:223], a[196:199], v[144:147]
ds_read_b64_tr_b16 v[242:243], v218 offset:45056
v_mfma_f32_16x16x32_bf16 v[148:151], v[220:223], a[200:203], v[148:151]
s_add_u32 m0, s37, 3072
v_mfma_f32_16x16x32_bf16 v[148:151], v[224:227], a[216:219], v[148:151]
buffer_load_dwordx4 v211, s[4:7], s38 offen lds
s_add_u32 s38, s38, 524288
v_mfma_f32_16x16x32_bf16 v[152:155], v[224:227], a[220:223], v[152:155]
v_mfma_f32_16x16x32_bf16 v[152:155], v[220:223], a[204:207], v[152:155]
s_waitcnt lgkmcnt(4)
buffer_load_dwordx4 a[176:179], v204, s[8:11], s39 offen offset:3072 sc1
v_mfma_f32_16x16x32_bf16 v[168:171], v[228:231], a[204:207], v[168:171]
ds_read_b64_tr_b16 v[244:245], v219 offset:32768
v_mfma_f32_16x16x32_bf16 v[168:171], v[232:235], a[220:223], v[168:171]
ds_read_b64_tr_b16 v[246:247], v219 offset:36864
v_mfma_f32_16x16x32_bf16 v[164:167], v[232:235], a[216:219], v[164:167]
ds_read_b64_tr_b16 v[248:249], v219 offset:40960
v_mfma_f32_16x16x32_bf16 v[164:167], v[228:231], a[200:203], v[164:167]
ds_read_b64_tr_b16 v[250:251], v219 offset:45056
v_mfma_f32_16x16x32_bf16 v[160:163], v[228:231], a[196:199], v[160:163]
v_mfma_f32_16x16x32_bf16 v[160:163], v[232:235], a[212:215], v[160:163]
v_mfma_f32_16x16x32_bf16 v[156:159], v[232:235], a[208:211], v[156:159]
v_mfma_f32_16x16x32_bf16 v[156:159], v[228:231], a[192:195], v[156:159]
s_waitcnt lgkmcnt(4)
buffer_load_dwordx4 a[180:183], v205, s[8:11], s39 offen offset:3072 sc1
v_mfma_f32_16x16x32_bf16 v[172:175], v[236:239], a[192:195], v[172:175]
s_waitcnt vmcnt(14)
s_barrier
ds_read_b64_tr_b16 v[220:221], v212 offset:49152
v_mfma_f32_16x16x32_bf16 v[172:175], v[240:243], a[208:211], v[172:175]
ds_read_b64_tr_b16 v[222:223], v212 offset:53248
v_mfma_f32_16x16x32_bf16 v[176:179], v[240:243], a[212:215], v[176:179]
ds_read_b64_tr_b16 v[224:225], v212 offset:57344
v_mfma_f32_16x16x32_bf16 v[176:179], v[236:239], a[196:199], v[176:179]
ds_read_b64_tr_b16 v[226:227], v212 offset:61440
v_mfma_f32_16x16x32_bf16 v[180:183], v[236:239], a[200:203], v[180:183]
v_mfma_f32_16x16x32_bf16 v[180:183], v[240:243], a[216:219], v[180:183]
v_mfma_f32_16x16x32_bf16 v[184:187], v[240:243], a[220:223], v[184:187]
v_mfma_f32_16x16x32_bf16 v[184:187], v[236:239], a[204:207], v[184:187]
s_waitcnt lgkmcnt(4)
buffer_load_dwordx4 a[184:187], v206, s[8:11], s39 offen offset:3072 sc1
v_mfma_f32_16x16x32_bf16 v[200:203], v[244:247], a[204:207], v[200:203]
ds_read_b64_tr_b16 v[228:229], v213 offset:49152
v_mfma_f32_16x16x32_bf16 v[200:203], v[248:251], a[220:223], v[200:203]
ds_read_b64_tr_b16 v[230:231], v213 offset:53248
v_mfma_f32_16x16x32_bf16 v[196:199], v[248:251], a[216:219], v[196:199]
ds_read_b64_tr_b16 v[232:233], v213 offset:57344
v_mfma_f32_16x16x32_bf16 v[196:199], v[244:247], a[200:203], v[196:199]
ds_read_b64_tr_b16 v[234:235], v213 offset:61440
v_mfma_f32_16x16x32_bf16 v[192:195], v[244:247], a[196:199], v[192:195]
v_mfma_f32_16x16x32_bf16 v[192:195], v[248:251], a[212:215], v[192:195]
v_mfma_f32_16x16x32_bf16 v[188:191], v[248:251], a[208:211], v[188:191]
v_mfma_f32_16x16x32_bf16 v[188:191], v[244:247], a[192:195], v[188:191]
s_waitcnt lgkmcnt(4)
buffer_load_dwordx4 a[188:191], v207, s[8:11], s39 offen offset:3072 sc1
s_add_u32 s39, s39, 4096
v_mfma_f32_16x16x32_bf16 v[76:79], v[220:223], a[224:227], v[76:79]
ds_read_b64_tr_b16 v[236:237], v214 offset:49152
v_mfma_f32_16x16x32_bf16 v[76:79], v[224:227], a[240:243], v[76:79]
ds_read_b64_tr_b16 v[238:239], v214 offset:53248
v_mfma_f32_16x16x32_bf16 v[80:83], v[224:227], a[244:247], v[80:83]
ds_read_b64_tr_b16 v[240:241], v214 offset:57344
v_mfma_f32_16x16x32_bf16 v[80:83], v[220:223], a[228:231], v[80:83]
ds_read_b64_tr_b16 v[242:243], v214 offset:61440
v_mfma_f32_16x16x32_bf16 v[84:87], v[220:223], a[232:235], v[84:87]
s_add_u32 m0, s37, 16384
v_mfma_f32_16x16x32_bf16 v[84:87], v[224:227], a[248:251], v[84:87]
buffer_load_dwordx4 v208, s[4:7], s38 offen lds
v_mfma_f32_16x16x32_bf16 v[88:91], v[224:227], a[252:255], v[88:91]
v_mfma_f32_16x16x32_bf16 v[88:91], v[220:223], a[236:239], v[88:91]
s_waitcnt lgkmcnt(4)
buffer_load_dwordx4 a[192:195], v204, s[8:11], s39 offen offset:0 sc1
v_mfma_f32_16x16x32_bf16 v[104:107], v[228:231], a[236:239], v[104:107]
ds_read_b64_tr_b16 v[244:245], v215 offset:49152
v_mfma_f32_16x16x32_bf16 v[104:107], v[232:235], a[252:255], v[104:107]
ds_read_b64_tr_b16 v[246:247], v215 offset:53248
v_mfma_f32_16x16x32_bf16 v[100:103], v[232:235], a[248:251], v[100:103]
ds_read_b64_tr_b16 v[248:249], v215 offset:57344
v_mfma_f32_16x16x32_bf16 v[100:103], v[228:231], a[232:235], v[100:103]
ds_read_b64_tr_b16 v[250:251], v215 offset:61440
v_mfma_f32_16x16x32_bf16 v[96:99], v[228:231], a[228:231], v[96:99]
s_add_u32 m0, s37, 17408
v_mfma_f32_16x16x32_bf16 v[96:99], v[232:235], a[244:247], v[96:99]
buffer_load_dwordx4 v209, s[4:7], s38 offen lds
v_mfma_f32_16x16x32_bf16 v[92:95], v[232:235], a[240:243], v[92:95]
v_mfma_f32_16x16x32_bf16 v[92:95], v[228:231], a[224:227], v[92:95]
s_waitcnt lgkmcnt(4)
buffer_load_dwordx4 a[196:199], v205, s[8:11], s39 offen offset:0 sc1
v_mfma_f32_16x16x32_bf16 v[108:111], v[236:239], a[224:227], v[108:111]
ds_read_b64_tr_b16 v[220:221], v216 offset:49152
v_mfma_f32_16x16x32_bf16 v[108:111], v[240:243], a[240:243], v[108:111]
ds_read_b64_tr_b16 v[222:223], v216 offset:53248
v_mfma_f32_16x16x32_bf16 v[112:115], v[240:243], a[244:247], v[112:115]
ds_read_b64_tr_b16 v[224:225], v216 offset:57344
v_mfma_f32_16x16x32_bf16 v[112:115], v[236:239], a[228:231], v[112:115]
ds_read_b64_tr_b16 v[226:227], v216 offset:61440
v_mfma_f32_16x16x32_bf16 v[116:119], v[236:239], a[232:235], v[116:119]
v_mfma_f32_16x16x32_bf16 v[116:119], v[240:243], a[248:251], v[116:119]
v_mfma_f32_16x16x32_bf16 v[120:123], v[240:243], a[252:255], v[120:123]
v_mfma_f32_16x16x32_bf16 v[120:123], v[236:239], a[236:239], v[120:123]
s_waitcnt lgkmcnt(4)
buffer_load_dwordx4 a[200:203], v206, s[8:11], s39 offen offset:0 sc1
v_mfma_f32_16x16x32_bf16 v[136:139], v[244:247], a[236:239], v[136:139]
ds_read_b64_tr_b16 v[228:229], v217 offset:49152
v_mfma_f32_16x16x32_bf16 v[136:139], v[248:251], a[252:255], v[136:139]
ds_read_b64_tr_b16 v[230:231], v217 offset:53248
v_mfma_f32_16x16x32_bf16 v[132:135], v[248:251], a[248:251], v[132:135]
ds_read_b64_tr_b16 v[232:233], v217 offset:57344
v_mfma_f32_16x16x32_bf16 v[132:135], v[244:247], a[232:235], v[132:135]
ds_read_b64_tr_b16 v[234:235], v217 offset:61440
v_mfma_f32_16x16x32_bf16 v[128:131], v[244:247], a[228:231], v[128:131]
s_add_u32 m0, s37, 18432
v_mfma_f32_16x16x32_bf16 v[128:131], v[248:251], a[244:247], v[128:131]
buffer_load_dwordx4 v210, s[4:7], s38 offen lds
v_mfma_f32_16x16x32_bf16 v[124:127], v[248:251], a[240:243], v[124:127]
v_mfma_f32_16x16x32_bf16 v[124:127], v[244:247], a[224:227], v[124:127]
s_waitcnt lgkmcnt(4)
buffer_load_dwordx4 a[204:207], v207, s[8:11], s39 offen offset:0 sc1
v_mfma_f32_16x16x32_bf16 v[140:143], v[220:223], a[224:227], v[140:143]
ds_read_b64_tr_b16 v[236:237], v218 offset:49152
v_mfma_f32_16x16x32_bf16 v[140:143], v[224:227], a[240:243], v[140:143]
ds_read_b64_tr_b16 v[238:239], v218 offset:53248
v_mfma_f32_16x16x32_bf16 v[144:147], v[224:227], a[244:247], v[144:147]
ds_read_b64_tr_b16 v[240:241], v218 offset:57344
v_mfma_f32_16x16x32_bf16 v[144:147], v[220:223], a[228:231], v[144:147]
ds_read_b64_tr_b16 v[242:243], v218 offset:61440
v_mfma_f32_16x16x32_bf16 v[148:151], v[220:223], a[232:235], v[148:151]
s_add_u32 m0, s37, 19456
v_mfma_f32_16x16x32_bf16 v[148:151], v[224:227], a[248:251], v[148:151]
buffer_load_dwordx4 v211, s[4:7], s38 offen lds
s_add_u32 s38, s38, 524288
v_mfma_f32_16x16x32_bf16 v[152:155], v[224:227], a[252:255], v[152:155]
v_mfma_f32_16x16x32_bf16 v[152:155], v[220:223], a[236:239], v[152:155]
s_waitcnt lgkmcnt(4)
buffer_load_dwordx4 a[208:211], v204, s[8:11], s39 offen offset:1024 sc1
v_mfma_f32_16x16x32_bf16 v[168:171], v[228:231], a[236:239], v[168:171]
ds_read_b64_tr_b16 v[244:245], v219 offset:49152
v_mfma_f32_16x16x32_bf16 v[168:171], v[232:235], a[252:255], v[168:171]
ds_read_b64_tr_b16 v[246:247], v219 offset:53248
v_mfma_f32_16x16x32_bf16 v[164:167], v[232:235], a[248:251], v[164:167]
ds_read_b64_tr_b16 v[248:249], v219 offset:57344
v_mfma_f32_16x16x32_bf16 v[164:167], v[228:231], a[232:235], v[164:167]
ds_read_b64_tr_b16 v[250:251], v219 offset:61440
v_mfma_f32_16x16x32_bf16 v[160:163], v[228:231], a[228:231], v[160:163]
v_mfma_f32_16x16x32_bf16 v[160:163], v[232:235], a[244:247], v[160:163]
v_mfma_f32_16x16x32_bf16 v[156:159], v[232:235], a[240:243], v[156:159]
v_mfma_f32_16x16x32_bf16 v[156:159], v[228:231], a[224:227], v[156:159]
s_waitcnt lgkmcnt(4)
buffer_load_dwordx4 a[212:215], v205, s[8:11], s39 offen offset:1024 sc1
v_mfma_f32_16x16x32_bf16 v[172:175], v[236:239], a[224:227], v[172:175]
s_waitcnt vmcnt(14)
s_barrier
ds_read_b64_tr_b16 v[220:221], v212 offset:0
v_mfma_f32_16x16x32_bf16 v[172:175], v[240:243], a[240:243], v[172:175]
ds_read_b64_tr_b16 v[222:223], v212 offset:4096
v_mfma_f32_16x16x32_bf16 v[176:179], v[240:243], a[244:247], v[176:179]
ds_read_b64_tr_b16 v[224:225], v212 offset:8192
v_mfma_f32_16x16x32_bf16 v[176:179], v[236:239], a[228:231], v[176:179]
ds_read_b64_tr_b16 v[226:227], v212 offset:12288
v_mfma_f32_16x16x32_bf16 v[180:183], v[236:239], a[232:235], v[180:183]
v_mfma_f32_16x16x32_bf16 v[180:183], v[240:243], a[248:251], v[180:183]
v_mfma_f32_16x16x32_bf16 v[184:187], v[240:243], a[252:255], v[184:187]
v_mfma_f32_16x16x32_bf16 v[184:187], v[236:239], a[236:239], v[184:187]
s_waitcnt lgkmcnt(4)
buffer_load_dwordx4 a[216:219], v206, s[8:11], s39 offen offset:1024 sc1
v_mfma_f32_16x16x32_bf16 v[200:203], v[244:247], a[236:239], v[200:203]
ds_read_b64_tr_b16 v[228:229], v213 offset:0
v_mfma_f32_16x16x32_bf16 v[200:203], v[248:251], a[252:255], v[200:203]
ds_read_b64_tr_b16 v[230:231], v213 offset:4096
v_mfma_f32_16x16x32_bf16 v[196:199], v[248:251], a[248:251], v[196:199]
ds_read_b64_tr_b16 v[232:233], v213 offset:8192
v_mfma_f32_16x16x32_bf16 v[196:199], v[244:247], a[232:235], v[196:199]
ds_read_b64_tr_b16 v[234:235], v213 offset:12288
v_mfma_f32_16x16x32_bf16 v[192:195], v[244:247], a[228:231], v[192:195]
v_mfma_f32_16x16x32_bf16 v[192:195], v[248:251], a[244:247], v[192:195]
v_mfma_f32_16x16x32_bf16 v[188:191], v[248:251], a[240:243], v[188:191]
v_mfma_f32_16x16x32_bf16 v[188:191], v[244:247], a[224:227], v[188:191]
s_waitcnt lgkmcnt(4)
buffer_load_dwordx4 a[220:223], v207, s[8:11], s39 offen offset:1024 sc1
s_sub_u32 s40, s40, 1
s_cmp_lg_u32 s40, 0
s_cbranch_scc1 L_qp_loop
v_mfma_f32_16x16x32_bf16 v[76:79], v[220:223], a[128:131], v[76:79]
ds_read_b64_tr_b16 v[236:237], v214 offset:0
v_mfma_f32_16x16x32_bf16 v[76:79], v[224:227], a[144:147], v[76:79]
ds_read_b64_tr_b16 v[238:239], v214 offset:4096
v_mfma_f32_16x16x32_bf16 v[80:83], v[224:227], a[148:151], v[80:83]
ds_read_b64_tr_b16 v[240:241], v214 offset:8192
v_mfma_f32_16x16x32_bf16 v[80:83], v[220:223], a[132:135], v[80:83]
ds_read_b64_tr_b16 v[242:243], v214 offset:12288
v_mfma_f32_16x16x32_bf16 v[84:87], v[220:223], a[136:139], v[84:87]
s_add_u32 m0, s37, 32768
v_mfma_f32_16x16x32_bf16 v[84:87], v[224:227], a[152:155], v[84:87]
buffer_load_dwordx4 v208, s[4:7], s38 offen lds
v_mfma_f32_16x16x32_bf16 v[88:91], v[224:227], a[156:159], v[88:91]
v_mfma_f32_16x16x32_bf16 v[88:91], v[220:223], a[140:143], v[88:91]
s_waitcnt lgkmcnt(4)
buffer_load_dwordx4 a[224:227], v204, s[8:11], s39 offen offset:2048 sc1
v_mfma_f32_16x16x32_bf16 v[104:107], v[228:231], a[140:143], v[104:107]
ds_read_b64_tr_b16 v[244:245], v215 offset:0
v_mfma_f32_16x16x32_bf16 v[104:107], v[232:235], a[156:159], v[104:107]
ds_read_b64_tr_b16 v[246:247], v215 offset:4096
v_mfma_f32_16x16x32_bf16 v[100:103], v[232:235], a[152:155], v[100:103]
ds_read_b64_tr_b16 v[248:249], v215 offset:8192
v_mfma_f32_16x16x32_bf16 v[100:103], v[228:231], a[136:139], v[100:103]
ds_read_b64_tr_b16 v[250:251], v215 offset:12288
v_mfma_f32_16x16x32_bf16 v[96:99], v[228:231], a[132:135], v[96:99]
s_add_u32 m0, s37, 33792
v_mfma_f32_16x16x32_bf16 v[96:99], v[232:235], a[148:151], v[96:99]
buffer_load_dwordx4 v209, s[4:7], s38 offen lds
v_mfma_f32_16x16x32_bf16 v[92:95], v[232:235], a[144:147], v[92:95]
v_mfma_f32_16x16x32_bf16 v[92:95], v[228:231], a[128:131], v[92:95]
s_waitcnt lgkmcnt(4)
buffer_load_dwordx4 a[228:231], v205, s[8:11], s39 offen offset:2048 sc1
v_mfma_f32_16x16x32_bf16 v[108:111], v[236:239], a[128:131], v[108:111]
ds_read_b64_tr_b16 v[220:221], v216 offset:0
v_mfma_f32_16x16x32_bf16 v[108:111], v[240:243], a[144:147], v[108:111]
ds_read_b64_tr_b16 v[222:223], v216 offset:4096
v_mfma_f32_16x16x32_bf16 v[112:115], v[240:243], a[148:151], v[112:115]
ds_read_b64_tr_b16 v[224:225], v216 offset:8192
v_mfma_f32_16x16x32_bf16 v[112:115], v[236:239], a[132:135], v[112:115]
ds_read_b64_tr_b16 v[226:227], v216 offset:12288
v_mfma_f32_16x16x32_bf16 v[116:119], v[236:239], a[136:139], v[116:119]
s_add_u32 m0, s43, 0
v_mfma_f32_16x16x32_bf16 v[116:119], v[240:243], a[152:155], v[116:119]
buffer_load_dwordx4 v2, s[8:11], s41 offen offset:0 lds
v_mfma_f32_16x16x32_bf16 v[120:123], v[240:243], a[156:159], v[120:123]
v_mfma_f32_16x16x32_bf16 v[120:123], v[236:239], a[140:143], v[120:123]
s_waitcnt lgkmcnt(4)
buffer_load_dwordx4 a[232:235], v206, s[8:11], s39 offen offset:2048 sc1
v_mfma_f32_16x16x32_bf16 v[136:139], v[244:247], a[140:143], v[136:139]
ds_read_b64_tr_b16 v[228:229], v217 offset:0
v_mfma_f32_16x16x32_bf16 v[136:139], v[248:251], a[156:159], v[136:139]
ds_read_b64_tr_b16 v[230:231], v217 offset:4096
v_mfma_f32_16x16x32_bf16 v[132:135], v[248:251], a[152:155], v[132:135]
ds_read_b64_tr_b16 v[232:233], v217 offset:8192
v_mfma_f32_16x16x32_bf16 v[132:135], v[244:247], a[136:139], v[132:135]
ds_read_b64_tr_b16 v[234:235], v217 offset:12288
v_mfma_f32_16x16x32_bf16 v[128:131], v[244:247], a[132:135], v[128:131]
s_add_u32 m0, s37, 34816
v_mfma_f32_16x16x32_bf16 v[128:131], v[248:251], a[148:151], v[128:131]
buffer_load_dwordx4 v210, s[4:7], s38 offen lds
v_mfma_f32_16x16x32_bf16 v[124:127], v[248:251], a[144:147], v[124:127]
v_mfma_f32_16x16x32_bf16 v[124:127], v[244:247], a[128:131], v[124:127]
s_waitcnt lgkmcnt(4)
buffer_load_dwordx4 a[236:239], v207, s[8:11], s39 offen offset:2048 sc1
v_mfma_f32_16x16x32_bf16 v[140:143], v[220:223], a[128:131], v[140:143]
ds_read_b64_tr_b16 v[236:237], v218 offset:0
v_mfma_f32_16x16x32_bf16 v[140:143], v[224:227], a[144:147], v[140:143]
ds_read_b64_tr_b16 v[238:239], v218 offset:4096
v_mfma_f32_16x16x32_bf16 v[144:147], v[224:227], a[148:151], v[144:147]
ds_read_b64_tr_b16 v[240:241], v218 offset:8192
v_mfma_f32_16x16x32_bf16 v[144:147], v[220:223], a[132:135], v[144:147]
ds_read_b64_tr_b16 v[242:243], v218 offset:12288
v_mfma_f32_16x16x32_bf16 v[148:151], v[220:223], a[136:139], v[148:151]
s_add_u32 m0, s37, 35840
v_mfma_f32_16x16x32_bf16 v[148:151], v[224:227], a[152:155], v[148:151]
buffer_load_dwordx4 v211, s[4:7], s38 offen lds
s_add_u32 s38, s38, 524288
v_mfma_f32_16x16x32_bf16 v[152:155], v[224:227], a[156:159], v[152:155]
v_mfma_f32_16x16x32_bf16 v[152:155], v[220:223], a[140:143], v[152:155]
s_waitcnt lgkmcnt(4)
buffer_load_dwordx4 a[240:243], v204, s[8:11], s39 offen offset:3072 sc1
v_mfma_f32_16x16x32_bf16 v[168:171], v[228:231], a[140:143], v[168:171]
ds_read_b64_tr_b16 v[244:245], v219 offset:0
v_mfma_f32_16x16x32_bf16 v[168:171], v[232:235], a[156:159], v[168:171]
ds_read_b64_tr_b16 v[246:247], v219 offset:4096
v_mfma_f32_16x16x32_bf16 v[164:167], v[232:235], a[152:155], v[164:167]
ds_read_b64_tr_b16 v[248:249], v219 offset:8192
v_mfma_f32_16x16x32_bf16 v[164:167], v[228:231], a[136:139], v[164:167]
ds_read_b64_tr_b16 v[250:251], v219 offset:12288
v_mfma_f32_16x16x32_bf16 v[160:163], v[228:231], a[132:135], v[160:163]
s_add_u32 m0, s43, 0
v_mfma_f32_16x16x32_bf16 v[160:163], v[232:235], a[148:151], v[160:163]
buffer_load_dwordx4 v2, s[8:11], s41 offen offset:1024 lds
v_mfma_f32_16x16x32_bf16 v[156:159], v[232:235], a[144:147], v[156:159]
v_mfma_f32_16x16x32_bf16 v[156:159], v[228:231], a[128:131], v[156:159]
s_waitcnt lgkmcnt(4)
buffer_load_dwordx4 a[244:247], v205, s[8:11], s39 offen offset:3072 sc1
v_mfma_f32_16x16x32_bf16 v[172:175], v[236:239], a[128:131], v[172:175]
s_waitcnt vmcnt(16)
s_barrier
ds_read_b64_tr_b16 v[220:221], v212 offset:16384
v_mfma_f32_16x16x32_bf16 v[172:175], v[240:243], a[144:147], v[172:175]
ds_read_b64_tr_b16 v[222:223], v212 offset:20480
v_mfma_f32_16x16x32_bf16 v[176:179], v[240:243], a[148:151], v[176:179]
ds_read_b64_tr_b16 v[224:225], v212 offset:24576
v_mfma_f32_16x16x32_bf16 v[176:179], v[236:239], a[132:135], v[176:179]
ds_read_b64_tr_b16 v[226:227], v212 offset:28672
v_mfma_f32_16x16x32_bf16 v[180:183], v[236:239], a[136:139], v[180:183]
s_add_u32 m0, s43, 0
v_mfma_f32_16x16x32_bf16 v[180:183], v[240:243], a[152:155], v[180:183]
buffer_load_dwordx4 v2, s[8:11], s41 offen offset:2048 lds
v_mfma_f32_16x16x32_bf16 v[184:187], v[240:243], a[156:159], v[184:187]
v_mfma_f32_16x16x32_bf16 v[184:187], v[236:239], a[140:143], v[184:187]
s_waitcnt lgkmcnt(4)
buffer_load_dwordx4 a[248:251], v206, s[8:11], s39 offen offset:3072 sc1
v_mfma_f32_16x16x32_bf16 v[200:203], v[244:247], a[140:143], v[200:203]
ds_read_b64_tr_b16 v[228:229], v213 offset:16384
v_mfma_f32_16x16x32_bf16 v[200:203], v[248:251], a[156:159], v[200:203]
ds_read_b64_tr_b16 v[230:231], v213 offset:20480
v_mfma_f32_16x16x32_bf16 v[196:199], v[248:251], a[152:155], v[196:199]
ds_read_b64_tr_b16 v[232:233], v213 offset:24576
v_mfma_f32_16x16x32_bf16 v[196:199], v[244:247], a[136:139], v[196:199]
ds_read_b64_tr_b16 v[234:235], v213 offset:28672
v_mfma_f32_16x16x32_bf16 v[192:195], v[244:247], a[132:135], v[192:195]
s_add_u32 m0, s43, 0
v_mfma_f32_16x16x32_bf16 v[192:195], v[248:251], a[148:151], v[192:195]
buffer_load_dwordx4 v2, s[8:11], s41 offen offset:3072 lds
v_mfma_f32_16x16x32_bf16 v[188:191], v[248:251], a[144:147], v[188:191]
v_mfma_f32_16x16x32_bf16 v[188:191], v[244:247], a[128:131], v[188:191]
s_waitcnt lgkmcnt(4)
buffer_load_dwordx4 a[252:255], v207, s[8:11], s39 offen offset:3072 sc1
s_add_u32 s39, s39, 4096
v_mfma_f32_16x16x32_bf16 v[76:79], v[220:223], a[160:163], v[76:79]
ds_read_b64_tr_b16 v[236:237], v214 offset:16384
v_mfma_f32_16x16x32_bf16 v[76:79], v[224:227], a[176:179], v[76:79]
ds_read_b64_tr_b16 v[238:239], v214 offset:20480
v_mfma_f32_16x16x32_bf16 v[80:83], v[224:227], a[180:183], v[80:83]
ds_read_b64_tr_b16 v[240:241], v214 offset:24576
v_mfma_f32_16x16x32_bf16 v[80:83], v[220:223], a[164:167], v[80:83]
ds_read_b64_tr_b16 v[242:243], v214 offset:28672
v_mfma_f32_16x16x32_bf16 v[84:87], v[220:223], a[168:171], v[84:87]
s_add_u32 m0, s37, 49152
v_mfma_f32_16x16x32_bf16 v[84:87], v[224:227], a[184:187], v[84:87]
buffer_load_dwordx4 v208, s[4:7], s38 offen lds
v_mfma_f32_16x16x32_bf16 v[88:91], v[224:227], a[188:191], v[88:91]
v_mfma_f32_16x16x32_bf16 v[88:91], v[220:223], a[172:175], v[88:91]
s_waitcnt lgkmcnt(4)
v_mfma_f32_16x16x32_bf16 v[104:107], v[228:231], a[172:175], v[104:107]
ds_read_b64_tr_b16 v[244:245], v215 offset:16384
v_mfma_f32_16x16x32_bf16 v[104:107], v[232:235], a[188:191], v[104:107]
ds_read_b64_tr_b16 v[246:247], v215 offset:20480
v_mfma_f32_16x16x32_bf16 v[100:103], v[232:235], a[184:187], v[100:103]
ds_read_b64_tr_b16 v[248:249], v215 offset:24576
v_mfma_f32_16x16x32_bf16 v[100:103], v[228:231], a[168:171], v[100:103]
ds_read_b64_tr_b16 v[250:251], v215 offset:28672
v_mfma_f32_16x16x32_bf16 v[96:99], v[228:231], a[164:167], v[96:99]
s_add_u32 m0, s37, 50176
v_mfma_f32_16x16x32_bf16 v[96:99], v[232:235], a[180:183], v[96:99]
buffer_load_dwordx4 v209, s[4:7], s38 offen lds
v_mfma_f32_16x16x32_bf16 v[92:95], v[232:235], a[176:179], v[92:95]
v_mfma_f32_16x16x32_bf16 v[92:95], v[228:231], a[160:163], v[92:95]
s_waitcnt lgkmcnt(4)
v_mfma_f32_16x16x32_bf16 v[108:111], v[236:239], a[160:163], v[108:111]
ds_read_b64_tr_b16 v[220:221], v216 offset:16384
v_mfma_f32_16x16x32_bf16 v[108:111], v[240:243], a[176:179], v[108:111]
ds_read_b64_tr_b16 v[222:223], v216 offset:20480
v_mfma_f32_16x16x32_bf16 v[112:115], v[240:243], a[180:183], v[112:115]
ds_read_b64_tr_b16 v[224:225], v216 offset:24576
v_mfma_f32_16x16x32_bf16 v[112:115], v[236:239], a[164:167], v[112:115]
s_add_u32 s42, s41, 4096
ds_read_b64_tr_b16 v[226:227], v216 offset:28672
v_mfma_f32_16x16x32_bf16 v[116:119], v[236:239], a[168:171], v[116:119]
s_add_u32 m0, s43, 4096
v_mfma_f32_16x16x32_bf16 v[116:119], v[240:243], a[184:187], v[116:119]
buffer_load_dwordx4 v2, s[8:11], s42 offen offset:0 lds
v_mfma_f32_16x16x32_bf16 v[120:123], v[240:243], a[188:191], v[120:123]
v_mfma_f32_16x16x32_bf16 v[120:123], v[236:239], a[172:175], v[120:123]
s_waitcnt lgkmcnt(4)
v_mfma_f32_16x16x32_bf16 v[136:139], v[244:247], a[172:175], v[136:139]
ds_read_b64_tr_b16 v[228:229], v217 offset:16384
v_mfma_f32_16x16x32_bf16 v[136:139], v[248:251], a[188:191], v[136:139]
ds_read_b64_tr_b16 v[230:231], v217 offset:20480
v_mfma_f32_16x16x32_bf16 v[132:135], v[248:251], a[184:187], v[132:135]
ds_read_b64_tr_b16 v[232:233], v217 offset:24576
v_mfma_f32_16x16x32_bf16 v[132:135], v[244:247], a[168:171], v[132:135]
ds_read_b64_tr_b16 v[234:235], v217 offset:28672
v_mfma_f32_16x16x32_bf16 v[128:131], v[244:247], a[164:167], v[128:131]
s_add_u32 m0, s37, 51200
v_mfma_f32_16x16x32_bf16 v[128:131], v[248:251], a[180:183], v[128:131]
buffer_load_dwordx4 v210, s[4:7], s38 offen lds
v_mfma_f32_16x16x32_bf16 v[124:127], v[248:251], a[176:179], v[124:127]
v_mfma_f32_16x16x32_bf16 v[124:127], v[244:247], a[160:163], v[124:127]
s_waitcnt lgkmcnt(4)
v_mfma_f32_16x16x32_bf16 v[140:143], v[220:223], a[160:163], v[140:143]
ds_read_b64_tr_b16 v[236:237], v218 offset:16384
v_mfma_f32_16x16x32_bf16 v[140:143], v[224:227], a[176:179], v[140:143]
ds_read_b64_tr_b16 v[238:239], v218 offset:20480
v_mfma_f32_16x16x32_bf16 v[144:147], v[224:227], a[180:183], v[144:147]
ds_read_b64_tr_b16 v[240:241], v218 offset:24576
v_mfma_f32_16x16x32_bf16 v[144:147], v[220:223], a[164:167], v[144:147]
ds_read_b64_tr_b16 v[242:243], v218 offset:28672
v_mfma_f32_16x16x32_bf16 v[148:151], v[220:223], a[168:171], v[148:151]
s_add_u32 m0, s37, 52224
v_mfma_f32_16x16x32_bf16 v[148:151], v[224:227], a[184:187], v[148:151]
buffer_load_dwordx4 v211, s[4:7], s38 offen lds
s_add_u32 s38, s38, 524288
v_mfma_f32_16x16x32_bf16 v[152:155], v[224:227], a[188:191], v[152:155]
v_mfma_f32_16x16x32_bf16 v[152:155], v[220:223], a[172:175], v[152:155]
s_waitcnt lgkmcnt(4)
v_mfma_f32_16x16x32_bf16 v[168:171], v[228:231], a[172:175], v[168:171]
ds_read_b64_tr_b16 v[244:245], v219 offset:16384
v_mfma_f32_16x16x32_bf16 v[168:171], v[232:235], a[188:191], v[168:171]
ds_read_b64_tr_b16 v[246:247], v219 offset:20480
v_mfma_f32_16x16x32_bf16 v[164:167], v[232:235], a[184:187], v[164:167]
ds_read_b64_tr_b16 v[248:249], v219 offset:24576
v_mfma_f32_16x16x32_bf16 v[164:167], v[228:231], a[168:171], v[164:167]
ds_read_b64_tr_b16 v[250:251], v219 offset:28672
v_mfma_f32_16x16x32_bf16 v[160:163], v[228:231], a[164:167], v[160:163]
s_add_u32 m0, s43, 4096
v_mfma_f32_16x16x32_bf16 v[160:163], v[232:235], a[180:183], v[160:163]
buffer_load_dwordx4 v2, s[8:11], s42 offen offset:1024 lds
v_mfma_f32_16x16x32_bf16 v[156:159], v[232:235], a[176:179], v[156:159]
v_mfma_f32_16x16x32_bf16 v[156:159], v[228:231], a[160:163], v[156:159]
s_waitcnt lgkmcnt(4)
v_mfma_f32_16x16x32_bf16 v[172:175], v[236:239], a[160:163], v[172:175]
s_waitcnt vmcnt(13)
s_barrier
ds_read_b64_tr_b16 v[220:221], v212 offset:32768
v_mfma_f32_16x16x32_bf16 v[172:175], v[240:243], a[176:179], v[172:175]
ds_read_b64_tr_b16 v[222:223], v212 offset:36864
v_mfma_f32_16x16x32_bf16 v[176:179], v[240:243], a[180:183], v[176:179]
ds_read_b64_tr_b16 v[224:225], v212 offset:40960
v_mfma_f32_16x16x32_bf16 v[176:179], v[236:239], a[164:167], v[176:179]
ds_read_b64_tr_b16 v[226:227], v212 offset:45056
v_mfma_f32_16x16x32_bf16 v[180:183], v[236:239], a[168:171], v[180:183]
s_add_u32 m0, s43, 4096
v_mfma_f32_16x16x32_bf16 v[180:183], v[240:243], a[184:187], v[180:183]
buffer_load_dwordx4 v2, s[8:11], s42 offen offset:2048 lds
v_mfma_f32_16x16x32_bf16 v[184:187], v[240:243], a[188:191], v[184:187]
v_mfma_f32_16x16x32_bf16 v[184:187], v[236:239], a[172:175], v[184:187]
s_waitcnt lgkmcnt(4)
v_mfma_f32_16x16x32_bf16 v[200:203], v[244:247], a[172:175], v[200:203]
ds_read_b64_tr_b16 v[228:229], v213 offset:32768
v_mfma_f32_16x16x32_bf16 v[200:203], v[248:251], a[188:191], v[200:203]
ds_read_b64_tr_b16 v[230:231], v213 offset:36864
v_mfma_f32_16x16x32_bf16 v[196:199], v[248:251], a[184:187], v[196:199]
ds_read_b64_tr_b16 v[232:233], v213 offset:40960
v_mfma_f32_16x16x32_bf16 v[196:199], v[244:247], a[168:171], v[196:199]
ds_read_b64_tr_b16 v[234:235], v213 offset:45056
v_mfma_f32_16x16x32_bf16 v[192:195], v[244:247], a[164:167], v[192:195]
s_add_u32 m0, s43, 4096
v_mfma_f32_16x16x32_bf16 v[192:195], v[248:251], a[180:183], v[192:195]
buffer_load_dwordx4 v2, s[8:11], s42 offen offset:3072 lds
s_add_u32 s41, s41, 16384
s_add_u32 s43, s43, 32768
s_and_b32 s43, s43, 0x1ffff
v_mfma_f32_16x16x32_bf16 v[188:191], v[248:251], a[176:179], v[188:191]
v_mfma_f32_16x16x32_bf16 v[188:191], v[244:247], a[160:163], v[188:191]
s_waitcnt lgkmcnt(4)
v_mfma_f32_16x16x32_bf16 v[76:79], v[220:223], a[192:195], v[76:79]
ds_read_b64_tr_b16 v[236:237], v214 offset:32768
v_mfma_f32_16x16x32_bf16 v[76:79], v[224:227], a[208:211], v[76:79]
ds_read_b64_tr_b16 v[238:239], v214 offset:36864
v_mfma_f32_16x16x32_bf16 v[80:83], v[224:227], a[212:215], v[80:83]
ds_read_b64_tr_b16 v[240:241], v214 offset:40960
v_mfma_f32_16x16x32_bf16 v[80:83], v[220:223], a[196:199], v[80:83]
ds_read_b64_tr_b16 v[242:243], v214 offset:45056
v_mfma_f32_16x16x32_bf16 v[84:87], v[220:223], a[200:203], v[84:87]
s_add_u32 m0, s43, 0
v_mfma_f32_16x16x32_bf16 v[84:87], v[224:227], a[216:219], v[84:87]
buffer_load_dwordx4 v2, s[8:11], s41 offen offset:0 lds
v_mfma_f32_16x16x32_bf16 v[88:91], v[224:227], a[220:223], v[88:91]
v_mfma_f32_16x16x32_bf16 v[88:91], v[220:223], a[204:207], v[88:91]
s_waitcnt lgkmcnt(4)
v_mfma_f32_16x16x32_bf16 v[104:107], v[228:231], a[204:207], v[104:107]
ds_read_b64_tr_b16 v[244:245], v215 offset:32768
v_mfma_f32_16x16x32_bf16 v[104:107], v[232:235], a[220:223], v[104:107]
ds_read_b64_tr_b16 v[246:247], v215 offset:36864
v_mfma_f32_16x16x32_bf16 v[100:103], v[232:235], a[216:219], v[100:103]
ds_read_b64_tr_b16 v[248:249], v215 offset:40960
v_mfma_f32_16x16x32_bf16 v[100:103], v[228:231], a[200:203], v[100:103]
ds_read_b64_tr_b16 v[250:251], v215 offset:45056
v_mfma_f32_16x16x32_bf16 v[96:99], v[228:231], a[196:199], v[96:99]
s_add_u32 m0, s43, 0
v_mfma_f32_16x16x32_bf16 v[96:99], v[232:235], a[212:215], v[96:99]
buffer_load_dwordx4 v2, s[8:11], s41 offen offset:1024 lds
v_mfma_f32_16x16x32_bf16 v[92:95], v[232:235], a[208:211], v[92:95]
v_mfma_f32_16x16x32_bf16 v[92:95], v[228:231], a[192:195], v[92:95]
s_waitcnt lgkmcnt(4)
v_mfma_f32_16x16x32_bf16 v[108:111], v[236:239], a[192:195], v[108:111]
ds_read_b64_tr_b16 v[220:221], v216 offset:32768
v_mfma_f32_16x16x32_bf16 v[108:111], v[240:243], a[208:211], v[108:111]
ds_read_b64_tr_b16 v[222:223], v216 offset:36864
v_mfma_f32_16x16x32_bf16 v[112:115], v[240:243], a[212:215], v[112:115]
ds_read_b64_tr_b16 v[224:225], v216 offset:40960
v_mfma_f32_16x16x32_bf16 v[112:115], v[236:239], a[196:199], v[112:115]
ds_read_b64_tr_b16 v[226:227], v216 offset:45056
v_mfma_f32_16x16x32_bf16 v[116:119], v[236:239], a[200:203], v[116:119]
s_add_u32 m0, s43, 0
v_mfma_f32_16x16x32_bf16 v[116:119], v[240:243], a[216:219], v[116:119]
buffer_load_dwordx4 v2, s[8:11], s41 offen offset:2048 lds
v_mfma_f32_16x16x32_bf16 v[120:123], v[240:243], a[220:223], v[120:123]
v_mfma_f32_16x16x32_bf16 v[120:123], v[236:239], a[204:207], v[120:123]
s_waitcnt lgkmcnt(4)
v_mfma_f32_16x16x32_bf16 v[136:139], v[244:247], a[204:207], v[136:139]
ds_read_b64_tr_b16 v[228:229], v217 offset:32768
v_mfma_f32_16x16x32_bf16 v[136:139], v[248:251], a[220:223], v[136:139]
ds_read_b64_tr_b16 v[230:231], v217 offset:36864
v_mfma_f32_16x16x32_bf16 v[132:135], v[248:251], a[216:219], v[132:135]
ds_read_b64_tr_b16 v[232:233], v217 offset:40960
v_mfma_f32_16x16x32_bf16 v[132:135], v[244:247], a[200:203], v[132:135]
ds_read_b64_tr_b16 v[234:235], v217 offset:45056
v_mfma_f32_16x16x32_bf16 v[128:131], v[244:247], a[196:199], v[128:131]
s_add_u32 m0, s43, 0
v_mfma_f32_16x16x32_bf16 v[128:131], v[248:251], a[212:215], v[128:131]
buffer_load_dwordx4 v2, s[8:11], s41 offen offset:3072 lds
v_mfma_f32_16x16x32_bf16 v[124:127], v[248:251], a[208:211], v[124:127]
v_mfma_f32_16x16x32_bf16 v[124:127], v[244:247], a[192:195], v[124:127]
s_waitcnt lgkmcnt(4)
v_mfma_f32_16x16x32_bf16 v[140:143], v[220:223], a[192:195], v[140:143]
ds_read_b64_tr_b16 v[236:237], v218 offset:32768
v_mfma_f32_16x16x32_bf16 v[140:143], v[224:227], a[208:211], v[140:143]
ds_read_b64_tr_b16 v[238:239], v218 offset:36864
v_mfma_f32_16x16x32_bf16 v[144:147], v[224:227], a[212:215], v[144:147]
ds_read_b64_tr_b16 v[240:241], v218 offset:40960
v_mfma_f32_16x16x32_bf16 v[144:147], v[220:223], a[196:199], v[144:147]
s_add_u32 s42, s41, 4096
ds_read_b64_tr_b16 v[242:243], v218 offset:45056
v_mfma_f32_16x16x32_bf16 v[148:151], v[220:223], a[200:203], v[148:151]
s_add_u32 m0, s43, 4096
v_mfma_f32_16x16x32_bf16 v[148:151], v[224:227], a[216:219], v[148:151]
buffer_load_dwordx4 v2, s[8:11], s42 offen offset:0 lds
v_mfma_f32_16x16x32_bf16 v[152:155], v[224:227], a[220:223], v[152:155]
v_mfma_f32_16x16x32_bf16 v[152:155], v[220:223], a[204:207], v[152:155]
s_waitcnt lgkmcnt(4)
v_mfma_f32_16x16x32_bf16 v[168:171], v[228:231], a[204:207], v[168:171]
ds_read_b64_tr_b16 v[244:245], v219 offset:32768
v_mfma_f32_16x16x32_bf16 v[168:171], v[232:235], a[220:223], v[168:171]
ds_read_b64_tr_b16 v[246:247], v219 offset:36864
v_mfma_f32_16x16x32_bf16 v[164:167], v[232:235], a[216:219], v[164:167]
ds_read_b64_tr_b16 v[248:249], v219 offset:40960
v_mfma_f32_16x16x32_bf16 v[164:167], v[228:231], a[200:203], v[164:167]
ds_read_b64_tr_b16 v[250:251], v219 offset:45056
v_mfma_f32_16x16x32_bf16 v[160:163], v[228:231], a[196:199], v[160:163]
s_add_u32 m0, s43, 4096
v_mfma_f32_16x16x32_bf16 v[160:163], v[232:235], a[212:215], v[160:163]
buffer_load_dwordx4 v2, s[8:11], s42 offen offset:1024 lds
v_mfma_f32_16x16x32_bf16 v[156:159], v[232:235], a[208:211], v[156:159]
v_mfma_f32_16x16x32_bf16 v[156:159], v[228:231], a[192:195], v[156:159]
s_waitcnt lgkmcnt(4)
v_mfma_f32_16x16x32_bf16 v[172:175], v[236:239], a[192:195], v[172:175]
s_waitcnt vmcnt(9)
s_barrier
ds_read_b64_tr_b16 v[220:221], v212 offset:49152
v_mfma_f32_16x16x32_bf16 v[172:175], v[240:243], a[208:211], v[172:175]
ds_read_b64_tr_b16 v[222:223], v212 offset:53248
v_mfma_f32_16x16x32_bf16 v[176:179], v[240:243], a[212:215], v[176:179]
ds_read_b64_tr_b16 v[224:225], v212 offset:57344
v_mfma_f32_16x16x32_bf16 v[176:179], v[236:239], a[196:199], v[176:179]
ds_read_b64_tr_b16 v[226:227], v212 offset:61440
v_mfma_f32_16x16x32_bf16 v[180:183], v[236:239], a[200:203], v[180:183]
s_add_u32 m0, s43, 4096
v_mfma_f32_16x16x32_bf16 v[180:183], v[240:243], a[216:219], v[180:183]
buffer_load_dwordx4 v2, s[8:11], s42 offen offset:2048 lds
v_mfma_f32_16x16x32_bf16 v[184:187], v[240:243], a[220:223], v[184:187]
v_mfma_f32_16x16x32_bf16 v[184:187], v[236:239], a[204:207], v[184:187]
s_waitcnt lgkmcnt(4)
v_mfma_f32_16x16x32_bf16 v[200:203], v[244:247], a[204:207], v[200:203]
ds_read_b64_tr_b16 v[228:229], v213 offset:49152
v_mfma_f32_16x16x32_bf16 v[200:203], v[248:251], a[220:223], v[200:203]
ds_read_b64_tr_b16 v[230:231], v213 offset:53248
v_mfma_f32_16x16x32_bf16 v[196:199], v[248:251], a[216:219], v[196:199]
ds_read_b64_tr_b16 v[232:233], v213 offset:57344
v_mfma_f32_16x16x32_bf16 v[196:199], v[244:247], a[200:203], v[196:199]
ds_read_b64_tr_b16 v[234:235], v213 offset:61440
v_mfma_f32_16x16x32_bf16 v[192:195], v[244:247], a[196:199], v[192:195]
s_add_u32 m0, s43, 4096
v_mfma_f32_16x16x32_bf16 v[192:195], v[248:251], a[212:215], v[192:195]
buffer_load_dwordx4 v2, s[8:11], s42 offen offset:3072 lds
s_add_u32 s41, s41, 16384
s_add_u32 s43, s43, 32768
s_and_b32 s43, s43, 0x1ffff
v_mfma_f32_16x16x32_bf16 v[188:191], v[248:251], a[208:211], v[188:191]
v_mfma_f32_16x16x32_bf16 v[188:191], v[244:247], a[192:195], v[188:191]
s_waitcnt lgkmcnt(4)
v_mfma_f32_16x16x32_bf16 v[76:79], v[220:223], a[224:227], v[76:79]
ds_read_b64_tr_b16 v[236:237], v214 offset:49152
v_mfma_f32_16x16x32_bf16 v[76:79], v[224:227], a[240:243], v[76:79]
ds_read_b64_tr_b16 v[238:239], v214 offset:53248
v_mfma_f32_16x16x32_bf16 v[80:83], v[224:227], a[244:247], v[80:83]
ds_read_b64_tr_b16 v[240:241], v214 offset:57344
v_mfma_f32_16x16x32_bf16 v[80:83], v[220:223], a[228:231], v[80:83]
ds_read_b64_tr_b16 v[242:243], v214 offset:61440
v_mfma_f32_16x16x32_bf16 v[84:87], v[220:223], a[232:235], v[84:87]
v_mfma_f32_16x16x32_bf16 v[84:87], v[224:227], a[248:251], v[84:87]
v_mfma_f32_16x16x32_bf16 v[88:91], v[224:227], a[252:255], v[88:91]
v_mfma_f32_16x16x32_bf16 v[88:91], v[220:223], a[236:239], v[88:91]
s_waitcnt lgkmcnt(4)
v_mfma_f32_16x16x32_bf16 v[104:107], v[228:231], a[236:239], v[104:107]
ds_read_b64_tr_b16 v[244:245], v215 offset:49152
v_mfma_f32_16x16x32_bf16 v[104:107], v[232:235], a[252:255], v[104:107]
ds_read_b64_tr_b16 v[246:247], v215 offset:53248
v_mfma_f32_16x16x32_bf16 v[100:103], v[232:235], a[248:251], v[100:103]
ds_read_b64_tr_b16 v[248:249], v215 offset:57344
v_mfma_f32_16x16x32_bf16 v[100:103], v[228:231], a[232:235], v[100:103]
ds_read_b64_tr_b16 v[250:251], v215 offset:61440
v_mfma_f32_16x16x32_bf16 v[96:99], v[228:231], a[228:231], v[96:99]
v_mfma_f32_16x16x32_bf16 v[96:99], v[232:235], a[244:247], v[96:99]
v_mfma_f32_16x16x32_bf16 v[92:95], v[232:235], a[240:243], v[92:95]
v_mfma_f32_16x16x32_bf16 v[92:95], v[228:231], a[224:227], v[92:95]
s_waitcnt lgkmcnt(4)
v_mfma_f32_16x16x32_bf16 v[108:111], v[236:239], a[224:227], v[108:111]
ds_read_b64_tr_b16 v[220:221], v216 offset:49152
v_mfma_f32_16x16x32_bf16 v[108:111], v[240:243], a[240:243], v[108:111]
ds_read_b64_tr_b16 v[222:223], v216 offset:53248
v_mfma_f32_16x16x32_bf16 v[112:115], v[240:243], a[244:247], v[112:115]
ds_read_b64_tr_b16 v[224:225], v216 offset:57344
v_mfma_f32_16x16x32_bf16 v[112:115], v[236:239], a[228:231], v[112:115]
ds_read_b64_tr_b16 v[226:227], v216 offset:61440
v_mfma_f32_16x16x32_bf16 v[116:119], v[236:239], a[232:235], v[116:119]
v_mfma_f32_16x16x32_bf16 v[116:119], v[240:243], a[248:251], v[116:119]
v_mfma_f32_16x16x32_bf16 v[120:123], v[240:243], a[252:255], v[120:123]
v_mfma_f32_16x16x32_bf16 v[120:123], v[236:239], a[236:239], v[120:123]
s_waitcnt lgkmcnt(4)
v_mfma_f32_16x16x32_bf16 v[136:139], v[244:247], a[236:239], v[136:139]
ds_read_b64_tr_b16 v[228:229], v217 offset:49152
v_mfma_f32_16x16x32_bf16 v[136:139], v[248:251], a[252:255], v[136:139]
ds_read_b64_tr_b16 v[230:231], v217 offset:53248
v_mfma_f32_16x16x32_bf16 v[132:135], v[248:251], a[248:251], v[132:135]
ds_read_b64_tr_b16 v[232:233], v217 offset:57344
v_mfma_f32_16x16x32_bf16 v[132:135], v[244:247], a[232:235], v[132:135]
ds_read_b64_tr_b16 v[234:235], v217 offset:61440
v_mfma_f32_16x16x32_bf16 v[128:131], v[244:247], a[228:231], v[128:131]
v_mfma_f32_16x16x32_bf16 v[128:131], v[248:251], a[244:247], v[128:131]
v_mfma_f32_16x16x32_bf16 v[124:127], v[248:251], a[240:243], v[124:127]
v_mfma_f32_16x16x32_bf16 v[124:127], v[244:247], a[224:227], v[124:127]
s_waitcnt lgkmcnt(4)
v_mfma_f32_16x16x32_bf16 v[140:143], v[220:223], a[224:227], v[140:143]
ds_read_b64_tr_b16 v[236:237], v218 offset:49152
v_mfma_f32_16x16x32_bf16 v[140:143], v[224:227], a[240:243], v[140:143]
ds_read_b64_tr_b16 v[238:239], v218 offset:53248
v_mfma_f32_16x16x32_bf16 v[144:147], v[224:227], a[244:247], v[144:147]
ds_read_b64_tr_b16 v[240:241], v218 offset:57344
v_mfma_f32_16x16x32_bf16 v[144:147], v[220:223], a[228:231], v[144:147]
ds_read_b64_tr_b16 v[242:243], v218 offset:61440
v_mfma_f32_16x16x32_bf16 v[148:151], v[220:223], a[232:235], v[148:151]
v_mfma_f32_16x16x32_bf16 v[148:151], v[224:227], a[248:251], v[148:151]
v_mfma_f32_16x16x32_bf16 v[152:155], v[224:227], a[252:255], v[152:155]
v_mfma_f32_16x16x32_bf16 v[152:155], v[220:223], a[236:239], v[152:155]
s_waitcnt lgkmcnt(4)
v_mfma_f32_16x16x32_bf16 v[168:171], v[228:231], a[236:239], v[168:171]
ds_read_b64_tr_b16 v[244:245], v219 offset:49152
v_mfma_f32_16x16x32_bf16 v[168:171], v[232:235], a[252:255], v[168:171]
ds_read_b64_tr_b16 v[246:247], v219 offset:53248
v_mfma_f32_16x16x32_bf16 v[164:167], v[232:235], a[248:251], v[164:167]
ds_read_b64_tr_b16 v[248:249], v219 offset:57344
v_mfma_f32_16x16x32_bf16 v[164:167], v[228:231], a[232:235], v[164:167]
ds_read_b64_tr_b16 v[250:251], v219 offset:61440
v_mfma_f32_16x16x32_bf16 v[160:163], v[228:231], a[228:231], v[160:163]
v_mfma_f32_16x16x32_bf16 v[160:163], v[232:235], a[244:247], v[160:163]
v_mfma_f32_16x16x32_bf16 v[156:159], v[232:235], a[240:243], v[156:159]
v_mfma_f32_16x16x32_bf16 v[156:159], v[228:231], a[224:227], v[156:159]
s_waitcnt lgkmcnt(4)
v_mfma_f32_16x16x32_bf16 v[172:175], v[236:239], a[224:227], v[172:175]
v_mfma_f32_16x16x32_bf16 v[172:175], v[240:243], a[240:243], v[172:175]
v_mfma_f32_16x16x32_bf16 v[176:179], v[240:243], a[244:247], v[176:179]
v_mfma_f32_16x16x32_bf16 v[176:179], v[236:239], a[228:231], v[176:179]
v_mfma_f32_16x16x32_bf16 v[180:183], v[236:239], a[232:235], v[180:183]
v_mfma_f32_16x16x32_bf16 v[180:183], v[240:243], a[248:251], v[180:183]
v_mfma_f32_16x16x32_bf16 v[184:187], v[240:243], a[252:255], v[184:187]
v_mfma_f32_16x16x32_bf16 v[184:187], v[236:239], a[236:239], v[184:187]
s_waitcnt lgkmcnt(0)
v_mfma_f32_16x16x32_bf16 v[200:203], v[244:247], a[236:239], v[200:203]
v_mfma_f32_16x16x32_bf16 v[200:203], v[248:251], a[252:255], v[200:203]
v_mfma_f32_16x16x32_bf16 v[196:199], v[248:251], a[248:251], v[196:199]
v_mfma_f32_16x16x32_bf16 v[196:199], v[244:247], a[232:235], v[196:199]
v_mfma_f32_16x16x32_bf16 v[192:195], v[244:247], a[228:231], v[192:195]
v_mfma_f32_16x16x32_bf16 v[192:195], v[248:251], a[244:247], v[192:195]
v_mfma_f32_16x16x32_bf16 v[188:191], v[248:251], a[240:243], v[188:191]
v_mfma_f32_16x16x32_bf16 v[188:191], v[244:247], a[224:227], v[188:191]
s_nop 7
v_cvt_pk_bf16_f32 v12, v76, v77
v_cvt_pk_bf16_f32 v13, v78, v79
v_cvt_pk_bf16_f32 v14, v92, v93
v_cvt_pk_bf16_f32 v15, v94, v95
v_cvt_pk_bf16_f32 v16, v108, v109
v_cvt_pk_bf16_f32 v17, v110, v111
v_cvt_pk_bf16_f32 v18, v124, v125
v_cvt_pk_bf16_f32 v19, v126, v127
v_cvt_pk_bf16_f32 v20, v140, v141
v_cvt_pk_bf16_f32 v21, v142, v143
v_cvt_pk_bf16_f32 v22, v156, v157
v_cvt_pk_bf16_f32 v23, v158, v159
v_cvt_pk_bf16_f32 v24, v172, v173
v_cvt_pk_bf16_f32 v25, v174, v175
v_cvt_pk_bf16_f32 v26, v188, v189
v_cvt_pk_bf16_f32 v27, v190, v191
v_cvt_pk_bf16_f32 v28, v80, v81
v_cvt_pk_bf16_f32 v29, v82, v83
v_cvt_pk_bf16_f32 v30, v96, v97
v_cvt_pk_bf16_f32 v31, v98, v99
v_cvt_pk_bf16_f32 v32, v112, v113
v_cvt_pk_bf16_f32 v33, v114, v115
v_cvt_pk_bf16_f32 v34, v128, v129
v_cvt_pk_bf16_f32 v35, v130, v131
v_cvt_pk_bf16_f32 v36, v144, v145
v_cvt_pk_bf16_f32 v37, v146, v147
v_cvt_pk_bf16_f32 v38, v160, v161
v_cvt_pk_bf16_f32 v39, v162, v163
v_cvt_pk_bf16_f32 v40, v176, v177
v_cvt_pk_bf16_f32 v41, v178, v179
v_cvt_pk_bf16_f32 v42, v192, v193
v_cvt_pk_bf16_f32 v43, v194, v195
v_cvt_pk_bf16_f32 v44, v84, v85
v_cvt_pk_bf16_f32 v45, v86, v87
v_cvt_pk_bf16_f32 v46, v100, v101
v_cvt_pk_bf16_f32 v47, v102, v103
v_cvt_pk_bf16_f32 v48, v116, v117
v_cvt_pk_bf16_f32 v49, v118, v119
v_cvt_pk_bf16_f32 v50, v132, v133
v_cvt_pk_bf16_f32 v51, v134, v135
v_cvt_pk_bf16_f32 v52, v148, v149
v_cvt_pk_bf16_f32 v53, v150, v151
v_cvt_pk_bf16_f32 v54, v164, v165
v_cvt_pk_bf16_f32 v55, v166, v167
v_cvt_pk_bf16_f32 v56, v180, v181
v_cvt_pk_bf16_f32 v57, v182, v183
v_cvt_pk_bf16_f32 v58, v196, v197
v_cvt_pk_bf16_f32 v59, v198, v199
v_cvt_pk_bf16_f32 v60, v88, v89
v_cvt_pk_bf16_f32 v61, v90, v91
v_cvt_pk_bf16_f32 v62, v104, v105
v_cvt_pk_bf16_f32 v63, v106, v107
v_cvt_pk_bf16_f32 v64, v120, v121
v_cvt_pk_bf16_f32 v65, v122, v123
v_cvt_pk_bf16_f32 v66, v136, v137
v_cvt_pk_bf16_f32 v67, v138, v139
v_cvt_pk_bf16_f32 v68, v152, v153
v_cvt_pk_bf16_f32 v69, v154, v155
v_cvt_pk_bf16_f32 v70, v168, v169
v_cvt_pk_bf16_f32 v71, v170, v171
v_cvt_pk_bf16_f32 v72, v184, v185
v_cvt_pk_bf16_f32 v73, v186, v187
v_cvt_pk_bf16_f32 v74, v200, v201
v_cvt_pk_bf16_f32 v75, v202, v203
v_lshrrev_b32 v208, 1, v1
v_lshlrev_b32 v208, 7, v208
s_and_b32 s19, s19, 0xffff
s_and_b32 s21, s21, 0xffff
s_and_b32 s23, s23, 0xffff
s_mov_b32 s56, 7340032
s_mov_b32 s57, 7340032
s_mov_b32 s58, 7340032
v_max_u32 v4, v4, v5
s_nop 1
v_max_u32_dpp v4, v4, v4 row_ror:8 row_mask:0xf bank_mask:0xf
s_nop 1
v_max_u32_dpp v4, v4, v4 row_ror:4 row_mask:0xf bank_mask:0xf
s_nop 1
v_max_u32_dpp v4, v4, v4 row_ror:2 row_mask:0xf bank_mask:0xf
s_nop 1
v_max_u32_dpp v4, v4, v4 row_ror:1 row_mask:0xf bank_mask:0xf
v_mov_b32 v6, v4
s_nop 1
v_permlane32_swap_b32 v4, v6
v_max_u32 v4, v4, v6
v_mov_b32 v6, v4
s_nop 1
v_permlane16_swap_b32 v4, v6
v_max_u32 v4, v4, v6
v_lshrrev_b32 v4, 7, v4
v_subrev_u32 v4, 25, v4
v_max_i32 v4, 0, v4
v_min_i32 v4, 100, v4
v_cvt_f32_i32 v4, v4
s_nop 0
v_readfirstlane_b32 s48, v4
v_mov_b32 v188, 0
v_mov_b32 v189, 0
v_mov_b32 v190, 0
v_mov_b32 v191, 0
v_mov_b32 v200, 0x3f803f80
v_accvgpr_write_b32 a180, v200
v_accvgpr_write_b32 a176, 0
v_accvgpr_write_b32 a181, v200
v_accvgpr_write_b32 a177, 0
v_accvgpr_write_b32 a182, v200
v_accvgpr_write_b32 a178, 0
v_accvgpr_write_b32 a183, v200
v_accvgpr_write_b32 a179, 0
L_at_go:
v_mov_b32 v196, v2
s_mov_b32 s44, 0
s_waitcnt vmcnt(8)
s_barrier
ds_read_b128 a[128:131], v196 offset:0
ds_read_b128 a[132:135], v196 offset:1024
ds_read_b128 a[136:139], v196 offset:2048
ds_read_b128 a[140:143], v196 offset:3072
s_waitcnt lgkmcnt(0)
v_mfma_f32_16x16x32_bf16 v[76:79], a[128:131], v[12:15], 0
v_mfma_f32_16x16x32_bf16 v[76:79], a[132:135], v[16:19], v[76:79]
v_mfma_f32_16x16x32_bf16 v[76:79], a[136:139], v[20:23], v[76:79]
v_mfma_f32_16x16x32_bf16 v[76:79], a[140:143], v[24:27], v[76:79]
v_mfma_f32_16x16x32_bf16 v[80:83], a[128:131], v[28:31], 0
v_mfma_f32_16x16x32_bf16 v[80:83], a[132:135], v[32:35], v[80:83]
v_mfma_f32_16x16x32_bf16 v[80:83], a[136:139], v[36:39], v[80:83]
v_mfma_f32_16x16x32_bf16 v[80:83], a[140:143], v[40:43], v[80:83]
v_mfma_f32_16x16x32_bf16 v[84:87], a[128:131], v[44:47], 0
v_mfma_f32_16x16x32_bf16 v[84:87], a[132:135], v[48:51], v[84:87]
v_mfma_f32_16x16x32_bf16 v[84:87], a[136:139], v[52:55], v[84:87]
v_mfma_f32_16x16x32_bf16 v[84:87], a[140:143], v[56:59], v[84:87]
v_mfma_f32_16x16x32_bf16 v[88:91], a[128:131], v[60:63], 0
ds_read_b128 a[144:147], v196 offset:4096
v_mfma_f32_16x16x32_bf16 v[88:91], a[132:135], v[64:67], v[88:91]
v_mfma_f32_16x16x32_bf16 v[88:91], a[136:139], v[68:71], v[88:91]
v_mfma_f32_16x16x32_bf16 v[88:91], a[140:143], v[72:75], v[88:91]
s_nop 0
ds_read_b128 a[148:151], v196 offset:5120
s_nop 0
ds_read_b128 a[152:155], v196 offset:6144
s_nop 0
ds_read_b128 a[156:159], v196 offset:7168
s_waitcnt lgkmcnt(0)
v_mfma_f32_16x16x32_bf16 v[92:95], a[144:147], v[12:15], 0
v_mfma_f32_16x16x32_bf16 v[92:95], a[148:151], v[16:19], v[92:95]
v_mfma_f32_16x16x32_bf16 v[92:95], a[152:155], v[20:23], v[92:95]
v_mfma_f32_16x16x32_bf16 v[92:95], a[156:159], v[24:27], v[92:95]
v_mfma_f32_16x16x32_bf16 v[96:99], a[144:147], v[28:31], 0
v_mfma_f32_16x16x32_bf16 v[96:99], a[148:151], v[32:35], v[96:99]
v_mfma_f32_16x16x32_bf16 v[96:99], a[152:155], v[36:39], v[96:99]
v_mfma_f32_16x16x32_bf16 v[96:99], a[156:159], v[40:43], v[96:99]
v_mfma_f32_16x16x32_bf16 v[100:103], a[144:147], v[44:47], 0
v_mfma_f32_16x16x32_bf16 v[100:103], a[148:151], v[48:51], v[100:103]
v_mfma_f32_16x16x32_bf16 v[100:103], a[152:155], v[52:55], v[100:103]
v_mfma_f32_16x16x32_bf16 v[100:103], a[156:159], v[56:59], v[100:103]
v_mfma_f32_16x16x32_bf16 v[104:107], a[144:147], v[60:63], 0
ds_read_b128 a[128:131], v196 offset:8192
v_mfma_f32_16x16x32_bf16 v[104:107], a[148:151], v[64:67], v[104:107]
v_mfma_f32_16x16x32_bf16 v[104:107], a[152:155], v[68:71], v[104:107]
v_mfma_f32_16x16x32_bf16 v[104:107], a[156:159], v[72:75], v[104:107]
s_nop 0
ds_read_b128 a[132:135], v196 offset:9216
s_nop 0
ds_read_b128 a[136:139], v196 offset:10240
s_nop 0
ds_read_b128 a[140:143], v196 offset:11264
s_waitcnt lgkmcnt(0)
s_nop 7
s_cmp_lg_u32 s45, 0
s_cbranch_scc1 L_at_havemax
v_max3_f32 v192, v76, v77, v78
v_max3_f32 v192, v192, v79, v92
v_max3_f32 v192, v192, v93, v94
v_max_f32 v192, v192, v95
v_max3_f32 v193, v80, v81, v82
v_max3_f32 v193, v193, v83, v96
v_max3_f32 v193, v193, v97, v98
v_max_f32 v193, v193, v99
v_max3_f32 v194, v84, v85, v86
v_max3_f32 v194, v194, v87, v100
v_max3_f32 v194, v194, v101, v102
v_max_f32 v194, v194, v103
v_max3_f32 v195, v88, v89, v90
v_max3_f32 v195, v195, v91, v104
v_max3_f32 v195, v195, v105, v106
v_max_f32 v195, v195, v107
v_mov_b32 v200, v192
s_nop 1
v_permlane32_swap_b32 v192, v200
v_max_f32 v192, v192, v200
v_mov_b32 v200, v192
s_nop 1
v_permlane16_swap_b32 v192, v200
v_max_f32 v192, v192, v200
v_mov_b32 v200, v193
s_nop 1
v_permlane32_swap_b32 v193, v200
v_max_f32 v193, v193, v200
v_mov_b32 v200, v193
s_nop 1
v_permlane16_swap_b32 v193, v200
v_max_f32 v193, v193, v200
v_mov_b32 v200, v194
s_nop 1
v_permlane32_swap_b32 v194, v200
v_max_f32 v194, v194, v200
v_mov_b32 v200, v194
s_nop 1
v_permlane16_swap_b32 v194, v200
v_max_f32 v194, v194, v200
v_mov_b32 v200, v195
s_nop 1
v_permlane32_swap_b32 v195, v200
v_max_f32 v195, v195, v200
v_mov_b32 v200, v195
s_nop 1
v_permlane16_swap_b32 v195, v200
v_max_f32 v195, v195, v200
v_add_f32 v192, s48, v192
v_sub_f32 v172, 0, v192
v_sub_f32 v173, 0, v192
v_sub_f32 v174, 0, v192
v_sub_f32 v175, 0, v192
v_add_f32 v193, s48, v193
v_sub_f32 v176, 0, v193
v_sub_f32 v177, 0, v193
v_sub_f32 v178, 0, v193
v_sub_f32 v179, 0, v193
v_add_f32 v194, s48, v194
v_sub_f32 v180, 0, v194
v_sub_f32 v181, 0, v194
v_sub_f32 v182, 0, v194
v_sub_f32 v183, 0, v194
v_add_f32 v195, s48, v195
v_sub_f32 v184, 0, v195
v_sub_f32 v185, 0, v195
v_sub_f32 v186, 0, v195
v_sub_f32 v187, 0, v195
L_at_havemax:
v_add_f32 v76, v76, v172
v_add_f32 v77, v77, v173
v_add_f32 v78, v78, v174
v_add_f32 v79, v79, v175
v_add_f32 v80, v80, v176
v_add_f32 v81, v81, v177
v_add_f32 v82, v82, v178
v_add_f32 v83, v83, v179
v_add_f32 v84, v84, v180
v_add_f32 v85, v85, v181
v_add_f32 v86, v86, v182
v_add_f32 v87, v87, v183
v_add_f32 v88, v88, v184
v_add_f32 v89, v89, v185
v_add_f32 v90, v90, v186
v_add_f32 v91, v91, v187
v_add_f32 v92, v92, v172
v_add_f32 v93, v93, v173
v_add_f32 v94, v94, v174
v_add_f32 v95, v95, v175
v_add_f32 v96, v96, v176
v_add_f32 v97, v97, v177
v_add_f32 v98, v98, v178
v_add_f32 v99, v99, v179
v_add_f32 v100, v100, v180
v_add_f32 v101, v101, v181
v_add_f32 v102, v102, v182
v_add_f32 v103, v103, v183
v_add_f32 v104, v104, v184
v_add_f32 v105, v105, v185
v_add_f32 v106, v106, v186
v_add_f32 v107, v107, v187
v_mfma_f32_16x16x32_bf16 v[108:111], a[128:131], v[12:15], v[172:175]
s_mov_b32 m0, s43
v_mfma_f32_16x16x32_bf16 v[108:111], a[132:135], v[16:19], v[108:111]
v_exp_f32 v76, v76
v_mfma_f32_16x16x32_bf16 v[108:111], a[136:139], v[20:23], v[108:111]
buffer_load_dwordx4 v2, s[8:11], s41 offen offset:0 lds
v_mfma_f32_16x16x32_bf16 v[108:111], a[140:143], v[24:27], v[108:111]
v_exp_f32 v77, v77
v_mfma_f32_16x16x32_bf16 v[112:115], a[128:131], v[28:31], v[176:179]
v_add_f32 v188, v188, v76
v_mfma_f32_16x16x32_bf16 v[112:115], a[132:135], v[32:35], v[112:115]
v_exp_f32 v88, v88
v_mfma_f32_16x16x32_bf16 v[112:115], a[136:139], v[36:39], v[112:115]
v_add_f32 v188, v188, v77
v_cvt_pk_bf16_f32 v140, v76, v77
v_mfma_f32_16x16x32_bf16 v[112:115], a[140:143], v[40:43], v[112:115]
v_exp_f32 v89, v89
v_mfma_f32_16x16x32_bf16 v[116:119], a[128:131], v[44:47], v[180:183]
v_mfma_f32_16x16x32_bf16 v[116:119], a[132:135], v[48:51], v[116:119]
v_exp_f32 v78, v78
v_mfma_f32_16x16x32_bf16 v[116:119], a[136:139], v[52:55], v[116:119]
buffer_load_dwordx4 v2, s[8:11], s41 offen offset:1024 lds
v_cvt_pk_bf16_f32 v152, v88, v89
v_mfma_f32_16x16x32_bf16 v[116:119], a[140:143], v[56:59], v[116:119]
v_exp_f32 v79, v79
v_mfma_f32_16x16x32_bf16 v[120:123], a[128:131], v[60:63], v[184:187]
ds_read_b128 a[144:147], v196 offset:12288
v_add_f32 v188, v188, v78
v_mfma_f32_16x16x32_bf16 v[120:123], a[132:135], v[64:67], v[120:123]
v_exp_f32 v80, v80
v_mfma_f32_16x16x32_bf16 v[120:123], a[136:139], v[68:71], v[120:123]
v_add_f32 v188, v188, v79
v_cvt_pk_bf16_f32 v141, v78, v79
v_mfma_f32_16x16x32_bf16 v[120:123], a[140:143], v[72:75], v[120:123]
v_exp_f32 v81, v81
s_nop 0
ds_read_b128 a[148:151], v196 offset:13312
v_add_f32 v189, v189, v80
s_nop 0
v_exp_f32 v82, v82
s_nop 0
buffer_load_dwordx4 v2, s[8:11], s41 offen offset:2048 lds
v_add_f32 v189, v189, v81
v_cvt_pk_bf16_f32 v144, v80, v81
s_nop 0
v_exp_f32 v83, v83
s_nop 0
ds_read_b128 a[152:155], v196 offset:14336
v_add_f32 v189, v189, v82
s_nop 0
v_exp_f32 v90, v90
s_nop 0
v_add_f32 v189, v189, v83
v_cvt_pk_bf16_f32 v145, v82, v83
s_nop 0
v_exp_f32 v91, v91
s_nop 0
ds_read_b128 a[156:159], v196 offset:15360
s_nop 0
v_exp_f32 v84, v84
s_nop 0
buffer_load_dwordx4 v2, s[8:11], s41 offen offset:3072 lds
v_cvt_pk_bf16_f32 v153, v90, v91
s_nop 0
v_exp_f32 v85, v85
s_nop 0
s_add_u32 m0, s43, 4096
s_add_u32 s42, s41, 4096
v_add_f32 v190, v190, v84
s_nop 0
v_exp_f32 v86, v86
s_nop 0
buffer_load_dwordx4 v2, s[8:11], s42 offen offset:0 lds
v_add_f32 v190, v190, v85
v_cvt_pk_bf16_f32 v148, v84, v85
s_nop 0
s_waitcnt lgkmcnt(0)
v_exp_f32 v87, v87
v_mfma_f32_16x16x32_bf16 v[124:127], a[144:147], v[12:15], v[172:175]
v_add_f32 v190, v190, v86
v_mfma_f32_16x16x32_bf16 v[124:127], a[148:151], v[16:19], v[124:127]
s_add_u32 s44, s44, 32768
v_exp_f32 v92, v92
v_mfma_f32_16x16x32_bf16 v[124:127], a[152:155], v[20:23], v[124:127]
s_and_b32 s44, s44, 0x1ffff
buffer_load_dwordx4 v2, s[8:11], s42 offen offset:1024 lds
v_add_f32 v190, v190, v87
v_cvt_pk_bf16_f32 v149, v86, v87
v_mfma_f32_16x16x32_bf16 v[124:127], a[156:159], v[24:27], v[124:127]
v_exp_f32 v93, v93
v_mfma_f32_16x16x32_bf16 v[128:131], a[144:147], v[28:31], v[176:179]
v_add_f32 v188, v188, v92
v_mfma_f32_16x16x32_bf16 v[128:131], a[148:151], v[32:35], v[128:131]
v_exp_f32 v104, v104
v_mfma_f32_16x16x32_bf16 v[128:131], a[152:155], v[36:39], v[128:131]
buffer_load_dwordx4 v2, s[8:11], s42 offen offset:2048 lds
v_add_f32 v188, v188, v93
v_cvt_pk_bf16_f32 v142, v92, v93
v_mfma_f32_16x16x32_bf16 v[128:131], a[156:159], v[40:43], v[128:131]
v_exp_f32 v105, v105
v_mfma_f32_16x16x32_bf16 v[132:135], a[144:147], v[44:47], v[180:183]
v_add_u32 v210, s44, v2
v_mfma_f32_16x16x32_bf16 v[132:135], a[148:151], v[48:51], v[132:135]
v_exp_f32 v94, v94
v_mfma_f32_16x16x32_bf16 v[132:135], a[152:155], v[52:55], v[132:135]
buffer_load_dwordx4 v2, s[8:11], s42 offen offset:3072 lds
v_cvt_pk_bf16_f32 v154, v104, v105
s_add_u32 s41, s41, 16384
s_add_u32 s43, s43, 32768
s_and_b32 s43, s43, 0x1ffff
v_mfma_f32_16x16x32_bf16 v[132:135], a[156:159], v[56:59], v[132:135]
v_exp_f32 v95, v95
v_mfma_f32_16x16x32_bf16 v[136:139], a[144:147], v[60:63], v[184:187]
s_waitcnt vmcnt(8)
s_barrier
ds_read_b128 a[128:131], v210 offset:0
v_add_f32 v188, v188, v94
v_mfma_f32_16x16x32_bf16 v[136:139], a[148:151], v[64:67], v[136:139]
v_exp_f32 v96, v96
v_mfma_f32_16x16x32_bf16 v[136:139], a[152:155], v[68:71], v[136:139]
v_add_f32 v188, v188, v95
v_cvt_pk_bf16_f32 v143, v94, v95
v_mfma_f32_16x16x32_bf16 v[136:139], a[156:159], v[72:75], v[136:139]
v_exp_f32 v97, v97
s_nop 0
ds_read_b128 a[132:135], v210 offset:1024
v_add_f32 v189, v189, v96
s_nop 0
v_exp_f32 v98, v98
s_nop 0
v_add_f32 v189, v189, v97
v_cvt_pk_bf16_f32 v146, v96, v97
s_nop 0
v_exp_f32 v99, v99
s_nop 0
ds_read_b128 a[136:139], v210 offset:2048
v_add_f32 v189, v189, v98
s_nop 0
v_exp_f32 v106, v106
s_nop 0
v_add_f32 v189, v189, v99
v_cvt_pk_bf16_f32 v147, v98, v99
s_nop 0
v_exp_f32 v107, v107
s_nop 0
ds_read_b128 a[140:143], v210 offset:3072
v_mov_b32 v196, v210
s_nop 0
v_exp_f32 v100, v100
s_nop 0
v_cvt_pk_bf16_f32 v155, v106, v107
s_nop 0
v_exp_f32 v101, v101
s_nop 0
ds_read_b128 a[160:163], v210 offset:16384
v_add_f32 v190, v190, v100
s_nop 0
v_exp_f32 v102, v102
s_nop 0
v_add_f32 v190, v190, v101
v_cvt_pk_bf16_f32 v150, v100, v101
s_nop 0
s_waitcnt lgkmcnt(1)
v_exp_f32 v103, v103
s_mov_b32 s46, 31
.p2align 6
L_at_loop:
v_mfma_f32_16x16x32_bf16 v[76:79], a[128:131], v[12:15], v[172:175]
ds_read_b128 a[164:167], v196 offset:17408
v_add_f32 v190, v190, v102
v_mfma_f32_16x16x32_bf16 v[76:79], a[132:135], v[16:19], v[76:79]
v_exp_f32 v108, v108
v_mfma_f32_16x16x32_bf16 v[76:79], a[136:139], v[20:23], v[76:79]
v_add_f32 v190, v190, v103
v_cvt_pk_bf16_f32 v151, v102, v103
v_mfma_f32_16x16x32_bf16 v[76:79], a[140:143], v[24:27], v[76:79]
v_exp_f32 v109, v109
v_mfma_f32_16x16x32_bf16 v[80:83], a[128:131], v[28:31], v[176:179]
ds_read_b128 a[168:171], v196 offset:18432
v_add_f32 v188, v188, v108
v_mfma_f32_16x16x32_bf16 v[80:83], a[132:135], v[32:35], v[80:83]
v_exp_f32 v120, v120
v_mfma_f32_16x16x32_bf16 v[80:83], a[136:139], v[36:39], v[80:83]
v_add_f32 v188, v188, v109
v_cvt_pk_bf16_f32 v156, v108, v109
v_mfma_f32_16x16x32_bf16 v[80:83], a[140:143], v[40:43], v[80:83]
v_exp_f32 v121, v121
v_mfma_f32_16x16x32_bf16 v[84:87], a[128:131], v[44:47], v[180:183]
s_mov_b32 m0, s43
ds_read_b128 a[172:175], v196 offset:19456
buffer_load_dword v209, v208, s[24:27], s28 offen
v_mfma_f32_16x16x32_bf16 v[84:87], a[132:135], v[48:51], v[84:87]
v_exp_f32 v110, v110
v_mfma_f32_16x16x32_bf16 v[84:87], a[136:139], v[52:55], v[84:87]
buffer_load_dwordx4 v2, s[8:11], s41 offen offset:0 lds
v_cvt_pk_bf16_f32 v168, v120, v121
v_mfma_f32_16x16x32_bf16 v[84:87], a[140:143], v[56:59], v[84:87]
v_exp_f32 v111, v111
v_mfma_f32_16x16x32_bf16 v[88:91], a[128:131], v[60:63], v[184:187]
ds_read_b128 a[144:147], v196 offset:4096
v_add_f32 v188, v188, v110
v_mfma_f32_16x16x32_bf16 v[88:91], a[132:135], v[64:67], v[88:91]
s_add_u32 s28, s28, 4096
v_exp_f32 v112, v112
v_mfma_f32_16x16x32_bf16 v[88:91], a[136:139], v[68:71], v[88:91]
s_add_u32 s29, s29, 1
v_add_f32 v188, v188, v111
v_cvt_pk_bf16_f32 v157, v110, v111
v_mfma_f32_16x16x32_bf16 v[88:91], a[140:143], v[72:75], v[88:91]
s_waitcnt lgkmcnt(4)
v_exp_f32 v113, v113
v_mfma_f32_16x16x32_bf16 a[0:3], a[160:163], v[140:143], a[0:3]
ds_read_b128 a[148:151], v196 offset:5120
v_add_f32 v189, v189, v112
v_mfma_f32_16x16x32_bf16 a[4:7], a[160:163], v[144:147], a[4:7]
s_and_b32 s59, s29, 1
v_exp_f32 v114, v114
v_mfma_f32_16x16x32_bf16 a[8:11], a[160:163], v[148:151], a[8:11]
s_cmp_eq_u32 s59, 0
v_add_f32 v189, v189, v113
v_cvt_pk_bf16_f32 v160, v112, v113
v_mfma_f32_16x16x32_bf16 a[12:15], a[160:163], v[152:155], a[12:15]
s_waitcnt lgkmcnt(4)
v_exp_f32 v115, v115
v_mfma_f32_16x16x32_bf16 a[28:31], a[164:167], v[152:155], a[28:31]
ds_read_b128 a[152:155], v196 offset:6144
v_add_f32 v189, v189, v114
v_mfma_f32_16x16x32_bf16 a[24:27], a[164:167], v[148:151], a[24:27]
s_cselect_b32 s24, s18, s24
v_exp_f32 v122, v122
v_mfma_f32_16x16x32_bf16 a[20:23], a[164:167], v[144:147], a[20:23]
s_cselect_b32 s25, s19, s25
v_add_f32 v189, v189, v115
v_cvt_pk_bf16_f32 v161, v114, v115
v_mfma_f32_16x16x32_bf16 a[16:19], a[164:167], v[140:143], a[16:19]
s_waitcnt lgkmcnt(4)
v_exp_f32 v123, v123
v_mfma_f32_16x16x32_bf16 a[32:35], a[168:171], v[140:143], a[32:35]
ds_read_b128 a[156:159], v196 offset:7168
v_mfma_f32_16x16x32_bf16 a[36:39], a[168:171], v[144:147], a[36:39]
s_cselect_b32 s26, s56, s26
v_exp_f32 v116, v116
v_mfma_f32_16x16x32_bf16 a[40:43], a[168:171], v[148:151], a[40:43]
s_cselect_b64 s[18:19], s[20:21], s[18:19]
buffer_load_dwordx4 v2, s[8:11], s41 offen offset:1024 lds
v_cvt_pk_bf16_f32 v169, v122, v123
v_mfma_f32_16x16x32_bf16 a[44:47], a[168:171], v[152:155], a[44:47]
s_waitcnt lgkmcnt(4)
v_exp_f32 v117, v117
v_mfma_f32_16x16x32_bf16 a[60:63], a[172:175], v[152:155], a[60:63]
ds_read_b128 a[160:163], v196 offset:20480
v_add_f32 v190, v190, v116
v_mfma_f32_16x16x32_bf16 a[56:59], a[172:175], v[148:151], a[56:59]
s_cselect_b64 s[20:21], s[22:23], s[20:21]
v_exp_f32 v118, v118
v_mfma_f32_16x16x32_bf16 a[52:55], a[172:175], v[144:147], a[52:55]
s_cselect_b32 s56, s57, s56
v_add_f32 v190, v190, v117
v_cvt_pk_bf16_f32 v164, v116, v117
v_mfma_f32_16x16x32_bf16 a[48:51], a[172:175], v[140:143], a[48:51]
s_waitcnt lgkmcnt(1)
v_exp_f32 v119, v119
v_mfma_f32_16x16x32_bf16 a[176:179], a[180:183], v[152:155], a[176:179]
v_mfma_f32_16x16x32_bf16 v[92:95], a[144:147], v[12:15], v[172:175]
ds_read_b128 a[164:167], v196 offset:21504
v_add_f32 v190, v190, v118
v_mfma_f32_16x16x32_bf16 v[92:95], a[148:151], v[16:19], v[92:95]
s_cselect_b32 s57, s58, s57
v_exp_f32 v124, v124
v_mfma_f32_16x16x32_bf16 v[92:95], a[152:155], v[20:23], v[92:95]
s_cselect_b32 s58, 0, s58
v_add_f32 v190, v190, v119
v_cvt_pk_bf16_f32 v165, v118, v119
v_mfma_f32_16x16x32_bf16 v[92:95], a[156:159], v[24:27], v[92:95]
v_exp_f32 v125, v125
v_mfma_f32_16x16x32_bf16 v[96:99], a[144:147], v[28:31], v[176:179]
ds_read_b128 a[168:171], v196 offset:22528
v_add_f32 v188, v188, v124
v_mfma_f32_16x16x32_bf16 v[96:99], a[148:151], v[32:35], v[96:99]
s_cselect_b32 s59, 0x2000, 0
v_exp_f32 v136, v136
v_mfma_f32_16x16x32_bf16 v[96:99], a[152:155], v[36:39], v[96:99]
s_sub_u32 s28, s28, s59
v_add_f32 v188, v188, v125
v_cvt_pk_bf16_f32 v158, v124, v125
v_mfma_f32_16x16x32_bf16 v[96:99], a[156:159], v[40:43], v[96:99]
v_exp_f32 v137, v137
v_mfma_f32_16x16x32_bf16 v[100:103], a[144:147], v[44:47], v[180:183]
ds_read_b128 a[172:175], v196 offset:23552
v_mfma_f32_16x16x32_bf16 v[100:103], a[148:151], v[48:51], v[100:103]
v_exp_f32 v126, v126
v_mfma_f32_16x16x32_bf16 v[100:103], a[152:155], v[52:55], v[100:103]
buffer_load_dwordx4 v2, s[8:11], s41 offen offset:2048 lds
v_cvt_pk_bf16_f32 v170, v136, v137
v_mfma_f32_16x16x32_bf16 v[100:103], a[156:159], v[56:59], v[100:103]
v_exp_f32 v127, v127
v_mfma_f32_16x16x32_bf16 v[104:107], a[144:147], v[60:63], v[184:187]
ds_read_b128 a[128:131], v196 offset:8192
v_add_f32 v188, v188, v126
v_mfma_f32_16x16x32_bf16 v[104:107], a[148:151], v[64:67], v[104:107]
v_exp_f32 v128, v128
v_mfma_f32_16x16x32_bf16 v[104:107], a[152:155], v[68:71], v[104:107]
v_add_f32 v188, v188, v127
v_cvt_pk_bf16_f32 v159, v126, v127
v_mfma_f32_16x16x32_bf16 v[104:107], a[156:159], v[72:75], v[104:107]
s_waitcnt lgkmcnt(4)
v_exp_f32 v129, v129
v_mfma_f32_16x16x32_bf16 a[64:67], a[160:163], v[140:143], a[64:67]
ds_read_b128 a[132:135], v196 offset:9216
v_add_f32 v189, v189, v128
v_mfma_f32_16x16x32_bf16 a[68:71], a[160:163], v[144:147], a[68:71]
v_exp_f32 v130, v130
v_mfma_f32_16x16x32_bf16 a[72:75], a[160:163], v[148:151], a[72:75]
v_add_f32 v189, v189, v129
v_cvt_pk_bf16_f32 v162, v128, v129
v_mfma_f32_16x16x32_bf16 a[76:79], a[160:163], v[152:155], a[76:79]
s_waitcnt lgkmcnt(4)
v_exp_f32 v131, v131
v_mfma_f32_16x16x32_bf16 a[92:95], a[164:167], v[152:155], a[92:95]
ds_read_b128 a[136:139], v196 offset:10240
v_add_f32 v189, v189, v130
v_mfma_f32_16x16x32_bf16 a[88:91], a[164:167], v[148:151], a[88:91]
v_exp_f32 v138, v138
v_mfma_f32_16x16x32_bf16 a[84:87], a[164:167], v[144:147], a[84:87]
v_add_f32 v189, v189, v131
v_cvt_pk_bf16_f32 v163, v130, v131
v_mfma_f32_16x16x32_bf16 a[80:83], a[164:167], v[140:143], a[80:83]
s_waitcnt lgkmcnt(4)
v_exp_f32 v139, v139
v_mfma_f32_16x16x32_bf16 a[96:99], a[168:171], v[140:143], a[96:99]
ds_read_b128 a[140:143], v196 offset:11264
v_mfma_f32_16x16x32_bf16 a[100:103], a[168:171], v[144:147], a[100:103]
v_exp_f32 v132, v132
v_mfma_f32_16x16x32_bf16 a[104:107], a[168:171], v[148:151], a[104:107]
buffer_load_dwordx4 v2, s[8:11], s41 offen offset:3072 lds
v_cvt_pk_bf16_f32 v171, v138, v139
v_mfma_f32_16x16x32_bf16 a[108:111], a[168:171], v[152:155], a[108:111]
s_waitcnt lgkmcnt(4)
v_exp_f32 v133, v133
v_mfma_f32_16x16x32_bf16 a[124:127], a[172:175], v[152:155], a[124:127]
ds_read_b128 a[160:163], v196 offset:24576
v_add_f32 v190, v190, v132
v_mfma_f32_16x16x32_bf16 a[120:123], a[172:175], v[148:151], a[120:123]
v_exp_f32 v134, v134
v_mfma_f32_16x16x32_bf16 a[116:119], a[172:175], v[144:147], a[116:119]
v_add_f32 v190, v190, v133
v_cvt_pk_bf16_f32 v166, v132, v133
v_mfma_f32_16x16x32_bf16 a[112:115], a[172:175], v[140:143], a[112:115]
s_waitcnt lgkmcnt(1)
v_exp_f32 v135, v135
v_mfma_f32_16x16x32_bf16 v[108:111], a[128:131], v[12:15], v[172:175]
ds_read_b128 a[164:167], v196 offset:25600
v_add_f32 v190, v190, v134
v_mfma_f32_16x16x32_bf16 v[108:111], a[132:135], v[16:19], v[108:111]
v_exp_f32 v76, v76
v_mfma_f32_16x16x32_bf16 v[108:111], a[136:139], v[20:23], v[108:111]
v_add_f32 v190, v190, v135
v_cvt_pk_bf16_f32 v167, v134, v135
v_mfma_f32_16x16x32_bf16 v[108:111], a[140:143], v[24:27], v[108:111]
v_exp_f32 v77, v77
v_mfma_f32_16x16x32_bf16 v[112:115], a[128:131], v[28:31], v[176:179]
ds_read_b128 a[168:171], v196 offset:26624
v_add_f32 v188, v188, v76
v_mfma_f32_16x16x32_bf16 v[112:115], a[132:135], v[32:35], v[112:115]
v_exp_f32 v88, v88
v_mfma_f32_16x16x32_bf16 v[112:115], a[136:139], v[36:39], v[112:115]
v_add_f32 v188, v188, v77
v_cvt_pk_bf16_f32 v140, v76, v77
v_mfma_f32_16x16x32_bf16 v[112:115], a[140:143], v[40:43], v[112:115]
v_exp_f32 v89, v89
v_mfma_f32_16x16x32_bf16 v[116:119], a[128:131], v[44:47], v[180:183]
s_add_u32 m0, s43, 4096
s_add_u32 s42, s41, 4096
ds_read_b128 a[172:175], v196 offset:27648
v_mfma_f32_16x16x32_bf16 v[116:119], a[132:135], v[48:51], v[116:119]
v_exp_f32 v78, v78
v_mfma_f32_16x16x32_bf16 v[116:119], a[136:139], v[52:55], v[116:119]
buffer_load_dwordx4 v2, s[8:11], s42 offen offset:0 lds
v_cvt_pk_bf16_f32 v152, v88, v89
v_mfma_f32_16x16x32_bf16 v[116:119], a[140:143], v[56:59], v[116:119]
v_exp_f32 v79, v79
v_mfma_f32_16x16x32_bf16 v[120:123], a[128:131], v[60:63], v[184:187]
ds_read_b128 a[144:147], v196 offset:12288
v_add_f32 v188, v188, v78
v_mfma_f32_16x16x32_bf16 v[120:123], a[132:135], v[64:67], v[120:123]
v_exp_f32 v80, v80
v_mfma_f32_16x16x32_bf16 v[120:123], a[136:139], v[68:71], v[120:123]
v_add_f32 v188, v188, v79
v_cvt_pk_bf16_f32 v141, v78, v79
v_mfma_f32_16x16x32_bf16 v[120:123], a[140:143], v[72:75], v[120:123]
s_waitcnt lgkmcnt(4)
v_exp_f32 v81, v81
v_mfma_f32_16x16x32_bf16 a[0:3], a[160:163], v[156:159], a[0:3]
ds_read_b128 a[148:151], v196 offset:13312
v_add_f32 v189, v189, v80
v_mfma_f32_16x16x32_bf16 a[4:7], a[160:163], v[160:163], a[4:7]
v_exp_f32 v82, v82
v_mfma_f32_16x16x32_bf16 a[8:11], a[160:163], v[164:167], a[8:11]
v_add_f32 v189, v189, v81
v_cvt_pk_bf16_f32 v144, v80, v81
v_mfma_f32_16x16x32_bf16 a[12:15], a[160:163], v[168:171], a[12:15]
s_waitcnt lgkmcnt(4)
v_exp_f32 v83, v83
v_mfma_f32_16x16x32_bf16 a[28:31], a[164:167], v[168:171], a[28:31]
ds_read_b128 a[152:155], v196 offset:14336
v_add_f32 v189, v189, v82
v_mfma_f32_16x16x32_bf16 a[24:27], a[164:167], v[164:167], a[24:27]
v_exp_f32 v90, v90
v_mfma_f32_16x16x32_bf16 a[20:23], a[164:167], v[160:163], a[20:23]
v_add_f32 v189, v189, v83
v_cvt_pk_bf16_f32 v145, v82, v83
v_mfma_f32_16x16x32_bf16 a[16:19], a[164:167], v[156:159], a[16:19]
s_waitcnt lgkmcnt(4)
v_exp_f32 v91, v91
v_mfma_f32_16x16x32_bf16 a[32:35], a[168:171], v[156:159], a[32:35]
ds_read_b128 a[156:159], v196 offset:15360
v_mfma_f32_16x16x32_bf16 a[36:39], a[168:171], v[160:163], a[36:39]
v_exp_f32 v84, v84
v_mfma_f32_16x16x32_bf16 a[40:43], a[168:171], v[164:167], a[40:43]
buffer_load_dwordx4 v2, s[8:11], s42 offen offset:1024 lds
v_cvt_pk_bf16_f32 v153, v90, v91
v_mfma_f32_16x16x32_bf16 a[44:47], a[168:171], v[168:171], a[44:47]
s_waitcnt lgkmcnt(4)
v_exp_f32 v85, v85
v_mfma_f32_16x16x32_bf16 a[60:63], a[172:175], v[168:171], a[60:63]
ds_read_b128 a[160:163], v196 offset:28672
v_add_f32 v190, v190, v84
v_mfma_f32_16x16x32_bf16 a[56:59], a[172:175], v[164:167], a[56:59]
v_exp_f32 v86, v86
v_mfma_f32_16x16x32_bf16 a[52:55], a[172:175], v[160:163], a[52:55]
v_add_f32 v190, v190, v85
v_cvt_pk_bf16_f32 v148, v84, v85
v_mfma_f32_16x16x32_bf16 a[48:51], a[172:175], v[156:159], a[48:51]
s_waitcnt lgkmcnt(1)
v_exp_f32 v87, v87
v_mfma_f32_16x16x32_bf16 a[176:179], a[180:183], v[168:171], a[176:179]
v_mfma_f32_16x16x32_bf16 v[124:127], a[144:147], v[12:15], v[172:175]
ds_read_b128 a[164:167], v196 offset:29696
v_add_f32 v190, v190, v86
v_mfma_f32_16x16x32_bf16 v[124:127], a[148:151], v[16:19], v[124:127]
s_add_u32 s44, s44, 32768
v_exp_f32 v92, v92
v_mfma_f32_16x16x32_bf16 v[124:127], a[152:155], v[20:23], v[124:127]
s_and_b32 s44, s44, 0x1ffff
v_add_f32 v190, v190, v87
v_cvt_pk_bf16_f32 v149, v86, v87
v_mfma_f32_16x16x32_bf16 v[124:127], a[156:159], v[24:27], v[124:127]
v_exp_f32 v93, v93
v_mfma_f32_16x16x32_bf16 v[128:131], a[144:147], v[28:31], v[176:179]
ds_read_b128 a[168:171], v196 offset:30720
v_add_f32 v188, v188, v92
v_mfma_f32_16x16x32_bf16 v[128:131], a[148:151], v[32:35], v[128:131]
v_exp_f32 v104, v104
v_mfma_f32_16x16x32_bf16 v[128:131], a[152:155], v[36:39], v[128:131]
v_add_f32 v188, v188, v93
v_cvt_pk_bf16_f32 v142, v92, v93
v_mfma_f32_16x16x32_bf16 v[128:131], a[156:159], v[40:43], v[128:131]
v_exp_f32 v105, v105
v_mfma_f32_16x16x32_bf16 v[132:135], a[144:147], v[44:47], v[180:183]
ds_read_b128 a[172:175], v196 offset:31744
v_add_u32 v210, s44, v2
v_mfma_f32_16x16x32_bf16 v[132:135], a[148:151], v[48:51], v[132:135]
v_exp_f32 v94, v94
v_mfma_f32_16x16x32_bf16 v[132:135], a[152:155], v[52:55], v[132:135]
buffer_load_dwordx4 v2, s[8:11], s42 offen offset:2048 lds
v_cvt_pk_bf16_f32 v154, v104, v105
v_mfma_f32_16x16x32_bf16 v[132:135], a[156:159], v[56:59], v[132:135]
v_exp_f32 v95, v95
v_mfma_f32_16x16x32_bf16 v[136:139], a[144:147], v[60:63], v[184:187]
s_waitcnt vmcnt(7)
s_barrier
ds_read_b128 a[128:131], v210 offset:0
v_add_f32 v188, v188, v94
v_mfma_f32_16x16x32_bf16 v[136:139], a[148:151], v[64:67], v[136:139]
v_exp_f32 v96, v96
v_mfma_f32_16x16x32_bf16 v[136:139], a[152:155], v[68:71], v[136:139]
v_add_f32 v188, v188, v95
v_cvt_pk_bf16_f32 v143, v94, v95
v_mfma_f32_16x16x32_bf16 v[136:139], a[156:159], v[72:75], v[136:139]
s_waitcnt lgkmcnt(4)
v_exp_f32 v97, v97
v_mfma_f32_16x16x32_bf16 a[64:67], a[160:163], v[156:159], a[64:67]
ds_read_b128 a[132:135], v210 offset:1024
v_add_f32 v189, v189, v96
v_mfma_f32_16x16x32_bf16 a[68:71], a[160:163], v[160:163], a[68:71]
v_exp_f32 v98, v98
v_mfma_f32_16x16x32_bf16 a[72:75], a[160:163], v[164:167], a[72:75]
v_add_f32 v189, v189, v97
v_cvt_pk_bf16_f32 v146, v96, v97
v_mfma_f32_16x16x32_bf16 a[76:79], a[160:163], v[168:171], a[76:79]
s_waitcnt lgkmcnt(4)
v_exp_f32 v99, v99
v_mfma_f32_16x16x32_bf16 a[92:95], a[164:167], v[168:171], a[92:95]
ds_read_b128 a[136:139], v210 offset:2048
v_add_f32 v189, v189, v98
v_mfma_f32_16x16x32_bf16 a[88:91], a[164:167], v[164:167], a[88:91]
v_exp_f32 v106, v106
v_mfma_f32_16x16x32_bf16 a[84:87], a[164:167], v[160:163], a[84:87]
v_add_f32 v189, v189, v99
v_cvt_pk_bf16_f32 v147, v98, v99
v_mfma_f32_16x16x32_bf16 a[80:83], a[164:167], v[156:159], a[80:83]
s_waitcnt lgkmcnt(4)
v_exp_f32 v107, v107
v_mfma_f32_16x16x32_bf16 a[96:99], a[168:171], v[156:159], a[96:99]
ds_read_b128 a[140:143], v210 offset:3072
v_mov_b32 v196, v210
v_mfma_f32_16x16x32_bf16 a[100:103], a[168:171], v[160:163], a[100:103]
v_exp_f32 v100, v100
v_mfma_f32_16x16x32_bf16 a[104:107], a[168:171], v[164:167], a[104:107]
buffer_load_dwordx4 v2, s[8:11], s42 offen offset:3072 lds
v_cvt_pk_bf16_f32 v155, v106, v107
s_add_u32 s41, s41, 16384
s_add_u32 s43, s43, 32768
s_and_b32 s43, s43, 0x1ffff
v_mfma_f32_16x16x32_bf16 a[108:111], a[168:171], v[168:171], a[108:111]
s_waitcnt lgkmcnt(4)
v_exp_f32 v101, v101
v_mfma_f32_16x16x32_bf16 a[124:127], a[172:175], v[168:171], a[124:127]
ds_read_b128 a[160:163], v210 offset:16384
v_add_f32 v190, v190, v100
v_mfma_f32_16x16x32_bf16 a[120:123], a[172:175], v[164:167], a[120:123]
s_sub_u32 s46, s46, 1
v_exp_f32 v102, v102
v_mfma_f32_16x16x32_bf16 a[116:119], a[172:175], v[160:163], a[116:119]
s_cmp_lg_u32 s46, 0
v_add_f32 v190, v190, v101
v_cvt_pk_bf16_f32 v150, v100, v101
v_mfma_f32_16x16x32_bf16 a[112:115], a[172:175], v[156:159], a[112:115]
s_waitcnt lgkmcnt(1)
v_exp_f32 v103, v103
s_cbranch_scc1 L_at_loop
s_nop 0
ds_read_b128 a[164:167], v196 offset:17408
v_add_f32 v190, v190, v102
s_nop 0
v_exp_f32 v108, v108
s_nop 0
v_add_f32 v190, v190, v103
v_cvt_pk_bf16_f32 v151, v102, v103
s_nop 0
v_exp_f32 v109, v109
s_nop 0
ds_read_b128 a[168:171], v196 offset:18432
v_add_f32 v188, v188, v108
s_nop 0
v_exp_f32 v120, v120
s_nop 0
v_add_f32 v188, v188, v109
v_cvt_pk_bf16_f32 v156, v108, v109
s_nop 0
v_exp_f32 v121, v121
s_nop 0
ds_read_b128 a[172:175], v196 offset:19456
s_nop 0
v_exp_f32 v110, v110
s_nop 0
v_cvt_pk_bf16_f32 v168, v120, v121
s_nop 0
v_exp_f32 v111, v111
s_nop 0
v_add_f32 v188, v188, v110
s_nop 0
v_exp_f32 v112, v112
s_nop 0
v_add_f32 v188, v188, v111
v_cvt_pk_bf16_f32 v157, v110, v111
s_nop 0
s_waitcnt lgkmcnt(3)
v_exp_f32 v113, v113
v_mfma_f32_16x16x32_bf16 a[0:3], a[160:163], v[140:143], a[0:3]
v_add_f32 v189, v189, v112
v_mfma_f32_16x16x32_bf16 a[4:7], a[160:163], v[144:147], a[4:7]
v_exp_f32 v114, v114
v_mfma_f32_16x16x32_bf16 a[8:11], a[160:163], v[148:151], a[8:11]
v_add_f32 v189, v189, v113
v_cvt_pk_bf16_f32 v160, v112, v113
v_mfma_f32_16x16x32_bf16 a[12:15], a[160:163], v[152:155], a[12:15]
s_waitcnt lgkmcnt(2)
v_exp_f32 v115, v115
v_mfma_f32_16x16x32_bf16 a[28:31], a[164:167], v[152:155], a[28:31]
v_add_f32 v189, v189, v114
v_mfma_f32_16x16x32_bf16 a[24:27], a[164:167], v[148:151], a[24:27]
v_exp_f32 v122, v122
v_mfma_f32_16x16x32_bf16 a[20:23], a[164:167], v[144:147], a[20:23]
v_add_f32 v189, v189, v115
v_cvt_pk_bf16_f32 v161, v114, v115
v_mfma_f32_16x16x32_bf16 a[16:19], a[164:167], v[140:143], a[16:19]
s_waitcnt lgkmcnt(1)
v_exp_f32 v123, v123
v_mfma_f32_16x16x32_bf16 a[32:35], a[168:171], v[140:143], a[32:35]
v_mfma_f32_16x16x32_bf16 a[36:39], a[168:171], v[144:147], a[36:39]
v_exp_f32 v116, v116
v_mfma_f32_16x16x32_bf16 a[40:43], a[168:171], v[148:151], a[40:43]
v_cvt_pk_bf16_f32 v169, v122, v123
v_mfma_f32_16x16x32_bf16 a[44:47], a[168:171], v[152:155], a[44:47]
s_waitcnt lgkmcnt(0)
v_exp_f32 v117, v117
v_mfma_f32_16x16x32_bf16 a[60:63], a[172:175], v[152:155], a[60:63]
ds_read_b128 a[160:163], v196 offset:20480
v_add_f32 v190, v190, v116
v_mfma_f32_16x16x32_bf16 a[56:59], a[172:175], v[148:151], a[56:59]
v_exp_f32 v118, v118
v_mfma_f32_16x16x32_bf16 a[52:55], a[172:175], v[144:147], a[52:55]
v_add_f32 v190, v190, v117
v_cvt_pk_bf16_f32 v164, v116, v117
v_mfma_f32_16x16x32_bf16 a[48:51], a[172:175], v[140:143], a[48:51]
v_exp_f32 v119, v119
v_mfma_f32_16x16x32_bf16 a[176:179], a[180:183], v[152:155], a[176:179]
s_nop 0
ds_read_b128 a[164:167], v196 offset:21504
v_add_f32 v190, v190, v118
s_nop 0
v_exp_f32 v124, v124
s_nop 0
v_add_f32 v190, v190, v119
v_cvt_pk_bf16_f32 v165, v118, v119
s_nop 0
v_exp_f32 v125, v125
s_nop 0
ds_read_b128 a[168:171], v196 offset:22528
v_add_f32 v188, v188, v124
s_nop 0
v_exp_f32 v136, v136
s_nop 0
v_add_f32 v188, v188, v125
v_cvt_pk_bf16_f32 v158, v124, v125
s_nop 0
v_exp_f32 v137, v137
s_nop 0
ds_read_b128 a[172:175], v196 offset:23552
s_nop 0
v_exp_f32 v126, v126
s_nop 0
v_cvt_pk_bf16_f32 v170, v136, v137
s_nop 0
v_exp_f32 v127, v127
s_nop 0
v_add_f32 v188, v188, v126
s_nop 0
v_exp_f32 v128, v128
s_nop 0
v_add_f32 v188, v188, v127
v_cvt_pk_bf16_f32 v159, v126, v127
s_nop 0
s_waitcnt lgkmcnt(3)
v_exp_f32 v129, v129
v_mfma_f32_16x16x32_bf16 a[64:67], a[160:163], v[140:143], a[64:67]
v_add_f32 v189, v189, v128
v_mfma_f32_16x16x32_bf16 a[68:71], a[160:163], v[144:147], a[68:71]
v_exp_f32 v130, v130
v_mfma_f32_16x16x32_bf16 a[72:75], a[160:163], v[148:151], a[72:75]
v_add_f32 v189, v189, v129
v_cvt_pk_bf16_f32 v162, v128, v129
v_mfma_f32_16x16x32_bf16 a[76:79], a[160:163], v[152:155], a[76:79]
s_waitcnt lgkmcnt(2)
v_exp_f32 v131, v131
v_mfma_f32_16x16x32_bf16 a[92:95], a[164:167], v[152:155], a[92:95]
v_add_f32 v189, v189, v130
v_mfma_f32_16x16x32_bf16 a[88:91], a[164:167], v[148:151], a[88:91]
v_exp_f32 v138, v138
v_mfma_f32_16x16x32_bf16 a[84:87], a[164:167], v[144:147], a[84:87]
v_add_f32 v189, v189, v131
v_cvt_pk_bf16_f32 v163, v130, v131
v_mfma_f32_16x16x32_bf16 a[80:83], a[164:167], v[140:143], a[80:83]
s_waitcnt lgkmcnt(1)
v_exp_f32 v139, v139
v_mfma_f32_16x16x32_bf16 a[96:99], a[168:171], v[140:143], a[96:99]
v_mfma_f32_16x16x32_bf16 a[100:103], a[168:171], v[144:147], a[100:103]
v_exp_f32 v132, v132
v_mfma_f32_16x16x32_bf16 a[104:107], a[168:171], v[148:151], a[104:107]
v_cvt_pk_bf16_f32 v171, v138, v139
v_mfma_f32_16x16x32_bf16 a[108:111], a[168:171], v[152:155], a[108:111]
s_waitcnt lgkmcnt(0)
v_exp_f32 v133, v133
v_mfma_f32_16x16x32_bf16 a[124:127], a[172:175], v[152:155], a[124:127]
ds_read_b128 a[160:163], v196 offset:24576
v_add_f32 v190, v190, v132
v_mfma_f32_16x16x32_bf16 a[120:123], a[172:175], v[148:151], a[120:123]
v_exp_f32 v134, v134
v_mfma_f32_16x16x32_bf16 a[116:119], a[172:175], v[144:147], a[116:119]
v_add_f32 v190, v190, v133
v_cvt_pk_bf16_f32 v166, v132, v133
v_mfma_f32_16x16x32_bf16 a[112:115], a[172:175], v[140:143], a[112:115]
v_exp_f32 v135, v135
s_nop 0
ds_read_b128 a[164:167], v196 offset:25600
v_add_f32 v190, v190, v134
s_nop 0
v_add_f32 v190, v190, v135
v_cvt_pk_bf16_f32 v167, v134, v135
s_nop 0
ds_read_b128 a[168:171], v196 offset:26624
s_nop 0
ds_read_b128 a[172:175], v196 offset:27648
s_waitcnt lgkmcnt(3)
v_mfma_f32_16x16x32_bf16 a[0:3], a[160:163], v[156:159], a[0:3]
v_mfma_f32_16x16x32_bf16 a[4:7], a[160:163], v[160:163], a[4:7]
v_mfma_f32_16x16x32_bf16 a[8:11], a[160:163], v[164:167], a[8:11]
v_mfma_f32_16x16x32_bf16 a[12:15], a[160:163], v[168:171], a[12:15]
s_waitcnt lgkmcnt(2)
v_mfma_f32_16x16x32_bf16 a[28:31], a[164:167], v[168:171], a[28:31]
v_mfma_f32_16x16x32_bf16 a[24:27], a[164:167], v[164:167], a[24:27]
v_mfma_f32_16x16x32_bf16 a[20:23], a[164:167], v[160:163], a[20:23]
v_mfma_f32_16x16x32_bf16 a[16:19], a[164:167], v[156:159], a[16:19]
s_waitcnt lgkmcnt(1)
v_mfma_f32_16x16x32_bf16 a[32:35], a[168:171], v[156:159], a[32:35]
v_mfma_f32_16x16x32_bf16 a[36:39], a[168:171], v[160:163], a[36:39]
v_mfma_f32_16x16x32_bf16 a[40:43], a[168:171], v[164:167], a[40:43]
v_mfma_f32_16x16x32_bf16 a[44:47], a[168:171], v[168:171], a[44:47]
s_waitcnt lgkmcnt(0)
v_mfma_f32_16x16x32_bf16 a[60:63], a[172:175], v[168:171], a[60:63]
ds_read_b128 a[160:163], v196 offset:28672
v_mfma_f32_16x16x32_bf16 a[56:59], a[172:175], v[164:167], a[56:59]
v_mfma_f32_16x16x32_bf16 a[52:55], a[172:175], v[160:163], a[52:55]
v_mfma_f32_16x16x32_bf16 a[48:51], a[172:175], v[156:159], a[48:51]
v_mfma_f32_16x16x32_bf16 a[176:179], a[180:183], v[168:171], a[176:179]
s_nop 0
ds_read_b128 a[164:167], v196 offset:29696
s_nop 0
ds_read_b128 a[168:171], v196 offset:30720
s_nop 0
ds_read_b128 a[172:175], v196 offset:31744
s_waitcnt lgkmcnt(3)
v_mfma_f32_16x16x32_bf16 a[64:67], a[160:163], v[156:159], a[64:67]
v_mfma_f32_16x16x32_bf16 a[68:71], a[160:163], v[160:163], a[68:71]
v_mfma_f32_16x16x32_bf16 a[72:75], a[160:163], v[164:167], a[72:75]
v_mfma_f32_16x16x32_bf16 a[76:79], a[160:163], v[168:171], a[76:79]
s_waitcnt lgkmcnt(2)
v_mfma_f32_16x16x32_bf16 a[92:95], a[164:167], v[168:171], a[92:95]
v_mfma_f32_16x16x32_bf16 a[88:91], a[164:167], v[164:167], a[88:91]
v_mfma_f32_16x16x32_bf16 a[84:87], a[164:167], v[160:163], a[84:87]
v_mfma_f32_16x16x32_bf16 a[80:83], a[164:167], v[156:159], a[80:83]
s_waitcnt lgkmcnt(1)
v_mfma_f32_16x16x32_bf16 a[96:99], a[168:171], v[156:159], a[96:99]
v_mfma_f32_16x16x32_bf16 a[100:103], a[168:171], v[160:163], a[100:103]
v_mfma_f32_16x16x32_bf16 a[104:107], a[168:171], v[164:167], a[104:107]
v_mfma_f32_16x16x32_bf16 a[108:111], a[168:171], v[168:171], a[108:111]
s_waitcnt lgkmcnt(0)
v_mfma_f32_16x16x32_bf16 a[124:127], a[172:175], v[168:171], a[124:127]
v_mfma_f32_16x16x32_bf16 a[120:123], a[172:175], v[164:167], a[120:123]
v_mfma_f32_16x16x32_bf16 a[116:119], a[172:175], v[160:163], a[116:119]
v_mfma_f32_16x16x32_bf16 a[112:115], a[172:175], v[156:159], a[112:115]
s_nop 7
v_mov_b32 v200, v188
s_nop 1
v_permlane32_swap_b32 v188, v200
v_add_f32 v188, v188, v200
v_mov_b32 v200, v188
s_nop 1
v_permlane16_swap_b32 v188, v200
v_add_f32 v188, v188, v200
v_mov_b32 v200, v189
s_nop 1
v_permlane32_swap_b32 v189, v200
v_add_f32 v189, v189, v200
v_mov_b32 v200, v189
s_nop 1
v_permlane16_swap_b32 v189, v200
v_add_f32 v189, v189, v200
v_mov_b32 v200, v190
s_nop 1
v_permlane32_swap_b32 v190, v200
v_add_f32 v190, v190, v200
v_mov_b32 v200, v190
s_nop 1
v_permlane16_swap_b32 v190, v200
v_add_f32 v190, v190, v200
v_accvgpr_read_b32 v191, a176
s_cmp_lg_u32 s45, 0
s_cbranch_scc1 L_at_nov
v_mov_b32 v201, 0x45000000
v_cmp_nle_f32 s[60:61], v188, v201
v_cmp_nle_f32 vcc, v189, v201
s_nop 1
s_or_b64 s[60:61], s[60:61], vcc
v_cmp_nle_f32 vcc, v190, v201
s_nop 1
s_or_b64 s[60:61], s[60:61], vcc
v_cmp_nle_f32 vcc, v191, v201
s_nop 1
s_or_b64 s[60:61], s[60:61], vcc
s_cmp_lg_u64 s[60:61], 0
s_cselect_b32 s34, 1, 0
v_mov_b32 v202, s34
s_lshl_b32 s35, s30, 2
s_add_u32 s35, s35, 163824
v_mov_b32 v203, s35
ds_write_b32 v203, v202
L_at_nov:
v_rcp_f32 v188, v188
v_rcp_f32 v189, v189
v_rcp_f32 v190, v190
v_rcp_f32 v191, v191
s_nop 0
v_mov_b32 v140, v188
v_mov_b32 v141, v188
v_mov_b32 v142, v189
v_mov_b32 v143, v189
v_mov_b32 v144, v190
v_mov_b32 v145, v190
v_mov_b32 v146, v191
v_mov_b32 v147, v191
s_lshl_b32 s62, s36, 17
s_lshl_b32 s34, s31, 12
s_add_u32 s62, s62, s34
s_add_u32 s62, s62, 8454144
v_accvgpr_read_b32 v76, a0
v_accvgpr_read_b32 v77, a1
v_accvgpr_read_b32 v78, a2
v_accvgpr_read_b32 v79, a3
v_accvgpr_read_b32 v80, a16
v_accvgpr_read_b32 v81, a17
v_accvgpr_read_b32 v82, a18
v_accvgpr_read_b32 v83, a19
v_pk_mul_f32 v[76:77], v[76:77], v[140:141]
v_pk_mul_f32 v[78:79], v[78:79], v[140:141]
v_pk_mul_f32 v[80:81], v[80:81], v[140:141]
v_pk_mul_f32 v[82:83], v[82:83], v[140:141]
v_cvt_pk_bf16_f32 v108, v76, v77
v_cvt_pk_bf16_f32 v109, v78, v79
v_cvt_pk_bf16_f32 v110, v80, v81
v_cvt_pk_bf16_f32 v111, v82, v83
buffer_store_dwordx4 v[108:111], v2, s[8:11], s62 offen offset:0 sc1
v_accvgpr_read_b32 v84, a32
v_accvgpr_read_b32 v85, a33
v_accvgpr_read_b32 v86, a34
v_accvgpr_read_b32 v87, a35
v_accvgpr_read_b32 v88, a48
v_accvgpr_read_b32 v89, a49
v_accvgpr_read_b32 v90, a50
v_accvgpr_read_b32 v91, a51
v_pk_mul_f32 v[84:85], v[84:85], v[140:141]
v_pk_mul_f32 v[86:87], v[86:87], v[140:141]
v_pk_mul_f32 v[88:89], v[88:89], v[140:141]
v_pk_mul_f32 v[90:91], v[90:91], v[140:141]
v_cvt_pk_bf16_f32 v112, v84, v85
v_cvt_pk_bf16_f32 v113, v86, v87
v_cvt_pk_bf16_f32 v114, v88, v89
v_cvt_pk_bf16_f32 v115, v90, v91
buffer_store_dwordx4 v[112:115], v2, s[8:11], s62 offen offset:1024 sc1
v_accvgpr_read_b32 v92, a64
v_accvgpr_read_b32 v93, a65
v_accvgpr_read_b32 v94, a66
v_accvgpr_read_b32 v95, a67
v_accvgpr_read_b32 v96, a80
v_accvgpr_read_b32 v97, a81
v_accvgpr_read_b32 v98, a82
v_accvgpr_read_b32 v99, a83
v_pk_mul_f32 v[92:93], v[92:93], v[140:141]
v_pk_mul_f32 v[94:95], v[94:95], v[140:141]
v_pk_mul_f32 v[96:97], v[96:97], v[140:141]
v_pk_mul_f32 v[98:99], v[98:99], v[140:141]
v_cvt_pk_bf16_f32 v116, v92, v93
v_cvt_pk_bf16_f32 v117, v94, v95
v_cvt_pk_bf16_f32 v118, v96, v97
v_cvt_pk_bf16_f32 v119, v98, v99
buffer_store_dwordx4 v[116:119], v2, s[8:11], s62 offen offset:2048 sc1
v_accvgpr_read_b32 v100, a96
v_accvgpr_read_b32 v101, a97
v_accvgpr_read_b32 v102, a98
v_accvgpr_read_b32 v103, a99
v_accvgpr_read_b32 v104, a112
v_accvgpr_read_b32 v105, a113
v_accvgpr_read_b32 v106, a114
v_accvgpr_read_b32 v107, a115
v_pk_mul_f32 v[100:101], v[100:101], v[140:141]
v_pk_mul_f32 v[102:103], v[102:103], v[140:141]
v_pk_mul_f32 v[104:105], v[104:105], v[140:141]
v_pk_mul_f32 v[106:107], v[106:107], v[140:141]
v_cvt_pk_bf16_f32 v120, v100, v101
v_cvt_pk_bf16_f32 v121, v102, v103
v_cvt_pk_bf16_f32 v122, v104, v105
v_cvt_pk_bf16_f32 v123, v106, v107
buffer_store_dwordx4 v[120:123], v2, s[8:11], s62 offen offset:3072 sc1
s_add_u32 s62, s62, 131072
v_accvgpr_read_b32 v76, a4
v_accvgpr_read_b32 v77, a5
v_accvgpr_read_b32 v78, a6
v_accvgpr_read_b32 v79, a7
v_accvgpr_read_b32 v80, a20
v_accvgpr_read_b32 v81, a21
v_accvgpr_read_b32 v82, a22
v_accvgpr_read_b32 v83, a23
v_pk_mul_f32 v[76:77], v[76:77], v[142:143]
v_pk_mul_f32 v[78:79], v[78:79], v[142:143]
v_pk_mul_f32 v[80:81], v[80:81], v[142:143]
v_pk_mul_f32 v[82:83], v[82:83], v[142:143]
v_cvt_pk_bf16_f32 v108, v76, v77
v_cvt_pk_bf16_f32 v109, v78, v79
v_cvt_pk_bf16_f32 v110, v80, v81
v_cvt_pk_bf16_f32 v111, v82, v83
buffer_store_dwordx4 v[108:111], v2, s[8:11], s62 offen offset:0 sc1
v_accvgpr_read_b32 v84, a36
v_accvgpr_read_b32 v85, a37
v_accvgpr_read_b32 v86, a38
v_accvgpr_read_b32 v87, a39
v_accvgpr_read_b32 v88, a52
v_accvgpr_read_b32 v89, a53
v_accvgpr_read_b32 v90, a54
v_accvgpr_read_b32 v91, a55
v_pk_mul_f32 v[84:85], v[84:85], v[142:143]
v_pk_mul_f32 v[86:87], v[86:87], v[142:143]
v_pk_mul_f32 v[88:89], v[88:89], v[142:143]
v_pk_mul_f32 v[90:91], v[90:91], v[142:143]
v_cvt_pk_bf16_f32 v112, v84, v85
v_cvt_pk_bf16_f32 v113, v86, v87
v_cvt_pk_bf16_f32 v114, v88, v89
v_cvt_pk_bf16_f32 v115, v90, v91
buffer_store_dwordx4 v[112:115], v2, s[8:11], s62 offen offset:1024 sc1
v_accvgpr_read_b32 v92, a68
v_accvgpr_read_b32 v93, a69
v_accvgpr_read_b32 v94, a70
v_accvgpr_read_b32 v95, a71
v_accvgpr_read_b32 v96, a84
v_accvgpr_read_b32 v97, a85
v_accvgpr_read_b32 v98, a86
v_accvgpr_read_b32 v99, a87
v_pk_mul_f32 v[92:93], v[92:93], v[142:143]
v_pk_mul_f32 v[94:95], v[94:95], v[142:143]
v_pk_mul_f32 v[96:97], v[96:97], v[142:143]
v_pk_mul_f32 v[98:99], v[98:99], v[142:143]
v_cvt_pk_bf16_f32 v116, v92, v93
v_cvt_pk_bf16_f32 v117, v94, v95
v_cvt_pk_bf16_f32 v118, v96, v97
v_cvt_pk_bf16_f32 v119, v98, v99
buffer_store_dwordx4 v[116:119], v2, s[8:11], s62 offen offset:2048 sc1
v_accvgpr_read_b32 v100, a100
v_accvgpr_read_b32 v101, a101
v_accvgpr_read_b32 v102, a102
v_accvgpr_read_b32 v103, a103
v_accvgpr_read_b32 v104, a116
v_accvgpr_read_b32 v105, a117
v_accvgpr_read_b32 v106, a118
v_accvgpr_read_b32 v107, a119
v_pk_mul_f32 v[100:101], v[100:101], v[142:143]
v_pk_mul_f32 v[102:103], v[102:103], v[142:143]
v_pk_mul_f32 v[104:105], v[104:105], v[142:143]
v_pk_mul_f32 v[106:107], v[106:107], v[142:143]
v_cvt_pk_bf16_f32 v120, v100, v101
v_cvt_pk_bf16_f32 v121, v102, v103
v_cvt_pk_bf16_f32 v122, v104, v105
v_cvt_pk_bf16_f32 v123, v106, v107
buffer_store_dwordx4 v[120:123], v2, s[8:11], s62 offen offset:3072 sc1
s_add_u32 s62, s62, 131072
v_accvgpr_read_b32 v76, a8
v_accvgpr_read_b32 v77, a9
v_accvgpr_read_b32 v78, a10
v_accvgpr_read_b32 v79, a11
v_accvgpr_read_b32 v80, a24
v_accvgpr_read_b32 v81, a25
v_accvgpr_read_b32 v82, a26
v_accvgpr_read_b32 v83, a27
v_pk_mul_f32 v[76:77], v[76:77], v[144:145]
v_pk_mul_f32 v[78:79], v[78:79], v[144:145]
v_pk_mul_f32 v[80:81], v[80:81], v[144:145]
v_pk_mul_f32 v[82:83], v[82:83], v[144:145]
v_cvt_pk_bf16_f32 v108, v76, v77
v_cvt_pk_bf16_f32 v109, v78, v79
v_cvt_pk_bf16_f32 v110, v80, v81
v_cvt_pk_bf16_f32 v111, v82, v83
buffer_store_dwordx4 v[108:111], v2, s[8:11], s62 offen offset:0 sc1
v_accvgpr_read_b32 v84, a40
v_accvgpr_read_b32 v85, a41
v_accvgpr_read_b32 v86, a42
v_accvgpr_read_b32 v87, a43
v_accvgpr_read_b32 v88, a56
v_accvgpr_read_b32 v89, a57
v_accvgpr_read_b32 v90, a58
v_accvgpr_read_b32 v91, a59
v_pk_mul_f32 v[84:85], v[84:85], v[144:145]
v_pk_mul_f32 v[86:87], v[86:87], v[144:145]
v_pk_mul_f32 v[88:89], v[88:89], v[144:145]
v_pk_mul_f32 v[90:91], v[90:91], v[144:145]
v_cvt_pk_bf16_f32 v112, v84, v85
v_cvt_pk_bf16_f32 v113, v86, v87
v_cvt_pk_bf16_f32 v114, v88, v89
v_cvt_pk_bf16_f32 v115, v90, v91
buffer_store_dwordx4 v[112:115], v2, s[8:11], s62 offen offset:1024 sc1
v_accvgpr_read_b32 v92, a72
v_accvgpr_read_b32 v93, a73
v_accvgpr_read_b32 v94, a74
v_accvgpr_read_b32 v95, a75
v_accvgpr_read_b32 v96, a88
v_accvgpr_read_b32 v97, a89
v_accvgpr_read_b32 v98, a90
v_accvgpr_read_b32 v99, a91
v_pk_mul_f32 v[92:93], v[92:93], v[144:145]
v_pk_mul_f32 v[94:95], v[94:95], v[144:145]
v_pk_mul_f32 v[96:97], v[96:97], v[144:145]
v_pk_mul_f32 v[98:99], v[98:99], v[144:145]
v_cvt_pk_bf16_f32 v116, v92, v93
v_cvt_pk_bf16_f32 v117, v94, v95
v_cvt_pk_bf16_f32 v118, v96, v97
v_cvt_pk_bf16_f32 v119, v98, v99
buffer_store_dwordx4 v[116:119], v2, s[8:11], s62 offen offset:2048 sc1
v_accvgpr_read_b32 v100, a104
v_accvgpr_read_b32 v101, a105
v_accvgpr_read_b32 v102, a106
v_accvgpr_read_b32 v103, a107
v_accvgpr_read_b32 v104, a120
v_accvgpr_read_b32 v105, a121
v_accvgpr_read_b32 v106, a122
v_accvgpr_read_b32 v107, a123
v_pk_mul_f32 v[100:101], v[100:101], v[144:145]
v_pk_mul_f32 v[102:103], v[102:103], v[144:145]
v_pk_mul_f32 v[104:105], v[104:105], v[144:145]
v_pk_mul_f32 v[106:107], v[106:107], v[144:145]
v_cvt_pk_bf16_f32 v120, v100, v101
v_cvt_pk_bf16_f32 v121, v102, v103
v_cvt_pk_bf16_f32 v122, v104, v105
v_cvt_pk_bf16_f32 v123, v106, v107
buffer_store_dwordx4 v[120:123], v2, s[8:11], s62 offen offset:3072 sc1
s_add_u32 s62, s62, 131072
v_accvgpr_read_b32 v76, a12
v_accvgpr_read_b32 v77, a13
v_accvgpr_read_b32 v78, a14
v_accvgpr_read_b32 v79, a15
v_accvgpr_read_b32 v80, a28
v_accvgpr_read_b32 v81, a29
v_accvgpr_read_b32 v82, a30
v_accvgpr_read_b32 v83, a31
v_pk_mul_f32 v[76:77], v[76:77], v[146:147]
v_pk_mul_f32 v[78:79], v[78:79], v[146:147]
v_pk_mul_f32 v[80:81], v[80:81], v[146:147]
v_pk_mul_f32 v[82:83], v[82:83], v[146:147]
v_cvt_pk_bf16_f32 v108, v76, v77
v_cvt_pk_bf16_f32 v109, v78, v79
v_cvt_pk_bf16_f32 v110, v80, v81
v_cvt_pk_bf16_f32 v111, v82, v83
buffer_store_dwordx4 v[108:111], v2, s[8:11], s62 offen offset:0 sc1
v_accvgpr_read_b32 v84, a44
v_accvgpr_read_b32 v85, a45
v_accvgpr_read_b32 v86, a46
v_accvgpr_read_b32 v87, a47
v_accvgpr_read_b32 v88, a60
v_accvgpr_read_b32 v89, a61
v_accvgpr_read_b32 v90, a62
v_accvgpr_read_b32 v91, a63
v_pk_mul_f32 v[84:85], v[84:85], v[146:147]
v_pk_mul_f32 v[86:87], v[86:87], v[146:147]
v_pk_mul_f32 v[88:89], v[88:89], v[146:147]
v_pk_mul_f32 v[90:91], v[90:91], v[146:147]
v_cvt_pk_bf16_f32 v112, v84, v85
v_cvt_pk_bf16_f32 v113, v86, v87
v_cvt_pk_bf16_f32 v114, v88, v89
v_cvt_pk_bf16_f32 v115, v90, v91
buffer_store_dwordx4 v[112:115], v2, s[8:11], s62 offen offset:1024 sc1
v_accvgpr_read_b32 v92, a76
v_accvgpr_read_b32 v93, a77
v_accvgpr_read_b32 v94, a78
v_accvgpr_read_b32 v95, a79
v_accvgpr_read_b32 v96, a92
v_accvgpr_read_b32 v97, a93
v_accvgpr_read_b32 v98, a94
v_accvgpr_read_b32 v99, a95
v_pk_mul_f32 v[92:93], v[92:93], v[146:147]
v_pk_mul_f32 v[94:95], v[94:95], v[146:147]
v_pk_mul_f32 v[96:97], v[96:97], v[146:147]
v_pk_mul_f32 v[98:99], v[98:99], v[146:147]
v_cvt_pk_bf16_f32 v116, v92, v93
v_cvt_pk_bf16_f32 v117, v94, v95
v_cvt_pk_bf16_f32 v118, v96, v97
v_cvt_pk_bf16_f32 v119, v98, v99
buffer_store_dwordx4 v[116:119], v2, s[8:11], s62 offen offset:2048 sc1
v_accvgpr_read_b32 v100, a108
v_accvgpr_read_b32 v101, a109
v_accvgpr_read_b32 v102, a110
v_accvgpr_read_b32 v103, a111
v_accvgpr_read_b32 v104, a124
v_accvgpr_read_b32 v105, a125
v_accvgpr_read_b32 v106, a126
v_accvgpr_read_b32 v107, a127
v_pk_mul_f32 v[100:101], v[100:101], v[146:147]
v_pk_mul_f32 v[102:103], v[102:103], v[146:147]
v_pk_mul_f32 v[104:105], v[104:105], v[146:147]
v_pk_mul_f32 v[106:107], v[106:107], v[146:147]
v_cvt_pk_bf16_f32 v120, v100, v101
v_cvt_pk_bf16_f32 v121, v102, v103
v_cvt_pk_bf16_f32 v122, v104, v105
v_cvt_pk_bf16_f32 v123, v106, v107
buffer_store_dwordx4 v[120:123], v2, s[8:11], s62 offen offset:3072 sc1
s_cmp_lg_u32 s45, 0
s_cbranch_scc1 L_at_ok
s_waitcnt lgkmcnt(0)
s_barrier
v_mov_b32 v203, 163824
ds_read_b128 v[204:207], v203
s_waitcnt lgkmcnt(0)
v_or_b32 v204, v204, v205
v_or_b32 v206, v206, v207
v_or_b32 v204, v204, v206
s_nop 0
v_readfirstlane_b32 s34, v204
s_nop 3
s_cmp_lg_u32 s34, 0
s_cbranch_scc1 L_at_fallback
L_at_ok:
s_lshl_b32 s3, s33, 5
s_add_u32 s3, s3, s31
L_phase_op:
s_barrier
s_load_dwordx2 s[4:5], s[0:1], 32
s_load_dwordx2 s[6:7], s[0:1], 104
s_load_dwordx2 s[8:9], s[0:1], 0
v_lshrrev_b32 v2, 6, v0
v_and_b32 v1, 63, v0
v_readfirstlane_b32 s24, v2
v_lshlrev_b32 v2, 4, v1
s_and_b32 s28, s2, 7
s_lshr_b32 s29, s2, 3
s_and_b32 s27, s28, 1
s_lshr_b32 s25, s28, 1
s_lshl_b32 s25, s25, 2
s_lshr_b32 s26, s29, 3
s_add_u32 s25, s25, s26
s_and_b32 s26, s29, 7
s_lshl_b32 s28, s24, 15
v_lshrrev_b32 v3, 4, v1
v_add_u32 v3, 0, v3
v_and_b32 v4, 7, v3
v_lshlrev_b32 v4, 1, v4
v_and_b32 v9, 15, v1
v_xor_b32 v4, v4, v9
v_lshlrev_b32 v3, 11, v3
v_lshl_add_u32 v3, v4, 4, v3
v_add_u32 v9, s28, v3
v_lshrrev_b32 v3, 4, v1
v_add_u32 v3, 4, v3
v_and_b32 v4, 7, v3
v_lshlrev_b32 v4, 1, v4
v_and_b32 v10, 15, v1
v_xor_b32 v4, v4, v10
v_lshlrev_b32 v3, 11, v3
v_lshl_add_u32 v3, v4, 4, v3
v_add_u32 v10, s28, v3
v_lshrrev_b32 v3, 4, v1
v_add_u32 v3, 8, v3
v_and_b32 v4, 7, v3
v_lshlrev_b32 v4, 1, v4
v_and_b32 v11, 15, v1
v_xor_b32 v4, v4, v11
v_lshlrev_b32 v3, 11, v3
v_lshl_add_u32 v3, v4, 4, v3
v_add_u32 v11, s28, v3
v_lshrrev_b32 v3, 4, v1
v_add_u32 v3, 12, v3
v_and_b32 v4, 7, v3
v_lshlrev_b32 v4, 1, v4
v_and_b32 v12, 15, v1
v_xor_b32 v4, v4, v12
v_lshlrev_b32 v3, 11, v3
v_lshl_add_u32 v3, v4, 4, v3
v_add_u32 v12, s28, v3
v_add_u32 v5, 0, v2
v_add_u32 v6, 131072, v2
s_waitcnt lgkmcnt(0)
s_mov_b32 s12, s4
s_and_b32 s13, s5, 0xffff
s_mov_b32 s14, 0x800000
s_mov_b32 s15, 0x20000
s_mov_b32 s16, s6
s_and_b32 s17, s7, 0xffff
s_mov_b32 s18, 0x10000000
s_mov_b32 s19, 0x20000
s_mov_b32 s20, s8
s_and_b32 s21, s9, 0xffff
s_mov_b32 s22, 0x400000
s_mov_b32 s23, 0x20000
s_lshl_b32 s31, s24, 12
s_lshl_b32 s32, s26, 8
s_mul_i32 s28, s27, 4194304
s_add_u32 s32, s32, s28
s_lshl_b32 s30, s25, 3
s_lshl_b32 s28, s24, 1
s_add_u32 s30, s30, s28
s_mul_i32 s33, s30, 131072
s_mul_i32 s28, s27, 65536
s_add_u32 s33, s33, s28
s_add_u32 s33, s33, 8454144
s_waitcnt vmcnt(0)
s_barrier
s_lshl_b32 s28, s3, 7
s_add_u32 s28, s28, 57016320
s_cmp_lg_u32 s24, 0
s_cbranch_scc1 L_opp_pubd
v_mov_b32 v3, 0
v_mov_b32 v4, 1
s_mov_b64 exec, 1
buffer_store_dword v4, v3, s[16:19], s28 offen sc1
s_mov_b64 exec, -1
L_opp_pubd:
s_add_u32 m0, s31, 0
s_nop 0
buffer_load_dwordx4 v9, s[12:15], s32 offen lds
s_add_u32 m0, s31, 1024
s_nop 0
buffer_load_dwordx4 v10, s[12:15], s32 offen lds
s_add_u32 m0, s31, 2048
s_nop 0
buffer_load_dwordx4 v11, s[12:15], s32 offen lds
s_add_u32 m0, s31, 3072
s_nop 0
buffer_load_dwordx4 v12, s[12:15], s32 offen lds
s_add_u32 s32, s32, 131072
s_add_u32 m0, s31, 16384
s_nop 0
buffer_load_dwordx4 v9, s[12:15], s32 offen lds
s_add_u32 m0, s31, 17408
s_nop 0
buffer_load_dwordx4 v10, s[12:15], s32 offen lds
s_add_u32 m0, s31, 18432
s_nop 0
buffer_load_dwordx4 v11, s[12:15], s32 offen lds
s_add_u32 m0, s31, 19456
s_nop 0
buffer_load_dwordx4 v12, s[12:15], s32 offen lds
s_add_u32 s32, s32, 131072
s_add_u32 m0, s31, 32768
s_nop 0
buffer_load_dwordx4 v9, s[12:15], s32 offen lds
s_add_u32 m0, s31, 33792
s_nop 0
buffer_load_dwordx4 v10, s[12:15], s32 offen lds
s_add_u32 m0, s31, 34816
s_nop 0
buffer_load_dwordx4 v11, s[12:15], s32 offen lds
s_add_u32 m0, s31, 35840
s_nop 0
buffer_load_dwordx4 v12, s[12:15], s32 offen lds
s_add_u32 s32, s32, 131072
s_lshl_b32 s38, s27, 3
v_bfe_u32 v3, v1, 1, 1
v_add_u32 v3, 0, v3
v_xor_b32 v3, s38, v3
v_bfe_u32 v4, v1, 2, 3
v_lshlrev_b32 v4, 1, v4
v_xor_b32 v3, v3, v4
v_lshrrev_b32 v4, 2, v1
v_lshlrev_b32 v4, 8, v4
v_lshl_add_u32 v3, v3, 4, v4
v_and_b32 v4, 1, v1
v_lshl_add_u32 v13, v4, 3, v3
v_add_u32 v21, 0x10000, v13
v_bfe_u32 v3, v1, 1, 1
v_add_u32 v3, 2, v3
v_xor_b32 v3, s38, v3
v_bfe_u32 v4, v1, 2, 3
v_lshlrev_b32 v4, 1, v4
v_xor_b32 v3, v3, v4
v_lshrrev_b32 v4, 2, v1
v_lshlrev_b32 v4, 8, v4
v_lshl_add_u32 v3, v3, 4, v4
v_and_b32 v4, 1, v1
v_lshl_add_u32 v14, v4, 3, v3
v_add_u32 v22, 0x10000, v14
v_bfe_u32 v3, v1, 1, 1
v_add_u32 v3, 4, v3
v_xor_b32 v3, s38, v3
v_bfe_u32 v4, v1, 2, 3
v_lshlrev_b32 v4, 1, v4
v_xor_b32 v3, v3, v4
v_lshrrev_b32 v4, 2, v1
v_lshlrev_b32 v4, 8, v4
v_lshl_add_u32 v3, v3, 4, v4
v_and_b32 v4, 1, v1
v_lshl_add_u32 v15, v4, 3, v3
v_add_u32 v23, 0x10000, v15
v_bfe_u32 v3, v1, 1, 1
v_add_u32 v3, 6, v3
v_xor_b32 v3, s38, v3
v_bfe_u32 v4, v1, 2, 3
v_lshlrev_b32 v4, 1, v4
v_xor_b32 v3, v3, v4
v_lshrrev_b32 v4, 2, v1
v_lshlrev_b32 v4, 8, v4
v_lshl_add_u32 v3, v3, 4, v4
v_and_b32 v4, 1, v1
v_lshl_add_u32 v16, v4, 3, v3
v_add_u32 v24, 0x10000, v16
v_bfe_u32 v3, v1, 1, 1
v_add_u32 v3, 8, v3
v_xor_b32 v3, s38, v3
v_bfe_u32 v4, v1, 2, 3
v_lshlrev_b32 v4, 1, v4
v_xor_b32 v3, v3, v4
v_lshrrev_b32 v4, 2, v1
v_lshlrev_b32 v4, 8, v4
v_lshl_add_u32 v3, v3, 4, v4
v_and_b32 v4, 1, v1
v_lshl_add_u32 v17, v4, 3, v3
v_add_u32 v25, 0x10000, v17
v_bfe_u32 v3, v1, 1, 1
v_add_u32 v3, 10, v3
v_xor_b32 v3, s38, v3
v_bfe_u32 v4, v1, 2, 3
v_lshlrev_b32 v4, 1, v4
v_xor_b32 v3, v3, v4
v_lshrrev_b32 v4, 2, v1
v_lshlrev_b32 v4, 8, v4
v_lshl_add_u32 v3, v3, 4, v4
v_and_b32 v4, 1, v1
v_lshl_add_u32 v18, v4, 3, v3
v_add_u32 v26, 0x10000, v18
v_bfe_u32 v3, v1, 1, 1
v_add_u32 v3, 12, v3
v_xor_b32 v3, s38, v3
v_bfe_u32 v4, v1, 2, 3
v_lshlrev_b32 v4, 1, v4
v_xor_b32 v3, v3, v4
v_lshrrev_b32 v4, 2, v1
v_lshlrev_b32 v4, 8, v4
v_lshl_add_u32 v3, v3, 4, v4
v_and_b32 v4, 1, v1
v_lshl_add_u32 v19, v4, 3, v3
v_add_u32 v27, 0x10000, v19
v_bfe_u32 v3, v1, 1, 1
v_add_u32 v3, 14, v3
v_xor_b32 v3, s38, v3
v_bfe_u32 v4, v1, 2, 3
v_lshlrev_b32 v4, 1, v4
v_xor_b32 v3, v3, v4
v_lshrrev_b32 v4, 2, v1
v_lshlrev_b32 v4, 8, v4
v_lshl_add_u32 v3, v3, 4, v4
v_and_b32 v4, 1, v1
v_lshl_add_u32 v20, v4, 3, v3
v_add_u32 v28, 0x10000, v20
v_mov_b32 v32, 0
v_mov_b32 v33, 0
v_mov_b32 v34, 0
v_mov_b32 v35, 0
v_mov_b32 v36, 0
v_mov_b32 v37, 0
v_mov_b32 v38, 0
v_mov_b32 v39, 0
v_mov_b32 v40, 0
v_mov_b32 v41, 0
v_mov_b32 v42, 0
v_mov_b32 v43, 0
v_mov_b32 v44, 0
v_mov_b32 v45, 0
v_mov_b32 v46, 0
v_mov_b32 v47, 0
v_mov_b32 v48, 0
v_mov_b32 v49, 0
v_mov_b32 v50, 0
v_mov_b32 v51, 0
v_mov_b32 v52, 0
v_mov_b32 v53, 0
v_mov_b32 v54, 0
v_mov_b32 v55, 0
v_mov_b32 v56, 0
v_mov_b32 v57, 0
v_mov_b32 v58, 0
v_mov_b32 v59, 0
v_mov_b32 v60, 0
v_mov_b32 v61, 0
v_mov_b32 v62, 0
v_mov_b32 v63, 0
v_mov_b32 v64, 0
v_mov_b32 v65, 0
v_mov_b32 v66, 0
v_mov_b32 v67, 0
v_mov_b32 v68, 0
v_mov_b32 v69, 0
v_mov_b32 v70, 0
v_mov_b32 v71, 0
v_mov_b32 v72, 0
v_mov_b32 v73, 0
v_mov_b32 v74, 0
v_mov_b32 v75, 0
v_mov_b32 v76, 0
v_mov_b32 v77, 0
v_mov_b32 v78, 0
v_mov_b32 v79, 0
v_mov_b32 v80, 0
v_mov_b32 v81, 0
v_mov_b32 v82, 0
v_mov_b32 v83, 0
v_mov_b32 v84, 0
v_mov_b32 v85, 0
v_mov_b32 v86, 0
v_mov_b32 v87, 0
v_mov_b32 v88, 0
v_mov_b32 v89, 0
v_mov_b32 v90, 0
v_mov_b32 v91, 0
v_mov_b32 v92, 0
v_mov_b32 v93, 0
v_mov_b32 v94, 0
v_mov_b32 v95, 0
s_lshr_b32 s28, s25, 1
s_lshl_b32 s28, s28, 5
s_lshl_b32 s29, s27, 4
s_add_u32 s28, s28, s29
s_lshl_b32 s28, s28, 7
s_add_u32 s28, s28, 57016320
v_and_b32 v3, 15, v1
v_lshlrev_b32 v3, 7, v3
s_mov_b32 s29, 0x200000
L_opw_aw:
buffer_load_dword v4, v3, s[16:19], s28 offen sc1
s_waitcnt vmcnt(0)
v_cmp_eq_u32 vcc, 0, v4
s_sub_u32 s29, s29, 1
s_cmp_eq_u32 s29, 0
s_cbranch_scc1 L_opw_awd
s_cmp_lg_u64 vcc, 0
s_cbranch_scc1 L_opw_aw
L_opw_awd:
buffer_load_dwordx4 a[0:3], v5, s[16:19], s33 offen offset:0 sc1
s_nop 0
buffer_load_dwordx4 a[4:7], v6, s[16:19], s33 offen offset:0 sc1
buffer_load_dwordx4 a[8:11], v5, s[16:19], s33 offen offset:1024 sc1
buffer_load_dwordx4 a[12:15], v6, s[16:19], s33 offen offset:1024 sc1
buffer_load_dwordx4 a[16:19], v5, s[16:19], s33 offen offset:2048 sc1
buffer_load_dwordx4 a[20:23], v6, s[16:19], s33 offen offset:2048 sc1
buffer_load_dwordx4 a[24:27], v5, s[16:19], s33 offen offset:3072 sc1
buffer_load_dwordx4 a[28:31], v6, s[16:19], s33 offen offset:3072 sc1
s_add_u32 s33, s33, 4096
buffer_load_dwordx4 a[32:35], v5, s[16:19], s33 offen offset:0 sc1
buffer_load_dwordx4 a[36:39], v6, s[16:19], s33 offen offset:0 sc1
buffer_load_dwordx4 a[40:43], v5, s[16:19], s33 offen offset:1024 sc1
buffer_load_dwordx4 a[44:47], v6, s[16:19], s33 offen offset:1024 sc1
s_waitcnt lgkmcnt(0)
s_barrier
ds_read_b64_tr_b16 a[128:129], v13 offset:0
ds_read_b64_tr_b16 a[130:131], v13 offset:4096
ds_read_b64_tr_b16 a[132:133], v13 offset:8192
ds_read_b64_tr_b16 a[134:135], v13 offset:12288
ds_read_b64_tr_b16 a[136:137], v14 offset:0
ds_read_b64_tr_b16 a[138:139], v14 offset:4096
ds_read_b64_tr_b16 a[140:141], v14 offset:8192
ds_read_b64_tr_b16 a[142:143], v14 offset:12288
ds_read_b64_tr_b16 a[144:145], v15 offset:0
ds_read_b64_tr_b16 a[146:147], v15 offset:4096
ds_read_b64_tr_b16 a[148:149], v15 offset:8192
ds_read_b64_tr_b16 a[150:151], v15 offset:12288
s_waitcnt vmcnt(8) lgkmcnt(8)
s_mov_b32 s34, 3
L_op_loop:
v_mfma_f32_16x16x32_bf16 v[32:35], a[128:131], a[0:3], v[32:35]
ds_read_b64_tr_b16 a[152:153], v16 offset:0
v_mfma_f32_16x16x32_bf16 v[32:35], a[132:135], a[8:11], v[32:35]
s_add_u32 m0, s31, 49152
ds_read_b64_tr_b16 a[154:155], v16 offset:4096
v_mfma_f32_16x16x32_bf16 v[36:39], a[132:135], a[12:15], v[36:39]
ds_read_b64_tr_b16 a[156:157], v16 offset:8192
buffer_load_dwordx4 v9, s[12:15], s32 offen lds
v_mfma_f32_16x16x32_bf16 v[36:39], a[128:131], a[4:7], v[36:39]
s_waitcnt lgkmcnt(7)
ds_read_b64_tr_b16 a[158:159], v16 offset:12288
buffer_load_dwordx4 a[48:51], v5, s[16:19], s33 offen offset:2048 sc1
v_mfma_f32_16x16x32_bf16 v[44:47], a[136:139], a[4:7], v[44:47]
ds_read_b64_tr_b16 a[128:129], v17 offset:0
v_mfma_f32_16x16x32_bf16 v[44:47], a[140:143], a[12:15], v[44:47]
s_add_u32 m0, s31, 50176
ds_read_b64_tr_b16 a[130:131], v17 offset:4096
v_mfma_f32_16x16x32_bf16 v[40:43], a[140:143], a[8:11], v[40:43]
ds_read_b64_tr_b16 a[132:133], v17 offset:8192
buffer_load_dwordx4 v10, s[12:15], s32 offen lds
v_mfma_f32_16x16x32_bf16 v[40:43], a[136:139], a[0:3], v[40:43]
s_waitcnt lgkmcnt(7)
ds_read_b64_tr_b16 a[134:135], v17 offset:12288
buffer_load_dwordx4 a[52:55], v6, s[16:19], s33 offen offset:2048 sc1
v_mfma_f32_16x16x32_bf16 v[48:51], a[144:147], a[0:3], v[48:51]
ds_read_b64_tr_b16 a[136:137], v18 offset:0
v_mfma_f32_16x16x32_bf16 v[48:51], a[148:151], a[8:11], v[48:51]
s_add_u32 m0, s31, 51200
ds_read_b64_tr_b16 a[138:139], v18 offset:4096
v_mfma_f32_16x16x32_bf16 v[52:55], a[148:151], a[12:15], v[52:55]
ds_read_b64_tr_b16 a[140:141], v18 offset:8192
buffer_load_dwordx4 v11, s[12:15], s32 offen lds
v_mfma_f32_16x16x32_bf16 v[52:55], a[144:147], a[4:7], v[52:55]
s_waitcnt lgkmcnt(7)
ds_read_b64_tr_b16 a[142:143], v18 offset:12288
buffer_load_dwordx4 a[56:59], v5, s[16:19], s33 offen offset:3072 sc1
v_mfma_f32_16x16x32_bf16 v[60:63], a[152:155], a[4:7], v[60:63]
ds_read_b64_tr_b16 a[144:145], v19 offset:0
v_mfma_f32_16x16x32_bf16 v[60:63], a[156:159], a[12:15], v[60:63]
s_add_u32 m0, s31, 52224
ds_read_b64_tr_b16 a[146:147], v19 offset:4096
v_mfma_f32_16x16x32_bf16 v[56:59], a[156:159], a[8:11], v[56:59]
ds_read_b64_tr_b16 a[148:149], v19 offset:8192
buffer_load_dwordx4 v12, s[12:15], s32 offen lds
s_add_u32 s32, s32, 131072
v_mfma_f32_16x16x32_bf16 v[56:59], a[152:155], a[0:3], v[56:59]
s_waitcnt lgkmcnt(7)
ds_read_b64_tr_b16 a[150:151], v19 offset:12288
buffer_load_dwordx4 a[60:63], v6, s[16:19], s33 offen offset:3072 sc1
s_add_u32 s33, s33, 4096
v_mfma_f32_16x16x32_bf16 v[64:67], a[128:131], a[0:3], v[64:67]
ds_read_b64_tr_b16 a[152:153], v20 offset:0
v_mfma_f32_16x16x32_bf16 v[64:67], a[132:135], a[8:11], v[64:67]
ds_read_b64_tr_b16 a[154:155], v20 offset:4096
v_mfma_f32_16x16x32_bf16 v[68:71], a[132:135], a[12:15], v[68:71]
ds_read_b64_tr_b16 a[156:157], v20 offset:8192
v_mfma_f32_16x16x32_bf16 v[68:71], a[128:131], a[4:7], v[68:71]
s_waitcnt lgkmcnt(7)
ds_read_b64_tr_b16 a[158:159], v20 offset:12288
v_mfma_f32_16x16x32_bf16 v[76:79], a[136:139], a[4:7], v[76:79]
s_waitcnt vmcnt(17)
s_barrier
ds_read_b64_tr_b16 a[128:129], v13 offset:16384
v_mfma_f32_16x16x32_bf16 v[76:79], a[140:143], a[12:15], v[76:79]
ds_read_b64_tr_b16 a[130:131], v13 offset:20480
v_mfma_f32_16x16x32_bf16 v[72:75], a[140:143], a[8:11], v[72:75]
ds_read_b64_tr_b16 a[132:133], v13 offset:24576
v_mfma_f32_16x16x32_bf16 v[72:75], a[136:139], a[0:3], v[72:75]
s_waitcnt lgkmcnt(7)
ds_read_b64_tr_b16 a[134:135], v13 offset:28672
v_mfma_f32_16x16x32_bf16 v[80:83], a[144:147], a[0:3], v[80:83]
ds_read_b64_tr_b16 a[136:137], v14 offset:16384
v_mfma_f32_16x16x32_bf16 v[80:83], a[148:151], a[8:11], v[80:83]
ds_read_b64_tr_b16 a[138:139], v14 offset:20480
v_mfma_f32_16x16x32_bf16 v[84:87], a[148:151], a[12:15], v[84:87]
ds_read_b64_tr_b16 a[140:141], v14 offset:24576
v_mfma_f32_16x16x32_bf16 v[84:87], a[144:147], a[4:7], v[84:87]
s_waitcnt lgkmcnt(7)
ds_read_b64_tr_b16 a[142:143], v14 offset:28672
v_mfma_f32_16x16x32_bf16 v[92:95], a[152:155], a[4:7], v[92:95]
ds_read_b64_tr_b16 a[144:145], v15 offset:16384
v_mfma_f32_16x16x32_bf16 v[92:95], a[156:159], a[12:15], v[92:95]
ds_read_b64_tr_b16 a[146:147], v15 offset:20480
v_mfma_f32_16x16x32_bf16 v[88:91], a[156:159], a[8:11], v[88:91]
ds_read_b64_tr_b16 a[148:149], v15 offset:24576
v_mfma_f32_16x16x32_bf16 v[88:91], a[152:155], a[0:3], v[88:91]
s_waitcnt vmcnt(12) lgkmcnt(7)
ds_read_b64_tr_b16 a[150:151], v15 offset:28672
v_mfma_f32_16x16x32_bf16 v[32:35], a[128:131], a[16:19], v[32:35]
ds_read_b64_tr_b16 a[152:153], v16 offset:16384
v_mfma_f32_16x16x32_bf16 v[32:35], a[132:135], a[24:27], v[32:35]
s_add_u32 m0, s31, 65536
ds_read_b64_tr_b16 a[154:155], v16 offset:20480
v_mfma_f32_16x16x32_bf16 v[36:39], a[132:135], a[28:31], v[36:39]
ds_read_b64_tr_b16 a[156:157], v16 offset:24576
buffer_load_dwordx4 v9, s[12:15], s32 offen lds
v_mfma_f32_16x16x32_bf16 v[36:39], a[128:131], a[20:23], v[36:39]
s_waitcnt lgkmcnt(7)
ds_read_b64_tr_b16 a[158:159], v16 offset:28672
buffer_load_dwordx4 a[64:67], v5, s[16:19], s33 offen offset:0 sc1
v_mfma_f32_16x16x32_bf16 v[44:47], a[136:139], a[20:23], v[44:47]
ds_read_b64_tr_b16 a[128:129], v17 offset:16384
v_mfma_f32_16x16x32_bf16 v[44:47], a[140:143], a[28:31], v[44:47]
s_add_u32 m0, s31, 66560
ds_read_b64_tr_b16 a[130:131], v17 offset:20480
v_mfma_f32_16x16x32_bf16 v[40:43], a[140:143], a[24:27], v[40:43]
ds_read_b64_tr_b16 a[132:133], v17 offset:24576
buffer_load_dwordx4 v10, s[12:15], s32 offen lds
v_mfma_f32_16x16x32_bf16 v[40:43], a[136:139], a[16:19], v[40:43]
s_waitcnt lgkmcnt(7)
ds_read_b64_tr_b16 a[134:135], v17 offset:28672
buffer_load_dwordx4 a[68:71], v6, s[16:19], s33 offen offset:0 sc1
v_mfma_f32_16x16x32_bf16 v[48:51], a[144:147], a[16:19], v[48:51]
ds_read_b64_tr_b16 a[136:137], v18 offset:16384
v_mfma_f32_16x16x32_bf16 v[48:51], a[148:151], a[24:27], v[48:51]
s_add_u32 m0, s31, 67584
ds_read_b64_tr_b16 a[138:139], v18 offset:20480
v_mfma_f32_16x16x32_bf16 v[52:55], a[148:151], a[28:31], v[52:55]
ds_read_b64_tr_b16 a[140:141], v18 offset:24576
buffer_load_dwordx4 v11, s[12:15], s32 offen lds
v_mfma_f32_16x16x32_bf16 v[52:55], a[144:147], a[20:23], v[52:55]
s_waitcnt lgkmcnt(7)
ds_read_b64_tr_b16 a[142:143], v18 offset:28672
buffer_load_dwordx4 a[72:75], v5, s[16:19], s33 offen offset:1024 sc1
v_mfma_f32_16x16x32_bf16 v[60:63], a[152:155], a[20:23], v[60:63]
ds_read_b64_tr_b16 a[144:145], v19 offset:16384
v_mfma_f32_16x16x32_bf16 v[60:63], a[156:159], a[28:31], v[60:63]
s_add_u32 m0, s31, 68608
ds_read_b64_tr_b16 a[146:147], v19 offset:20480
v_mfma_f32_16x16x32_bf16 v[56:59], a[156:159], a[24:27], v[56:59]
ds_read_b64_tr_b16 a[148:149], v19 offset:24576
buffer_load_dwordx4 v12, s[12:15], s32 offen lds
s_add_u32 s32, s32, 131072
v_mfma_f32_16x16x32_bf16 v[56:59], a[152:155], a[16:19], v[56:59]
s_waitcnt lgkmcnt(7)
ds_read_b64_tr_b16 a[150:151], v19 offset:28672
buffer_load_dwordx4 a[76:79], v6, s[16:19], s33 offen offset:1024 sc1
v_mfma_f32_16x16x32_bf16 v[64:67], a[128:131], a[16:19], v[64:67]
ds_read_b64_tr_b16 a[152:153], v20 offset:16384
v_mfma_f32_16x16x32_bf16 v[64:67], a[132:135], a[24:27], v[64:67]
ds_read_b64_tr_b16 a[154:155], v20 offset:20480
v_mfma_f32_16x16x32_bf16 v[68:71], a[132:135], a[28:31], v[68:71]
ds_read_b64_tr_b16 a[156:157], v20 offset:24576
v_mfma_f32_16x16x32_bf16 v[68:71], a[128:131], a[20:23], v[68:71]
s_waitcnt lgkmcnt(7)
ds_read_b64_tr_b16 a[158:159], v20 offset:28672
v_mfma_f32_16x16x32_bf16 v[76:79], a[136:139], a[20:23], v[76:79]
s_waitcnt vmcnt(17)
s_barrier
ds_read_b64_tr_b16 a[128:129], v13 offset:32768
v_mfma_f32_16x16x32_bf16 v[76:79], a[140:143], a[28:31], v[76:79]
ds_read_b64_tr_b16 a[130:131], v13 offset:36864
v_mfma_f32_16x16x32_bf16 v[72:75], a[140:143], a[24:27], v[72:75]
ds_read_b64_tr_b16 a[132:133], v13 offset:40960
v_mfma_f32_16x16x32_bf16 v[72:75], a[136:139], a[16:19], v[72:75]
s_waitcnt lgkmcnt(7)
ds_read_b64_tr_b16 a[134:135], v13 offset:45056
v_mfma_f32_16x16x32_bf16 v[80:83], a[144:147], a[16:19], v[80:83]
ds_read_b64_tr_b16 a[136:137], v14 offset:32768
v_mfma_f32_16x16x32_bf16 v[80:83], a[148:151], a[24:27], v[80:83]
ds_read_b64_tr_b16 a[138:139], v14 offset:36864
v_mfma_f32_16x16x32_bf16 v[84:87], a[148:151], a[28:31], v[84:87]
ds_read_b64_tr_b16 a[140:141], v14 offset:40960
v_mfma_f32_16x16x32_bf16 v[84:87], a[144:147], a[20:23], v[84:87]
s_waitcnt lgkmcnt(7)
ds_read_b64_tr_b16 a[142:143], v14 offset:45056
v_mfma_f32_16x16x32_bf16 v[92:95], a[152:155], a[20:23], v[92:95]
ds_read_b64_tr_b16 a[144:145], v15 offset:32768
v_mfma_f32_16x16x32_bf16 v[92:95], a[156:159], a[28:31], v[92:95]
ds_read_b64_tr_b16 a[146:147], v15 offset:36864
v_mfma_f32_16x16x32_bf16 v[88:91], a[156:159], a[24:27], v[88:91]
ds_read_b64_tr_b16 a[148:149], v15 offset:40960
v_mfma_f32_16x16x32_bf16 v[88:91], a[152:155], a[16:19], v[88:91]
s_waitcnt vmcnt(16) lgkmcnt(7)
ds_read_b64_tr_b16 a[150:151], v15 offset:45056
v_mfma_f32_16x16x32_bf16 v[32:35], a[128:131], a[32:35], v[32:35]
ds_read_b64_tr_b16 a[152:153], v16 offset:32768
v_mfma_f32_16x16x32_bf16 v[32:35], a[132:135], a[40:43], v[32:35]
s_add_u32 m0, s31, 81920
ds_read_b64_tr_b16 a[154:155], v16 offset:36864
v_mfma_f32_16x16x32_bf16 v[36:39], a[132:135], a[44:47], v[36:39]
ds_read_b64_tr_b16 a[156:157], v16 offset:40960
buffer_load_dwordx4 v9, s[12:15], s32 offen lds
v_mfma_f32_16x16x32_bf16 v[36:39], a[128:131], a[36:39], v[36:39]
s_waitcnt lgkmcnt(7)
ds_read_b64_tr_b16 a[158:159], v16 offset:45056
buffer_load_dwordx4 a[80:83], v5, s[16:19], s33 offen offset:2048 sc1
v_mfma_f32_16x16x32_bf16 v[44:47], a[136:139], a[36:39], v[44:47]
ds_read_b64_tr_b16 a[128:129], v17 offset:32768
v_mfma_f32_16x16x32_bf16 v[44:47], a[140:143], a[44:47], v[44:47]
s_add_u32 m0, s31, 82944
ds_read_b64_tr_b16 a[130:131], v17 offset:36864
v_mfma_f32_16x16x32_bf16 v[40:43], a[140:143], a[40:43], v[40:43]
ds_read_b64_tr_b16 a[132:133], v17 offset:40960
buffer_load_dwordx4 v10, s[12:15], s32 offen lds
v_mfma_f32_16x16x32_bf16 v[40:43], a[136:139], a[32:35], v[40:43]
s_waitcnt lgkmcnt(7)
ds_read_b64_tr_b16 a[134:135], v17 offset:45056
buffer_load_dwordx4 a[84:87], v6, s[16:19], s33 offen offset:2048 sc1
v_mfma_f32_16x16x32_bf16 v[48:51], a[144:147], a[32:35], v[48:51]
ds_read_b64_tr_b16 a[136:137], v18 offset:32768
v_mfma_f32_16x16x32_bf16 v[48:51], a[148:151], a[40:43], v[48:51]
s_add_u32 m0, s31, 83968
ds_read_b64_tr_b16 a[138:139], v18 offset:36864
v_mfma_f32_16x16x32_bf16 v[52:55], a[148:151], a[44:47], v[52:55]
ds_read_b64_tr_b16 a[140:141], v18 offset:40960
buffer_load_dwordx4 v11, s[12:15], s32 offen lds
v_mfma_f32_16x16x32_bf16 v[52:55], a[144:147], a[36:39], v[52:55]
s_waitcnt lgkmcnt(7)
ds_read_b64_tr_b16 a[142:143], v18 offset:45056
buffer_load_dwordx4 a[88:91], v5, s[16:19], s33 offen offset:3072 sc1
v_mfma_f32_16x16x32_bf16 v[60:63], a[152:155], a[36:39], v[60:63]
ds_read_b64_tr_b16 a[144:145], v19 offset:32768
v_mfma_f32_16x16x32_bf16 v[60:63], a[156:159], a[44:47], v[60:63]
s_add_u32 m0, s31, 84992
ds_read_b64_tr_b16 a[146:147], v19 offset:36864
v_mfma_f32_16x16x32_bf16 v[56:59], a[156:159], a[40:43], v[56:59]
ds_read_b64_tr_b16 a[148:149], v19 offset:40960
buffer_load_dwordx4 v12, s[12:15], s32 offen lds
s_add_u32 s32, s32, 131072
v_mfma_f32_16x16x32_bf16 v[56:59], a[152:155], a[32:35], v[56:59]
s_waitcnt lgkmcnt(7)
ds_read_b64_tr_b16 a[150:151], v19 offset:45056
buffer_load_dwordx4 a[92:95], v6, s[16:19], s33 offen offset:3072 sc1
s_add_u32 s33, s33, 4096
v_mfma_f32_16x16x32_bf16 v[64:67], a[128:131], a[32:35], v[64:67]
ds_read_b64_tr_b16 a[152:153], v20 offset:32768
v_mfma_f32_16x16x32_bf16 v[64:67], a[132:135], a[40:43], v[64:67]
ds_read_b64_tr_b16 a[154:155], v20 offset:36864
v_mfma_f32_16x16x32_bf16 v[68:71], a[132:135], a[44:47], v[68:71]
ds_read_b64_tr_b16 a[156:157], v20 offset:40960
v_mfma_f32_16x16x32_bf16 v[68:71], a[128:131], a[36:39], v[68:71]
s_waitcnt lgkmcnt(7)
ds_read_b64_tr_b16 a[158:159], v20 offset:45056
v_mfma_f32_16x16x32_bf16 v[76:79], a[136:139], a[36:39], v[76:79]
s_waitcnt vmcnt(17)
s_barrier
ds_read_b64_tr_b16 a[128:129], v13 offset:49152
v_mfma_f32_16x16x32_bf16 v[76:79], a[140:143], a[44:47], v[76:79]
ds_read_b64_tr_b16 a[130:131], v13 offset:53248
v_mfma_f32_16x16x32_bf16 v[72:75], a[140:143], a[40:43], v[72:75]
ds_read_b64_tr_b16 a[132:133], v13 offset:57344
v_mfma_f32_16x16x32_bf16 v[72:75], a[136:139], a[32:35], v[72:75]
s_waitcnt lgkmcnt(7)
ds_read_b64_tr_b16 a[134:135], v13 offset:61440
v_mfma_f32_16x16x32_bf16 v[80:83], a[144:147], a[32:35], v[80:83]
ds_read_b64_tr_b16 a[136:137], v14 offset:49152
v_mfma_f32_16x16x32_bf16 v[80:83], a[148:151], a[40:43], v[80:83]
ds_read_b64_tr_b16 a[138:139], v14 offset:53248
v_mfma_f32_16x16x32_bf16 v[84:87], a[148:151], a[44:47], v[84:87]
ds_read_b64_tr_b16 a[140:141], v14 offset:57344
v_mfma_f32_16x16x32_bf16 v[84:87], a[144:147], a[36:39], v[84:87]
s_waitcnt lgkmcnt(7)
ds_read_b64_tr_b16 a[142:143], v14 offset:61440
v_mfma_f32_16x16x32_bf16 v[92:95], a[152:155], a[36:39], v[92:95]
ds_read_b64_tr_b16 a[144:145], v15 offset:49152
v_mfma_f32_16x16x32_bf16 v[92:95], a[156:159], a[44:47], v[92:95]
ds_read_b64_tr_b16 a[146:147], v15 offset:53248
v_mfma_f32_16x16x32_bf16 v[88:91], a[156:159], a[40:43], v[88:91]
ds_read_b64_tr_b16 a[148:149], v15 offset:57344
v_mfma_f32_16x16x32_bf16 v[88:91], a[152:155], a[32:35], v[88:91]
s_waitcnt vmcnt(16) lgkmcnt(7)
ds_read_b64_tr_b16 a[150:151], v15 offset:61440
v_mfma_f32_16x16x32_bf16 v[32:35], a[128:131], a[48:51], v[32:35]
ds_read_b64_tr_b16 a[152:153], v16 offset:49152
v_mfma_f32_16x16x32_bf16 v[32:35], a[132:135], a[56:59], v[32:35]
s_add_u32 m0, s31, 98304
ds_read_b64_tr_b16 a[154:155], v16 offset:53248
v_mfma_f32_16x16x32_bf16 v[36:39], a[132:135], a[60:63], v[36:39]
ds_read_b64_tr_b16 a[156:157], v16 offset:57344
buffer_load_dwordx4 v9, s[12:15], s32 offen lds
v_mfma_f32_16x16x32_bf16 v[36:39], a[128:131], a[52:55], v[36:39]
s_waitcnt lgkmcnt(7)
ds_read_b64_tr_b16 a[158:159], v16 offset:61440
buffer_load_dwordx4 a[96:99], v5, s[16:19], s33 offen offset:0 sc1
v_mfma_f32_16x16x32_bf16 v[44:47], a[136:139], a[52:55], v[44:47]
ds_read_b64_tr_b16 a[128:129], v17 offset:49152
v_mfma_f32_16x16x32_bf16 v[44:47], a[140:143], a[60:63], v[44:47]
s_add_u32 m0, s31, 99328
ds_read_b64_tr_b16 a[130:131], v17 offset:53248
v_mfma_f32_16x16x32_bf16 v[40:43], a[140:143], a[56:59], v[40:43]
ds_read_b64_tr_b16 a[132:133], v17 offset:57344
buffer_load_dwordx4 v10, s[12:15], s32 offen lds
v_mfma_f32_16x16x32_bf16 v[40:43], a[136:139], a[48:51], v[40:43]
s_waitcnt lgkmcnt(7)
ds_read_b64_tr_b16 a[134:135], v17 offset:61440
buffer_load_dwordx4 a[100:103], v6, s[16:19], s33 offen offset:0 sc1
v_mfma_f32_16x16x32_bf16 v[48:51], a[144:147], a[48:51], v[48:51]
ds_read_b64_tr_b16 a[136:137], v18 offset:49152
v_mfma_f32_16x16x32_bf16 v[48:51], a[148:151], a[56:59], v[48:51]
s_add_u32 m0, s31, 100352
ds_read_b64_tr_b16 a[138:139], v18 offset:53248
v_mfma_f32_16x16x32_bf16 v[52:55], a[148:151], a[60:63], v[52:55]
ds_read_b64_tr_b16 a[140:141], v18 offset:57344
buffer_load_dwordx4 v11, s[12:15], s32 offen lds
v_mfma_f32_16x16x32_bf16 v[52:55], a[144:147], a[52:55], v[52:55]
s_waitcnt lgkmcnt(7)
ds_read_b64_tr_b16 a[142:143], v18 offset:61440
buffer_load_dwordx4 a[104:107], v5, s[16:19], s33 offen offset:1024 sc1
v_mfma_f32_16x16x32_bf16 v[60:63], a[152:155], a[52:55], v[60:63]
ds_read_b64_tr_b16 a[144:145], v19 offset:49152
v_mfma_f32_16x16x32_bf16 v[60:63], a[156:159], a[60:63], v[60:63]
s_add_u32 m0, s31, 101376
ds_read_b64_tr_b16 a[146:147], v19 offset:53248
v_mfma_f32_16x16x32_bf16 v[56:59], a[156:159], a[56:59], v[56:59]
ds_read_b64_tr_b16 a[148:149], v19 offset:57344
buffer_load_dwordx4 v12, s[12:15], s32 offen lds
s_add_u32 s32, s32, 131072
v_mfma_f32_16x16x32_bf16 v[56:59], a[152:155], a[48:51], v[56:59]
s_waitcnt lgkmcnt(7)
ds_read_b64_tr_b16 a[150:151], v19 offset:61440
buffer_load_dwordx4 a[108:111], v6, s[16:19], s33 offen offset:1024 sc1
v_mfma_f32_16x16x32_bf16 v[64:67], a[128:131], a[48:51], v[64:67]
ds_read_b64_tr_b16 a[152:153], v20 offset:49152
v_mfma_f32_16x16x32_bf16 v[64:67], a[132:135], a[56:59], v[64:67]
ds_read_b64_tr_b16 a[154:155], v20 offset:53248
v_mfma_f32_16x16x32_bf16 v[68:71], a[132:135], a[60:63], v[68:71]
ds_read_b64_tr_b16 a[156:157], v20 offset:57344
v_mfma_f32_16x16x32_bf16 v[68:71], a[128:131], a[52:55], v[68:71]
s_waitcnt lgkmcnt(7)
ds_read_b64_tr_b16 a[158:159], v20 offset:61440
v_mfma_f32_16x16x32_bf16 v[76:79], a[136:139], a[52:55], v[76:79]
s_waitcnt vmcnt(17)
s_barrier
ds_read_b64_tr_b16 a[128:129], v21 offset:0
v_mfma_f32_16x16x32_bf16 v[76:79], a[140:143], a[60:63], v[76:79]
ds_read_b64_tr_b16 a[130:131], v21 offset:4096
v_mfma_f32_16x16x32_bf16 v[72:75], a[140:143], a[56:59], v[72:75]
ds_read_b64_tr_b16 a[132:133], v21 offset:8192
v_mfma_f32_16x16x32_bf16 v[72:75], a[136:139], a[48:51], v[72:75]
s_waitcnt lgkmcnt(7)
ds_read_b64_tr_b16 a[134:135], v21 offset:12288
v_mfma_f32_16x16x32_bf16 v[80:83], a[144:147], a[48:51], v[80:83]
ds_read_b64_tr_b16 a[136:137], v22 offset:0
v_mfma_f32_16x16x32_bf16 v[80:83], a[148:151], a[56:59], v[80:83]
ds_read_b64_tr_b16 a[138:139], v22 offset:4096
v_mfma_f32_16x16x32_bf16 v[84:87], a[148:151], a[60:63], v[84:87]
ds_read_b64_tr_b16 a[140:141], v22 offset:8192
v_mfma_f32_16x16x32_bf16 v[84:87], a[144:147], a[52:55], v[84:87]
s_waitcnt lgkmcnt(7)
ds_read_b64_tr_b16 a[142:143], v22 offset:12288
v_mfma_f32_16x16x32_bf16 v[92:95], a[152:155], a[52:55], v[92:95]
ds_read_b64_tr_b16 a[144:145], v23 offset:0
v_mfma_f32_16x16x32_bf16 v[92:95], a[156:159], a[60:63], v[92:95]
ds_read_b64_tr_b16 a[146:147], v23 offset:4096
v_mfma_f32_16x16x32_bf16 v[88:91], a[156:159], a[56:59], v[88:91]
ds_read_b64_tr_b16 a[148:149], v23 offset:8192
v_mfma_f32_16x16x32_bf16 v[88:91], a[152:155], a[48:51], v[88:91]
s_waitcnt vmcnt(16) lgkmcnt(7)
ds_read_b64_tr_b16 a[150:151], v23 offset:12288
v_mfma_f32_16x16x32_bf16 v[32:35], a[128:131], a[64:67], v[32:35]
ds_read_b64_tr_b16 a[152:153], v24 offset:0
v_mfma_f32_16x16x32_bf16 v[32:35], a[132:135], a[72:75], v[32:35]
s_add_u32 m0, s31, 114688
ds_read_b64_tr_b16 a[154:155], v24 offset:4096
v_mfma_f32_16x16x32_bf16 v[36:39], a[132:135], a[76:79], v[36:39]
ds_read_b64_tr_b16 a[156:157], v24 offset:8192
buffer_load_dwordx4 v9, s[12:15], s32 offen lds
v_mfma_f32_16x16x32_bf16 v[36:39], a[128:131], a[68:71], v[36:39]
s_waitcnt lgkmcnt(7)
ds_read_b64_tr_b16 a[158:159], v24 offset:12288
buffer_load_dwordx4 a[112:115], v5, s[16:19], s33 offen offset:2048 sc1
v_mfma_f32_16x16x32_bf16 v[44:47], a[136:139], a[68:71], v[44:47]
ds_read_b64_tr_b16 a[128:129], v25 offset:0
v_mfma_f32_16x16x32_bf16 v[44:47], a[140:143], a[76:79], v[44:47]
s_add_u32 m0, s31, 115712
ds_read_b64_tr_b16 a[130:131], v25 offset:4096
v_mfma_f32_16x16x32_bf16 v[40:43], a[140:143], a[72:75], v[40:43]
ds_read_b64_tr_b16 a[132:133], v25 offset:8192
buffer_load_dwordx4 v10, s[12:15], s32 offen lds
v_mfma_f32_16x16x32_bf16 v[40:43], a[136:139], a[64:67], v[40:43]
s_waitcnt lgkmcnt(7)
ds_read_b64_tr_b16 a[134:135], v25 offset:12288
buffer_load_dwordx4 a[116:119], v6, s[16:19], s33 offen offset:2048 sc1
v_mfma_f32_16x16x32_bf16 v[48:51], a[144:147], a[64:67], v[48:51]
ds_read_b64_tr_b16 a[136:137], v26 offset:0
v_mfma_f32_16x16x32_bf16 v[48:51], a[148:151], a[72:75], v[48:51]
s_add_u32 m0, s31, 116736
ds_read_b64_tr_b16 a[138:139], v26 offset:4096
v_mfma_f32_16x16x32_bf16 v[52:55], a[148:151], a[76:79], v[52:55]
ds_read_b64_tr_b16 a[140:141], v26 offset:8192
buffer_load_dwordx4 v11, s[12:15], s32 offen lds
v_mfma_f32_16x16x32_bf16 v[52:55], a[144:147], a[68:71], v[52:55]
s_waitcnt lgkmcnt(7)
ds_read_b64_tr_b16 a[142:143], v26 offset:12288
buffer_load_dwordx4 a[120:123], v5, s[16:19], s33 offen offset:3072 sc1
v_mfma_f32_16x16x32_bf16 v[60:63], a[152:155], a[68:71], v[60:63]
ds_read_b64_tr_b16 a[144:145], v27 offset:0
v_mfma_f32_16x16x32_bf16 v[60:63], a[156:159], a[76:79], v[60:63]
s_add_u32 m0, s31, 117760
ds_read_b64_tr_b16 a[146:147], v27 offset:4096
v_mfma_f32_16x16x32_bf16 v[56:59], a[156:159], a[72:75], v[56:59]
ds_read_b64_tr_b16 a[148:149], v27 offset:8192
buffer_load_dwordx4 v12, s[12:15], s32 offen lds
s_add_u32 s32, s32, 131072
v_mfma_f32_16x16x32_bf16 v[56:59], a[152:155], a[64:67], v[56:59]
s_waitcnt lgkmcnt(7)
ds_read_b64_tr_b16 a[150:151], v27 offset:12288
buffer_load_dwordx4 a[124:127], v6, s[16:19], s33 offen offset:3072 sc1
s_add_u32 s33, s33, 4096
v_mfma_f32_16x16x32_bf16 v[64:67], a[128:131], a[64:67], v[64:67]
ds_read_b64_tr_b16 a[152:153], v28 offset:0
v_mfma_f32_16x16x32_bf16 v[64:67], a[132:135], a[72:75], v[64:67]
ds_read_b64_tr_b16 a[154:155], v28 offset:4096
v_mfma_f32_16x16x32_bf16 v[68:71], a[132:135], a[76:79], v[68:71]
ds_read_b64_tr_b16 a[156:157], v28 offset:8192
v_mfma_f32_16x16x32_bf16 v[68:71], a[128:131], a[68:71], v[68:71]
s_waitcnt lgkmcnt(7)
ds_read_b64_tr_b16 a[158:159], v28 offset:12288
v_mfma_f32_16x16x32_bf16 v[76:79], a[136:139], a[68:71], v[76:79]
s_waitcnt vmcnt(17)
s_barrier
ds_read_b64_tr_b16 a[128:129], v21 offset:16384
v_mfma_f32_16x16x32_bf16 v[76:79], a[140:143], a[76:79], v[76:79]
ds_read_b64_tr_b16 a[130:131], v21 offset:20480
v_mfma_f32_16x16x32_bf16 v[72:75], a[140:143], a[72:75], v[72:75]
ds_read_b64_tr_b16 a[132:133], v21 offset:24576
v_mfma_f32_16x16x32_bf16 v[72:75], a[136:139], a[64:67], v[72:75]
s_waitcnt lgkmcnt(7)
ds_read_b64_tr_b16 a[134:135], v21 offset:28672
v_mfma_f32_16x16x32_bf16 v[80:83], a[144:147], a[64:67], v[80:83]
ds_read_b64_tr_b16 a[136:137], v22 offset:16384
v_mfma_f32_16x16x32_bf16 v[80:83], a[148:151], a[72:75], v[80:83]
ds_read_b64_tr_b16 a[138:139], v22 offset:20480
v_mfma_f32_16x16x32_bf16 v[84:87], a[148:151], a[76:79], v[84:87]
ds_read_b64_tr_b16 a[140:141], v22 offset:24576
v_mfma_f32_16x16x32_bf16 v[84:87], a[144:147], a[68:71], v[84:87]
s_waitcnt lgkmcnt(7)
ds_read_b64_tr_b16 a[142:143], v22 offset:28672
v_mfma_f32_16x16x32_bf16 v[92:95], a[152:155], a[68:71], v[92:95]
ds_read_b64_tr_b16 a[144:145], v23 offset:16384
v_mfma_f32_16x16x32_bf16 v[92:95], a[156:159], a[76:79], v[92:95]
ds_read_b64_tr_b16 a[146:147], v23 offset:20480
v_mfma_f32_16x16x32_bf16 v[88:91], a[156:159], a[72:75], v[88:91]
ds_read_b64_tr_b16 a[148:149], v23 offset:24576
v_mfma_f32_16x16x32_bf16 v[88:91], a[152:155], a[64:67], v[88:91]
s_waitcnt vmcnt(16) lgkmcnt(7)
ds_read_b64_tr_b16 a[150:151], v23 offset:28672
v_mfma_f32_16x16x32_bf16 v[32:35], a[128:131], a[80:83], v[32:35]
ds_read_b64_tr_b16 a[152:153], v24 offset:16384
v_mfma_f32_16x16x32_bf16 v[32:35], a[132:135], a[88:91], v[32:35]
s_add_u32 m0, s31, 0
ds_read_b64_tr_b16 a[154:155], v24 offset:20480
v_mfma_f32_16x16x32_bf16 v[36:39], a[132:135], a[92:95], v[36:39]
ds_read_b64_tr_b16 a[156:157], v24 offset:24576
buffer_load_dwordx4 v9, s[12:15], s32 offen lds
v_mfma_f32_16x16x32_bf16 v[36:39], a[128:131], a[84:87], v[36:39]
s_waitcnt lgkmcnt(7)
ds_read_b64_tr_b16 a[158:159], v24 offset:28672
buffer_load_dwordx4 a[0:3], v5, s[16:19], s33 offen offset:0 sc1
v_mfma_f32_16x16x32_bf16 v[44:47], a[136:139], a[84:87], v[44:47]
ds_read_b64_tr_b16 a[128:129], v25 offset:16384
v_mfma_f32_16x16x32_bf16 v[44:47], a[140:143], a[92:95], v[44:47]
s_add_u32 m0, s31, 1024
ds_read_b64_tr_b16 a[130:131], v25 offset:20480
v_mfma_f32_16x16x32_bf16 v[40:43], a[140:143], a[88:91], v[40:43]
ds_read_b64_tr_b16 a[132:133], v25 offset:24576
buffer_load_dwordx4 v10, s[12:15], s32 offen lds
v_mfma_f32_16x16x32_bf16 v[40:43], a[136:139], a[80:83], v[40:43]
s_waitcnt lgkmcnt(7)
ds_read_b64_tr_b16 a[134:135], v25 offset:28672
buffer_load_dwordx4 a[4:7], v6, s[16:19], s33 offen offset:0 sc1
v_mfma_f32_16x16x32_bf16 v[48:51], a[144:147], a[80:83], v[48:51]
ds_read_b64_tr_b16 a[136:137], v26 offset:16384
v_mfma_f32_16x16x32_bf16 v[48:51], a[148:151], a[88:91], v[48:51]
s_add_u32 m0, s31, 2048
ds_read_b64_tr_b16 a[138:139], v26 offset:20480
v_mfma_f32_16x16x32_bf16 v[52:55], a[148:151], a[92:95], v[52:55]
ds_read_b64_tr_b16 a[140:141], v26 offset:24576
buffer_load_dwordx4 v11, s[12:15], s32 offen lds
v_mfma_f32_16x16x32_bf16 v[52:55], a[144:147], a[84:87], v[52:55]
s_waitcnt lgkmcnt(7)
ds_read_b64_tr_b16 a[142:143], v26 offset:28672
buffer_load_dwordx4 a[8:11], v5, s[16:19], s33 offen offset:1024 sc1
v_mfma_f32_16x16x32_bf16 v[60:63], a[152:155], a[84:87], v[60:63]
ds_read_b64_tr_b16 a[144:145], v27 offset:16384
v_mfma_f32_16x16x32_bf16 v[60:63], a[156:159], a[92:95], v[60:63]
s_add_u32 m0, s31, 3072
ds_read_b64_tr_b16 a[146:147], v27 offset:20480
v_mfma_f32_16x16x32_bf16 v[56:59], a[156:159], a[88:91], v[56:59]
ds_read_b64_tr_b16 a[148:149], v27 offset:24576
buffer_load_dwordx4 v12, s[12:15], s32 offen lds
s_add_u32 s32, s32, 131072
v_mfma_f32_16x16x32_bf16 v[56:59], a[152:155], a[80:83], v[56:59]
s_waitcnt lgkmcnt(7)
ds_read_b64_tr_b16 a[150:151], v27 offset:28672
buffer_load_dwordx4 a[12:15], v6, s[16:19], s33 offen offset:1024 sc1
v_mfma_f32_16x16x32_bf16 v[64:67], a[128:131], a[80:83], v[64:67]
ds_read_b64_tr_b16 a[152:153], v28 offset:16384
v_mfma_f32_16x16x32_bf16 v[64:67], a[132:135], a[88:91], v[64:67]
ds_read_b64_tr_b16 a[154:155], v28 offset:20480
v_mfma_f32_16x16x32_bf16 v[68:71], a[132:135], a[92:95], v[68:71]
ds_read_b64_tr_b16 a[156:157], v28 offset:24576
v_mfma_f32_16x16x32_bf16 v[68:71], a[128:131], a[84:87], v[68:71]
s_waitcnt lgkmcnt(7)
ds_read_b64_tr_b16 a[158:159], v28 offset:28672
v_mfma_f32_16x16x32_bf16 v[76:79], a[136:139], a[84:87], v[76:79]
s_waitcnt vmcnt(17)
s_barrier
ds_read_b64_tr_b16 a[128:129], v21 offset:32768
v_mfma_f32_16x16x32_bf16 v[76:79], a[140:143], a[92:95], v[76:79]
ds_read_b64_tr_b16 a[130:131], v21 offset:36864
v_mfma_f32_16x16x32_bf16 v[72:75], a[140:143], a[88:91], v[72:75]
ds_read_b64_tr_b16 a[132:133], v21 offset:40960
v_mfma_f32_16x16x32_bf16 v[72:75], a[136:139], a[80:83], v[72:75]
s_waitcnt lgkmcnt(7)
ds_read_b64_tr_b16 a[134:135], v21 offset:45056
v_mfma_f32_16x16x32_bf16 v[80:83], a[144:147], a[80:83], v[80:83]
ds_read_b64_tr_b16 a[136:137], v22 offset:32768
v_mfma_f32_16x16x32_bf16 v[80:83], a[148:151], a[88:91], v[80:83]
ds_read_b64_tr_b16 a[138:139], v22 offset:36864
v_mfma_f32_16x16x32_bf16 v[84:87], a[148:151], a[92:95], v[84:87]
ds_read_b64_tr_b16 a[140:141], v22 offset:40960
v_mfma_f32_16x16x32_bf16 v[84:87], a[144:147], a[84:87], v[84:87]
s_waitcnt lgkmcnt(7)
ds_read_b64_tr_b16 a[142:143], v22 offset:45056
v_mfma_f32_16x16x32_bf16 v[92:95], a[152:155], a[84:87], v[92:95]
ds_read_b64_tr_b16 a[144:145], v23 offset:32768
v_mfma_f32_16x16x32_bf16 v[92:95], a[156:159], a[92:95], v[92:95]
ds_read_b64_tr_b16 a[146:147], v23 offset:36864
v_mfma_f32_16x16x32_bf16 v[88:91], a[156:159], a[88:91], v[88:91]
ds_read_b64_tr_b16 a[148:149], v23 offset:40960
v_mfma_f32_16x16x32_bf16 v[88:91], a[152:155], a[80:83], v[88:91]
s_waitcnt vmcnt(16) lgkmcnt(7)
ds_read_b64_tr_b16 a[150:151], v23 offset:45056
v_mfma_f32_16x16x32_bf16 v[32:35], a[128:131], a[96:99], v[32:35]
ds_read_b64_tr_b16 a[152:153], v24 offset:32768
v_mfma_f32_16x16x32_bf16 v[32:35], a[132:135], a[104:107], v[32:35]
s_add_u32 m0, s31, 16384
ds_read_b64_tr_b16 a[154:155], v24 offset:36864
v_mfma_f32_16x16x32_bf16 v[36:39], a[132:135], a[108:111], v[36:39]
ds_read_b64_tr_b16 a[156:157], v24 offset:40960
buffer_load_dwordx4 v9, s[12:15], s32 offen lds
v_mfma_f32_16x16x32_bf16 v[36:39], a[128:131], a[100:103], v[36:39]
s_waitcnt lgkmcnt(7)
ds_read_b64_tr_b16 a[158:159], v24 offset:45056
buffer_load_dwordx4 a[16:19], v5, s[16:19], s33 offen offset:2048 sc1
v_mfma_f32_16x16x32_bf16 v[44:47], a[136:139], a[100:103], v[44:47]
ds_read_b64_tr_b16 a[128:129], v25 offset:32768
v_mfma_f32_16x16x32_bf16 v[44:47], a[140:143], a[108:111], v[44:47]
s_add_u32 m0, s31, 17408
ds_read_b64_tr_b16 a[130:131], v25 offset:36864
v_mfma_f32_16x16x32_bf16 v[40:43], a[140:143], a[104:107], v[40:43]
ds_read_b64_tr_b16 a[132:133], v25 offset:40960
buffer_load_dwordx4 v10, s[12:15], s32 offen lds
v_mfma_f32_16x16x32_bf16 v[40:43], a[136:139], a[96:99], v[40:43]
s_waitcnt lgkmcnt(7)
ds_read_b64_tr_b16 a[134:135], v25 offset:45056
buffer_load_dwordx4 a[20:23], v6, s[16:19], s33 offen offset:2048 sc1
v_mfma_f32_16x16x32_bf16 v[48:51], a[144:147], a[96:99], v[48:51]
ds_read_b64_tr_b16 a[136:137], v26 offset:32768
v_mfma_f32_16x16x32_bf16 v[48:51], a[148:151], a[104:107], v[48:51]
s_add_u32 m0, s31, 18432
ds_read_b64_tr_b16 a[138:139], v26 offset:36864
v_mfma_f32_16x16x32_bf16 v[52:55], a[148:151], a[108:111], v[52:55]
ds_read_b64_tr_b16 a[140:141], v26 offset:40960
buffer_load_dwordx4 v11, s[12:15], s32 offen lds
v_mfma_f32_16x16x32_bf16 v[52:55], a[144:147], a[100:103], v[52:55]
s_waitcnt lgkmcnt(7)
ds_read_b64_tr_b16 a[142:143], v26 offset:45056
buffer_load_dwordx4 a[24:27], v5, s[16:19], s33 offen offset:3072 sc1
v_mfma_f32_16x16x32_bf16 v[60:63], a[152:155], a[100:103], v[60:63]
ds_read_b64_tr_b16 a[144:145], v27 offset:32768
v_mfma_f32_16x16x32_bf16 v[60:63], a[156:159], a[108:111], v[60:63]
s_add_u32 m0, s31, 19456
ds_read_b64_tr_b16 a[146:147], v27 offset:36864
v_mfma_f32_16x16x32_bf16 v[56:59], a[156:159], a[104:107], v[56:59]
ds_read_b64_tr_b16 a[148:149], v27 offset:40960
buffer_load_dwordx4 v12, s[12:15], s32 offen lds
s_add_u32 s32, s32, 131072
v_mfma_f32_16x16x32_bf16 v[56:59], a[152:155], a[96:99], v[56:59]
s_waitcnt lgkmcnt(7)
ds_read_b64_tr_b16 a[150:151], v27 offset:45056
buffer_load_dwordx4 a[28:31], v6, s[16:19], s33 offen offset:3072 sc1
s_add_u32 s33, s33, 4096
v_mfma_f32_16x16x32_bf16 v[64:67], a[128:131], a[96:99], v[64:67]
ds_read_b64_tr_b16 a[152:153], v28 offset:32768
v_mfma_f32_16x16x32_bf16 v[64:67], a[132:135], a[104:107], v[64:67]
ds_read_b64_tr_b16 a[154:155], v28 offset:36864
v_mfma_f32_16x16x32_bf16 v[68:71], a[132:135], a[108:111], v[68:71]
ds_read_b64_tr_b16 a[156:157], v28 offset:40960
v_mfma_f32_16x16x32_bf16 v[68:71], a[128:131], a[100:103], v[68:71]
s_waitcnt lgkmcnt(7)
ds_read_b64_tr_b16 a[158:159], v28 offset:45056
v_mfma_f32_16x16x32_bf16 v[76:79], a[136:139], a[100:103], v[76:79]
s_waitcnt vmcnt(17)
s_barrier
ds_read_b64_tr_b16 a[128:129], v21 offset:49152
v_mfma_f32_16x16x32_bf16 v[76:79], a[140:143], a[108:111], v[76:79]
ds_read_b64_tr_b16 a[130:131], v21 offset:53248
v_mfma_f32_16x16x32_bf16 v[72:75], a[140:143], a[104:107], v[72:75]
ds_read_b64_tr_b16 a[132:133], v21 offset:57344
v_mfma_f32_16x16x32_bf16 v[72:75], a[136:139], a[96:99], v[72:75]
s_waitcnt lgkmcnt(7)
ds_read_b64_tr_b16 a[134:135], v21 offset:61440
v_mfma_f32_16x16x32_bf16 v[80:83], a[144:147], a[96:99], v[80:83]
ds_read_b64_tr_b16 a[136:137], v22 offset:49152
v_mfma_f32_16x16x32_bf16 v[80:83], a[148:151], a[104:107], v[80:83]
ds_read_b64_tr_b16 a[138:139], v22 offset:53248
v_mfma_f32_16x16x32_bf16 v[84:87], a[148:151], a[108:111], v[84:87]
ds_read_b64_tr_b16 a[140:141], v22 offset:57344
v_mfma_f32_16x16x32_bf16 v[84:87], a[144:147], a[100:103], v[84:87]
s_waitcnt lgkmcnt(7)
ds_read_b64_tr_b16 a[142:143], v22 offset:61440
v_mfma_f32_16x16x32_bf16 v[92:95], a[152:155], a[100:103], v[92:95]
ds_read_b64_tr_b16 a[144:145], v23 offset:49152
v_mfma_f32_16x16x32_bf16 v[92:95], a[156:159], a[108:111], v[92:95]
ds_read_b64_tr_b16 a[146:147], v23 offset:53248
v_mfma_f32_16x16x32_bf16 v[88:91], a[156:159], a[104:107], v[88:91]
ds_read_b64_tr_b16 a[148:149], v23 offset:57344
v_mfma_f32_16x16x32_bf16 v[88:91], a[152:155], a[96:99], v[88:91]
s_waitcnt vmcnt(16) lgkmcnt(7)
ds_read_b64_tr_b16 a[150:151], v23 offset:61440
v_mfma_f32_16x16x32_bf16 v[32:35], a[128:131], a[112:115], v[32:35]
ds_read_b64_tr_b16 a[152:153], v24 offset:49152
v_mfma_f32_16x16x32_bf16 v[32:35], a[132:135], a[120:123], v[32:35]
s_add_u32 m0, s31, 32768
ds_read_b64_tr_b16 a[154:155], v24 offset:53248
v_mfma_f32_16x16x32_bf16 v[36:39], a[132:135], a[124:127], v[36:39]
ds_read_b64_tr_b16 a[156:157], v24 offset:57344
buffer_load_dwordx4 v9, s[12:15], s32 offen lds
v_mfma_f32_16x16x32_bf16 v[36:39], a[128:131], a[116:119], v[36:39]
s_waitcnt lgkmcnt(7)
ds_read_b64_tr_b16 a[158:159], v24 offset:61440
buffer_load_dwordx4 a[32:35], v5, s[16:19], s33 offen offset:0 sc1
v_mfma_f32_16x16x32_bf16 v[44:47], a[136:139], a[116:119], v[44:47]
ds_read_b64_tr_b16 a[128:129], v25 offset:49152
v_mfma_f32_16x16x32_bf16 v[44:47], a[140:143], a[124:127], v[44:47]
s_add_u32 m0, s31, 33792
ds_read_b64_tr_b16 a[130:131], v25 offset:53248
v_mfma_f32_16x16x32_bf16 v[40:43], a[140:143], a[120:123], v[40:43]
ds_read_b64_tr_b16 a[132:133], v25 offset:57344
buffer_load_dwordx4 v10, s[12:15], s32 offen lds
v_mfma_f32_16x16x32_bf16 v[40:43], a[136:139], a[112:115], v[40:43]
s_waitcnt lgkmcnt(7)
ds_read_b64_tr_b16 a[134:135], v25 offset:61440
buffer_load_dwordx4 a[36:39], v6, s[16:19], s33 offen offset:0 sc1
v_mfma_f32_16x16x32_bf16 v[48:51], a[144:147], a[112:115], v[48:51]
ds_read_b64_tr_b16 a[136:137], v26 offset:49152
v_mfma_f32_16x16x32_bf16 v[48:51], a[148:151], a[120:123], v[48:51]
s_add_u32 m0, s31, 34816
ds_read_b64_tr_b16 a[138:139], v26 offset:53248
v_mfma_f32_16x16x32_bf16 v[52:55], a[148:151], a[124:127], v[52:55]
ds_read_b64_tr_b16 a[140:141], v26 offset:57344
buffer_load_dwordx4 v11, s[12:15], s32 offen lds
v_mfma_f32_16x16x32_bf16 v[52:55], a[144:147], a[116:119], v[52:55]
s_waitcnt lgkmcnt(7)
ds_read_b64_tr_b16 a[142:143], v26 offset:61440
buffer_load_dwordx4 a[40:43], v5, s[16:19], s33 offen offset:1024 sc1
v_mfma_f32_16x16x32_bf16 v[60:63], a[152:155], a[116:119], v[60:63]
ds_read_b64_tr_b16 a[144:145], v27 offset:49152
v_mfma_f32_16x16x32_bf16 v[60:63], a[156:159], a[124:127], v[60:63]
s_add_u32 m0, s31, 35840
ds_read_b64_tr_b16 a[146:147], v27 offset:53248
v_mfma_f32_16x16x32_bf16 v[56:59], a[156:159], a[120:123], v[56:59]
ds_read_b64_tr_b16 a[148:149], v27 offset:57344
buffer_load_dwordx4 v12, s[12:15], s32 offen lds
s_add_u32 s32, s32, 131072
v_mfma_f32_16x16x32_bf16 v[56:59], a[152:155], a[112:115], v[56:59]
s_waitcnt lgkmcnt(7)
ds_read_b64_tr_b16 a[150:151], v27 offset:61440
buffer_load_dwordx4 a[44:47], v6, s[16:19], s33 offen offset:1024 sc1
v_mfma_f32_16x16x32_bf16 v[64:67], a[128:131], a[112:115], v[64:67]
ds_read_b64_tr_b16 a[152:153], v28 offset:49152
v_mfma_f32_16x16x32_bf16 v[64:67], a[132:135], a[120:123], v[64:67]
ds_read_b64_tr_b16 a[154:155], v28 offset:53248
v_mfma_f32_16x16x32_bf16 v[68:71], a[132:135], a[124:127], v[68:71]
ds_read_b64_tr_b16 a[156:157], v28 offset:57344
v_mfma_f32_16x16x32_bf16 v[68:71], a[128:131], a[116:119], v[68:71]
s_waitcnt lgkmcnt(7)
ds_read_b64_tr_b16 a[158:159], v28 offset:61440
v_mfma_f32_16x16x32_bf16 v[76:79], a[136:139], a[116:119], v[76:79]
s_waitcnt vmcnt(17)
s_barrier
ds_read_b64_tr_b16 a[128:129], v13 offset:0
v_mfma_f32_16x16x32_bf16 v[76:79], a[140:143], a[124:127], v[76:79]
ds_read_b64_tr_b16 a[130:131], v13 offset:4096
v_mfma_f32_16x16x32_bf16 v[72:75], a[140:143], a[120:123], v[72:75]
ds_read_b64_tr_b16 a[132:133], v13 offset:8192
v_mfma_f32_16x16x32_bf16 v[72:75], a[136:139], a[112:115], v[72:75]
s_waitcnt lgkmcnt(7)
ds_read_b64_tr_b16 a[134:135], v13 offset:12288
v_mfma_f32_16x16x32_bf16 v[80:83], a[144:147], a[112:115], v[80:83]
ds_read_b64_tr_b16 a[136:137], v14 offset:0
v_mfma_f32_16x16x32_bf16 v[80:83], a[148:151], a[120:123], v[80:83]
ds_read_b64_tr_b16 a[138:139], v14 offset:4096
v_mfma_f32_16x16x32_bf16 v[84:87], a[148:151], a[124:127], v[84:87]
ds_read_b64_tr_b16 a[140:141], v14 offset:8192
v_mfma_f32_16x16x32_bf16 v[84:87], a[144:147], a[116:119], v[84:87]
s_waitcnt lgkmcnt(7)
ds_read_b64_tr_b16 a[142:143], v14 offset:12288
v_mfma_f32_16x16x32_bf16 v[92:95], a[152:155], a[116:119], v[92:95]
ds_read_b64_tr_b16 a[144:145], v15 offset:0
v_mfma_f32_16x16x32_bf16 v[92:95], a[156:159], a[124:127], v[92:95]
ds_read_b64_tr_b16 a[146:147], v15 offset:4096
v_mfma_f32_16x16x32_bf16 v[88:91], a[156:159], a[120:123], v[88:91]
ds_read_b64_tr_b16 a[148:149], v15 offset:8192
v_mfma_f32_16x16x32_bf16 v[88:91], a[152:155], a[112:115], v[88:91]
s_waitcnt vmcnt(16) lgkmcnt(7)
ds_read_b64_tr_b16 a[150:151], v15 offset:12288
s_sub_u32 s34, s34, 1
s_cmp_lg_u32 s34, 0
s_cbranch_scc1 L_op_loop
s_lshl_b32 s37, s26, 1
s_add_u32 s37, s37, s27
v_lshrrev_b32 v3, 4, v1
v_lshlrev_b32 v129, 4, v3
s_lshl_b32 s39, s30, 15
s_lshl_b32 s28, s37, 11
s_add_u32 s39, s39, s28
s_add_u32 s39, s39, 52494336
s_lshl_b32 s40, s37, 8
s_add_u32 s40, s40, 71376896
v_mfma_f32_16x16x32_bf16 v[32:35], a[128:131], a[0:3], v[32:35]
ds_read_b64_tr_b16 a[152:153], v16 offset:0
v_mfma_f32_16x16x32_bf16 v[32:35], a[132:135], a[8:11], v[32:35]
s_add_u32 m0, s31, 49152
ds_read_b64_tr_b16 a[154:155], v16 offset:4096
v_mfma_f32_16x16x32_bf16 v[36:39], a[132:135], a[12:15], v[36:39]
ds_read_b64_tr_b16 a[156:157], v16 offset:8192
buffer_load_dwordx4 v9, s[12:15], s32 offen lds
v_mfma_f32_16x16x32_bf16 v[36:39], a[128:131], a[4:7], v[36:39]
s_waitcnt lgkmcnt(7)
ds_read_b64_tr_b16 a[158:159], v16 offset:12288
buffer_load_dwordx4 a[48:51], v5, s[16:19], s33 offen offset:2048 sc1
v_mfma_f32_16x16x32_bf16 v[44:47], a[136:139], a[4:7], v[44:47]
ds_read_b64_tr_b16 a[128:129], v17 offset:0
v_mfma_f32_16x16x32_bf16 v[44:47], a[140:143], a[12:15], v[44:47]
s_add_u32 m0, s31, 50176
ds_read_b64_tr_b16 a[130:131], v17 offset:4096
v_mfma_f32_16x16x32_bf16 v[40:43], a[140:143], a[8:11], v[40:43]
ds_read_b64_tr_b16 a[132:133], v17 offset:8192
buffer_load_dwordx4 v10, s[12:15], s32 offen lds
v_mfma_f32_16x16x32_bf16 v[40:43], a[136:139], a[0:3], v[40:43]
s_waitcnt lgkmcnt(7)
ds_read_b64_tr_b16 a[134:135], v17 offset:12288
buffer_load_dwordx4 a[52:55], v6, s[16:19], s33 offen offset:2048 sc1
v_mfma_f32_16x16x32_bf16 v[48:51], a[144:147], a[0:3], v[48:51]
ds_read_b64_tr_b16 a[136:137], v18 offset:0
v_mfma_f32_16x16x32_bf16 v[48:51], a[148:151], a[8:11], v[48:51]
s_add_u32 m0, s31, 51200
ds_read_b64_tr_b16 a[138:139], v18 offset:4096
v_mfma_f32_16x16x32_bf16 v[52:55], a[148:151], a[12:15], v[52:55]
ds_read_b64_tr_b16 a[140:141], v18 offset:8192
buffer_load_dwordx4 v11, s[12:15], s32 offen lds
v_mfma_f32_16x16x32_bf16 v[52:55], a[144:147], a[4:7], v[52:55]
s_waitcnt lgkmcnt(7)
ds_read_b64_tr_b16 a[142:143], v18 offset:12288
buffer_load_dwordx4 a[56:59], v5, s[16:19], s33 offen offset:3072 sc1
v_mfma_f32_16x16x32_bf16 v[60:63], a[152:155], a[4:7], v[60:63]
ds_read_b64_tr_b16 a[144:145], v19 offset:0
v_mfma_f32_16x16x32_bf16 v[60:63], a[156:159], a[12:15], v[60:63]
s_add_u32 m0, s31, 52224
ds_read_b64_tr_b16 a[146:147], v19 offset:4096
v_mfma_f32_16x16x32_bf16 v[56:59], a[156:159], a[8:11], v[56:59]
ds_read_b64_tr_b16 a[148:149], v19 offset:8192
buffer_load_dwordx4 v12, s[12:15], s32 offen lds
s_add_u32 s32, s32, 131072
v_mfma_f32_16x16x32_bf16 v[56:59], a[152:155], a[0:3], v[56:59]
s_waitcnt lgkmcnt(7)
ds_read_b64_tr_b16 a[150:151], v19 offset:12288
buffer_load_dwordx4 a[60:63], v6, s[16:19], s33 offen offset:3072 sc1
s_add_u32 s33, s33, 4096
v_mfma_f32_16x16x32_bf16 v[64:67], a[128:131], a[0:3], v[64:67]
ds_read_b64_tr_b16 a[152:153], v20 offset:0
v_mfma_f32_16x16x32_bf16 v[64:67], a[132:135], a[8:11], v[64:67]
ds_read_b64_tr_b16 a[154:155], v20 offset:4096
v_mfma_f32_16x16x32_bf16 v[68:71], a[132:135], a[12:15], v[68:71]
ds_read_b64_tr_b16 a[156:157], v20 offset:8192
buffer_load_dwordx4 v[96:99], v2, s[16:19], s39 offen offset:0 sc1
v_mfma_f32_16x16x32_bf16 v[68:71], a[128:131], a[4:7], v[68:71]
s_waitcnt lgkmcnt(7)
ds_read_b64_tr_b16 a[158:159], v20 offset:12288
v_mfma_f32_16x16x32_bf16 v[76:79], a[136:139], a[4:7], v[76:79]
s_waitcnt vmcnt(18)
s_barrier
ds_read_b64_tr_b16 a[128:129], v13 offset:16384
v_mfma_f32_16x16x32_bf16 v[76:79], a[140:143], a[12:15], v[76:79]
ds_read_b64_tr_b16 a[130:131], v13 offset:20480
v_mfma_f32_16x16x32_bf16 v[72:75], a[140:143], a[8:11], v[72:75]
ds_read_b64_tr_b16 a[132:133], v13 offset:24576
buffer_load_dwordx4 v[100:103], v2, s[16:19], s39 offen offset:1024 sc1
v_mfma_f32_16x16x32_bf16 v[72:75], a[136:139], a[0:3], v[72:75]
s_waitcnt lgkmcnt(7)
ds_read_b64_tr_b16 a[134:135], v13 offset:28672
v_mfma_f32_16x16x32_bf16 v[80:83], a[144:147], a[0:3], v[80:83]
ds_read_b64_tr_b16 a[136:137], v14 offset:16384
v_mfma_f32_16x16x32_bf16 v[80:83], a[148:151], a[8:11], v[80:83]
s_add_u32 s39, s39, 32768
ds_read_b64_tr_b16 a[138:139], v14 offset:20480
v_mfma_f32_16x16x32_bf16 v[84:87], a[148:151], a[12:15], v[84:87]
ds_read_b64_tr_b16 a[140:141], v14 offset:24576
buffer_load_dwordx4 v[104:107], v2, s[16:19], s39 offen offset:0 sc1
v_mfma_f32_16x16x32_bf16 v[84:87], a[144:147], a[4:7], v[84:87]
s_waitcnt lgkmcnt(7)
ds_read_b64_tr_b16 a[142:143], v14 offset:28672
v_mfma_f32_16x16x32_bf16 v[92:95], a[152:155], a[4:7], v[92:95]
ds_read_b64_tr_b16 a[144:145], v15 offset:16384
v_mfma_f32_16x16x32_bf16 v[92:95], a[156:159], a[12:15], v[92:95]
ds_read_b64_tr_b16 a[146:147], v15 offset:20480
v_mfma_f32_16x16x32_bf16 v[88:91], a[156:159], a[8:11], v[88:91]
ds_read_b64_tr_b16 a[148:149], v15 offset:24576
buffer_load_dwordx4 v[108:111], v2, s[16:19], s39 offen offset:1024 sc1
v_mfma_f32_16x16x32_bf16 v[88:91], a[152:155], a[0:3], v[88:91]
s_waitcnt vmcnt(20) lgkmcnt(7)
ds_read_b64_tr_b16 a[150:151], v15 offset:28672
v_mfma_f32_16x16x32_bf16 v[32:35], a[128:131], a[16:19], v[32:35]
ds_read_b64_tr_b16 a[152:153], v16 offset:16384
v_mfma_f32_16x16x32_bf16 v[32:35], a[132:135], a[24:27], v[32:35]
s_add_u32 m0, s31, 65536
ds_read_b64_tr_b16 a[154:155], v16 offset:20480
v_mfma_f32_16x16x32_bf16 v[36:39], a[132:135], a[28:31], v[36:39]
ds_read_b64_tr_b16 a[156:157], v16 offset:24576
buffer_load_dwordx4 v9, s[12:15], s32 offen lds
v_mfma_f32_16x16x32_bf16 v[36:39], a[128:131], a[20:23], v[36:39]
s_waitcnt lgkmcnt(7)
ds_read_b64_tr_b16 a[158:159], v16 offset:28672
buffer_load_dwordx4 a[64:67], v5, s[16:19], s33 offen offset:0 sc1
v_mfma_f32_16x16x32_bf16 v[44:47], a[136:139], a[20:23], v[44:47]
ds_read_b64_tr_b16 a[128:129], v17 offset:16384
v_mfma_f32_16x16x32_bf16 v[44:47], a[140:143], a[28:31], v[44:47]
s_add_u32 m0, s31, 66560
ds_read_b64_tr_b16 a[130:131], v17 offset:20480
v_mfma_f32_16x16x32_bf16 v[40:43], a[140:143], a[24:27], v[40:43]
ds_read_b64_tr_b16 a[132:133], v17 offset:24576
buffer_load_dwordx4 v10, s[12:15], s32 offen lds
v_mfma_f32_16x16x32_bf16 v[40:43], a[136:139], a[16:19], v[40:43]
s_waitcnt lgkmcnt(7)
ds_read_b64_tr_b16 a[134:135], v17 offset:28672
buffer_load_dwordx4 a[68:71], v6, s[16:19], s33 offen offset:0 sc1
v_mfma_f32_16x16x32_bf16 v[48:51], a[144:147], a[16:19], v[48:51]
ds_read_b64_tr_b16 a[136:137], v18 offset:16384
v_mfma_f32_16x16x32_bf16 v[48:51], a[148:151], a[24:27], v[48:51]
s_add_u32 m0, s31, 67584
ds_read_b64_tr_b16 a[138:139], v18 offset:20480
v_mfma_f32_16x16x32_bf16 v[52:55], a[148:151], a[28:31], v[52:55]
ds_read_b64_tr_b16 a[140:141], v18 offset:24576
buffer_load_dwordx4 v11, s[12:15], s32 offen lds
v_mfma_f32_16x16x32_bf16 v[52:55], a[144:147], a[20:23], v[52:55]
s_waitcnt lgkmcnt(7)
ds_read_b64_tr_b16 a[142:143], v18 offset:28672
buffer_load_dwordx4 a[72:75], v5, s[16:19], s33 offen offset:1024 sc1
v_mfma_f32_16x16x32_bf16 v[60:63], a[152:155], a[20:23], v[60:63]
ds_read_b64_tr_b16 a[144:145], v19 offset:16384
v_mfma_f32_16x16x32_bf16 v[60:63], a[156:159], a[28:31], v[60:63]
s_add_u32 m0, s31, 68608
ds_read_b64_tr_b16 a[146:147], v19 offset:20480
v_mfma_f32_16x16x32_bf16 v[56:59], a[156:159], a[24:27], v[56:59]
ds_read_b64_tr_b16 a[148:149], v19 offset:24576
buffer_load_dwordx4 v12, s[12:15], s32 offen lds
s_add_u32 s32, s32, 131072
v_mfma_f32_16x16x32_bf16 v[56:59], a[152:155], a[16:19], v[56:59]
s_waitcnt lgkmcnt(7)
ds_read_b64_tr_b16 a[150:151], v19 offset:28672
buffer_load_dwordx4 a[76:79], v6, s[16:19], s33 offen offset:1024 sc1
v_mfma_f32_16x16x32_bf16 v[64:67], a[128:131], a[16:19], v[64:67]
ds_read_b64_tr_b16 a[152:153], v20 offset:16384
v_mfma_f32_16x16x32_bf16 v[64:67], a[132:135], a[24:27], v[64:67]
ds_read_b64_tr_b16 a[154:155], v20 offset:20480
v_mfma_f32_16x16x32_bf16 v[68:71], a[132:135], a[28:31], v[68:71]
ds_read_b64_tr_b16 a[156:157], v20 offset:24576
buffer_load_dwordx4 v[112:115], v129, s[16:19], s40 offen offset:0
v_mfma_f32_16x16x32_bf16 v[68:71], a[128:131], a[20:23], v[68:71]
s_waitcnt lgkmcnt(7)
ds_read_b64_tr_b16 a[158:159], v20 offset:28672
v_mfma_f32_16x16x32_bf16 v[76:79], a[136:139], a[20:23], v[76:79]
s_waitcnt vmcnt(22)
s_barrier
ds_read_b64_tr_b16 a[128:129], v13 offset:32768
v_mfma_f32_16x16x32_bf16 v[76:79], a[140:143], a[28:31], v[76:79]
ds_read_b64_tr_b16 a[130:131], v13 offset:36864
v_mfma_f32_16x16x32_bf16 v[72:75], a[140:143], a[24:27], v[72:75]
ds_read_b64_tr_b16 a[132:133], v13 offset:40960
buffer_load_dwordx4 v[116:119], v129, s[16:19], s40 offen offset:64
v_mfma_f32_16x16x32_bf16 v[72:75], a[136:139], a[16:19], v[72:75]
s_waitcnt lgkmcnt(7)
ds_read_b64_tr_b16 a[134:135], v13 offset:45056
v_mfma_f32_16x16x32_bf16 v[80:83], a[144:147], a[16:19], v[80:83]
ds_read_b64_tr_b16 a[136:137], v14 offset:32768
v_mfma_f32_16x16x32_bf16 v[80:83], a[148:151], a[24:27], v[80:83]
ds_read_b64_tr_b16 a[138:139], v14 offset:36864
v_mfma_f32_16x16x32_bf16 v[84:87], a[148:151], a[28:31], v[84:87]
ds_read_b64_tr_b16 a[140:141], v14 offset:40960
buffer_load_dwordx4 v[120:123], v129, s[16:19], s40 offen offset:128
v_mfma_f32_16x16x32_bf16 v[84:87], a[144:147], a[20:23], v[84:87]
s_waitcnt lgkmcnt(7)
ds_read_b64_tr_b16 a[142:143], v14 offset:45056
v_mfma_f32_16x16x32_bf16 v[92:95], a[152:155], a[20:23], v[92:95]
ds_read_b64_tr_b16 a[144:145], v15 offset:32768
v_mfma_f32_16x16x32_bf16 v[92:95], a[156:159], a[28:31], v[92:95]
ds_read_b64_tr_b16 a[146:147], v15 offset:36864
v_mfma_f32_16x16x32_bf16 v[88:91], a[156:159], a[24:27], v[88:91]
ds_read_b64_tr_b16 a[148:149], v15 offset:40960
buffer_load_dwordx4 v[124:127], v129, s[16:19], s40 offen offset:192
v_mfma_f32_16x16x32_bf16 v[88:91], a[152:155], a[16:19], v[88:91]
s_waitcnt vmcnt(24) lgkmcnt(7)
ds_read_b64_tr_b16 a[150:151], v15 offset:45056
v_mfma_f32_16x16x32_bf16 v[32:35], a[128:131], a[32:35], v[32:35]
ds_read_b64_tr_b16 a[152:153], v16 offset:32768
v_mfma_f32_16x16x32_bf16 v[32:35], a[132:135], a[40:43], v[32:35]
s_add_u32 m0, s31, 81920
ds_read_b64_tr_b16 a[154:155], v16 offset:36864
v_mfma_f32_16x16x32_bf16 v[36:39], a[132:135], a[44:47], v[36:39]
ds_read_b64_tr_b16 a[156:157], v16 offset:40960
buffer_load_dwordx4 v9, s[12:15], s32 offen lds
v_mfma_f32_16x16x32_bf16 v[36:39], a[128:131], a[36:39], v[36:39]
s_waitcnt lgkmcnt(7)
ds_read_b64_tr_b16 a[158:159], v16 offset:45056
buffer_load_dwordx4 a[80:83], v5, s[16:19], s33 offen offset:2048 sc1
v_mfma_f32_16x16x32_bf16 v[44:47], a[136:139], a[36:39], v[44:47]
ds_read_b64_tr_b16 a[128:129], v17 offset:32768
v_mfma_f32_16x16x32_bf16 v[44:47], a[140:143], a[44:47], v[44:47]
s_add_u32 m0, s31, 82944
ds_read_b64_tr_b16 a[130:131], v17 offset:36864
v_mfma_f32_16x16x32_bf16 v[40:43], a[140:143], a[40:43], v[40:43]
ds_read_b64_tr_b16 a[132:133], v17 offset:40960
buffer_load_dwordx4 v10, s[12:15], s32 offen lds
v_mfma_f32_16x16x32_bf16 v[40:43], a[136:139], a[32:35], v[40:43]
s_waitcnt lgkmcnt(7)
ds_read_b64_tr_b16 a[134:135], v17 offset:45056
buffer_load_dwordx4 a[84:87], v6, s[16:19], s33 offen offset:2048 sc1
v_mfma_f32_16x16x32_bf16 v[48:51], a[144:147], a[32:35], v[48:51]
ds_read_b64_tr_b16 a[136:137], v18 offset:32768
v_mfma_f32_16x16x32_bf16 v[48:51], a[148:151], a[40:43], v[48:51]
s_add_u32 m0, s31, 83968
ds_read_b64_tr_b16 a[138:139], v18 offset:36864
v_mfma_f32_16x16x32_bf16 v[52:55], a[148:151], a[44:47], v[52:55]
ds_read_b64_tr_b16 a[140:141], v18 offset:40960
buffer_load_dwordx4 v11, s[12:15], s32 offen lds
v_mfma_f32_16x16x32_bf16 v[52:55], a[144:147], a[36:39], v[52:55]
s_waitcnt lgkmcnt(7)
ds_read_b64_tr_b16 a[142:143], v18 offset:45056
buffer_load_dwordx4 a[88:91], v5, s[16:19], s33 offen offset:3072 sc1
v_mfma_f32_16x16x32_bf16 v[60:63], a[152:155], a[36:39], v[60:63]
ds_read_b64_tr_b16 a[144:145], v19 offset:32768
v_mfma_f32_16x16x32_bf16 v[60:63], a[156:159], a[44:47], v[60:63]
s_add_u32 m0, s31, 84992
ds_read_b64_tr_b16 a[146:147], v19 offset:36864
v_mfma_f32_16x16x32_bf16 v[56:59], a[156:159], a[40:43], v[56:59]
ds_read_b64_tr_b16 a[148:149], v19 offset:40960
buffer_load_dwordx4 v12, s[12:15], s32 offen lds
s_add_u32 s32, s32, 131072
v_mfma_f32_16x16x32_bf16 v[56:59], a[152:155], a[32:35], v[56:59]
s_waitcnt lgkmcnt(7)
ds_read_b64_tr_b16 a[150:151], v19 offset:45056
buffer_load_dwordx4 a[92:95], v6, s[16:19], s33 offen offset:3072 sc1
s_add_u32 s33, s33, 4096
v_mfma_f32_16x16x32_bf16 v[64:67], a[128:131], a[32:35], v[64:67]
ds_read_b64_tr_b16 a[152:153], v20 offset:32768
v_mfma_f32_16x16x32_bf16 v[64:67], a[132:135], a[40:43], v[64:67]
s_add_u32 s40, s40, 24576
ds_read_b64_tr_b16 a[154:155], v20 offset:36864
v_mfma_f32_16x16x32_bf16 v[68:71], a[132:135], a[44:47], v[68:71]
ds_read_b64_tr_b16 a[156:157], v20 offset:40960
buffer_load_dwordx4 v[164:167], v129, s[16:19], s40 offen offset:0
v_mfma_f32_16x16x32_bf16 v[68:71], a[128:131], a[36:39], v[68:71]
s_waitcnt lgkmcnt(7)
ds_read_b64_tr_b16 a[158:159], v20 offset:45056
v_mfma_f32_16x16x32_bf16 v[76:79], a[136:139], a[36:39], v[76:79]
s_waitcnt vmcnt(26)
s_barrier
ds_read_b64_tr_b16 a[128:129], v13 offset:49152
v_mfma_f32_16x16x32_bf16 v[76:79], a[140:143], a[44:47], v[76:79]
ds_read_b64_tr_b16 a[130:131], v13 offset:53248
v_mfma_f32_16x16x32_bf16 v[72:75], a[140:143], a[40:43], v[72:75]
ds_read_b64_tr_b16 a[132:133], v13 offset:57344
buffer_load_dwordx4 v[168:171], v129, s[16:19], s40 offen offset:64
v_mfma_f32_16x16x32_bf16 v[72:75], a[136:139], a[32:35], v[72:75]
s_waitcnt lgkmcnt(7)
ds_read_b64_tr_b16 a[134:135], v13 offset:61440
v_mfma_f32_16x16x32_bf16 v[80:83], a[144:147], a[32:35], v[80:83]
ds_read_b64_tr_b16 a[136:137], v14 offset:49152
v_mfma_f32_16x16x32_bf16 v[80:83], a[148:151], a[40:43], v[80:83]
ds_read_b64_tr_b16 a[138:139], v14 offset:53248
v_mfma_f32_16x16x32_bf16 v[84:87], a[148:151], a[44:47], v[84:87]
ds_read_b64_tr_b16 a[140:141], v14 offset:57344
buffer_load_dwordx4 v[172:175], v129, s[16:19], s40 offen offset:128
v_mfma_f32_16x16x32_bf16 v[84:87], a[144:147], a[36:39], v[84:87]
s_waitcnt lgkmcnt(7)
ds_read_b64_tr_b16 a[142:143], v14 offset:61440
v_mfma_f32_16x16x32_bf16 v[92:95], a[152:155], a[36:39], v[92:95]
ds_read_b64_tr_b16 a[144:145], v15 offset:49152
v_mfma_f32_16x16x32_bf16 v[92:95], a[156:159], a[44:47], v[92:95]
ds_read_b64_tr_b16 a[146:147], v15 offset:53248
v_mfma_f32_16x16x32_bf16 v[88:91], a[156:159], a[40:43], v[88:91]
ds_read_b64_tr_b16 a[148:149], v15 offset:57344
buffer_load_dwordx4 v[176:179], v129, s[16:19], s40 offen offset:192
v_mfma_f32_16x16x32_bf16 v[88:91], a[152:155], a[32:35], v[88:91]
s_waitcnt vmcnt(28) lgkmcnt(7)
ds_read_b64_tr_b16 a[150:151], v15 offset:61440
v_mfma_f32_16x16x32_bf16 v[32:35], a[128:131], a[48:51], v[32:35]
ds_read_b64_tr_b16 a[152:153], v16 offset:49152
v_mfma_f32_16x16x32_bf16 v[32:35], a[132:135], a[56:59], v[32:35]
s_add_u32 m0, s31, 98304
ds_read_b64_tr_b16 a[154:155], v16 offset:53248
v_mfma_f32_16x16x32_bf16 v[36:39], a[132:135], a[60:63], v[36:39]
ds_read_b64_tr_b16 a[156:157], v16 offset:57344
buffer_load_dwordx4 v9, s[12:15], s32 offen lds
v_mfma_f32_16x16x32_bf16 v[36:39], a[128:131], a[52:55], v[36:39]
s_waitcnt lgkmcnt(7)
ds_read_b64_tr_b16 a[158:159], v16 offset:61440
buffer_load_dwordx4 a[96:99], v5, s[16:19], s33 offen offset:0 sc1
v_mfma_f32_16x16x32_bf16 v[44:47], a[136:139], a[52:55], v[44:47]
ds_read_b64_tr_b16 a[128:129], v17 offset:49152
v_mfma_f32_16x16x32_bf16 v[44:47], a[140:143], a[60:63], v[44:47]
s_add_u32 m0, s31, 99328
ds_read_b64_tr_b16 a[130:131], v17 offset:53248
v_mfma_f32_16x16x32_bf16 v[40:43], a[140:143], a[56:59], v[40:43]
ds_read_b64_tr_b16 a[132:133], v17 offset:57344
buffer_load_dwordx4 v10, s[12:15], s32 offen lds
v_mfma_f32_16x16x32_bf16 v[40:43], a[136:139], a[48:51], v[40:43]
s_waitcnt lgkmcnt(7)
ds_read_b64_tr_b16 a[134:135], v17 offset:61440
buffer_load_dwordx4 a[100:103], v6, s[16:19], s33 offen offset:0 sc1
v_mfma_f32_16x16x32_bf16 v[48:51], a[144:147], a[48:51], v[48:51]
ds_read_b64_tr_b16 a[136:137], v18 offset:49152
v_mfma_f32_16x16x32_bf16 v[48:51], a[148:151], a[56:59], v[48:51]
s_add_u32 m0, s31, 100352
ds_read_b64_tr_b16 a[138:139], v18 offset:53248
v_mfma_f32_16x16x32_bf16 v[52:55], a[148:151], a[60:63], v[52:55]
ds_read_b64_tr_b16 a[140:141], v18 offset:57344
buffer_load_dwordx4 v11, s[12:15], s32 offen lds
v_mfma_f32_16x16x32_bf16 v[52:55], a[144:147], a[52:55], v[52:55]
s_waitcnt lgkmcnt(7)
ds_read_b64_tr_b16 a[142:143], v18 offset:61440
buffer_load_dwordx4 a[104:107], v5, s[16:19], s33 offen offset:1024 sc1
v_mfma_f32_16x16x32_bf16 v[60:63], a[152:155], a[52:55], v[60:63]
ds_read_b64_tr_b16 a[144:145], v19 offset:49152
v_mfma_f32_16x16x32_bf16 v[60:63], a[156:159], a[60:63], v[60:63]
s_add_u32 m0, s31, 101376
ds_read_b64_tr_b16 a[146:147], v19 offset:53248
v_mfma_f32_16x16x32_bf16 v[56:59], a[156:159], a[56:59], v[56:59]
ds_read_b64_tr_b16 a[148:149], v19 offset:57344
buffer_load_dwordx4 v12, s[12:15], s32 offen lds
s_add_u32 s32, s32, 131072
v_mfma_f32_16x16x32_bf16 v[56:59], a[152:155], a[48:51], v[56:59]
s_waitcnt lgkmcnt(7)
ds_read_b64_tr_b16 a[150:151], v19 offset:61440
buffer_load_dwordx4 a[108:111], v6, s[16:19], s33 offen offset:1024 sc1
v_mfma_f32_16x16x32_bf16 v[64:67], a[128:131], a[48:51], v[64:67]
ds_read_b64_tr_b16 a[152:153], v20 offset:49152
v_mfma_f32_16x16x32_bf16 v[64:67], a[132:135], a[56:59], v[64:67]
s_add_u32 s40, s40, 24576
ds_read_b64_tr_b16 a[154:155], v20 offset:53248
v_mfma_f32_16x16x32_bf16 v[68:71], a[132:135], a[60:63], v[68:71]
ds_read_b64_tr_b16 a[156:157], v20 offset:57344
buffer_load_dwordx4 v[180:183], v129, s[16:19], s40 offen offset:0
v_mfma_f32_16x16x32_bf16 v[68:71], a[128:131], a[52:55], v[68:71]
s_waitcnt lgkmcnt(7)
ds_read_b64_tr_b16 a[158:159], v20 offset:61440
v_mfma_f32_16x16x32_bf16 v[76:79], a[136:139], a[52:55], v[76:79]
s_waitcnt vmcnt(26)
s_barrier
ds_read_b64_tr_b16 a[128:129], v21 offset:0
v_mfma_f32_16x16x32_bf16 v[76:79], a[140:143], a[60:63], v[76:79]
ds_read_b64_tr_b16 a[130:131], v21 offset:4096
v_mfma_f32_16x16x32_bf16 v[72:75], a[140:143], a[56:59], v[72:75]
ds_read_b64_tr_b16 a[132:133], v21 offset:8192
buffer_load_dwordx4 v[184:187], v129, s[16:19], s40 offen offset:64
v_mfma_f32_16x16x32_bf16 v[72:75], a[136:139], a[48:51], v[72:75]
s_waitcnt lgkmcnt(7)
ds_read_b64_tr_b16 a[134:135], v21 offset:12288
v_mfma_f32_16x16x32_bf16 v[80:83], a[144:147], a[48:51], v[80:83]
ds_read_b64_tr_b16 a[136:137], v22 offset:0
v_mfma_f32_16x16x32_bf16 v[80:83], a[148:151], a[56:59], v[80:83]
ds_read_b64_tr_b16 a[138:139], v22 offset:4096
v_mfma_f32_16x16x32_bf16 v[84:87], a[148:151], a[60:63], v[84:87]
ds_read_b64_tr_b16 a[140:141], v22 offset:8192
buffer_load_dwordx4 v[188:191], v129, s[16:19], s40 offen offset:128
v_mfma_f32_16x16x32_bf16 v[84:87], a[144:147], a[52:55], v[84:87]
s_waitcnt lgkmcnt(7)
ds_read_b64_tr_b16 a[142:143], v22 offset:12288
v_mfma_f32_16x16x32_bf16 v[92:95], a[152:155], a[52:55], v[92:95]
ds_read_b64_tr_b16 a[144:145], v23 offset:0
v_mfma_f32_16x16x32_bf16 v[92:95], a[156:159], a[60:63], v[92:95]
ds_read_b64_tr_b16 a[146:147], v23 offset:4096
v_mfma_f32_16x16x32_bf16 v[88:91], a[156:159], a[56:59], v[88:91]
ds_read_b64_tr_b16 a[148:149], v23 offset:8192
buffer_load_dwordx4 v[192:195], v129, s[16:19], s40 offen offset:192
v_mfma_f32_16x16x32_bf16 v[88:91], a[152:155], a[48:51], v[88:91]
s_waitcnt vmcnt(28) lgkmcnt(7)
ds_read_b64_tr_b16 a[150:151], v23 offset:12288
v_mfma_f32_16x16x32_bf16 v[32:35], a[128:131], a[64:67], v[32:35]
ds_read_b64_tr_b16 a[152:153], v24 offset:0
v_mfma_f32_16x16x32_bf16 v[32:35], a[132:135], a[72:75], v[32:35]
s_add_u32 m0, s31, 114688
ds_read_b64_tr_b16 a[154:155], v24 offset:4096
v_mfma_f32_16x16x32_bf16 v[36:39], a[132:135], a[76:79], v[36:39]
ds_read_b64_tr_b16 a[156:157], v24 offset:8192
buffer_load_dwordx4 v9, s[12:15], s32 offen lds
v_mfma_f32_16x16x32_bf16 v[36:39], a[128:131], a[68:71], v[36:39]
s_waitcnt lgkmcnt(7)
ds_read_b64_tr_b16 a[158:159], v24 offset:12288
buffer_load_dwordx4 a[112:115], v5, s[16:19], s33 offen offset:2048 sc1
v_mfma_f32_16x16x32_bf16 v[44:47], a[136:139], a[68:71], v[44:47]
ds_read_b64_tr_b16 a[128:129], v25 offset:0
v_mfma_f32_16x16x32_bf16 v[44:47], a[140:143], a[76:79], v[44:47]
s_add_u32 m0, s31, 115712
ds_read_b64_tr_b16 a[130:131], v25 offset:4096
v_mfma_f32_16x16x32_bf16 v[40:43], a[140:143], a[72:75], v[40:43]
ds_read_b64_tr_b16 a[132:133], v25 offset:8192
buffer_load_dwordx4 v10, s[12:15], s32 offen lds
v_mfma_f32_16x16x32_bf16 v[40:43], a[136:139], a[64:67], v[40:43]
s_waitcnt lgkmcnt(7)
ds_read_b64_tr_b16 a[134:135], v25 offset:12288
buffer_load_dwordx4 a[116:119], v6, s[16:19], s33 offen offset:2048 sc1
v_mfma_f32_16x16x32_bf16 v[48:51], a[144:147], a[64:67], v[48:51]
ds_read_b64_tr_b16 a[136:137], v26 offset:0
v_mfma_f32_16x16x32_bf16 v[48:51], a[148:151], a[72:75], v[48:51]
s_add_u32 m0, s31, 116736
ds_read_b64_tr_b16 a[138:139], v26 offset:4096
v_mfma_f32_16x16x32_bf16 v[52:55], a[148:151], a[76:79], v[52:55]
ds_read_b64_tr_b16 a[140:141], v26 offset:8192
buffer_load_dwordx4 v11, s[12:15], s32 offen lds
v_mfma_f32_16x16x32_bf16 v[52:55], a[144:147], a[68:71], v[52:55]
s_waitcnt lgkmcnt(7)
ds_read_b64_tr_b16 a[142:143], v26 offset:12288
buffer_load_dwordx4 a[120:123], v5, s[16:19], s33 offen offset:3072 sc1
v_mfma_f32_16x16x32_bf16 v[60:63], a[152:155], a[68:71], v[60:63]
ds_read_b64_tr_b16 a[144:145], v27 offset:0
v_mfma_f32_16x16x32_bf16 v[60:63], a[156:159], a[76:79], v[60:63]
s_add_u32 m0, s31, 117760
ds_read_b64_tr_b16 a[146:147], v27 offset:4096
v_mfma_f32_16x16x32_bf16 v[56:59], a[156:159], a[72:75], v[56:59]
ds_read_b64_tr_b16 a[148:149], v27 offset:8192
buffer_load_dwordx4 v12, s[12:15], s32 offen lds
s_add_u32 s32, s32, 131072
v_mfma_f32_16x16x32_bf16 v[56:59], a[152:155], a[64:67], v[56:59]
s_waitcnt lgkmcnt(7)
ds_read_b64_tr_b16 a[150:151], v27 offset:12288
buffer_load_dwordx4 a[124:127], v6, s[16:19], s33 offen offset:3072 sc1
s_add_u32 s33, s33, 4096
v_mfma_f32_16x16x32_bf16 v[64:67], a[128:131], a[64:67], v[64:67]
ds_read_b64_tr_b16 a[152:153], v28 offset:0
v_mfma_f32_16x16x32_bf16 v[64:67], a[132:135], a[72:75], v[64:67]
s_add_u32 s40, s40, 24576
ds_read_b64_tr_b16 a[154:155], v28 offset:4096
v_mfma_f32_16x16x32_bf16 v[68:71], a[132:135], a[76:79], v[68:71]
ds_read_b64_tr_b16 a[156:157], v28 offset:8192
buffer_load_dwordx4 v[196:199], v129, s[16:19], s40 offen offset:0
v_mfma_f32_16x16x32_bf16 v[68:71], a[128:131], a[68:71], v[68:71]
s_waitcnt lgkmcnt(7)
ds_read_b64_tr_b16 a[158:159], v28 offset:12288
v_mfma_f32_16x16x32_bf16 v[76:79], a[136:139], a[68:71], v[76:79]
s_waitcnt vmcnt(26)
s_barrier
ds_read_b64_tr_b16 a[128:129], v21 offset:16384
v_mfma_f32_16x16x32_bf16 v[76:79], a[140:143], a[76:79], v[76:79]
ds_read_b64_tr_b16 a[130:131], v21 offset:20480
v_mfma_f32_16x16x32_bf16 v[72:75], a[140:143], a[72:75], v[72:75]
ds_read_b64_tr_b16 a[132:133], v21 offset:24576
buffer_load_dwordx4 v[200:203], v129, s[16:19], s40 offen offset:64
v_mfma_f32_16x16x32_bf16 v[72:75], a[136:139], a[64:67], v[72:75]
s_waitcnt lgkmcnt(7)
ds_read_b64_tr_b16 a[134:135], v21 offset:28672
v_mfma_f32_16x16x32_bf16 v[80:83], a[144:147], a[64:67], v[80:83]
ds_read_b64_tr_b16 a[136:137], v22 offset:16384
v_mfma_f32_16x16x32_bf16 v[80:83], a[148:151], a[72:75], v[80:83]
ds_read_b64_tr_b16 a[138:139], v22 offset:20480
v_mfma_f32_16x16x32_bf16 v[84:87], a[148:151], a[76:79], v[84:87]
ds_read_b64_tr_b16 a[140:141], v22 offset:24576
buffer_load_dwordx4 v[204:207], v129, s[16:19], s40 offen offset:128
v_mfma_f32_16x16x32_bf16 v[84:87], a[144:147], a[68:71], v[84:87]
s_waitcnt lgkmcnt(7)
ds_read_b64_tr_b16 a[142:143], v22 offset:28672
v_mfma_f32_16x16x32_bf16 v[92:95], a[152:155], a[68:71], v[92:95]
ds_read_b64_tr_b16 a[144:145], v23 offset:16384
v_mfma_f32_16x16x32_bf16 v[92:95], a[156:159], a[76:79], v[92:95]
ds_read_b64_tr_b16 a[146:147], v23 offset:20480
v_mfma_f32_16x16x32_bf16 v[88:91], a[156:159], a[72:75], v[88:91]
ds_read_b64_tr_b16 a[148:149], v23 offset:24576
buffer_load_dwordx4 v[208:211], v129, s[16:19], s40 offen offset:192
v_mfma_f32_16x16x32_bf16 v[88:91], a[152:155], a[64:67], v[88:91]
s_waitcnt vmcnt(28) lgkmcnt(7)
ds_read_b64_tr_b16 a[150:151], v23 offset:28672
v_mfma_f32_16x16x32_bf16 v[32:35], a[128:131], a[80:83], v[32:35]
ds_read_b64_tr_b16 a[152:153], v24 offset:16384
v_mfma_f32_16x16x32_bf16 v[32:35], a[132:135], a[88:91], v[32:35]
ds_read_b64_tr_b16 a[154:155], v24 offset:20480
v_mfma_f32_16x16x32_bf16 v[36:39], a[132:135], a[92:95], v[36:39]
ds_read_b64_tr_b16 a[156:157], v24 offset:24576
v_mfma_f32_16x16x32_bf16 v[36:39], a[128:131], a[84:87], v[36:39]
s_waitcnt lgkmcnt(7)
ds_read_b64_tr_b16 a[158:159], v24 offset:28672
v_mfma_f32_16x16x32_bf16 v[44:47], a[136:139], a[84:87], v[44:47]
ds_read_b64_tr_b16 a[128:129], v25 offset:16384
v_mfma_f32_16x16x32_bf16 v[44:47], a[140:143], a[92:95], v[44:47]
ds_read_b64_tr_b16 a[130:131], v25 offset:20480
v_mfma_f32_16x16x32_bf16 v[40:43], a[140:143], a[88:91], v[40:43]
ds_read_b64_tr_b16 a[132:133], v25 offset:24576
v_mfma_f32_16x16x32_bf16 v[40:43], a[136:139], a[80:83], v[40:43]
s_waitcnt lgkmcnt(7)
ds_read_b64_tr_b16 a[134:135], v25 offset:28672
v_mfma_f32_16x16x32_bf16 v[48:51], a[144:147], a[80:83], v[48:51]
ds_read_b64_tr_b16 a[136:137], v26 offset:16384
v_mfma_f32_16x16x32_bf16 v[48:51], a[148:151], a[88:91], v[48:51]
ds_read_b64_tr_b16 a[138:139], v26 offset:20480
v_mfma_f32_16x16x32_bf16 v[52:55], a[148:151], a[92:95], v[52:55]
ds_read_b64_tr_b16 a[140:141], v26 offset:24576
v_mfma_f32_16x16x32_bf16 v[52:55], a[144:147], a[84:87], v[52:55]
s_waitcnt lgkmcnt(7)
ds_read_b64_tr_b16 a[142:143], v26 offset:28672
v_mfma_f32_16x16x32_bf16 v[60:63], a[152:155], a[84:87], v[60:63]
ds_read_b64_tr_b16 a[144:145], v27 offset:16384
v_mfma_f32_16x16x32_bf16 v[60:63], a[156:159], a[92:95], v[60:63]
ds_read_b64_tr_b16 a[146:147], v27 offset:20480
v_mfma_f32_16x16x32_bf16 v[56:59], a[156:159], a[88:91], v[56:59]
ds_read_b64_tr_b16 a[148:149], v27 offset:24576
v_mfma_f32_16x16x32_bf16 v[56:59], a[152:155], a[80:83], v[56:59]
s_waitcnt lgkmcnt(7)
ds_read_b64_tr_b16 a[150:151], v27 offset:28672
v_mfma_f32_16x16x32_bf16 v[64:67], a[128:131], a[80:83], v[64:67]
ds_read_b64_tr_b16 a[152:153], v28 offset:16384
v_mfma_f32_16x16x32_bf16 v[64:67], a[132:135], a[88:91], v[64:67]
ds_read_b64_tr_b16 a[154:155], v28 offset:20480
v_mfma_f32_16x16x32_bf16 v[68:71], a[132:135], a[92:95], v[68:71]
ds_read_b64_tr_b16 a[156:157], v28 offset:24576
v_mfma_f32_16x16x32_bf16 v[68:71], a[128:131], a[84:87], v[68:71]
s_waitcnt lgkmcnt(7)
ds_read_b64_tr_b16 a[158:159], v28 offset:28672
v_mfma_f32_16x16x32_bf16 v[76:79], a[136:139], a[84:87], v[76:79]
s_waitcnt vmcnt(17)
s_barrier
ds_read_b64_tr_b16 a[128:129], v21 offset:32768
v_mfma_f32_16x16x32_bf16 v[76:79], a[140:143], a[92:95], v[76:79]
ds_read_b64_tr_b16 a[130:131], v21 offset:36864
v_mfma_f32_16x16x32_bf16 v[72:75], a[140:143], a[88:91], v[72:75]
ds_read_b64_tr_b16 a[132:133], v21 offset:40960
v_mfma_f32_16x16x32_bf16 v[72:75], a[136:139], a[80:83], v[72:75]
s_waitcnt lgkmcnt(7)
ds_read_b64_tr_b16 a[134:135], v21 offset:45056
v_mfma_f32_16x16x32_bf16 v[80:83], a[144:147], a[80:83], v[80:83]
ds_read_b64_tr_b16 a[136:137], v22 offset:32768
v_mfma_f32_16x16x32_bf16 v[80:83], a[148:151], a[88:91], v[80:83]
ds_read_b64_tr_b16 a[138:139], v22 offset:36864
v_mfma_f32_16x16x32_bf16 v[84:87], a[148:151], a[92:95], v[84:87]
ds_read_b64_tr_b16 a[140:141], v22 offset:40960
v_mfma_f32_16x16x32_bf16 v[84:87], a[144:147], a[84:87], v[84:87]
s_waitcnt lgkmcnt(7)
ds_read_b64_tr_b16 a[142:143], v22 offset:45056
v_mfma_f32_16x16x32_bf16 v[92:95], a[152:155], a[84:87], v[92:95]
ds_read_b64_tr_b16 a[144:145], v23 offset:32768
v_mfma_f32_16x16x32_bf16 v[92:95], a[156:159], a[92:95], v[92:95]
ds_read_b64_tr_b16 a[146:147], v23 offset:36864
v_mfma_f32_16x16x32_bf16 v[88:91], a[156:159], a[88:91], v[88:91]
ds_read_b64_tr_b16 a[148:149], v23 offset:40960
v_mfma_f32_16x16x32_bf16 v[88:91], a[152:155], a[80:83], v[88:91]
s_waitcnt vmcnt(16) lgkmcnt(7)
ds_read_b64_tr_b16 a[150:151], v23 offset:45056
v_mfma_f32_16x16x32_bf16 v[32:35], a[128:131], a[96:99], v[32:35]
ds_read_b64_tr_b16 a[152:153], v24 offset:32768
v_mfma_f32_16x16x32_bf16 v[32:35], a[132:135], a[104:107], v[32:35]
ds_read_b64_tr_b16 a[154:155], v24 offset:36864
v_mfma_f32_16x16x32_bf16 v[36:39], a[132:135], a[108:111], v[36:39]
ds_read_b64_tr_b16 a[156:157], v24 offset:40960
v_mfma_f32_16x16x32_bf16 v[36:39], a[128:131], a[100:103], v[36:39]
s_waitcnt lgkmcnt(7)
ds_read_b64_tr_b16 a[158:159], v24 offset:45056
v_mfma_f32_16x16x32_bf16 v[44:47], a[136:139], a[100:103], v[44:47]
ds_read_b64_tr_b16 a[128:129], v25 offset:32768
v_mfma_f32_16x16x32_bf16 v[44:47], a[140:143], a[108:111], v[44:47]
ds_read_b64_tr_b16 a[130:131], v25 offset:36864
v_mfma_f32_16x16x32_bf16 v[40:43], a[140:143], a[104:107], v[40:43]
ds_read_b64_tr_b16 a[132:133], v25 offset:40960
v_mfma_f32_16x16x32_bf16 v[40:43], a[136:139], a[96:99], v[40:43]
s_waitcnt lgkmcnt(7)
ds_read_b64_tr_b16 a[134:135], v25 offset:45056
v_mfma_f32_16x16x32_bf16 v[48:51], a[144:147], a[96:99], v[48:51]
ds_read_b64_tr_b16 a[136:137], v26 offset:32768
v_mfma_f32_16x16x32_bf16 v[48:51], a[148:151], a[104:107], v[48:51]
ds_read_b64_tr_b16 a[138:139], v26 offset:36864
v_mfma_f32_16x16x32_bf16 v[52:55], a[148:151], a[108:111], v[52:55]
ds_read_b64_tr_b16 a[140:141], v26 offset:40960
v_mfma_f32_16x16x32_bf16 v[52:55], a[144:147], a[100:103], v[52:55]
s_waitcnt lgkmcnt(7)
ds_read_b64_tr_b16 a[142:143], v26 offset:45056
v_mfma_f32_16x16x32_bf16 v[60:63], a[152:155], a[100:103], v[60:63]
ds_read_b64_tr_b16 a[144:145], v27 offset:32768
v_mfma_f32_16x16x32_bf16 v[60:63], a[156:159], a[108:111], v[60:63]
ds_read_b64_tr_b16 a[146:147], v27 offset:36864
v_mfma_f32_16x16x32_bf16 v[56:59], a[156:159], a[104:107], v[56:59]
ds_read_b64_tr_b16 a[148:149], v27 offset:40960
v_mfma_f32_16x16x32_bf16 v[56:59], a[152:155], a[96:99], v[56:59]
s_waitcnt lgkmcnt(7)
ds_read_b64_tr_b16 a[150:151], v27 offset:45056
v_mfma_f32_16x16x32_bf16 v[64:67], a[128:131], a[96:99], v[64:67]
ds_read_b64_tr_b16 a[152:153], v28 offset:32768
v_mfma_f32_16x16x32_bf16 v[64:67], a[132:135], a[104:107], v[64:67]
ds_read_b64_tr_b16 a[154:155], v28 offset:36864
v_mfma_f32_16x16x32_bf16 v[68:71], a[132:135], a[108:111], v[68:71]
ds_read_b64_tr_b16 a[156:157], v28 offset:40960
v_mfma_f32_16x16x32_bf16 v[68:71], a[128:131], a[100:103], v[68:71]
s_waitcnt lgkmcnt(7)
ds_read_b64_tr_b16 a[158:159], v28 offset:45056
v_mfma_f32_16x16x32_bf16 v[76:79], a[136:139], a[100:103], v[76:79]
s_waitcnt vmcnt(5)
s_barrier
ds_read_b64_tr_b16 a[128:129], v21 offset:49152
v_mfma_f32_16x16x32_bf16 v[76:79], a[140:143], a[108:111], v[76:79]
ds_read_b64_tr_b16 a[130:131], v21 offset:53248
v_mfma_f32_16x16x32_bf16 v[72:75], a[140:143], a[104:107], v[72:75]
ds_read_b64_tr_b16 a[132:133], v21 offset:57344
v_mfma_f32_16x16x32_bf16 v[72:75], a[136:139], a[96:99], v[72:75]
s_waitcnt lgkmcnt(7)
ds_read_b64_tr_b16 a[134:135], v21 offset:61440
v_mfma_f32_16x16x32_bf16 v[80:83], a[144:147], a[96:99], v[80:83]
ds_read_b64_tr_b16 a[136:137], v22 offset:49152
v_mfma_f32_16x16x32_bf16 v[80:83], a[148:151], a[104:107], v[80:83]
ds_read_b64_tr_b16 a[138:139], v22 offset:53248
v_mfma_f32_16x16x32_bf16 v[84:87], a[148:151], a[108:111], v[84:87]
ds_read_b64_tr_b16 a[140:141], v22 offset:57344
v_mfma_f32_16x16x32_bf16 v[84:87], a[144:147], a[100:103], v[84:87]
s_waitcnt lgkmcnt(7)
ds_read_b64_tr_b16 a[142:143], v22 offset:61440
v_mfma_f32_16x16x32_bf16 v[92:95], a[152:155], a[100:103], v[92:95]
ds_read_b64_tr_b16 a[144:145], v23 offset:49152
v_mfma_f32_16x16x32_bf16 v[92:95], a[156:159], a[108:111], v[92:95]
ds_read_b64_tr_b16 a[146:147], v23 offset:53248
v_mfma_f32_16x16x32_bf16 v[88:91], a[156:159], a[104:107], v[88:91]
ds_read_b64_tr_b16 a[148:149], v23 offset:57344
v_mfma_f32_16x16x32_bf16 v[88:91], a[152:155], a[96:99], v[88:91]
s_waitcnt vmcnt(4) lgkmcnt(7)
ds_read_b64_tr_b16 a[150:151], v23 offset:61440
v_mfma_f32_16x16x32_bf16 v[32:35], a[128:131], a[112:115], v[32:35]
ds_read_b64_tr_b16 a[152:153], v24 offset:49152
v_mfma_f32_16x16x32_bf16 v[32:35], a[132:135], a[120:123], v[32:35]
ds_read_b64_tr_b16 a[154:155], v24 offset:53248
v_mfma_f32_16x16x32_bf16 v[36:39], a[132:135], a[124:127], v[36:39]
ds_read_b64_tr_b16 a[156:157], v24 offset:57344
v_mfma_f32_16x16x32_bf16 v[36:39], a[128:131], a[116:119], v[36:39]
s_waitcnt lgkmcnt(7)
ds_read_b64_tr_b16 a[158:159], v24 offset:61440
v_mfma_f32_16x16x32_bf16 v[44:47], a[136:139], a[116:119], v[44:47]
ds_read_b64_tr_b16 a[128:129], v25 offset:49152
v_mfma_f32_16x16x32_bf16 v[44:47], a[140:143], a[124:127], v[44:47]
ds_read_b64_tr_b16 a[130:131], v25 offset:53248
v_mfma_f32_16x16x32_bf16 v[40:43], a[140:143], a[120:123], v[40:43]
ds_read_b64_tr_b16 a[132:133], v25 offset:57344
v_mfma_f32_16x16x32_bf16 v[40:43], a[136:139], a[112:115], v[40:43]
s_waitcnt lgkmcnt(7)
ds_read_b64_tr_b16 a[134:135], v25 offset:61440
v_mfma_f32_16x16x32_bf16 v[48:51], a[144:147], a[112:115], v[48:51]
ds_read_b64_tr_b16 a[136:137], v26 offset:49152
v_mfma_f32_16x16x32_bf16 v[48:51], a[148:151], a[120:123], v[48:51]
ds_read_b64_tr_b16 a[138:139], v26 offset:53248
v_mfma_f32_16x16x32_bf16 v[52:55], a[148:151], a[124:127], v[52:55]
ds_read_b64_tr_b16 a[140:141], v26 offset:57344
v_mfma_f32_16x16x32_bf16 v[52:55], a[144:147], a[116:119], v[52:55]
s_waitcnt lgkmcnt(7)
ds_read_b64_tr_b16 a[142:143], v26 offset:61440
v_mfma_f32_16x16x32_bf16 v[60:63], a[152:155], a[116:119], v[60:63]
ds_read_b64_tr_b16 a[144:145], v27 offset:49152
v_mfma_f32_16x16x32_bf16 v[60:63], a[156:159], a[124:127], v[60:63]
ds_read_b64_tr_b16 a[146:147], v27 offset:53248
v_mfma_f32_16x16x32_bf16 v[56:59], a[156:159], a[120:123], v[56:59]
ds_read_b64_tr_b16 a[148:149], v27 offset:57344
v_mfma_f32_16x16x32_bf16 v[56:59], a[152:155], a[112:115], v[56:59]
s_waitcnt lgkmcnt(7)
ds_read_b64_tr_b16 a[150:151], v27 offset:61440
v_mfma_f32_16x16x32_bf16 v[64:67], a[128:131], a[112:115], v[64:67]
ds_read_b64_tr_b16 a[152:153], v28 offset:49152
v_mfma_f32_16x16x32_bf16 v[64:67], a[132:135], a[120:123], v[64:67]
ds_read_b64_tr_b16 a[154:155], v28 offset:53248
v_mfma_f32_16x16x32_bf16 v[68:71], a[132:135], a[124:127], v[68:71]
ds_read_b64_tr_b16 a[156:157], v28 offset:57344
v_mfma_f32_16x16x32_bf16 v[68:71], a[128:131], a[116:119], v[68:71]
s_waitcnt lgkmcnt(7)
ds_read_b64_tr_b16 a[158:159], v28 offset:61440
v_mfma_f32_16x16x32_bf16 v[76:79], a[136:139], a[116:119], v[76:79]
v_mfma_f32_16x16x32_bf16 v[76:79], a[140:143], a[124:127], v[76:79]
v_mfma_f32_16x16x32_bf16 v[72:75], a[140:143], a[120:123], v[72:75]
v_mfma_f32_16x16x32_bf16 v[72:75], a[136:139], a[112:115], v[72:75]
s_waitcnt lgkmcnt(4)
v_mfma_f32_16x16x32_bf16 v[80:83], a[144:147], a[112:115], v[80:83]
v_mfma_f32_16x16x32_bf16 v[80:83], a[148:151], a[120:123], v[80:83]
v_mfma_f32_16x16x32_bf16 v[84:87], a[148:151], a[124:127], v[84:87]
v_mfma_f32_16x16x32_bf16 v[84:87], a[144:147], a[116:119], v[84:87]
s_waitcnt lgkmcnt(0)
v_mfma_f32_16x16x32_bf16 v[92:95], a[152:155], a[116:119], v[92:95]
v_mfma_f32_16x16x32_bf16 v[92:95], a[156:159], a[124:127], v[92:95]
v_mfma_f32_16x16x32_bf16 v[88:91], a[156:159], a[120:123], v[88:91]
v_mfma_f32_16x16x32_bf16 v[88:91], a[152:155], a[112:115], v[88:91]
s_nop 7
s_lshl_b32 s35, s2, 2
s_add_u32 s35, s35, s24
s_lshl_b32 s36, s35, 7
s_lshl_b32 s35, s35, 12
s_add_u32 s35, s35, 48300032
v_cvt_pk_bf16_f32 v148, v64, v65
v_cvt_pk_bf16_f32 v149, v66, v67
v_cvt_pk_bf16_f32 v150, v72, v73
v_cvt_pk_bf16_f32 v151, v74, v75
v_cvt_pk_bf16_f32 v152, v80, v81
v_cvt_pk_bf16_f32 v153, v82, v83
v_cvt_pk_bf16_f32 v154, v88, v89
v_cvt_pk_bf16_f32 v155, v90, v91
v_cvt_pk_bf16_f32 v156, v68, v69
v_cvt_pk_bf16_f32 v157, v70, v71
v_cvt_pk_bf16_f32 v158, v76, v77
v_cvt_pk_bf16_f32 v159, v78, v79
v_cvt_pk_bf16_f32 v160, v84, v85
v_cvt_pk_bf16_f32 v161, v86, v87
v_cvt_pk_bf16_f32 v162, v92, v93
v_cvt_pk_bf16_f32 v163, v94, v95
s_add_u32 s36, s36, 56688640
buffer_store_dwordx4 v[148:151], v2, s[16:19], s35 offen offset:0 sc1
buffer_store_dwordx4 v[152:155], v2, s[16:19], s35 offen offset:1024 sc1
buffer_store_dwordx4 v[156:159], v2, s[16:19], s35 offen offset:2048 sc1
buffer_store_dwordx4 v[160:163], v2, s[16:19], s35 offen offset:3072 sc1
s_waitcnt vmcnt(0)
v_mov_b32 v3, 0
v_mov_b32 v4, 1
s_mov_b64 exec, 1
buffer_store_dword v4, v3, s[16:19], s36 offen sc1
s_mov_b64 exec, -1
v_add_f32 v112, v112, v164
v_add_f32 v180, v180, v196
v_add_f32 v113, v113, v165
v_add_f32 v181, v181, v197
v_add_f32 v114, v114, v166
v_add_f32 v182, v182, v198
v_add_f32 v115, v115, v167
v_add_f32 v183, v183, v199
v_add_f32 v116, v116, v168
v_add_f32 v184, v184, v200
v_add_f32 v117, v117, v169
v_add_f32 v185, v185, v201
v_add_f32 v118, v118, v170
v_add_f32 v186, v186, v202
v_add_f32 v119, v119, v171
v_add_f32 v187, v187, v203
v_add_f32 v120, v120, v172
v_add_f32 v188, v188, v204
v_add_f32 v121, v121, v173
v_add_f32 v189, v189, v205
v_add_f32 v122, v122, v174
v_add_f32 v190, v190, v206
v_add_f32 v123, v123, v175
v_add_f32 v191, v191, v207
v_add_f32 v124, v124, v176
v_add_f32 v192, v192, v208
v_add_f32 v125, v125, v177
v_add_f32 v193, v193, v209
v_add_f32 v126, v126, v178
v_add_f32 v194, v194, v210
v_add_f32 v127, v127, v179
v_add_f32 v195, v195, v211
v_add_f32 v112, v112, v180
v_add_f32 v113, v113, v181
v_add_f32 v114, v114, v182
v_add_f32 v115, v115, v183
v_add_f32 v116, v116, v184
v_add_f32 v117, v117, v185
v_add_f32 v118, v118, v186
v_add_f32 v119, v119, v187
v_add_f32 v120, v120, v188
v_add_f32 v121, v121, v189
v_add_f32 v122, v122, v190
v_add_f32 v123, v123, v191
v_add_f32 v124, v124, v192
v_add_f32 v125, v125, v193
v_add_f32 v126, v126, v194
v_add_f32 v127, v127, v195
v_cvt_pk_bf16_f32 v164, v112, v113
v_lshlrev_b32 v112, 16, v164
v_and_b32 v113, 0xffff0000, v164
v_cvt_pk_bf16_f32 v166, v114, v115
v_lshlrev_b32 v114, 16, v166
v_and_b32 v115, 0xffff0000, v166
v_cvt_pk_bf16_f32 v168, v116, v117
v_lshlrev_b32 v116, 16, v168
v_and_b32 v117, 0xffff0000, v168
v_cvt_pk_bf16_f32 v170, v118, v119
v_lshlrev_b32 v118, 16, v170
v_and_b32 v119, 0xffff0000, v170
v_cvt_pk_bf16_f32 v172, v120, v121
v_lshlrev_b32 v120, 16, v172
v_and_b32 v121, 0xffff0000, v172
v_cvt_pk_bf16_f32 v174, v122, v123
v_lshlrev_b32 v122, 16, v174
v_and_b32 v123, 0xffff0000, v174
v_cvt_pk_bf16_f32 v176, v124, v125
v_lshlrev_b32 v124, 16, v176
v_and_b32 v125, 0xffff0000, v176
v_cvt_pk_bf16_f32 v178, v126, v127
v_lshlrev_b32 v126, 16, v178
v_and_b32 v127, 0xffff0000, v178
v_lshlrev_b32 v214, 16, v96
v_and_b32 v215, 0xffff0000, v96
v_fma_f32 v32, v32, v112, v214
v_fma_f32 v33, v33, v113, v215
v_lshlrev_b32 v214, 16, v97
v_and_b32 v215, 0xffff0000, v97
v_fma_f32 v34, v34, v114, v214
v_fma_f32 v35, v35, v115, v215
v_lshlrev_b32 v214, 16, v98
v_and_b32 v215, 0xffff0000, v98
v_fma_f32 v40, v40, v116, v214
v_fma_f32 v41, v41, v117, v215
v_lshlrev_b32 v214, 16, v99
v_and_b32 v215, 0xffff0000, v99
v_fma_f32 v42, v42, v118, v214
v_fma_f32 v43, v43, v119, v215
v_lshlrev_b32 v214, 16, v100
v_and_b32 v215, 0xffff0000, v100
v_fma_f32 v48, v48, v120, v214
v_fma_f32 v49, v49, v121, v215
v_lshlrev_b32 v214, 16, v101
v_and_b32 v215, 0xffff0000, v101
v_fma_f32 v50, v50, v122, v214
v_fma_f32 v51, v51, v123, v215
v_lshlrev_b32 v214, 16, v102
v_and_b32 v215, 0xffff0000, v102
v_fma_f32 v56, v56, v124, v214
v_fma_f32 v57, v57, v125, v215
v_lshlrev_b32 v214, 16, v103
v_and_b32 v215, 0xffff0000, v103
v_fma_f32 v58, v58, v126, v214
v_fma_f32 v59, v59, v127, v215
v_lshlrev_b32 v214, 16, v104
v_and_b32 v215, 0xffff0000, v104
v_fma_f32 v36, v36, v112, v214
v_fma_f32 v37, v37, v113, v215
v_lshlrev_b32 v214, 16, v105
v_and_b32 v215, 0xffff0000, v105
v_fma_f32 v38, v38, v114, v214
v_fma_f32 v39, v39, v115, v215
v_lshlrev_b32 v214, 16, v106
v_and_b32 v215, 0xffff0000, v106
v_fma_f32 v44, v44, v116, v214
v_fma_f32 v45, v45, v117, v215
v_lshlrev_b32 v214, 16, v107
v_and_b32 v215, 0xffff0000, v107
v_fma_f32 v46, v46, v118, v214
v_fma_f32 v47, v47, v119, v215
v_lshlrev_b32 v214, 16, v108
v_and_b32 v215, 0xffff0000, v108
v_fma_f32 v52, v52, v120, v214
v_fma_f32 v53, v53, v121, v215
v_lshlrev_b32 v214, 16, v109
v_and_b32 v215, 0xffff0000, v109
v_fma_f32 v54, v54, v122, v214
v_fma_f32 v55, v55, v123, v215
v_lshlrev_b32 v214, 16, v110
v_and_b32 v215, 0xffff0000, v110
v_fma_f32 v60, v60, v124, v214
v_fma_f32 v61, v61, v125, v215
v_lshlrev_b32 v214, 16, v111
v_and_b32 v215, 0xffff0000, v111
v_fma_f32 v62, v62, v126, v214
v_fma_f32 v63, v63, v127, v215
v_mov_b32 v3, 0
s_xor_b32 s36, s2, 1
s_lshl_b32 s36, s36, 2
s_add_u32 s36, s36, s24
s_lshl_b32 s35, s36, 12
s_add_u32 s35, s35, 48300032
s_lshl_b32 s36, s36, 7
s_add_u32 s36, s36, 56688640
s_mov_b32 s29, 0x200000
L_opx_aw:
buffer_load_dword v4, v3, s[16:19], s36 offen sc1
s_waitcnt vmcnt(0)
v_cmp_eq_u32 vcc, 0, v4
s_sub_u32 s29, s29, 1
s_cmp_eq_u32 s29, 0
s_cbranch_scc1 L_opx_awd
s_cmp_lg_u64 vcc, 0
s_cbranch_scc1 L_opx_aw
L_opx_awd:
buffer_load_dwordx4 v[132:135], v2, s[16:19], s35 offen offset:0 sc1
buffer_load_dwordx4 v[136:139], v2, s[16:19], s35 offen offset:1024 sc1
buffer_load_dwordx4 v[140:143], v2, s[16:19], s35 offen offset:2048 sc1
buffer_load_dwordx4 v[144:147], v2, s[16:19], s35 offen offset:3072 sc1
s_waitcnt vmcnt(2)
v_lshlrev_b32 v212, 16, v132
v_and_b32 v213, 0xffff0000, v132
v_fmac_f32 v32, v212, v112
v_fmac_f32 v33, v213, v113
v_lshlrev_b32 v212, 16, v133
v_and_b32 v213, 0xffff0000, v133
v_fmac_f32 v34, v212, v114
v_fmac_f32 v35, v213, v115
v_cvt_pk_bf16_f32 v96, v32, v33
v_cvt_pk_bf16_f32 v97, v34, v35
v_lshlrev_b32 v212, 16, v134
v_and_b32 v213, 0xffff0000, v134
v_fmac_f32 v40, v212, v116
v_fmac_f32 v41, v213, v117
v_lshlrev_b32 v212, 16, v135
v_and_b32 v213, 0xffff0000, v135
v_fmac_f32 v42, v212, v118
v_fmac_f32 v43, v213, v119
v_cvt_pk_bf16_f32 v98, v40, v41
v_cvt_pk_bf16_f32 v99, v42, v43
v_lshlrev_b32 v212, 16, v136
v_and_b32 v213, 0xffff0000, v136
v_fmac_f32 v48, v212, v120
v_fmac_f32 v49, v213, v121
v_lshlrev_b32 v212, 16, v137
v_and_b32 v213, 0xffff0000, v137
v_fmac_f32 v50, v212, v122
v_fmac_f32 v51, v213, v123
v_cvt_pk_bf16_f32 v100, v48, v49
v_cvt_pk_bf16_f32 v101, v50, v51
v_lshlrev_b32 v212, 16, v138
v_and_b32 v213, 0xffff0000, v138
v_fmac_f32 v56, v212, v124
v_fmac_f32 v57, v213, v125
v_lshlrev_b32 v212, 16, v139
v_and_b32 v213, 0xffff0000, v139
v_fmac_f32 v58, v212, v126
v_fmac_f32 v59, v213, v127
v_cvt_pk_bf16_f32 v102, v56, v57
v_cvt_pk_bf16_f32 v103, v58, v59
s_lshl_b32 s35, s30, 15
s_lshl_b32 s28, s37, 11
s_add_u32 s35, s35, s28
s_add_u32 s35, s35, 25231360
buffer_store_dwordx4 v[96:99], v2, s[16:19], s35 offen offset:0 sc1
buffer_store_dwordx4 v[100:103], v2, s[16:19], s35 offen offset:1024 sc1
s_add_u32 s35, s35, 32768
s_waitcnt vmcnt(2)
v_lshlrev_b32 v212, 16, v140
v_and_b32 v213, 0xffff0000, v140
v_fmac_f32 v36, v212, v112
v_fmac_f32 v37, v213, v113
v_lshlrev_b32 v212, 16, v141
v_and_b32 v213, 0xffff0000, v141
v_fmac_f32 v38, v212, v114
v_fmac_f32 v39, v213, v115
v_cvt_pk_bf16_f32 v104, v36, v37
v_cvt_pk_bf16_f32 v105, v38, v39
v_lshlrev_b32 v212, 16, v142
v_and_b32 v213, 0xffff0000, v142
v_fmac_f32 v44, v212, v116
v_fmac_f32 v45, v213, v117
v_lshlrev_b32 v212, 16, v143
v_and_b32 v213, 0xffff0000, v143
v_fmac_f32 v46, v212, v118
v_fmac_f32 v47, v213, v119
v_cvt_pk_bf16_f32 v106, v44, v45
v_cvt_pk_bf16_f32 v107, v46, v47
v_lshlrev_b32 v212, 16, v144
v_and_b32 v213, 0xffff0000, v144
v_fmac_f32 v52, v212, v120
v_fmac_f32 v53, v213, v121
v_lshlrev_b32 v212, 16, v145
v_and_b32 v213, 0xffff0000, v145
v_fmac_f32 v54, v212, v122
v_fmac_f32 v55, v213, v123
v_cvt_pk_bf16_f32 v108, v52, v53
v_cvt_pk_bf16_f32 v109, v54, v55
v_lshlrev_b32 v212, 16, v146
v_and_b32 v213, 0xffff0000, v146
v_fmac_f32 v60, v212, v124
v_fmac_f32 v61, v213, v125
v_lshlrev_b32 v212, 16, v147
v_and_b32 v213, 0xffff0000, v147
v_fmac_f32 v62, v212, v126
v_fmac_f32 v63, v213, v127
v_cvt_pk_bf16_f32 v110, v60, v61
v_cvt_pk_bf16_f32 v111, v62, v63
buffer_store_dwordx4 v[104:107], v2, s[16:19], s35 offen offset:0 sc1
buffer_store_dwordx4 v[108:111], v2, s[16:19], s35 offen offset:1024 sc1
s_waitcnt vmcnt(0)
s_lshl_b32 s28, s2, 2
s_add_u32 s28, s28, s24
s_lshl_b32 s28, s28, 7
s_add_u32 s28, s28, 57049088
v_mov_b32 v3, 0
v_mov_b32 v4, 1
s_mov_b64 exec, 1
buffer_store_dword v4, v3, s[16:19], s28 offen sc1
s_mov_b64 exec, -1
L_phase_gu:
s_barrier
s_load_dwordx2 s[4:5], s[0:1], 48
s_load_dwordx2 s[6:7], s[0:1], 56
s_load_dwordx2 s[8:9], s[0:1], 104
v_lshrrev_b32 v2, 6, v0
v_and_b32 v1, 63, v0
v_readfirstlane_b32 s20, v2
v_lshlrev_b32 v2, 4, v1
s_and_b32 s24, s2, 7
s_lshr_b32 s25, s2, 3
s_lshr_b32 s21, s24, 2
s_lshl_b32 s21, s21, 2
s_lshr_b32 s22, s25, 3
s_add_u32 s21, s21, s22
s_and_b32 s22, s24, 3
s_lshl_b32 s22, s22, 3
s_and_b32 s25, s25, 7
s_add_u32 s22, s22, s25
s_and_b32 s23, s22, 1
v_add_u32 v5, 0, v2
v_add_u32 v6, 32768, v2
v_add_u32 v7, 65536, v2
v_add_u32 v8, 98304, v2
s_and_b32 s24, s20, 1
s_mul_i32 s24, s24, 448
s_mov_b32 s25, 4682
v_add_u32 v3, s24, v1
v_mul_lo_u32 v4, v3, s25
v_lshrrev_b32 v4, 16, v4
v_mul_u32_u24 v9, 14, v4
v_sub_u32 v3, v3, v9
v_mul_u32_u24 v9, 7168, v4
v_lshl_add_u32 v9, v3, 4, v9
v_add_u32 v3, s24, v1
v_add_u32 v3, 64, v3
v_mul_lo_u32 v4, v3, s25
v_lshrrev_b32 v4, 16, v4
v_mul_u32_u24 v10, 14, v4
v_sub_u32 v3, v3, v10
v_mul_u32_u24 v10, 7168, v4
v_lshl_add_u32 v10, v3, 4, v10
v_add_u32 v3, s24, v1
v_add_u32 v3, 128, v3
v_mul_lo_u32 v4, v3, s25
v_lshrrev_b32 v4, 16, v4
v_mul_u32_u24 v11, 14, v4
v_sub_u32 v3, v3, v11
v_mul_u32_u24 v11, 7168, v4
v_lshl_add_u32 v11, v3, 4, v11
v_add_u32 v3, s24, v1
v_add_u32 v3, 192, v3
v_mul_lo_u32 v4, v3, s25
v_lshrrev_b32 v4, 16, v4
v_mul_u32_u24 v12, 14, v4
v_sub_u32 v3, v3, v12
v_mul_u32_u24 v12, 7168, v4
v_lshl_add_u32 v12, v3, 4, v12
v_add_u32 v3, s24, v1
v_add_u32 v3, 256, v3
v_mul_lo_u32 v4, v3, s25
v_lshrrev_b32 v4, 16, v4
v_mul_u32_u24 v13, 14, v4
v_sub_u32 v3, v3, v13
v_mul_u32_u24 v13, 7168, v4
v_lshl_add_u32 v13, v3, 4, v13
v_add_u32 v3, s24, v1
v_add_u32 v3, 320, v3
v_mul_lo_u32 v4, v3, s25
v_lshrrev_b32 v4, 16, v4
v_mul_u32_u24 v14, 14, v4
v_sub_u32 v3, v3, v14
v_mul_u32_u24 v14, 7168, v4
v_lshl_add_u32 v14, v3, 4, v14
v_add_u32 v3, s24, v1
v_add_u32 v3, 384, v3
v_mul_lo_u32 v4, v3, s25
v_lshrrev_b32 v4, 16, v4
v_mul_u32_u24 v15, 14, v4
v_sub_u32 v3, v3, v15
v_mul_u32_u24 v15, 7168, v4
v_lshl_add_u32 v15, v3, 4, v15
v_lshrrev_b32 v3, 2, v1
v_mul_u32_u24 v3, 224, v3
v_and_b32 v4, 3, v1
v_lshl_add_u32 v3, v4, 3, v3
s_lshl_b32 s24, s23, 5
v_add_u32 v16, s24, v3
s_cmp_eq_u32 s23, 0
s_cselect_b32 s24, 192, 0
v_add_u32 v17, s24, v3
v_add_u32 v18, 57344, v16
v_add_u32 v19, 57344, v17
s_waitcnt lgkmcnt(0)
s_cmp_lt_u32 s20, 2
s_cselect_b32 s24, s4, s6
s_cselect_b32 s25, s5, s7
s_mov_b32 s12, s24
s_and_b32 s13, s25, 0xffff
s_mov_b32 s14, 7340032
s_mov_b32 s15, 0x20000
s_mov_b32 s16, s8
s_and_b32 s17, s9, 0xffff
s_mov_b32 s18, 0x10000000
s_mov_b32 s19, 0x20000
s_lshr_b32 s24, s20, 1
s_mul_i32 s26, s24, 14336
s_and_b32 s24, s20, 1
s_mul_i32 s24, s24, 7168
s_add_u32 s26, s26, s24
s_mul_i32 s27, s22, 224
s_lshl_b32 s30, s21, 4
s_lshl_b32 s24, s20, 2
s_add_u32 s30, s30, s24
s_lshl_b32 s28, s30, 15
s_add_u32 s28, s28, 29425664
s_lshr_b32 s31, s22, 1
s_lshl_b32 s35, s21, 4
s_add_u32 s31, s31, s35
s_and_b32 s32, s22, 1
s_add_u32 m0, s26, 0
s_nop 0
buffer_load_dwordx4 v9, s[12:15], s27 offen lds
s_add_u32 m0, s26, 1024
s_nop 0
buffer_load_dwordx4 v10, s[12:15], s27 offen lds
s_add_u32 m0, s26, 2048
s_nop 0
buffer_load_dwordx4 v11, s[12:15], s27 offen lds
s_add_u32 m0, s26, 3072
s_nop 0
buffer_load_dwordx4 v12, s[12:15], s27 offen lds
s_add_u32 m0, s26, 4096
s_nop 0
buffer_load_dwordx4 v13, s[12:15], s27 offen lds
s_add_u32 m0, s26, 5120
s_nop 0
buffer_load_dwordx4 v14, s[12:15], s27 offen lds
s_add_u32 m0, s26, 6144
s_nop 0
buffer_load_dwordx4 v15, s[12:15], s27 offen lds
s_add_u32 s27, s27, 458752
s_add_u32 m0, s26, 28672
s_nop 0
buffer_load_dwordx4 v9, s[12:15], s27 offen lds
s_add_u32 m0, s26, 29696
s_nop 0
buffer_load_dwordx4 v10, s[12:15], s27 offen lds
s_add_u32 m0, s26, 30720
s_nop 0
buffer_load_dwordx4 v11, s[12:15], s27 offen lds
s_add_u32 m0, s26, 31744
s_nop 0
buffer_load_dwordx4 v12, s[12:15], s27 offen lds
s_add_u32 m0, s26, 32768
s_nop 0
buffer_load_dwordx4 v13, s[12:15], s27 offen lds
s_add_u32 m0, s26, 33792
s_nop 0
buffer_load_dwordx4 v14, s[12:15], s27 offen lds
s_add_u32 m0, s26, 34816
s_nop 0
buffer_load_dwordx4 v15, s[12:15], s27 offen lds
s_add_u32 s27, s27, 458752
s_lshr_b32 s24, s31, 5
s_lshl_b32 s24, s24, 1
s_bfe_u32 s25, s31, 0x20003
s_lshl_b32 s25, s25, 6
s_add_u32 s24, s24, s25
s_lshl_b32 s24, s24, 2
s_bfe_u32 s25, s31, 0x20001
s_add_u32 s24, s24, s25
s_lshl_b32 s24, s24, 7
s_add_u32 s24, s24, 57049088
v_and_b32 v3, 1, v1
v_bfe_u32 v4, v1, 1, 3
v_lshl_add_u32 v3, v4, 3, v3
v_lshlrev_b32 v3, 9, v3
s_mov_b32 s25, 0x200000
L_guw_aw:
buffer_load_dword v4, v3, s[16:19], s24 offen sc1
s_waitcnt vmcnt(0)
v_cmp_eq_u32 vcc, 0, v4
s_sub_u32 s25, s25, 1
s_cmp_eq_u32 s25, 0
s_cbranch_scc1 L_guw_awd
s_cmp_lg_u64 vcc, 0
s_cbranch_scc1 L_guw_aw
L_guw_awd:
s_lshl_b32 s33, s31, 15
s_lshl_b32 s34, s20, 12
s_add_u32 s33, s33, s34
s_add_u32 s33, s33, 25231360
s_lshl_b32 s35, s32, 14
s_add_u32 s34, s33, s35
s_xor_b32 s35, s35, 16384
s_add_u32 s33, s33, s35
buffer_load_dwordx4 v[24:27], v2, s[16:19], s34 offen offset:0 sc1
buffer_load_dwordx4 v[28:31], v2, s[16:19], s34 offen offset:1024 sc1
buffer_load_dwordx4 v[32:35], v2, s[16:19], s34 offen offset:2048 sc1
buffer_load_dwordx4 v[36:39], v2, s[16:19], s34 offen offset:3072 sc1
buffer_load_dwordx4 v[40:43], v2, s[16:19], s33 offen offset:0 sc1
buffer_load_dwordx4 v[44:47], v2, s[16:19], s33 offen offset:1024 sc1
buffer_load_dwordx4 v[48:51], v2, s[16:19], s33 offen offset:2048 sc1
buffer_load_dwordx4 v[52:55], v2, s[16:19], s33 offen offset:3072 sc1
v_and_b32 v159, 127, v0
v_lshlrev_b32 v159, 4, v159
s_cmp_ge_u32 s20, 2
s_cselect_b32 s35, 4096, 0
s_lshl_b32 s36, s32, 11
s_add_u32 s35, s35, s36
s_add_u32 s35, s35, 71380992
buffer_load_dwordx4 v[120:123], v159, s[16:19], s35 offen
s_add_u32 s35, s35, 24576
buffer_load_dwordx4 v[124:127], v159, s[16:19], s35 offen
s_add_u32 s35, s35, 24576
buffer_load_dwordx4 v[128:131], v159, s[16:19], s35 offen
s_add_u32 s35, s35, 24576
buffer_load_dwordx4 v[132:135], v159, s[16:19], s35 offen
s_waitcnt vmcnt(4)
v_lshlrev_b32 v56, 16, v24
v_and_b32 v57, 0xffff0000, v24
v_lshlrev_b32 v58, 16, v25
v_and_b32 v59, 0xffff0000, v25
v_lshlrev_b32 v60, 16, v26
v_and_b32 v61, 0xffff0000, v26
v_lshlrev_b32 v62, 16, v27
v_and_b32 v63, 0xffff0000, v27
v_lshlrev_b32 v64, 16, v28
v_and_b32 v65, 0xffff0000, v28
v_lshlrev_b32 v66, 16, v29
v_and_b32 v67, 0xffff0000, v29
v_lshlrev_b32 v68, 16, v30
v_and_b32 v69, 0xffff0000, v30
v_lshlrev_b32 v70, 16, v31
v_and_b32 v71, 0xffff0000, v31
v_lshlrev_b32 v72, 16, v32
v_and_b32 v73, 0xffff0000, v32
v_lshlrev_b32 v74, 16, v33
v_and_b32 v75, 0xffff0000, v33
v_lshlrev_b32 v76, 16, v34
v_and_b32 v77, 0xffff0000, v34
v_lshlrev_b32 v78, 16, v35
v_and_b32 v79, 0xffff0000, v35
v_lshlrev_b32 v80, 16, v36
v_and_b32 v81, 0xffff0000, v36
v_lshlrev_b32 v82, 16, v37
v_and_b32 v83, 0xffff0000, v37
v_lshlrev_b32 v84, 16, v38
v_and_b32 v85, 0xffff0000, v38
v_lshlrev_b32 v86, 16, v39
v_and_b32 v87, 0xffff0000, v39
v_lshlrev_b32 v88, 16, v40
v_and_b32 v89, 0xffff0000, v40
v_lshlrev_b32 v90, 16, v41
v_and_b32 v91, 0xffff0000, v41
v_lshlrev_b32 v92, 16, v42
v_and_b32 v93, 0xffff0000, v42
v_lshlrev_b32 v94, 16, v43
v_and_b32 v95, 0xffff0000, v43
v_lshlrev_b32 v96, 16, v44
v_and_b32 v97, 0xffff0000, v44
v_lshlrev_b32 v98, 16, v45
v_and_b32 v99, 0xffff0000, v45
v_lshlrev_b32 v100, 16, v46
v_and_b32 v101, 0xffff0000, v46
v_lshlrev_b32 v102, 16, v47
v_and_b32 v103, 0xffff0000, v47
v_lshlrev_b32 v104, 16, v48
v_and_b32 v105, 0xffff0000, v48
v_lshlrev_b32 v106, 16, v49
v_and_b32 v107, 0xffff0000, v49
v_lshlrev_b32 v108, 16, v50
v_and_b32 v109, 0xffff0000, v50
v_lshlrev_b32 v110, 16, v51
v_and_b32 v111, 0xffff0000, v51
v_lshlrev_b32 v112, 16, v52
v_and_b32 v113, 0xffff0000, v52
v_lshlrev_b32 v114, 16, v53
v_and_b32 v115, 0xffff0000, v53
v_lshlrev_b32 v116, 16, v54
v_and_b32 v117, 0xffff0000, v54
v_lshlrev_b32 v118, 16, v55
v_and_b32 v119, 0xffff0000, v55
v_pk_add_f32 v[136:137], v[56:57], v[58:59]
v_pk_add_f32 v[138:139], v[60:61], v[62:63]
v_pk_add_f32 v[136:137], v[136:137], v[64:65]
v_pk_add_f32 v[138:139], v[138:139], v[66:67]
v_pk_add_f32 v[136:137], v[136:137], v[68:69]
v_pk_add_f32 v[138:139], v[138:139], v[70:71]
v_pk_add_f32 v[136:137], v[136:137], v[72:73]
v_pk_add_f32 v[138:139], v[138:139], v[74:75]
v_pk_add_f32 v[136:137], v[136:137], v[76:77]
v_pk_add_f32 v[138:139], v[138:139], v[78:79]
v_pk_add_f32 v[136:137], v[136:137], v[80:81]
v_pk_add_f32 v[138:139], v[138:139], v[82:83]
v_pk_add_f32 v[136:137], v[136:137], v[84:85]
v_pk_add_f32 v[138:139], v[138:139], v[86:87]
v_pk_add_f32 v[136:137], v[136:137], v[88:89]
v_pk_add_f32 v[138:139], v[138:139], v[90:91]
v_pk_add_f32 v[136:137], v[136:137], v[92:93]
v_pk_add_f32 v[138:139], v[138:139], v[94:95]
v_pk_add_f32 v[136:137], v[136:137], v[96:97]
v_pk_add_f32 v[138:139], v[138:139], v[98:99]
v_pk_add_f32 v[136:137], v[136:137], v[100:101]
v_pk_add_f32 v[138:139], v[138:139], v[102:103]
v_pk_add_f32 v[136:137], v[136:137], v[104:105]
v_pk_add_f32 v[138:139], v[138:139], v[106:107]
v_pk_add_f32 v[136:137], v[136:137], v[108:109]
v_pk_add_f32 v[138:139], v[138:139], v[110:111]
v_pk_add_f32 v[136:137], v[136:137], v[112:113]
v_pk_add_f32 v[138:139], v[138:139], v[114:115]
v_pk_add_f32 v[136:137], v[136:137], v[116:117]
v_pk_add_f32 v[138:139], v[138:139], v[118:119]
v_pk_add_f32 v[136:137], v[136:137], v[138:139]
v_add_f32 v160, v136, v137
v_mov_b32 v156, v160
s_nop 1
v_permlane32_swap_b32 v160, v156
v_add_f32 v160, v160, v156
v_mov_b32 v156, v160
s_nop 1
v_permlane16_swap_b32 v160, v156
v_add_f32 v160, v160, v156
v_and_b32 v157, 15, v1
v_lshlrev_b32 v157, 4, v157
v_add_u32 v157, 114688, v157
s_lshl_b32 s34, s20, 2
v_add_u32 v156, s34, v157
ds_write_b32 v156, v160
s_waitcnt vmcnt(0)
v_add_f32 v120, v120, v124
v_add_f32 v128, v128, v132
v_add_f32 v120, v120, v128
v_add_f32 v121, v121, v125
v_add_f32 v129, v129, v133
v_add_f32 v121, v121, v129
v_add_f32 v122, v122, v126
v_add_f32 v130, v130, v134
v_add_f32 v122, v122, v130
v_add_f32 v123, v123, v127
v_add_f32 v131, v131, v135
v_add_f32 v123, v123, v131
v_cvt_pk_bf16_f32 v124, v120, v121
v_cvt_pk_bf16_f32 v125, v122, v123
v_lshlrev_b32 v120, 16, v124
v_and_b32 v121, 0xffff0000, v124
v_lshlrev_b32 v122, 16, v125
v_and_b32 v123, 0xffff0000, v125
s_cmp_ge_u32 s20, 2
s_cbranch_scc1 L_l2_isc
v_mul_f32 v120, 0x3fb8aa3b, v120
v_mul_f32 v121, 0x3fb8aa3b, v121
v_mul_f32 v122, 0x3fb8aa3b, v122
v_mul_f32 v123, 0x3fb8aa3b, v123
s_branch L_l2_modd
L_l2_isc:
v_add_f32 v120, 1.0, v120
v_add_f32 v121, 1.0, v121
v_add_f32 v122, 1.0, v122
v_add_f32 v123, 1.0, v123
v_cvt_pk_bf16_f32 v124, v120, v121
v_cvt_pk_bf16_f32 v125, v122, v123
v_lshlrev_b32 v120, 16, v124
v_and_b32 v121, 0xffff0000, v124
v_lshlrev_b32 v122, 16, v125
v_and_b32 v123, 0xffff0000, v125
L_l2_modd:
v_lshlrev_b32 v159, 4, v0
v_add_u32 v159, 115200, v159
ds_write_b128 v159, v[120:123]
s_waitcnt lgkmcnt(0)
s_barrier
ds_read_b128 v[136:139], v157
s_waitcnt lgkmcnt(0)
v_add_f32 v136, v136, v137
v_add_f32 v138, v138, v139
v_add_f32 v136, v136, v138
v_mul_f32 v162, 0x3a800000, v136
v_sub_f32 v136, 0, v162
v_sub_f32 v137, 0, v162
v_pk_add_f32 v[56:57], v[56:57], v[136:137]
v_pk_add_f32 v[58:59], v[58:59], v[136:137]
v_pk_add_f32 v[60:61], v[60:61], v[136:137]
v_pk_add_f32 v[62:63], v[62:63], v[136:137]
v_pk_add_f32 v[64:65], v[64:65], v[136:137]
v_pk_add_f32 v[66:67], v[66:67], v[136:137]
v_pk_add_f32 v[68:69], v[68:69], v[136:137]
v_pk_add_f32 v[70:71], v[70:71], v[136:137]
v_pk_add_f32 v[72:73], v[72:73], v[136:137]
v_pk_add_f32 v[74:75], v[74:75], v[136:137]
v_pk_add_f32 v[76:77], v[76:77], v[136:137]
v_pk_add_f32 v[78:79], v[78:79], v[136:137]
v_pk_add_f32 v[80:81], v[80:81], v[136:137]
v_pk_add_f32 v[82:83], v[82:83], v[136:137]
v_pk_add_f32 v[84:85], v[84:85], v[136:137]
v_pk_add_f32 v[86:87], v[86:87], v[136:137]
v_pk_add_f32 v[88:89], v[88:89], v[136:137]
v_pk_add_f32 v[90:91], v[90:91], v[136:137]
v_pk_add_f32 v[92:93], v[92:93], v[136:137]
v_pk_add_f32 v[94:95], v[94:95], v[136:137]
v_pk_add_f32 v[96:97], v[96:97], v[136:137]
v_pk_add_f32 v[98:99], v[98:99], v[136:137]
v_pk_add_f32 v[100:101], v[100:101], v[136:137]
v_pk_add_f32 v[102:103], v[102:103], v[136:137]
v_pk_add_f32 v[104:105], v[104:105], v[136:137]
v_pk_add_f32 v[106:107], v[106:107], v[136:137]
v_pk_add_f32 v[108:109], v[108:109], v[136:137]
v_pk_add_f32 v[110:111], v[110:111], v[136:137]
v_pk_add_f32 v[112:113], v[112:113], v[136:137]
v_pk_add_f32 v[114:115], v[114:115], v[136:137]
v_pk_add_f32 v[116:117], v[116:117], v[136:137]
v_pk_add_f32 v[118:119], v[118:119], v[136:137]
v_pk_mul_f32 v[140:141], v[56:57], v[56:57]
v_pk_mul_f32 v[142:143], v[58:59], v[58:59]
v_pk_fma_f32 v[140:141], v[60:61], v[60:61], v[140:141]
v_pk_fma_f32 v[142:143], v[62:63], v[62:63], v[142:143]
v_pk_fma_f32 v[140:141], v[64:65], v[64:65], v[140:141]
v_pk_fma_f32 v[142:143], v[66:67], v[66:67], v[142:143]
v_pk_fma_f32 v[140:141], v[68:69], v[68:69], v[140:141]
v_pk_fma_f32 v[142:143], v[70:71], v[70:71], v[142:143]
v_pk_fma_f32 v[140:141], v[72:73], v[72:73], v[140:141]
v_pk_fma_f32 v[142:143], v[74:75], v[74:75], v[142:143]
v_pk_fma_f32 v[140:141], v[76:77], v[76:77], v[140:141]
v_pk_fma_f32 v[142:143], v[78:79], v[78:79], v[142:143]
v_pk_fma_f32 v[140:141], v[80:81], v[80:81], v[140:141]
v_pk_fma_f32 v[142:143], v[82:83], v[82:83], v[142:143]
v_pk_fma_f32 v[140:141], v[84:85], v[84:85], v[140:141]
v_pk_fma_f32 v[142:143], v[86:87], v[86:87], v[142:143]
v_pk_fma_f32 v[140:141], v[88:89], v[88:89], v[140:141]
v_pk_fma_f32 v[142:143], v[90:91], v[90:91], v[142:143]
v_pk_fma_f32 v[140:141], v[92:93], v[92:93], v[140:141]
v_pk_fma_f32 v[142:143], v[94:95], v[94:95], v[142:143]
v_pk_fma_f32 v[140:141], v[96:97], v[96:97], v[140:141]
v_pk_fma_f32 v[142:143], v[98:99], v[98:99], v[142:143]
v_pk_fma_f32 v[140:141], v[100:101], v[100:101], v[140:141]
v_pk_fma_f32 v[142:143], v[102:103], v[102:103], v[142:143]
v_pk_fma_f32 v[140:141], v[104:105], v[104:105], v[140:141]
v_pk_fma_f32 v[142:143], v[106:107], v[106:107], v[142:143]
v_pk_fma_f32 v[140:141], v[108:109], v[108:109], v[140:141]
v_pk_fma_f32 v[142:143], v[110:111], v[110:111], v[142:143]
v_pk_fma_f32 v[140:141], v[112:113], v[112:113], v[140:141]
v_pk_fma_f32 v[142:143], v[114:115], v[114:115], v[142:143]
v_pk_fma_f32 v[140:141], v[116:117], v[116:117], v[140:141]
v_pk_fma_f32 v[142:143], v[118:119], v[118:119], v[142:143]
v_pk_add_f32 v[140:141], v[140:141], v[142:143]
v_add_f32 v160, v140, v141
v_mov_b32 v156, v160
s_nop 1
v_permlane32_swap_b32 v160, v156
v_add_f32 v160, v160, v156
v_mov_b32 v156, v160
s_nop 1
v_permlane16_swap_b32 v160, v156
v_add_f32 v160, v160, v156
v_add_u32 v156, s34, v157
ds_write_b32 v156, v160 offset:256
s_waitcnt lgkmcnt(0)
s_barrier
ds_read_b128 v[136:139], v157 offset:256
v_lshrrev_b32 v159, 4, v1
v_lshlrev_b32 v159, 4, v159
s_lshl_b32 s35, s20, 9
s_add_u32 s35, s35, 115200
v_add_u32 v159, s35, v159
s_lshl_b32 s33, s31, 15
s_lshl_b32 s34, s20, 12
s_add_u32 s33, s33, s34
s_lshl_b32 s34, s32, 14
s_add_u32 s33, s33, s34
s_add_u32 s33, s33, 29425664
ds_read_b128 v[140:143], v159 offset:0
ds_read_b128 v[144:147], v159 offset:2048
ds_read_b128 v[148:151], v159 offset:64
ds_read_b128 v[152:155], v159 offset:2112
ds_read_b128 v[120:123], v159 offset:128
ds_read_b128 v[124:127], v159 offset:2176
ds_read_b128 v[128:131], v159 offset:192
ds_read_b128 v[132:135], v159 offset:2240
s_waitcnt lgkmcnt(8)
v_add_f32 v136, v136, v137
v_add_f32 v138, v138, v139
v_add_f32 v136, v136, v138
v_mov_b32 v156, 0x3727c5ac
v_fmac_f32 v156, 0x3a800000, v136
v_rsq_f32 v163, v156
s_nop 0
v_mul_f32 v163, 0x3fb8aa3b, v163
v_mov_b32 v138, v163
v_mov_b32 v139, v163
v_pk_mul_f32 v[56:57], v[56:57], v[138:139]
v_pk_mul_f32 v[58:59], v[58:59], v[138:139]
v_pk_mul_f32 v[60:61], v[60:61], v[138:139]
v_pk_mul_f32 v[62:63], v[62:63], v[138:139]
v_pk_mul_f32 v[64:65], v[64:65], v[138:139]
v_pk_mul_f32 v[66:67], v[66:67], v[138:139]
v_pk_mul_f32 v[68:69], v[68:69], v[138:139]
v_pk_mul_f32 v[70:71], v[70:71], v[138:139]
v_pk_mul_f32 v[72:73], v[72:73], v[138:139]
v_pk_mul_f32 v[74:75], v[74:75], v[138:139]
v_pk_mul_f32 v[76:77], v[76:77], v[138:139]
v_pk_mul_f32 v[78:79], v[78:79], v[138:139]
v_pk_mul_f32 v[80:81], v[80:81], v[138:139]
v_pk_mul_f32 v[82:83], v[82:83], v[138:139]
v_pk_mul_f32 v[84:85], v[84:85], v[138:139]
v_pk_mul_f32 v[86:87], v[86:87], v[138:139]
s_waitcnt lgkmcnt(4)
v_pk_fma_f32 v[140:141], v[56:57], v[144:145], v[140:141]
v_pk_fma_f32 v[142:143], v[58:59], v[146:147], v[142:143]
v_pk_fma_f32 v[148:149], v[60:61], v[152:153], v[148:149]
v_pk_fma_f32 v[150:151], v[62:63], v[154:155], v[150:151]
v_cvt_pk_bf16_f32 v24, v140, v141
v_cvt_pk_bf16_f32 v25, v142, v143
v_cvt_pk_bf16_f32 v26, v148, v149
v_cvt_pk_bf16_f32 v27, v150, v151
ds_read_b128 v[140:143], v159 offset:256
ds_read_b128 v[144:147], v159 offset:2304
ds_read_b128 v[148:151], v159 offset:320
ds_read_b128 v[152:155], v159 offset:2368
buffer_store_dwordx4 v[24:27], v2, s[16:19], s33 offen offset:0 sc1
s_waitcnt lgkmcnt(4)
v_pk_fma_f32 v[120:121], v[64:65], v[124:125], v[120:121]
v_pk_fma_f32 v[122:123], v[66:67], v[126:127], v[122:123]
v_pk_fma_f32 v[128:129], v[68:69], v[132:133], v[128:129]
v_pk_fma_f32 v[130:131], v[70:71], v[134:135], v[130:131]
v_cvt_pk_bf16_f32 v28, v120, v121
v_cvt_pk_bf16_f32 v29, v122, v123
v_cvt_pk_bf16_f32 v30, v128, v129
v_cvt_pk_bf16_f32 v31, v130, v131
ds_read_b128 v[120:123], v159 offset:384
ds_read_b128 v[124:127], v159 offset:2432
ds_read_b128 v[128:131], v159 offset:448
ds_read_b128 v[132:135], v159 offset:2496
buffer_store_dwordx4 v[28:31], v2, s[16:19], s33 offen offset:1024 sc1
s_waitcnt lgkmcnt(4)
v_pk_fma_f32 v[140:141], v[72:73], v[144:145], v[140:141]
v_pk_fma_f32 v[142:143], v[74:75], v[146:147], v[142:143]
v_pk_fma_f32 v[148:149], v[76:77], v[152:153], v[148:149]
v_pk_fma_f32 v[150:151], v[78:79], v[154:155], v[150:151]
v_cvt_pk_bf16_f32 v32, v140, v141
v_cvt_pk_bf16_f32 v33, v142, v143
v_cvt_pk_bf16_f32 v34, v148, v149
v_cvt_pk_bf16_f32 v35, v150, v151
buffer_store_dwordx4 v[32:35], v2, s[16:19], s33 offen offset:2048 sc1
s_waitcnt lgkmcnt(0)
v_pk_fma_f32 v[120:121], v[80:81], v[124:125], v[120:121]
v_pk_fma_f32 v[122:123], v[82:83], v[126:127], v[122:123]
v_pk_fma_f32 v[128:129], v[84:85], v[132:133], v[128:129]
v_pk_fma_f32 v[130:131], v[86:87], v[134:135], v[130:131]
v_cvt_pk_bf16_f32 v36, v120, v121
v_cvt_pk_bf16_f32 v37, v122, v123
v_cvt_pk_bf16_f32 v38, v128, v129
v_cvt_pk_bf16_f32 v39, v130, v131
buffer_store_dwordx4 v[36:39], v2, s[16:19], s33 offen offset:3072 sc1
s_waitcnt vmcnt(0)
s_barrier
s_lshl_b32 s35, s21, 5
s_add_u32 s36, s35, s22
s_lshl_b32 s36, s36, 7
s_add_u32 s36, s36, 56983552
s_cmp_lg_u32 s20, 0
s_cbranch_scc1 L_l2_pub
v_mov_b32 v156, 0
v_mov_b32 v157, 1
s_mov_b64 exec, 1
buffer_store_dword v157, v156, s[16:19], s36 offen sc1
s_mov_b64 exec, -1
L_l2_pub:
v_mov_b32 v24, 0
v_mov_b32 v25, 0
v_mov_b32 v26, 0
v_mov_b32 v27, 0
v_mov_b32 v28, 0
v_mov_b32 v29, 0
v_mov_b32 v30, 0
v_mov_b32 v31, 0
v_mov_b32 v32, 0
v_mov_b32 v33, 0
v_mov_b32 v34, 0
v_mov_b32 v35, 0
v_mov_b32 v36, 0
v_mov_b32 v37, 0
v_mov_b32 v38, 0
v_mov_b32 v39, 0
v_mov_b32 v40, 0
v_mov_b32 v41, 0
v_mov_b32 v42, 0
v_mov_b32 v43, 0
v_mov_b32 v44, 0
v_mov_b32 v45, 0
v_mov_b32 v46, 0
v_mov_b32 v47, 0
v_mov_b32 v48, 0
v_mov_b32 v49, 0
v_mov_b32 v50, 0
v_mov_b32 v51, 0
v_mov_b32 v52, 0
v_mov_b32 v53, 0
v_mov_b32 v54, 0
v_mov_b32 v55, 0
v_mov_b32 v56, 0
v_mov_b32 v57, 0
v_mov_b32 v58, 0
v_mov_b32 v59, 0
v_mov_b32 v60, 0
v_mov_b32 v61, 0
v_mov_b32 v62, 0
v_mov_b32 v63, 0
v_mov_b32 v64, 0
v_mov_b32 v65, 0
v_mov_b32 v66, 0
v_mov_b32 v67, 0
v_mov_b32 v68, 0
v_mov_b32 v69, 0
v_mov_b32 v70, 0
v_mov_b32 v71, 0
v_mov_b32 v72, 0
v_mov_b32 v73, 0
v_mov_b32 v74, 0
v_mov_b32 v75, 0
v_mov_b32 v76, 0
v_mov_b32 v77, 0
v_mov_b32 v78, 0
v_mov_b32 v79, 0
v_mov_b32 v80, 0
v_mov_b32 v81, 0
v_mov_b32 v82, 0
v_mov_b32 v83, 0
v_mov_b32 v84, 0
v_mov_b32 v85, 0
v_mov_b32 v86, 0
v_mov_b32 v87, 0
v_mov_b32 v88, 0
v_mov_b32 v89, 0
v_mov_b32 v90, 0
v_mov_b32 v91, 0
v_mov_b32 v92, 0
v_mov_b32 v93, 0
v_mov_b32 v94, 0
v_mov_b32 v95, 0
v_mov_b32 v96, 0
v_mov_b32 v97, 0
v_mov_b32 v98, 0
v_mov_b32 v99, 0
v_mov_b32 v100, 0
v_mov_b32 v101, 0
v_mov_b32 v102, 0
v_mov_b32 v103, 0
v_mov_b32 v104, 0
v_mov_b32 v105, 0
v_mov_b32 v106, 0
v_mov_b32 v107, 0
v_mov_b32 v108, 0
v_mov_b32 v109, 0
v_mov_b32 v110, 0
v_mov_b32 v111, 0
v_mov_b32 v112, 0
v_mov_b32 v113, 0
v_mov_b32 v114, 0
v_mov_b32 v115, 0
v_mov_b32 v116, 0
v_mov_b32 v117, 0
v_mov_b32 v118, 0
v_mov_b32 v119, 0
v_mov_b32 v120, 0
v_mov_b32 v121, 0
v_mov_b32 v122, 0
v_mov_b32 v123, 0
v_mov_b32 v124, 0
v_mov_b32 v125, 0
v_mov_b32 v126, 0
v_mov_b32 v127, 0
v_mov_b32 v128, 0
v_mov_b32 v129, 0
v_mov_b32 v130, 0
v_mov_b32 v131, 0
v_mov_b32 v132, 0
v_mov_b32 v133, 0
v_mov_b32 v134, 0
v_mov_b32 v135, 0
v_mov_b32 v136, 0
v_mov_b32 v137, 0
v_mov_b32 v138, 0
v_mov_b32 v139, 0
v_mov_b32 v140, 0
v_mov_b32 v141, 0
v_mov_b32 v142, 0
v_mov_b32 v143, 0
v_mov_b32 v144, 0
v_mov_b32 v145, 0
v_mov_b32 v146, 0
v_mov_b32 v147, 0
v_mov_b32 v148, 0
v_mov_b32 v149, 0
v_mov_b32 v150, 0
v_mov_b32 v151, 0
v_mov_b32 v152, 0
v_mov_b32 v153, 0
v_mov_b32 v154, 0
v_mov_b32 v155, 0
v_mov_b32 v156, 0
v_mov_b32 v157, 0
v_mov_b32 v158, 0
v_mov_b32 v159, 0
v_mov_b32 v160, 0
v_mov_b32 v161, 0
v_mov_b32 v162, 0
v_mov_b32 v163, 0
v_mov_b32 v164, 0
v_mov_b32 v165, 0
v_mov_b32 v166, 0
v_mov_b32 v167, 0
v_mov_b32 v168, 0
v_mov_b32 v169, 0
v_mov_b32 v170, 0
v_mov_b32 v171, 0
v_mov_b32 v172, 0
v_mov_b32 v173, 0
v_mov_b32 v174, 0
v_mov_b32 v175, 0
v_mov_b32 v176, 0
v_mov_b32 v177, 0
v_mov_b32 v178, 0
v_mov_b32 v179, 0
v_mov_b32 v180, 0
v_mov_b32 v181, 0
v_mov_b32 v182, 0
v_mov_b32 v183, 0
v_mov_b32 v184, 0
v_mov_b32 v185, 0
v_mov_b32 v186, 0
v_mov_b32 v187, 0
v_mov_b32 v188, 0
v_mov_b32 v189, 0
v_mov_b32 v190, 0
v_mov_b32 v191, 0
v_mov_b32 v192, 0
v_mov_b32 v193, 0
v_mov_b32 v194, 0
v_mov_b32 v195, 0
v_mov_b32 v196, 0
v_mov_b32 v197, 0
v_mov_b32 v198, 0
v_mov_b32 v199, 0
v_mov_b32 v200, 0
v_mov_b32 v201, 0
v_mov_b32 v202, 0
v_mov_b32 v203, 0
v_mov_b32 v204, 0
v_mov_b32 v205, 0
v_mov_b32 v206, 0
v_mov_b32 v207, 0
v_mov_b32 v208, 0
v_mov_b32 v209, 0
v_mov_b32 v210, 0
v_mov_b32 v211, 0
v_mov_b32 v212, 0
v_mov_b32 v213, 0
v_mov_b32 v214, 0
v_mov_b32 v215, 0
v_mov_b32 v216, 0
v_mov_b32 v217, 0
v_mov_b32 v218, 0
v_mov_b32 v219, 0
v_mov_b32 v220, 0
v_mov_b32 v221, 0
v_mov_b32 v222, 0
v_mov_b32 v223, 0
v_mov_b32 v224, 0
v_mov_b32 v225, 0
v_mov_b32 v226, 0
v_mov_b32 v227, 0
v_mov_b32 v228, 0
v_mov_b32 v229, 0
v_mov_b32 v230, 0
v_mov_b32 v231, 0
v_mov_b32 v232, 0
v_mov_b32 v233, 0
v_mov_b32 v234, 0
v_mov_b32 v235, 0
v_mov_b32 v236, 0
v_mov_b32 v237, 0
v_mov_b32 v238, 0
v_mov_b32 v239, 0
v_mov_b32 v240, 0
v_mov_b32 v241, 0
v_mov_b32 v242, 0
v_mov_b32 v243, 0
v_mov_b32 v244, 0
v_mov_b32 v245, 0
v_mov_b32 v246, 0
v_mov_b32 v247, 0
s_lshl_b32 s36, s20, 3
s_add_u32 s35, s35, s36
s_lshl_b32 s35, s35, 7
s_add_u32 s35, s35, 56983552
v_and_b32 v3, 7, v1
v_lshlrev_b32 v3, 7, v3
s_nop 0
s_mov_b32 s36, 0x200000
L_l2w_aw:
buffer_load_dword v4, v3, s[16:19], s35 offen sc1
s_waitcnt vmcnt(0)
v_cmp_eq_u32 vcc, 0, v4
s_sub_u32 s36, s36, 1
s_cmp_eq_u32 s36, 0
s_cbranch_scc1 L_l2w_awd
s_cmp_lg_u64 vcc, 0
s_cbranch_scc1 L_l2w_aw
L_l2w_awd:
buffer_load_dwordx4 a[0:3], v5, s[16:19], s28 offen offset:0 sc1
s_nop 0
buffer_load_dwordx4 a[4:7], v6, s[16:19], s28 offen offset:0 sc1
buffer_load_dwordx4 a[8:11], v7, s[16:19], s28 offen offset:0 sc1
buffer_load_dwordx4 a[12:15], v8, s[16:19], s28 offen offset:0 sc1
buffer_load_dwordx4 a[16:19], v5, s[16:19], s28 offen offset:1024 sc1
buffer_load_dwordx4 a[20:23], v6, s[16:19], s28 offen offset:1024 sc1
buffer_load_dwordx4 a[24:27], v7, s[16:19], s28 offen offset:1024 sc1
buffer_load_dwordx4 a[28:31], v8, s[16:19], s28 offen offset:1024 sc1
s_waitcnt lgkmcnt(0)
s_barrier
ds_read_b64_tr_b16 a[64:65], v16 offset:0
ds_read_b64_tr_b16 a[66:67], v16 offset:3584
ds_read_b64_tr_b16 a[68:69], v16 offset:7168
ds_read_b64_tr_b16 a[70:71], v16 offset:10752
ds_read_b64_tr_b16 a[72:73], v16 offset:14336
ds_read_b64_tr_b16 a[74:75], v16 offset:17920
ds_read_b64_tr_b16 a[76:77], v16 offset:21504
ds_read_b64_tr_b16 a[78:79], v16 offset:25088
s_waitcnt vmcnt(0) lgkmcnt(4)
s_mov_b32 s29, 3
L_gu_loop:
v_mfma_f32_16x16x32_bf16 v[24:27], a[64:67], a[0:3], v[24:27]
ds_read_b64_tr_b16 a[80:81], v16 offset:32
v_mfma_f32_16x16x32_bf16 v[24:27], a[68:71], a[16:19], v[24:27]
ds_read_b64_tr_b16 a[82:83], v16 offset:3616
v_mfma_f32_16x16x32_bf16 v[28:31], a[68:71], a[20:23], v[28:31]
ds_read_b64_tr_b16 a[84:85], v16 offset:7200
v_mfma_f32_16x16x32_bf16 v[28:31], a[64:67], a[4:7], v[28:31]
ds_read_b64_tr_b16 a[86:87], v16 offset:10784
v_mfma_f32_16x16x32_bf16 v[32:35], a[64:67], a[8:11], v[32:35]
s_add_u32 m0, s26, 57344
v_mfma_f32_16x16x32_bf16 v[32:35], a[68:71], a[24:27], v[32:35]
buffer_load_dwordx4 v9, s[12:15], s27 offen lds
v_mfma_f32_16x16x32_bf16 v[36:39], a[68:71], a[28:31], v[36:39]
v_mfma_f32_16x16x32_bf16 v[36:39], a[64:67], a[12:15], v[36:39]
s_waitcnt lgkmcnt(4)
buffer_load_dwordx4 a[32:35], v5, s[16:19], s28 offen offset:2048 sc1
v_mfma_f32_16x16x32_bf16 v[52:55], a[72:75], a[12:15], v[52:55]
ds_read_b64_tr_b16 a[88:89], v16 offset:14368
v_mfma_f32_16x16x32_bf16 v[52:55], a[76:79], a[28:31], v[52:55]
ds_read_b64_tr_b16 a[90:91], v16 offset:17952
v_mfma_f32_16x16x32_bf16 v[48:51], a[76:79], a[24:27], v[48:51]
ds_read_b64_tr_b16 a[92:93], v16 offset:21536
v_mfma_f32_16x16x32_bf16 v[48:51], a[72:75], a[8:11], v[48:51]
ds_read_b64_tr_b16 a[94:95], v16 offset:25120
v_mfma_f32_16x16x32_bf16 v[44:47], a[72:75], a[4:7], v[44:47]
s_add_u32 m0, s26, 58368
v_mfma_f32_16x16x32_bf16 v[44:47], a[76:79], a[20:23], v[44:47]
buffer_load_dwordx4 v10, s[12:15], s27 offen lds
v_mfma_f32_16x16x32_bf16 v[40:43], a[76:79], a[16:19], v[40:43]
v_mfma_f32_16x16x32_bf16 v[40:43], a[72:75], a[0:3], v[40:43]
s_waitcnt lgkmcnt(4)
buffer_load_dwordx4 a[36:39], v6, s[16:19], s28 offen offset:2048 sc1
v_mfma_f32_16x16x32_bf16 v[56:59], a[80:83], a[0:3], v[56:59]
ds_read_b64_tr_b16 a[64:65], v16 offset:64
v_mfma_f32_16x16x32_bf16 v[56:59], a[84:87], a[16:19], v[56:59]
ds_read_b64_tr_b16 a[66:67], v16 offset:3648
v_mfma_f32_16x16x32_bf16 v[60:63], a[84:87], a[20:23], v[60:63]
ds_read_b64_tr_b16 a[68:69], v16 offset:7232
v_mfma_f32_16x16x32_bf16 v[60:63], a[80:83], a[4:7], v[60:63]
ds_read_b64_tr_b16 a[70:71], v16 offset:10816
v_mfma_f32_16x16x32_bf16 v[64:67], a[80:83], a[8:11], v[64:67]
v_mfma_f32_16x16x32_bf16 v[64:67], a[84:87], a[24:27], v[64:67]
v_mfma_f32_16x16x32_bf16 v[68:71], a[84:87], a[28:31], v[68:71]
v_mfma_f32_16x16x32_bf16 v[68:71], a[80:83], a[12:15], v[68:71]
s_waitcnt lgkmcnt(4)
buffer_load_dwordx4 a[40:43], v7, s[16:19], s28 offen offset:2048 sc1
v_mfma_f32_16x16x32_bf16 v[84:87], a[88:91], a[12:15], v[84:87]
ds_read_b64_tr_b16 a[72:73], v16 offset:14400
v_mfma_f32_16x16x32_bf16 v[84:87], a[92:95], a[28:31], v[84:87]
ds_read_b64_tr_b16 a[74:75], v16 offset:17984
v_mfma_f32_16x16x32_bf16 v[80:83], a[92:95], a[24:27], v[80:83]
ds_read_b64_tr_b16 a[76:77], v16 offset:21568
v_mfma_f32_16x16x32_bf16 v[80:83], a[88:91], a[8:11], v[80:83]
ds_read_b64_tr_b16 a[78:79], v16 offset:25152
v_mfma_f32_16x16x32_bf16 v[76:79], a[88:91], a[4:7], v[76:79]
s_add_u32 m0, s26, 59392
v_mfma_f32_16x16x32_bf16 v[76:79], a[92:95], a[20:23], v[76:79]
buffer_load_dwordx4 v11, s[12:15], s27 offen lds
v_mfma_f32_16x16x32_bf16 v[72:75], a[92:95], a[16:19], v[72:75]
v_mfma_f32_16x16x32_bf16 v[72:75], a[88:91], a[0:3], v[72:75]
s_waitcnt lgkmcnt(4)
buffer_load_dwordx4 a[44:47], v8, s[16:19], s28 offen offset:2048 sc1
v_mfma_f32_16x16x32_bf16 v[88:91], a[64:67], a[0:3], v[88:91]
ds_read_b64_tr_b16 a[80:81], v16 offset:96
v_mfma_f32_16x16x32_bf16 v[88:91], a[68:71], a[16:19], v[88:91]
ds_read_b64_tr_b16 a[82:83], v16 offset:3680
v_mfma_f32_16x16x32_bf16 v[92:95], a[68:71], a[20:23], v[92:95]
ds_read_b64_tr_b16 a[84:85], v16 offset:7264
v_mfma_f32_16x16x32_bf16 v[92:95], a[64:67], a[4:7], v[92:95]
ds_read_b64_tr_b16 a[86:87], v16 offset:10848
v_mfma_f32_16x16x32_bf16 v[96:99], a[64:67], a[8:11], v[96:99]
v_mfma_f32_16x16x32_bf16 v[96:99], a[68:71], a[24:27], v[96:99]
v_mfma_f32_16x16x32_bf16 v[100:103], a[68:71], a[28:31], v[100:103]
v_mfma_f32_16x16x32_bf16 v[100:103], a[64:67], a[12:15], v[100:103]
s_waitcnt lgkmcnt(4)
buffer_load_dwordx4 a[48:51], v5, s[16:19], s28 offen offset:3072 sc1
v_mfma_f32_16x16x32_bf16 v[116:119], a[72:75], a[12:15], v[116:119]
ds_read_b64_tr_b16 a[88:89], v16 offset:14432
v_mfma_f32_16x16x32_bf16 v[116:119], a[76:79], a[28:31], v[116:119]
ds_read_b64_tr_b16 a[90:91], v16 offset:18016
v_mfma_f32_16x16x32_bf16 v[112:115], a[76:79], a[24:27], v[112:115]
ds_read_b64_tr_b16 a[92:93], v16 offset:21600
v_mfma_f32_16x16x32_bf16 v[112:115], a[72:75], a[8:11], v[112:115]
ds_read_b64_tr_b16 a[94:95], v16 offset:25184
v_mfma_f32_16x16x32_bf16 v[108:111], a[72:75], a[4:7], v[108:111]
s_add_u32 m0, s26, 60416
v_mfma_f32_16x16x32_bf16 v[108:111], a[76:79], a[20:23], v[108:111]
buffer_load_dwordx4 v12, s[12:15], s27 offen lds
v_mfma_f32_16x16x32_bf16 v[104:107], a[76:79], a[16:19], v[104:107]
v_mfma_f32_16x16x32_bf16 v[104:107], a[72:75], a[0:3], v[104:107]
s_waitcnt lgkmcnt(4)
buffer_load_dwordx4 a[52:55], v6, s[16:19], s28 offen offset:3072 sc1
v_mfma_f32_16x16x32_bf16 v[120:123], a[80:83], a[0:3], v[120:123]
ds_read_b64_tr_b16 a[64:65], v16 offset:128
v_mfma_f32_16x16x32_bf16 v[120:123], a[84:87], a[16:19], v[120:123]
ds_read_b64_tr_b16 a[66:67], v16 offset:3712
v_mfma_f32_16x16x32_bf16 v[124:127], a[84:87], a[20:23], v[124:127]
ds_read_b64_tr_b16 a[68:69], v16 offset:7296
v_mfma_f32_16x16x32_bf16 v[124:127], a[80:83], a[4:7], v[124:127]
ds_read_b64_tr_b16 a[70:71], v16 offset:10880
v_mfma_f32_16x16x32_bf16 v[128:131], a[80:83], a[8:11], v[128:131]
s_add_u32 m0, s26, 61440
v_mfma_f32_16x16x32_bf16 v[128:131], a[84:87], a[24:27], v[128:131]
buffer_load_dwordx4 v13, s[12:15], s27 offen lds
v_mfma_f32_16x16x32_bf16 v[132:135], a[84:87], a[28:31], v[132:135]
v_mfma_f32_16x16x32_bf16 v[132:135], a[80:83], a[12:15], v[132:135]
s_waitcnt lgkmcnt(4)
buffer_load_dwordx4 a[56:59], v7, s[16:19], s28 offen offset:3072 sc1
v_mfma_f32_16x16x32_bf16 v[148:151], a[88:91], a[12:15], v[148:151]
ds_read_b64_tr_b16 a[72:73], v16 offset:14464
v_mfma_f32_16x16x32_bf16 v[148:151], a[92:95], a[28:31], v[148:151]
ds_read_b64_tr_b16 a[74:75], v16 offset:18048
v_mfma_f32_16x16x32_bf16 v[144:147], a[92:95], a[24:27], v[144:147]
ds_read_b64_tr_b16 a[76:77], v16 offset:21632
v_mfma_f32_16x16x32_bf16 v[144:147], a[88:91], a[8:11], v[144:147]
ds_read_b64_tr_b16 a[78:79], v16 offset:25216
v_mfma_f32_16x16x32_bf16 v[140:143], a[88:91], a[4:7], v[140:143]
v_mfma_f32_16x16x32_bf16 v[140:143], a[92:95], a[20:23], v[140:143]
v_mfma_f32_16x16x32_bf16 v[136:139], a[92:95], a[16:19], v[136:139]
v_mfma_f32_16x16x32_bf16 v[136:139], a[88:91], a[0:3], v[136:139]
s_waitcnt lgkmcnt(4)
buffer_load_dwordx4 a[60:63], v8, s[16:19], s28 offen offset:3072 sc1
s_add_u32 s28, s28, 4096
v_mfma_f32_16x16x32_bf16 v[152:155], a[64:67], a[0:3], v[152:155]
ds_read_b64_tr_b16 a[80:81], v16 offset:160
v_mfma_f32_16x16x32_bf16 v[152:155], a[68:71], a[16:19], v[152:155]
ds_read_b64_tr_b16 a[82:83], v16 offset:3744
v_mfma_f32_16x16x32_bf16 v[156:159], a[68:71], a[20:23], v[156:159]
ds_read_b64_tr_b16 a[84:85], v16 offset:7328
v_mfma_f32_16x16x32_bf16 v[156:159], a[64:67], a[4:7], v[156:159]
ds_read_b64_tr_b16 a[86:87], v16 offset:10912
v_mfma_f32_16x16x32_bf16 v[160:163], a[64:67], a[8:11], v[160:163]
s_add_u32 m0, s26, 62464
v_mfma_f32_16x16x32_bf16 v[160:163], a[68:71], a[24:27], v[160:163]
buffer_load_dwordx4 v14, s[12:15], s27 offen lds
v_mfma_f32_16x16x32_bf16 v[164:167], a[68:71], a[28:31], v[164:167]
v_mfma_f32_16x16x32_bf16 v[164:167], a[64:67], a[12:15], v[164:167]
s_waitcnt lgkmcnt(4)
v_mfma_f32_16x16x32_bf16 v[180:183], a[72:75], a[12:15], v[180:183]
ds_read_b64_tr_b16 a[88:89], v16 offset:14496
v_mfma_f32_16x16x32_bf16 v[180:183], a[76:79], a[28:31], v[180:183]
ds_read_b64_tr_b16 a[90:91], v16 offset:18080
v_mfma_f32_16x16x32_bf16 v[176:179], a[76:79], a[24:27], v[176:179]
ds_read_b64_tr_b16 a[92:93], v16 offset:21664
v_mfma_f32_16x16x32_bf16 v[176:179], a[72:75], a[8:11], v[176:179]
ds_read_b64_tr_b16 a[94:95], v16 offset:25248
v_mfma_f32_16x16x32_bf16 v[172:175], a[72:75], a[4:7], v[172:175]
v_mfma_f32_16x16x32_bf16 v[172:175], a[76:79], a[20:23], v[172:175]
v_mfma_f32_16x16x32_bf16 v[168:171], a[76:79], a[16:19], v[168:171]
v_mfma_f32_16x16x32_bf16 v[168:171], a[72:75], a[0:3], v[168:171]
s_waitcnt lgkmcnt(4)
v_mfma_f32_16x16x32_bf16 v[184:187], a[80:83], a[0:3], v[184:187]
ds_read_b64_tr_b16 a[64:65], v17 offset:0
v_mfma_f32_16x16x32_bf16 v[184:187], a[84:87], a[16:19], v[184:187]
ds_read_b64_tr_b16 a[66:67], v17 offset:3584
v_mfma_f32_16x16x32_bf16 v[188:191], a[84:87], a[20:23], v[188:191]
ds_read_b64_tr_b16 a[68:69], v17 offset:7168
v_mfma_f32_16x16x32_bf16 v[188:191], a[80:83], a[4:7], v[188:191]
ds_read_b64_tr_b16 a[70:71], v17 offset:10752
v_mfma_f32_16x16x32_bf16 v[192:195], a[80:83], a[8:11], v[192:195]
s_add_u32 m0, s26, 63488
v_mfma_f32_16x16x32_bf16 v[192:195], a[84:87], a[24:27], v[192:195]
buffer_load_dwordx4 v15, s[12:15], s27 offen lds
s_add_u32 s27, s27, 458752
v_mfma_f32_16x16x32_bf16 v[196:199], a[84:87], a[28:31], v[196:199]
v_mfma_f32_16x16x32_bf16 v[196:199], a[80:83], a[12:15], v[196:199]
s_waitcnt lgkmcnt(4)
v_mfma_f32_16x16x32_bf16 v[212:215], a[88:91], a[12:15], v[212:215]
ds_read_b64_tr_b16 a[72:73], v17 offset:14336
v_mfma_f32_16x16x32_bf16 v[212:215], a[92:95], a[28:31], v[212:215]
ds_read_b64_tr_b16 a[74:75], v17 offset:17920
v_mfma_f32_16x16x32_bf16 v[208:211], a[92:95], a[24:27], v[208:211]
ds_read_b64_tr_b16 a[76:77], v17 offset:21504
v_mfma_f32_16x16x32_bf16 v[208:211], a[88:91], a[8:11], v[208:211]
ds_read_b64_tr_b16 a[78:79], v17 offset:25088
v_mfma_f32_16x16x32_bf16 v[204:207], a[88:91], a[4:7], v[204:207]
v_mfma_f32_16x16x32_bf16 v[204:207], a[92:95], a[20:23], v[204:207]
v_mfma_f32_16x16x32_bf16 v[200:203], a[92:95], a[16:19], v[200:203]
v_mfma_f32_16x16x32_bf16 v[200:203], a[88:91], a[0:3], v[200:203]
s_waitcnt lgkmcnt(4)
v_mfma_f32_16x16x32_bf16 v[216:219], a[64:67], a[0:3], v[216:219]
s_waitcnt vmcnt(15)
s_barrier
ds_read_b64_tr_b16 a[80:81], v16 offset:28672
v_mfma_f32_16x16x32_bf16 v[216:219], a[68:71], a[16:19], v[216:219]
ds_read_b64_tr_b16 a[82:83], v16 offset:32256
v_mfma_f32_16x16x32_bf16 v[220:223], a[68:71], a[20:23], v[220:223]
ds_read_b64_tr_b16 a[84:85], v16 offset:35840
v_mfma_f32_16x16x32_bf16 v[220:223], a[64:67], a[4:7], v[220:223]
ds_read_b64_tr_b16 a[86:87], v16 offset:39424
v_mfma_f32_16x16x32_bf16 v[224:227], a[64:67], a[8:11], v[224:227]
v_mfma_f32_16x16x32_bf16 v[224:227], a[68:71], a[24:27], v[224:227]
v_mfma_f32_16x16x32_bf16 v[228:231], a[68:71], a[28:31], v[228:231]
v_mfma_f32_16x16x32_bf16 v[228:231], a[64:67], a[12:15], v[228:231]
s_waitcnt lgkmcnt(4)
v_mfma_f32_16x16x32_bf16 v[244:247], a[72:75], a[12:15], v[244:247]
ds_read_b64_tr_b16 a[88:89], v16 offset:43008
v_mfma_f32_16x16x32_bf16 v[244:247], a[76:79], a[28:31], v[244:247]
ds_read_b64_tr_b16 a[90:91], v16 offset:46592
v_mfma_f32_16x16x32_bf16 v[240:243], a[76:79], a[24:27], v[240:243]
ds_read_b64_tr_b16 a[92:93], v16 offset:50176
v_mfma_f32_16x16x32_bf16 v[240:243], a[72:75], a[8:11], v[240:243]
ds_read_b64_tr_b16 a[94:95], v16 offset:53760
v_mfma_f32_16x16x32_bf16 v[236:239], a[72:75], a[4:7], v[236:239]
v_mfma_f32_16x16x32_bf16 v[236:239], a[76:79], a[20:23], v[236:239]
v_mfma_f32_16x16x32_bf16 v[232:235], a[76:79], a[16:19], v[232:235]
v_mfma_f32_16x16x32_bf16 v[232:235], a[72:75], a[0:3], v[232:235]
s_waitcnt vmcnt(2) lgkmcnt(4)
v_mfma_f32_16x16x32_bf16 v[24:27], a[80:83], a[32:35], v[24:27]
ds_read_b64_tr_b16 a[64:65], v16 offset:28704
v_mfma_f32_16x16x32_bf16 v[24:27], a[84:87], a[48:51], v[24:27]
ds_read_b64_tr_b16 a[66:67], v16 offset:32288
v_mfma_f32_16x16x32_bf16 v[28:31], a[84:87], a[52:55], v[28:31]
ds_read_b64_tr_b16 a[68:69], v16 offset:35872
v_mfma_f32_16x16x32_bf16 v[28:31], a[80:83], a[36:39], v[28:31]
ds_read_b64_tr_b16 a[70:71], v16 offset:39456
v_mfma_f32_16x16x32_bf16 v[32:35], a[80:83], a[40:43], v[32:35]
s_add_u32 m0, s26, 86016
v_mfma_f32_16x16x32_bf16 v[32:35], a[84:87], a[56:59], v[32:35]
buffer_load_dwordx4 v9, s[12:15], s27 offen lds
v_mfma_f32_16x16x32_bf16 v[36:39], a[84:87], a[60:63], v[36:39]
v_mfma_f32_16x16x32_bf16 v[36:39], a[80:83], a[44:47], v[36:39]
s_waitcnt lgkmcnt(4)
buffer_load_dwordx4 a[0:3], v5, s[16:19], s28 offen offset:0 sc1
v_mfma_f32_16x16x32_bf16 v[52:55], a[88:91], a[44:47], v[52:55]
ds_read_b64_tr_b16 a[72:73], v16 offset:43040
v_mfma_f32_16x16x32_bf16 v[52:55], a[92:95], a[60:63], v[52:55]
ds_read_b64_tr_b16 a[74:75], v16 offset:46624
v_mfma_f32_16x16x32_bf16 v[48:51], a[92:95], a[56:59], v[48:51]
ds_read_b64_tr_b16 a[76:77], v16 offset:50208
v_mfma_f32_16x16x32_bf16 v[48:51], a[88:91], a[40:43], v[48:51]
ds_read_b64_tr_b16 a[78:79], v16 offset:53792
v_mfma_f32_16x16x32_bf16 v[44:47], a[88:91], a[36:39], v[44:47]
s_add_u32 m0, s26, 87040
v_mfma_f32_16x16x32_bf16 v[44:47], a[92:95], a[52:55], v[44:47]
buffer_load_dwordx4 v10, s[12:15], s27 offen lds
v_mfma_f32_16x16x32_bf16 v[40:43], a[92:95], a[48:51], v[40:43]
v_mfma_f32_16x16x32_bf16 v[40:43], a[88:91], a[32:35], v[40:43]
s_waitcnt lgkmcnt(4)
buffer_load_dwordx4 a[4:7], v6, s[16:19], s28 offen offset:0 sc1
v_mfma_f32_16x16x32_bf16 v[56:59], a[64:67], a[32:35], v[56:59]
ds_read_b64_tr_b16 a[80:81], v16 offset:28736
v_mfma_f32_16x16x32_bf16 v[56:59], a[68:71], a[48:51], v[56:59]
ds_read_b64_tr_b16 a[82:83], v16 offset:32320
v_mfma_f32_16x16x32_bf16 v[60:63], a[68:71], a[52:55], v[60:63]
ds_read_b64_tr_b16 a[84:85], v16 offset:35904
v_mfma_f32_16x16x32_bf16 v[60:63], a[64:67], a[36:39], v[60:63]
ds_read_b64_tr_b16 a[86:87], v16 offset:39488
v_mfma_f32_16x16x32_bf16 v[64:67], a[64:67], a[40:43], v[64:67]
v_mfma_f32_16x16x32_bf16 v[64:67], a[68:71], a[56:59], v[64:67]
v_mfma_f32_16x16x32_bf16 v[68:71], a[68:71], a[60:63], v[68:71]
v_mfma_f32_16x16x32_bf16 v[68:71], a[64:67], a[44:47], v[68:71]
s_waitcnt lgkmcnt(4)
buffer_load_dwordx4 a[8:11], v7, s[16:19], s28 offen offset:0 sc1
v_mfma_f32_16x16x32_bf16 v[84:87], a[72:75], a[44:47], v[84:87]
ds_read_b64_tr_b16 a[88:89], v16 offset:43072
v_mfma_f32_16x16x32_bf16 v[84:87], a[76:79], a[60:63], v[84:87]
ds_read_b64_tr_b16 a[90:91], v16 offset:46656
v_mfma_f32_16x16x32_bf16 v[80:83], a[76:79], a[56:59], v[80:83]
ds_read_b64_tr_b16 a[92:93], v16 offset:50240
v_mfma_f32_16x16x32_bf16 v[80:83], a[72:75], a[40:43], v[80:83]
ds_read_b64_tr_b16 a[94:95], v16 offset:53824
v_mfma_f32_16x16x32_bf16 v[76:79], a[72:75], a[36:39], v[76:79]
s_add_u32 m0, s26, 88064
v_mfma_f32_16x16x32_bf16 v[76:79], a[76:79], a[52:55], v[76:79]
buffer_load_dwordx4 v11, s[12:15], s27 offen lds
v_mfma_f32_16x16x32_bf16 v[72:75], a[76:79], a[48:51], v[72:75]
v_mfma_f32_16x16x32_bf16 v[72:75], a[72:75], a[32:35], v[72:75]
s_waitcnt lgkmcnt(4)
buffer_load_dwordx4 a[12:15], v8, s[16:19], s28 offen offset:0 sc1
v_mfma_f32_16x16x32_bf16 v[88:91], a[80:83], a[32:35], v[88:91]
ds_read_b64_tr_b16 a[64:65], v16 offset:28768
v_mfma_f32_16x16x32_bf16 v[88:91], a[84:87], a[48:51], v[88:91]
ds_read_b64_tr_b16 a[66:67], v16 offset:32352
v_mfma_f32_16x16x32_bf16 v[92:95], a[84:87], a[52:55], v[92:95]
ds_read_b64_tr_b16 a[68:69], v16 offset:35936
v_mfma_f32_16x16x32_bf16 v[92:95], a[80:83], a[36:39], v[92:95]
ds_read_b64_tr_b16 a[70:71], v16 offset:39520
v_mfma_f32_16x16x32_bf16 v[96:99], a[80:83], a[40:43], v[96:99]
v_mfma_f32_16x16x32_bf16 v[96:99], a[84:87], a[56:59], v[96:99]
v_mfma_f32_16x16x32_bf16 v[100:103], a[84:87], a[60:63], v[100:103]
v_mfma_f32_16x16x32_bf16 v[100:103], a[80:83], a[44:47], v[100:103]
s_waitcnt lgkmcnt(4)
buffer_load_dwordx4 a[16:19], v5, s[16:19], s28 offen offset:1024 sc1
v_mfma_f32_16x16x32_bf16 v[116:119], a[88:91], a[44:47], v[116:119]
ds_read_b64_tr_b16 a[72:73], v16 offset:43104
v_mfma_f32_16x16x32_bf16 v[116:119], a[92:95], a[60:63], v[116:119]
ds_read_b64_tr_b16 a[74:75], v16 offset:46688
v_mfma_f32_16x16x32_bf16 v[112:115], a[92:95], a[56:59], v[112:115]
ds_read_b64_tr_b16 a[76:77], v16 offset:50272
v_mfma_f32_16x16x32_bf16 v[112:115], a[88:91], a[40:43], v[112:115]
ds_read_b64_tr_b16 a[78:79], v16 offset:53856
v_mfma_f32_16x16x32_bf16 v[108:111], a[88:91], a[36:39], v[108:111]
s_add_u32 m0, s26, 89088
v_mfma_f32_16x16x32_bf16 v[108:111], a[92:95], a[52:55], v[108:111]
buffer_load_dwordx4 v12, s[12:15], s27 offen lds
v_mfma_f32_16x16x32_bf16 v[104:107], a[92:95], a[48:51], v[104:107]
v_mfma_f32_16x16x32_bf16 v[104:107], a[88:91], a[32:35], v[104:107]
s_waitcnt lgkmcnt(4)
buffer_load_dwordx4 a[20:23], v6, s[16:19], s28 offen offset:1024 sc1
v_mfma_f32_16x16x32_bf16 v[120:123], a[64:67], a[32:35], v[120:123]
ds_read_b64_tr_b16 a[80:81], v16 offset:28800
v_mfma_f32_16x16x32_bf16 v[120:123], a[68:71], a[48:51], v[120:123]
ds_read_b64_tr_b16 a[82:83], v16 offset:32384
v_mfma_f32_16x16x32_bf16 v[124:127], a[68:71], a[52:55], v[124:127]
ds_read_b64_tr_b16 a[84:85], v16 offset:35968
v_mfma_f32_16x16x32_bf16 v[124:127], a[64:67], a[36:39], v[124:127]
ds_read_b64_tr_b16 a[86:87], v16 offset:39552
v_mfma_f32_16x16x32_bf16 v[128:131], a[64:67], a[40:43], v[128:131]
s_add_u32 m0, s26, 90112
v_mfma_f32_16x16x32_bf16 v[128:131], a[68:71], a[56:59], v[128:131]
buffer_load_dwordx4 v13, s[12:15], s27 offen lds
v_mfma_f32_16x16x32_bf16 v[132:135], a[68:71], a[60:63], v[132:135]
v_mfma_f32_16x16x32_bf16 v[132:135], a[64:67], a[44:47], v[132:135]
s_waitcnt lgkmcnt(4)
buffer_load_dwordx4 a[24:27], v7, s[16:19], s28 offen offset:1024 sc1
v_mfma_f32_16x16x32_bf16 v[148:151], a[72:75], a[44:47], v[148:151]
ds_read_b64_tr_b16 a[88:89], v16 offset:43136
v_mfma_f32_16x16x32_bf16 v[148:151], a[76:79], a[60:63], v[148:151]
ds_read_b64_tr_b16 a[90:91], v16 offset:46720
v_mfma_f32_16x16x32_bf16 v[144:147], a[76:79], a[56:59], v[144:147]
ds_read_b64_tr_b16 a[92:93], v16 offset:50304
v_mfma_f32_16x16x32_bf16 v[144:147], a[72:75], a[40:43], v[144:147]
ds_read_b64_tr_b16 a[94:95], v16 offset:53888
v_mfma_f32_16x16x32_bf16 v[140:143], a[72:75], a[36:39], v[140:143]
v_mfma_f32_16x16x32_bf16 v[140:143], a[76:79], a[52:55], v[140:143]
v_mfma_f32_16x16x32_bf16 v[136:139], a[76:79], a[48:51], v[136:139]
v_mfma_f32_16x16x32_bf16 v[136:139], a[72:75], a[32:35], v[136:139]
s_waitcnt lgkmcnt(4)
buffer_load_dwordx4 a[28:31], v8, s[16:19], s28 offen offset:1024 sc1
v_mfma_f32_16x16x32_bf16 v[152:155], a[80:83], a[32:35], v[152:155]
ds_read_b64_tr_b16 a[64:65], v16 offset:28832
v_mfma_f32_16x16x32_bf16 v[152:155], a[84:87], a[48:51], v[152:155]
ds_read_b64_tr_b16 a[66:67], v16 offset:32416
v_mfma_f32_16x16x32_bf16 v[156:159], a[84:87], a[52:55], v[156:159]
ds_read_b64_tr_b16 a[68:69], v16 offset:36000
v_mfma_f32_16x16x32_bf16 v[156:159], a[80:83], a[36:39], v[156:159]
ds_read_b64_tr_b16 a[70:71], v16 offset:39584
v_mfma_f32_16x16x32_bf16 v[160:163], a[80:83], a[40:43], v[160:163]
s_add_u32 m0, s26, 91136
v_mfma_f32_16x16x32_bf16 v[160:163], a[84:87], a[56:59], v[160:163]
buffer_load_dwordx4 v14, s[12:15], s27 offen lds
v_mfma_f32_16x16x32_bf16 v[164:167], a[84:87], a[60:63], v[164:167]
v_mfma_f32_16x16x32_bf16 v[164:167], a[80:83], a[44:47], v[164:167]
s_waitcnt lgkmcnt(4)
v_mfma_f32_16x16x32_bf16 v[180:183], a[88:91], a[44:47], v[180:183]
ds_read_b64_tr_b16 a[72:73], v16 offset:43168
v_mfma_f32_16x16x32_bf16 v[180:183], a[92:95], a[60:63], v[180:183]
ds_read_b64_tr_b16 a[74:75], v16 offset:46752
v_mfma_f32_16x16x32_bf16 v[176:179], a[92:95], a[56:59], v[176:179]
ds_read_b64_tr_b16 a[76:77], v16 offset:50336
v_mfma_f32_16x16x32_bf16 v[176:179], a[88:91], a[40:43], v[176:179]
ds_read_b64_tr_b16 a[78:79], v16 offset:53920
v_mfma_f32_16x16x32_bf16 v[172:175], a[88:91], a[36:39], v[172:175]
v_mfma_f32_16x16x32_bf16 v[172:175], a[92:95], a[52:55], v[172:175]
v_mfma_f32_16x16x32_bf16 v[168:171], a[92:95], a[48:51], v[168:171]
v_mfma_f32_16x16x32_bf16 v[168:171], a[88:91], a[32:35], v[168:171]
s_waitcnt lgkmcnt(4)
v_mfma_f32_16x16x32_bf16 v[184:187], a[64:67], a[32:35], v[184:187]
ds_read_b64_tr_b16 a[80:81], v17 offset:28672
v_mfma_f32_16x16x32_bf16 v[184:187], a[68:71], a[48:51], v[184:187]
ds_read_b64_tr_b16 a[82:83], v17 offset:32256
v_mfma_f32_16x16x32_bf16 v[188:191], a[68:71], a[52:55], v[188:191]
ds_read_b64_tr_b16 a[84:85], v17 offset:35840
v_mfma_f32_16x16x32_bf16 v[188:191], a[64:67], a[36:39], v[188:191]
ds_read_b64_tr_b16 a[86:87], v17 offset:39424
v_mfma_f32_16x16x32_bf16 v[192:195], a[64:67], a[40:43], v[192:195]
s_add_u32 m0, s26, 92160
v_mfma_f32_16x16x32_bf16 v[192:195], a[68:71], a[56:59], v[192:195]
buffer_load_dwordx4 v15, s[12:15], s27 offen lds
s_add_u32 s27, s27, 458752
v_mfma_f32_16x16x32_bf16 v[196:199], a[68:71], a[60:63], v[196:199]
v_mfma_f32_16x16x32_bf16 v[196:199], a[64:67], a[44:47], v[196:199]
s_waitcnt lgkmcnt(4)
v_mfma_f32_16x16x32_bf16 v[212:215], a[72:75], a[44:47], v[212:215]
ds_read_b64_tr_b16 a[88:89], v17 offset:43008
v_mfma_f32_16x16x32_bf16 v[212:215], a[76:79], a[60:63], v[212:215]
ds_read_b64_tr_b16 a[90:91], v17 offset:46592
v_mfma_f32_16x16x32_bf16 v[208:211], a[76:79], a[56:59], v[208:211]
ds_read_b64_tr_b16 a[92:93], v17 offset:50176
v_mfma_f32_16x16x32_bf16 v[208:211], a[72:75], a[40:43], v[208:211]
ds_read_b64_tr_b16 a[94:95], v17 offset:53760
v_mfma_f32_16x16x32_bf16 v[204:207], a[72:75], a[36:39], v[204:207]
v_mfma_f32_16x16x32_bf16 v[204:207], a[76:79], a[52:55], v[204:207]
v_mfma_f32_16x16x32_bf16 v[200:203], a[76:79], a[48:51], v[200:203]
v_mfma_f32_16x16x32_bf16 v[200:203], a[72:75], a[32:35], v[200:203]
s_waitcnt lgkmcnt(4)
v_mfma_f32_16x16x32_bf16 v[216:219], a[80:83], a[32:35], v[216:219]
s_waitcnt vmcnt(15)
s_barrier
ds_read_b64_tr_b16 a[64:65], v18 offset:0
v_mfma_f32_16x16x32_bf16 v[216:219], a[84:87], a[48:51], v[216:219]
ds_read_b64_tr_b16 a[66:67], v18 offset:3584
v_mfma_f32_16x16x32_bf16 v[220:223], a[84:87], a[52:55], v[220:223]
ds_read_b64_tr_b16 a[68:69], v18 offset:7168
v_mfma_f32_16x16x32_bf16 v[220:223], a[80:83], a[36:39], v[220:223]
ds_read_b64_tr_b16 a[70:71], v18 offset:10752
v_mfma_f32_16x16x32_bf16 v[224:227], a[80:83], a[40:43], v[224:227]
v_mfma_f32_16x16x32_bf16 v[224:227], a[84:87], a[56:59], v[224:227]
v_mfma_f32_16x16x32_bf16 v[228:231], a[84:87], a[60:63], v[228:231]
v_mfma_f32_16x16x32_bf16 v[228:231], a[80:83], a[44:47], v[228:231]
s_waitcnt lgkmcnt(4)
v_mfma_f32_16x16x32_bf16 v[244:247], a[88:91], a[44:47], v[244:247]
ds_read_b64_tr_b16 a[72:73], v18 offset:14336
v_mfma_f32_16x16x32_bf16 v[244:247], a[92:95], a[60:63], v[244:247]
ds_read_b64_tr_b16 a[74:75], v18 offset:17920
v_mfma_f32_16x16x32_bf16 v[240:243], a[92:95], a[56:59], v[240:243]
ds_read_b64_tr_b16 a[76:77], v18 offset:21504
v_mfma_f32_16x16x32_bf16 v[240:243], a[88:91], a[40:43], v[240:243]
ds_read_b64_tr_b16 a[78:79], v18 offset:25088
v_mfma_f32_16x16x32_bf16 v[236:239], a[88:91], a[36:39], v[236:239]
v_mfma_f32_16x16x32_bf16 v[236:239], a[92:95], a[52:55], v[236:239]
v_mfma_f32_16x16x32_bf16 v[232:235], a[92:95], a[48:51], v[232:235]
v_mfma_f32_16x16x32_bf16 v[232:235], a[88:91], a[32:35], v[232:235]
s_waitcnt vmcnt(2) lgkmcnt(4)
v_mfma_f32_16x16x32_bf16 v[24:27], a[64:67], a[0:3], v[24:27]
ds_read_b64_tr_b16 a[80:81], v18 offset:32
v_mfma_f32_16x16x32_bf16 v[24:27], a[68:71], a[16:19], v[24:27]
ds_read_b64_tr_b16 a[82:83], v18 offset:3616
v_mfma_f32_16x16x32_bf16 v[28:31], a[68:71], a[20:23], v[28:31]
ds_read_b64_tr_b16 a[84:85], v18 offset:7200
v_mfma_f32_16x16x32_bf16 v[28:31], a[64:67], a[4:7], v[28:31]
ds_read_b64_tr_b16 a[86:87], v18 offset:10784
v_mfma_f32_16x16x32_bf16 v[32:35], a[64:67], a[8:11], v[32:35]
s_add_u32 m0, s26, 0
v_mfma_f32_16x16x32_bf16 v[32:35], a[68:71], a[24:27], v[32:35]
buffer_load_dwordx4 v9, s[12:15], s27 offen lds
v_mfma_f32_16x16x32_bf16 v[36:39], a[68:71], a[28:31], v[36:39]
v_mfma_f32_16x16x32_bf16 v[36:39], a[64:67], a[12:15], v[36:39]
s_waitcnt lgkmcnt(4)
buffer_load_dwordx4 a[32:35], v5, s[16:19], s28 offen offset:2048 sc1
v_mfma_f32_16x16x32_bf16 v[52:55], a[72:75], a[12:15], v[52:55]
ds_read_b64_tr_b16 a[88:89], v18 offset:14368
v_mfma_f32_16x16x32_bf16 v[52:55], a[76:79], a[28:31], v[52:55]
ds_read_b64_tr_b16 a[90:91], v18 offset:17952
v_mfma_f32_16x16x32_bf16 v[48:51], a[76:79], a[24:27], v[48:51]
ds_read_b64_tr_b16 a[92:93], v18 offset:21536
v_mfma_f32_16x16x32_bf16 v[48:51], a[72:75], a[8:11], v[48:51]
ds_read_b64_tr_b16 a[94:95], v18 offset:25120
v_mfma_f32_16x16x32_bf16 v[44:47], a[72:75], a[4:7], v[44:47]
s_add_u32 m0, s26, 1024
v_mfma_f32_16x16x32_bf16 v[44:47], a[76:79], a[20:23], v[44:47]
buffer_load_dwordx4 v10, s[12:15], s27 offen lds
v_mfma_f32_16x16x32_bf16 v[40:43], a[76:79], a[16:19], v[40:43]
v_mfma_f32_16x16x32_bf16 v[40:43], a[72:75], a[0:3], v[40:43]
s_waitcnt lgkmcnt(4)
buffer_load_dwordx4 a[36:39], v6, s[16:19], s28 offen offset:2048 sc1
v_mfma_f32_16x16x32_bf16 v[56:59], a[80:83], a[0:3], v[56:59]
ds_read_b64_tr_b16 a[64:65], v18 offset:64
v_mfma_f32_16x16x32_bf16 v[56:59], a[84:87], a[16:19], v[56:59]
ds_read_b64_tr_b16 a[66:67], v18 offset:3648
v_mfma_f32_16x16x32_bf16 v[60:63], a[84:87], a[20:23], v[60:63]
ds_read_b64_tr_b16 a[68:69], v18 offset:7232
v_mfma_f32_16x16x32_bf16 v[60:63], a[80:83], a[4:7], v[60:63]
ds_read_b64_tr_b16 a[70:71], v18 offset:10816
v_mfma_f32_16x16x32_bf16 v[64:67], a[80:83], a[8:11], v[64:67]
v_mfma_f32_16x16x32_bf16 v[64:67], a[84:87], a[24:27], v[64:67]
v_mfma_f32_16x16x32_bf16 v[68:71], a[84:87], a[28:31], v[68:71]
v_mfma_f32_16x16x32_bf16 v[68:71], a[80:83], a[12:15], v[68:71]
s_waitcnt lgkmcnt(4)
buffer_load_dwordx4 a[40:43], v7, s[16:19], s28 offen offset:2048 sc1
v_mfma_f32_16x16x32_bf16 v[84:87], a[88:91], a[12:15], v[84:87]
ds_read_b64_tr_b16 a[72:73], v18 offset:14400
v_mfma_f32_16x16x32_bf16 v[84:87], a[92:95], a[28:31], v[84:87]
ds_read_b64_tr_b16 a[74:75], v18 offset:17984
v_mfma_f32_16x16x32_bf16 v[80:83], a[92:95], a[24:27], v[80:83]
ds_read_b64_tr_b16 a[76:77], v18 offset:21568
v_mfma_f32_16x16x32_bf16 v[80:83], a[88:91], a[8:11], v[80:83]
ds_read_b64_tr_b16 a[78:79], v18 offset:25152
v_mfma_f32_16x16x32_bf16 v[76:79], a[88:91], a[4:7], v[76:79]
s_add_u32 m0, s26, 2048
v_mfma_f32_16x16x32_bf16 v[76:79], a[92:95], a[20:23], v[76:79]
buffer_load_dwordx4 v11, s[12:15], s27 offen lds
v_mfma_f32_16x16x32_bf16 v[72:75], a[92:95], a[16:19], v[72:75]
v_mfma_f32_16x16x32_bf16 v[72:75], a[88:91], a[0:3], v[72:75]
s_waitcnt lgkmcnt(4)
buffer_load_dwordx4 a[44:47], v8, s[16:19], s28 offen offset:2048 sc1
v_mfma_f32_16x16x32_bf16 v[88:91], a[64:67], a[0:3], v[88:91]
ds_read_b64_tr_b16 a[80:81], v18 offset:96
v_mfma_f32_16x16x32_bf16 v[88:91], a[68:71], a[16:19], v[88:91]
ds_read_b64_tr_b16 a[82:83], v18 offset:3680
v_mfma_f32_16x16x32_bf16 v[92:95], a[68:71], a[20:23], v[92:95]
ds_read_b64_tr_b16 a[84:85], v18 offset:7264
v_mfma_f32_16x16x32_bf16 v[92:95], a[64:67], a[4:7], v[92:95]
ds_read_b64_tr_b16 a[86:87], v18 offset:10848
v_mfma_f32_16x16x32_bf16 v[96:99], a[64:67], a[8:11], v[96:99]
v_mfma_f32_16x16x32_bf16 v[96:99], a[68:71], a[24:27], v[96:99]
v_mfma_f32_16x16x32_bf16 v[100:103], a[68:71], a[28:31], v[100:103]
v_mfma_f32_16x16x32_bf16 v[100:103], a[64:67], a[12:15], v[100:103]
s_waitcnt lgkmcnt(4)
buffer_load_dwordx4 a[48:51], v5, s[16:19], s28 offen offset:3072 sc1
v_mfma_f32_16x16x32_bf16 v[116:119], a[72:75], a[12:15], v[116:119]
ds_read_b64_tr_b16 a[88:89], v18 offset:14432
v_mfma_f32_16x16x32_bf16 v[116:119], a[76:79], a[28:31], v[116:119]
ds_read_b64_tr_b16 a[90:91], v18 offset:18016
v_mfma_f32_16x16x32_bf16 v[112:115], a[76:79], a[24:27], v[112:115]
ds_read_b64_tr_b16 a[92:93], v18 offset:21600
v_mfma_f32_16x16x32_bf16 v[112:115], a[72:75], a[8:11], v[112:115]
ds_read_b64_tr_b16 a[94:95], v18 offset:25184
v_mfma_f32_16x16x32_bf16 v[108:111], a[72:75], a[4:7], v[108:111]
s_add_u32 m0, s26, 3072
v_mfma_f32_16x16x32_bf16 v[108:111], a[76:79], a[20:23], v[108:111]
buffer_load_dwordx4 v12, s[12:15], s27 offen lds
v_mfma_f32_16x16x32_bf16 v[104:107], a[76:79], a[16:19], v[104:107]
v_mfma_f32_16x16x32_bf16 v[104:107], a[72:75], a[0:3], v[104:107]
s_waitcnt lgkmcnt(4)
buffer_load_dwordx4 a[52:55], v6, s[16:19], s28 offen offset:3072 sc1
v_mfma_f32_16x16x32_bf16 v[120:123], a[80:83], a[0:3], v[120:123]
ds_read_b64_tr_b16 a[64:65], v18 offset:128
v_mfma_f32_16x16x32_bf16 v[120:123], a[84:87], a[16:19], v[120:123]
ds_read_b64_tr_b16 a[66:67], v18 offset:3712
v_mfma_f32_16x16x32_bf16 v[124:127], a[84:87], a[20:23], v[124:127]
ds_read_b64_tr_b16 a[68:69], v18 offset:7296
v_mfma_f32_16x16x32_bf16 v[124:127], a[80:83], a[4:7], v[124:127]
ds_read_b64_tr_b16 a[70:71], v18 offset:10880
v_mfma_f32_16x16x32_bf16 v[128:131], a[80:83], a[8:11], v[128:131]
s_add_u32 m0, s26, 4096
v_mfma_f32_16x16x32_bf16 v[128:131], a[84:87], a[24:27], v[128:131]
buffer_load_dwordx4 v13, s[12:15], s27 offen lds
v_mfma_f32_16x16x32_bf16 v[132:135], a[84:87], a[28:31], v[132:135]
v_mfma_f32_16x16x32_bf16 v[132:135], a[80:83], a[12:15], v[132:135]
s_waitcnt lgkmcnt(4)
buffer_load_dwordx4 a[56:59], v7, s[16:19], s28 offen offset:3072 sc1
v_mfma_f32_16x16x32_bf16 v[148:151], a[88:91], a[12:15], v[148:151]
ds_read_b64_tr_b16 a[72:73], v18 offset:14464
v_mfma_f32_16x16x32_bf16 v[148:151], a[92:95], a[28:31], v[148:151]
ds_read_b64_tr_b16 a[74:75], v18 offset:18048
v_mfma_f32_16x16x32_bf16 v[144:147], a[92:95], a[24:27], v[144:147]
ds_read_b64_tr_b16 a[76:77], v18 offset:21632
v_mfma_f32_16x16x32_bf16 v[144:147], a[88:91], a[8:11], v[144:147]
ds_read_b64_tr_b16 a[78:79], v18 offset:25216
v_mfma_f32_16x16x32_bf16 v[140:143], a[88:91], a[4:7], v[140:143]
v_mfma_f32_16x16x32_bf16 v[140:143], a[92:95], a[20:23], v[140:143]
v_mfma_f32_16x16x32_bf16 v[136:139], a[92:95], a[16:19], v[136:139]
v_mfma_f32_16x16x32_bf16 v[136:139], a[88:91], a[0:3], v[136:139]
s_waitcnt lgkmcnt(4)
buffer_load_dwordx4 a[60:63], v8, s[16:19], s28 offen offset:3072 sc1
s_add_u32 s28, s28, 4096
v_mfma_f32_16x16x32_bf16 v[152:155], a[64:67], a[0:3], v[152:155]
ds_read_b64_tr_b16 a[80:81], v18 offset:160
v_mfma_f32_16x16x32_bf16 v[152:155], a[68:71], a[16:19], v[152:155]
ds_read_b64_tr_b16 a[82:83], v18 offset:3744
v_mfma_f32_16x16x32_bf16 v[156:159], a[68:71], a[20:23], v[156:159]
ds_read_b64_tr_b16 a[84:85], v18 offset:7328
v_mfma_f32_16x16x32_bf16 v[156:159], a[64:67], a[4:7], v[156:159]
ds_read_b64_tr_b16 a[86:87], v18 offset:10912
v_mfma_f32_16x16x32_bf16 v[160:163], a[64:67], a[8:11], v[160:163]
s_add_u32 m0, s26, 5120
v_mfma_f32_16x16x32_bf16 v[160:163], a[68:71], a[24:27], v[160:163]
buffer_load_dwordx4 v14, s[12:15], s27 offen lds
v_mfma_f32_16x16x32_bf16 v[164:167], a[68:71], a[28:31], v[164:167]
v_mfma_f32_16x16x32_bf16 v[164:167], a[64:67], a[12:15], v[164:167]
s_waitcnt lgkmcnt(4)
v_mfma_f32_16x16x32_bf16 v[180:183], a[72:75], a[12:15], v[180:183]
ds_read_b64_tr_b16 a[88:89], v18 offset:14496
v_mfma_f32_16x16x32_bf16 v[180:183], a[76:79], a[28:31], v[180:183]
ds_read_b64_tr_b16 a[90:91], v18 offset:18080
v_mfma_f32_16x16x32_bf16 v[176:179], a[76:79], a[24:27], v[176:179]
ds_read_b64_tr_b16 a[92:93], v18 offset:21664
v_mfma_f32_16x16x32_bf16 v[176:179], a[72:75], a[8:11], v[176:179]
ds_read_b64_tr_b16 a[94:95], v18 offset:25248
v_mfma_f32_16x16x32_bf16 v[172:175], a[72:75], a[4:7], v[172:175]
v_mfma_f32_16x16x32_bf16 v[172:175], a[76:79], a[20:23], v[172:175]
v_mfma_f32_16x16x32_bf16 v[168:171], a[76:79], a[16:19], v[168:171]
v_mfma_f32_16x16x32_bf16 v[168:171], a[72:75], a[0:3], v[168:171]
s_waitcnt lgkmcnt(4)
v_mfma_f32_16x16x32_bf16 v[184:187], a[80:83], a[0:3], v[184:187]
ds_read_b64_tr_b16 a[64:65], v19 offset:0
v_mfma_f32_16x16x32_bf16 v[184:187], a[84:87], a[16:19], v[184:187]
ds_read_b64_tr_b16 a[66:67], v19 offset:3584
v_mfma_f32_16x16x32_bf16 v[188:191], a[84:87], a[20:23], v[188:191]
ds_read_b64_tr_b16 a[68:69], v19 offset:7168
v_mfma_f32_16x16x32_bf16 v[188:191], a[80:83], a[4:7], v[188:191]
ds_read_b64_tr_b16 a[70:71], v19 offset:10752
v_mfma_f32_16x16x32_bf16 v[192:195], a[80:83], a[8:11], v[192:195]
s_add_u32 m0, s26, 6144
v_mfma_f32_16x16x32_bf16 v[192:195], a[84:87], a[24:27], v[192:195]
buffer_load_dwordx4 v15, s[12:15], s27 offen lds
s_add_u32 s27, s27, 458752
v_mfma_f32_16x16x32_bf16 v[196:199], a[84:87], a[28:31], v[196:199]
v_mfma_f32_16x16x32_bf16 v[196:199], a[80:83], a[12:15], v[196:199]
s_waitcnt lgkmcnt(4)
v_mfma_f32_16x16x32_bf16 v[212:215], a[88:91], a[12:15], v[212:215]
ds_read_b64_tr_b16 a[72:73], v19 offset:14336
v_mfma_f32_16x16x32_bf16 v[212:215], a[92:95], a[28:31], v[212:215]
ds_read_b64_tr_b16 a[74:75], v19 offset:17920
v_mfma_f32_16x16x32_bf16 v[208:211], a[92:95], a[24:27], v[208:211]
ds_read_b64_tr_b16 a[76:77], v19 offset:21504
v_mfma_f32_16x16x32_bf16 v[208:211], a[88:91], a[8:11], v[208:211]
ds_read_b64_tr_b16 a[78:79], v19 offset:25088
v_mfma_f32_16x16x32_bf16 v[204:207], a[88:91], a[4:7], v[204:207]
v_mfma_f32_16x16x32_bf16 v[204:207], a[92:95], a[20:23], v[204:207]
v_mfma_f32_16x16x32_bf16 v[200:203], a[92:95], a[16:19], v[200:203]
v_mfma_f32_16x16x32_bf16 v[200:203], a[88:91], a[0:3], v[200:203]
s_waitcnt lgkmcnt(4)
v_mfma_f32_16x16x32_bf16 v[216:219], a[64:67], a[0:3], v[216:219]
s_waitcnt vmcnt(15)
s_barrier
ds_read_b64_tr_b16 a[80:81], v18 offset:28672
v_mfma_f32_16x16x32_bf16 v[216:219], a[68:71], a[16:19], v[216:219]
ds_read_b64_tr_b16 a[82:83], v18 offset:32256
v_mfma_f32_16x16x32_bf16 v[220:223], a[68:71], a[20:23], v[220:223]
ds_read_b64_tr_b16 a[84:85], v18 offset:35840
v_mfma_f32_16x16x32_bf16 v[220:223], a[64:67], a[4:7], v[220:223]
ds_read_b64_tr_b16 a[86:87], v18 offset:39424
v_mfma_f32_16x16x32_bf16 v[224:227], a[64:67], a[8:11], v[224:227]
v_mfma_f32_16x16x32_bf16 v[224:227], a[68:71], a[24:27], v[224:227]
v_mfma_f32_16x16x32_bf16 v[228:231], a[68:71], a[28:31], v[228:231]
v_mfma_f32_16x16x32_bf16 v[228:231], a[64:67], a[12:15], v[228:231]
s_waitcnt lgkmcnt(4)
v_mfma_f32_16x16x32_bf16 v[244:247], a[72:75], a[12:15], v[244:247]
ds_read_b64_tr_b16 a[88:89], v18 offset:43008
v_mfma_f32_16x16x32_bf16 v[244:247], a[76:79], a[28:31], v[244:247]
ds_read_b64_tr_b16 a[90:91], v18 offset:46592
v_mfma_f32_16x16x32_bf16 v[240:243], a[76:79], a[24:27], v[240:243]
ds_read_b64_tr_b16 a[92:93], v18 offset:50176
v_mfma_f32_16x16x32_bf16 v[240:243], a[72:75], a[8:11], v[240:243]
ds_read_b64_tr_b16 a[94:95], v18 offset:53760
v_mfma_f32_16x16x32_bf16 v[236:239], a[72:75], a[4:7], v[236:239]
v_mfma_f32_16x16x32_bf16 v[236:239], a[76:79], a[20:23], v[236:239]
v_mfma_f32_16x16x32_bf16 v[232:235], a[76:79], a[16:19], v[232:235]
v_mfma_f32_16x16x32_bf16 v[232:235], a[72:75], a[0:3], v[232:235]
s_waitcnt vmcnt(2) lgkmcnt(4)
v_mfma_f32_16x16x32_bf16 v[24:27], a[80:83], a[32:35], v[24:27]
ds_read_b64_tr_b16 a[64:65], v18 offset:28704
v_mfma_f32_16x16x32_bf16 v[24:27], a[84:87], a[48:51], v[24:27]
ds_read_b64_tr_b16 a[66:67], v18 offset:32288
v_mfma_f32_16x16x32_bf16 v[28:31], a[84:87], a[52:55], v[28:31]
ds_read_b64_tr_b16 a[68:69], v18 offset:35872
v_mfma_f32_16x16x32_bf16 v[28:31], a[80:83], a[36:39], v[28:31]
ds_read_b64_tr_b16 a[70:71], v18 offset:39456
v_mfma_f32_16x16x32_bf16 v[32:35], a[80:83], a[40:43], v[32:35]
s_add_u32 m0, s26, 28672
v_mfma_f32_16x16x32_bf16 v[32:35], a[84:87], a[56:59], v[32:35]
buffer_load_dwordx4 v9, s[12:15], s27 offen lds
v_mfma_f32_16x16x32_bf16 v[36:39], a[84:87], a[60:63], v[36:39]
v_mfma_f32_16x16x32_bf16 v[36:39], a[80:83], a[44:47], v[36:39]
s_waitcnt lgkmcnt(4)
buffer_load_dwordx4 a[0:3], v5, s[16:19], s28 offen offset:0 sc1
v_mfma_f32_16x16x32_bf16 v[52:55], a[88:91], a[44:47], v[52:55]
ds_read_b64_tr_b16 a[72:73], v18 offset:43040
v_mfma_f32_16x16x32_bf16 v[52:55], a[92:95], a[60:63], v[52:55]
ds_read_b64_tr_b16 a[74:75], v18 offset:46624
v_mfma_f32_16x16x32_bf16 v[48:51], a[92:95], a[56:59], v[48:51]
ds_read_b64_tr_b16 a[76:77], v18 offset:50208
v_mfma_f32_16x16x32_bf16 v[48:51], a[88:91], a[40:43], v[48:51]
ds_read_b64_tr_b16 a[78:79], v18 offset:53792
v_mfma_f32_16x16x32_bf16 v[44:47], a[88:91], a[36:39], v[44:47]
s_add_u32 m0, s26, 29696
v_mfma_f32_16x16x32_bf16 v[44:47], a[92:95], a[52:55], v[44:47]
buffer_load_dwordx4 v10, s[12:15], s27 offen lds
v_mfma_f32_16x16x32_bf16 v[40:43], a[92:95], a[48:51], v[40:43]
v_mfma_f32_16x16x32_bf16 v[40:43], a[88:91], a[32:35], v[40:43]
s_waitcnt lgkmcnt(4)
buffer_load_dwordx4 a[4:7], v6, s[16:19], s28 offen offset:0 sc1
v_mfma_f32_16x16x32_bf16 v[56:59], a[64:67], a[32:35], v[56:59]
ds_read_b64_tr_b16 a[80:81], v18 offset:28736
v_mfma_f32_16x16x32_bf16 v[56:59], a[68:71], a[48:51], v[56:59]
ds_read_b64_tr_b16 a[82:83], v18 offset:32320
v_mfma_f32_16x16x32_bf16 v[60:63], a[68:71], a[52:55], v[60:63]
ds_read_b64_tr_b16 a[84:85], v18 offset:35904
v_mfma_f32_16x16x32_bf16 v[60:63], a[64:67], a[36:39], v[60:63]
ds_read_b64_tr_b16 a[86:87], v18 offset:39488
v_mfma_f32_16x16x32_bf16 v[64:67], a[64:67], a[40:43], v[64:67]
v_mfma_f32_16x16x32_bf16 v[64:67], a[68:71], a[56:59], v[64:67]
v_mfma_f32_16x16x32_bf16 v[68:71], a[68:71], a[60:63], v[68:71]
v_mfma_f32_16x16x32_bf16 v[68:71], a[64:67], a[44:47], v[68:71]
s_waitcnt lgkmcnt(4)
buffer_load_dwordx4 a[8:11], v7, s[16:19], s28 offen offset:0 sc1
v_mfma_f32_16x16x32_bf16 v[84:87], a[72:75], a[44:47], v[84:87]
ds_read_b64_tr_b16 a[88:89], v18 offset:43072
v_mfma_f32_16x16x32_bf16 v[84:87], a[76:79], a[60:63], v[84:87]
ds_read_b64_tr_b16 a[90:91], v18 offset:46656
v_mfma_f32_16x16x32_bf16 v[80:83], a[76:79], a[56:59], v[80:83]
ds_read_b64_tr_b16 a[92:93], v18 offset:50240
v_mfma_f32_16x16x32_bf16 v[80:83], a[72:75], a[40:43], v[80:83]
ds_read_b64_tr_b16 a[94:95], v18 offset:53824
v_mfma_f32_16x16x32_bf16 v[76:79], a[72:75], a[36:39], v[76:79]
s_add_u32 m0, s26, 30720
v_mfma_f32_16x16x32_bf16 v[76:79], a[76:79], a[52:55], v[76:79]
buffer_load_dwordx4 v11, s[12:15], s27 offen lds
v_mfma_f32_16x16x32_bf16 v[72:75], a[76:79], a[48:51], v[72:75]
v_mfma_f32_16x16x32_bf16 v[72:75], a[72:75], a[32:35], v[72:75]
s_waitcnt lgkmcnt(4)
buffer_load_dwordx4 a[12:15], v8, s[16:19], s28 offen offset:0 sc1
v_mfma_f32_16x16x32_bf16 v[88:91], a[80:83], a[32:35], v[88:91]
ds_read_b64_tr_b16 a[64:65], v18 offset:28768
v_mfma_f32_16x16x32_bf16 v[88:91], a[84:87], a[48:51], v[88:91]
ds_read_b64_tr_b16 a[66:67], v18 offset:32352
v_mfma_f32_16x16x32_bf16 v[92:95], a[84:87], a[52:55], v[92:95]
ds_read_b64_tr_b16 a[68:69], v18 offset:35936
v_mfma_f32_16x16x32_bf16 v[92:95], a[80:83], a[36:39], v[92:95]
ds_read_b64_tr_b16 a[70:71], v18 offset:39520
v_mfma_f32_16x16x32_bf16 v[96:99], a[80:83], a[40:43], v[96:99]
v_mfma_f32_16x16x32_bf16 v[96:99], a[84:87], a[56:59], v[96:99]
v_mfma_f32_16x16x32_bf16 v[100:103], a[84:87], a[60:63], v[100:103]
v_mfma_f32_16x16x32_bf16 v[100:103], a[80:83], a[44:47], v[100:103]
s_waitcnt lgkmcnt(4)
buffer_load_dwordx4 a[16:19], v5, s[16:19], s28 offen offset:1024 sc1
v_mfma_f32_16x16x32_bf16 v[116:119], a[88:91], a[44:47], v[116:119]
ds_read_b64_tr_b16 a[72:73], v18 offset:43104
v_mfma_f32_16x16x32_bf16 v[116:119], a[92:95], a[60:63], v[116:119]
ds_read_b64_tr_b16 a[74:75], v18 offset:46688
v_mfma_f32_16x16x32_bf16 v[112:115], a[92:95], a[56:59], v[112:115]
ds_read_b64_tr_b16 a[76:77], v18 offset:50272
v_mfma_f32_16x16x32_bf16 v[112:115], a[88:91], a[40:43], v[112:115]
ds_read_b64_tr_b16 a[78:79], v18 offset:53856
v_mfma_f32_16x16x32_bf16 v[108:111], a[88:91], a[36:39], v[108:111]
s_add_u32 m0, s26, 31744
v_mfma_f32_16x16x32_bf16 v[108:111], a[92:95], a[52:55], v[108:111]
buffer_load_dwordx4 v12, s[12:15], s27 offen lds
v_mfma_f32_16x16x32_bf16 v[104:107], a[92:95], a[48:51], v[104:107]
v_mfma_f32_16x16x32_bf16 v[104:107], a[88:91], a[32:35], v[104:107]
s_waitcnt lgkmcnt(4)
buffer_load_dwordx4 a[20:23], v6, s[16:19], s28 offen offset:1024 sc1
v_mfma_f32_16x16x32_bf16 v[120:123], a[64:67], a[32:35], v[120:123]
ds_read_b64_tr_b16 a[80:81], v18 offset:28800
v_mfma_f32_16x16x32_bf16 v[120:123], a[68:71], a[48:51], v[120:123]
ds_read_b64_tr_b16 a[82:83], v18 offset:32384
v_mfma_f32_16x16x32_bf16 v[124:127], a[68:71], a[52:55], v[124:127]
ds_read_b64_tr_b16 a[84:85], v18 offset:35968
v_mfma_f32_16x16x32_bf16 v[124:127], a[64:67], a[36:39], v[124:127]
ds_read_b64_tr_b16 a[86:87], v18 offset:39552
v_mfma_f32_16x16x32_bf16 v[128:131], a[64:67], a[40:43], v[128:131]
s_add_u32 m0, s26, 32768
v_mfma_f32_16x16x32_bf16 v[128:131], a[68:71], a[56:59], v[128:131]
buffer_load_dwordx4 v13, s[12:15], s27 offen lds
v_mfma_f32_16x16x32_bf16 v[132:135], a[68:71], a[60:63], v[132:135]
v_mfma_f32_16x16x32_bf16 v[132:135], a[64:67], a[44:47], v[132:135]
s_waitcnt lgkmcnt(4)
buffer_load_dwordx4 a[24:27], v7, s[16:19], s28 offen offset:1024 sc1
v_mfma_f32_16x16x32_bf16 v[148:151], a[72:75], a[44:47], v[148:151]
ds_read_b64_tr_b16 a[88:89], v18 offset:43136
v_mfma_f32_16x16x32_bf16 v[148:151], a[76:79], a[60:63], v[148:151]
ds_read_b64_tr_b16 a[90:91], v18 offset:46720
v_mfma_f32_16x16x32_bf16 v[144:147], a[76:79], a[56:59], v[144:147]
ds_read_b64_tr_b16 a[92:93], v18 offset:50304
v_mfma_f32_16x16x32_bf16 v[144:147], a[72:75], a[40:43], v[144:147]
ds_read_b64_tr_b16 a[94:95], v18 offset:53888
v_mfma_f32_16x16x32_bf16 v[140:143], a[72:75], a[36:39], v[140:143]
v_mfma_f32_16x16x32_bf16 v[140:143], a[76:79], a[52:55], v[140:143]
v_mfma_f32_16x16x32_bf16 v[136:139], a[76:79], a[48:51], v[136:139]
v_mfma_f32_16x16x32_bf16 v[136:139], a[72:75], a[32:35], v[136:139]
s_waitcnt lgkmcnt(4)
buffer_load_dwordx4 a[28:31], v8, s[16:19], s28 offen offset:1024 sc1
v_mfma_f32_16x16x32_bf16 v[152:155], a[80:83], a[32:35], v[152:155]
ds_read_b64_tr_b16 a[64:65], v18 offset:28832
v_mfma_f32_16x16x32_bf16 v[152:155], a[84:87], a[48:51], v[152:155]
ds_read_b64_tr_b16 a[66:67], v18 offset:32416
v_mfma_f32_16x16x32_bf16 v[156:159], a[84:87], a[52:55], v[156:159]
ds_read_b64_tr_b16 a[68:69], v18 offset:36000
v_mfma_f32_16x16x32_bf16 v[156:159], a[80:83], a[36:39], v[156:159]
ds_read_b64_tr_b16 a[70:71], v18 offset:39584
v_mfma_f32_16x16x32_bf16 v[160:163], a[80:83], a[40:43], v[160:163]
s_add_u32 m0, s26, 33792
v_mfma_f32_16x16x32_bf16 v[160:163], a[84:87], a[56:59], v[160:163]
buffer_load_dwordx4 v14, s[12:15], s27 offen lds
v_mfma_f32_16x16x32_bf16 v[164:167], a[84:87], a[60:63], v[164:167]
v_mfma_f32_16x16x32_bf16 v[164:167], a[80:83], a[44:47], v[164:167]
s_waitcnt lgkmcnt(4)
v_mfma_f32_16x16x32_bf16 v[180:183], a[88:91], a[44:47], v[180:183]
ds_read_b64_tr_b16 a[72:73], v18 offset:43168
v_mfma_f32_16x16x32_bf16 v[180:183], a[92:95], a[60:63], v[180:183]
ds_read_b64_tr_b16 a[74:75], v18 offset:46752
v_mfma_f32_16x16x32_bf16 v[176:179], a[92:95], a[56:59], v[176:179]
ds_read_b64_tr_b16 a[76:77], v18 offset:50336
v_mfma_f32_16x16x32_bf16 v[176:179], a[88:91], a[40:43], v[176:179]
ds_read_b64_tr_b16 a[78:79], v18 offset:53920
v_mfma_f32_16x16x32_bf16 v[172:175], a[88:91], a[36:39], v[172:175]
v_mfma_f32_16x16x32_bf16 v[172:175], a[92:95], a[52:55], v[172:175]
v_mfma_f32_16x16x32_bf16 v[168:171], a[92:95], a[48:51], v[168:171]
v_mfma_f32_16x16x32_bf16 v[168:171], a[88:91], a[32:35], v[168:171]
s_waitcnt lgkmcnt(4)
v_mfma_f32_16x16x32_bf16 v[184:187], a[64:67], a[32:35], v[184:187]
ds_read_b64_tr_b16 a[80:81], v19 offset:28672
v_mfma_f32_16x16x32_bf16 v[184:187], a[68:71], a[48:51], v[184:187]
ds_read_b64_tr_b16 a[82:83], v19 offset:32256
v_mfma_f32_16x16x32_bf16 v[188:191], a[68:71], a[52:55], v[188:191]
ds_read_b64_tr_b16 a[84:85], v19 offset:35840
v_mfma_f32_16x16x32_bf16 v[188:191], a[64:67], a[36:39], v[188:191]
ds_read_b64_tr_b16 a[86:87], v19 offset:39424
v_mfma_f32_16x16x32_bf16 v[192:195], a[64:67], a[40:43], v[192:195]
s_add_u32 m0, s26, 34816
v_mfma_f32_16x16x32_bf16 v[192:195], a[68:71], a[56:59], v[192:195]
buffer_load_dwordx4 v15, s[12:15], s27 offen lds
s_add_u32 s27, s27, 458752
v_mfma_f32_16x16x32_bf16 v[196:199], a[68:71], a[60:63], v[196:199]
v_mfma_f32_16x16x32_bf16 v[196:199], a[64:67], a[44:47], v[196:199]
s_waitcnt lgkmcnt(4)
v_mfma_f32_16x16x32_bf16 v[212:215], a[72:75], a[44:47], v[212:215]
ds_read_b64_tr_b16 a[88:89], v19 offset:43008
v_mfma_f32_16x16x32_bf16 v[212:215], a[76:79], a[60:63], v[212:215]
ds_read_b64_tr_b16 a[90:91], v19 offset:46592
v_mfma_f32_16x16x32_bf16 v[208:211], a[76:79], a[56:59], v[208:211]
ds_read_b64_tr_b16 a[92:93], v19 offset:50176
v_mfma_f32_16x16x32_bf16 v[208:211], a[72:75], a[40:43], v[208:211]
ds_read_b64_tr_b16 a[94:95], v19 offset:53760
v_mfma_f32_16x16x32_bf16 v[204:207], a[72:75], a[36:39], v[204:207]
v_mfma_f32_16x16x32_bf16 v[204:207], a[76:79], a[52:55], v[204:207]
v_mfma_f32_16x16x32_bf16 v[200:203], a[76:79], a[48:51], v[200:203]
v_mfma_f32_16x16x32_bf16 v[200:203], a[72:75], a[32:35], v[200:203]
s_waitcnt lgkmcnt(4)
v_mfma_f32_16x16x32_bf16 v[216:219], a[80:83], a[32:35], v[216:219]
s_waitcnt vmcnt(15)
s_barrier
ds_read_b64_tr_b16 a[64:65], v16 offset:0
v_mfma_f32_16x16x32_bf16 v[216:219], a[84:87], a[48:51], v[216:219]
ds_read_b64_tr_b16 a[66:67], v16 offset:3584
v_mfma_f32_16x16x32_bf16 v[220:223], a[84:87], a[52:55], v[220:223]
ds_read_b64_tr_b16 a[68:69], v16 offset:7168
v_mfma_f32_16x16x32_bf16 v[220:223], a[80:83], a[36:39], v[220:223]
ds_read_b64_tr_b16 a[70:71], v16 offset:10752
v_mfma_f32_16x16x32_bf16 v[224:227], a[80:83], a[40:43], v[224:227]
v_mfma_f32_16x16x32_bf16 v[224:227], a[84:87], a[56:59], v[224:227]
v_mfma_f32_16x16x32_bf16 v[228:231], a[84:87], a[60:63], v[228:231]
v_mfma_f32_16x16x32_bf16 v[228:231], a[80:83], a[44:47], v[228:231]
s_waitcnt lgkmcnt(4)
v_mfma_f32_16x16x32_bf16 v[244:247], a[88:91], a[44:47], v[244:247]
ds_read_b64_tr_b16 a[72:73], v16 offset:14336
v_mfma_f32_16x16x32_bf16 v[244:247], a[92:95], a[60:63], v[244:247]
ds_read_b64_tr_b16 a[74:75], v16 offset:17920
v_mfma_f32_16x16x32_bf16 v[240:243], a[92:95], a[56:59], v[240:243]
ds_read_b64_tr_b16 a[76:77], v16 offset:21504
v_mfma_f32_16x16x32_bf16 v[240:243], a[88:91], a[40:43], v[240:243]
ds_read_b64_tr_b16 a[78:79], v16 offset:25088
v_mfma_f32_16x16x32_bf16 v[236:239], a[88:91], a[36:39], v[236:239]
v_mfma_f32_16x16x32_bf16 v[236:239], a[92:95], a[52:55], v[236:239]
v_mfma_f32_16x16x32_bf16 v[232:235], a[92:95], a[48:51], v[232:235]
v_mfma_f32_16x16x32_bf16 v[232:235], a[88:91], a[32:35], v[232:235]
s_waitcnt vmcnt(2) lgkmcnt(4)
s_sub_u32 s29, s29, 1
s_cmp_lg_u32 s29, 0
s_cbranch_scc1 L_gu_loop
v_mfma_f32_16x16x32_bf16 v[24:27], a[64:67], a[0:3], v[24:27]
ds_read_b64_tr_b16 a[80:81], v16 offset:32
v_mfma_f32_16x16x32_bf16 v[24:27], a[68:71], a[16:19], v[24:27]
ds_read_b64_tr_b16 a[82:83], v16 offset:3616
v_mfma_f32_16x16x32_bf16 v[28:31], a[68:71], a[20:23], v[28:31]
ds_read_b64_tr_b16 a[84:85], v16 offset:7200
v_mfma_f32_16x16x32_bf16 v[28:31], a[64:67], a[4:7], v[28:31]
ds_read_b64_tr_b16 a[86:87], v16 offset:10784
v_mfma_f32_16x16x32_bf16 v[32:35], a[64:67], a[8:11], v[32:35]
s_add_u32 m0, s26, 57344
v_mfma_f32_16x16x32_bf16 v[32:35], a[68:71], a[24:27], v[32:35]
buffer_load_dwordx4 v9, s[12:15], s27 offen lds
v_mfma_f32_16x16x32_bf16 v[36:39], a[68:71], a[28:31], v[36:39]
v_mfma_f32_16x16x32_bf16 v[36:39], a[64:67], a[12:15], v[36:39]
s_waitcnt lgkmcnt(4)
buffer_load_dwordx4 a[32:35], v5, s[16:19], s28 offen offset:2048 sc1
v_mfma_f32_16x16x32_bf16 v[52:55], a[72:75], a[12:15], v[52:55]
ds_read_b64_tr_b16 a[88:89], v16 offset:14368
v_mfma_f32_16x16x32_bf16 v[52:55], a[76:79], a[28:31], v[52:55]
ds_read_b64_tr_b16 a[90:91], v16 offset:17952
v_mfma_f32_16x16x32_bf16 v[48:51], a[76:79], a[24:27], v[48:51]
ds_read_b64_tr_b16 a[92:93], v16 offset:21536
v_mfma_f32_16x16x32_bf16 v[48:51], a[72:75], a[8:11], v[48:51]
ds_read_b64_tr_b16 a[94:95], v16 offset:25120
v_mfma_f32_16x16x32_bf16 v[44:47], a[72:75], a[4:7], v[44:47]
s_add_u32 m0, s26, 58368
v_mfma_f32_16x16x32_bf16 v[44:47], a[76:79], a[20:23], v[44:47]
buffer_load_dwordx4 v10, s[12:15], s27 offen lds
v_mfma_f32_16x16x32_bf16 v[40:43], a[76:79], a[16:19], v[40:43]
v_mfma_f32_16x16x32_bf16 v[40:43], a[72:75], a[0:3], v[40:43]
s_waitcnt lgkmcnt(4)
buffer_load_dwordx4 a[36:39], v6, s[16:19], s28 offen offset:2048 sc1
v_mfma_f32_16x16x32_bf16 v[56:59], a[80:83], a[0:3], v[56:59]
ds_read_b64_tr_b16 a[64:65], v16 offset:64
v_mfma_f32_16x16x32_bf16 v[56:59], a[84:87], a[16:19], v[56:59]
ds_read_b64_tr_b16 a[66:67], v16 offset:3648
v_mfma_f32_16x16x32_bf16 v[60:63], a[84:87], a[20:23], v[60:63]
ds_read_b64_tr_b16 a[68:69], v16 offset:7232
v_mfma_f32_16x16x32_bf16 v[60:63], a[80:83], a[4:7], v[60:63]
ds_read_b64_tr_b16 a[70:71], v16 offset:10816
v_mfma_f32_16x16x32_bf16 v[64:67], a[80:83], a[8:11], v[64:67]
v_mfma_f32_16x16x32_bf16 v[64:67], a[84:87], a[24:27], v[64:67]
v_mfma_f32_16x16x32_bf16 v[68:71], a[84:87], a[28:31], v[68:71]
v_mfma_f32_16x16x32_bf16 v[68:71], a[80:83], a[12:15], v[68:71]
s_waitcnt lgkmcnt(4)
buffer_load_dwordx4 a[40:43], v7, s[16:19], s28 offen offset:2048 sc1
v_mfma_f32_16x16x32_bf16 v[84:87], a[88:91], a[12:15], v[84:87]
ds_read_b64_tr_b16 a[72:73], v16 offset:14400
v_mfma_f32_16x16x32_bf16 v[84:87], a[92:95], a[28:31], v[84:87]
ds_read_b64_tr_b16 a[74:75], v16 offset:17984
v_mfma_f32_16x16x32_bf16 v[80:83], a[92:95], a[24:27], v[80:83]
ds_read_b64_tr_b16 a[76:77], v16 offset:21568
v_mfma_f32_16x16x32_bf16 v[80:83], a[88:91], a[8:11], v[80:83]
ds_read_b64_tr_b16 a[78:79], v16 offset:25152
v_mfma_f32_16x16x32_bf16 v[76:79], a[88:91], a[4:7], v[76:79]
s_add_u32 m0, s26, 59392
v_mfma_f32_16x16x32_bf16 v[76:79], a[92:95], a[20:23], v[76:79]
buffer_load_dwordx4 v11, s[12:15], s27 offen lds
v_mfma_f32_16x16x32_bf16 v[72:75], a[92:95], a[16:19], v[72:75]
v_mfma_f32_16x16x32_bf16 v[72:75], a[88:91], a[0:3], v[72:75]
s_waitcnt lgkmcnt(4)
buffer_load_dwordx4 a[44:47], v8, s[16:19], s28 offen offset:2048 sc1
v_mfma_f32_16x16x32_bf16 v[88:91], a[64:67], a[0:3], v[88:91]
ds_read_b64_tr_b16 a[80:81], v16 offset:96
v_mfma_f32_16x16x32_bf16 v[88:91], a[68:71], a[16:19], v[88:91]
ds_read_b64_tr_b16 a[82:83], v16 offset:3680
v_mfma_f32_16x16x32_bf16 v[92:95], a[68:71], a[20:23], v[92:95]
ds_read_b64_tr_b16 a[84:85], v16 offset:7264
v_mfma_f32_16x16x32_bf16 v[92:95], a[64:67], a[4:7], v[92:95]
ds_read_b64_tr_b16 a[86:87], v16 offset:10848
v_mfma_f32_16x16x32_bf16 v[96:99], a[64:67], a[8:11], v[96:99]
v_mfma_f32_16x16x32_bf16 v[96:99], a[68:71], a[24:27], v[96:99]
v_mfma_f32_16x16x32_bf16 v[100:103], a[68:71], a[28:31], v[100:103]
v_mfma_f32_16x16x32_bf16 v[100:103], a[64:67], a[12:15], v[100:103]
s_waitcnt lgkmcnt(4)
buffer_load_dwordx4 a[48:51], v5, s[16:19], s28 offen offset:3072 sc1
v_mfma_f32_16x16x32_bf16 v[116:119], a[72:75], a[12:15], v[116:119]
ds_read_b64_tr_b16 a[88:89], v16 offset:14432
v_mfma_f32_16x16x32_bf16 v[116:119], a[76:79], a[28:31], v[116:119]
ds_read_b64_tr_b16 a[90:91], v16 offset:18016
v_mfma_f32_16x16x32_bf16 v[112:115], a[76:79], a[24:27], v[112:115]
ds_read_b64_tr_b16 a[92:93], v16 offset:21600
v_mfma_f32_16x16x32_bf16 v[112:115], a[72:75], a[8:11], v[112:115]
ds_read_b64_tr_b16 a[94:95], v16 offset:25184
v_mfma_f32_16x16x32_bf16 v[108:111], a[72:75], a[4:7], v[108:111]
s_add_u32 m0, s26, 60416
v_mfma_f32_16x16x32_bf16 v[108:111], a[76:79], a[20:23], v[108:111]
buffer_load_dwordx4 v12, s[12:15], s27 offen lds
v_mfma_f32_16x16x32_bf16 v[104:107], a[76:79], a[16:19], v[104:107]
v_mfma_f32_16x16x32_bf16 v[104:107], a[72:75], a[0:3], v[104:107]
s_waitcnt lgkmcnt(4)
buffer_load_dwordx4 a[52:55], v6, s[16:19], s28 offen offset:3072 sc1
v_mfma_f32_16x16x32_bf16 v[120:123], a[80:83], a[0:3], v[120:123]
ds_read_b64_tr_b16 a[64:65], v16 offset:128
v_mfma_f32_16x16x32_bf16 v[120:123], a[84:87], a[16:19], v[120:123]
ds_read_b64_tr_b16 a[66:67], v16 offset:3712
v_mfma_f32_16x16x32_bf16 v[124:127], a[84:87], a[20:23], v[124:127]
ds_read_b64_tr_b16 a[68:69], v16 offset:7296
v_mfma_f32_16x16x32_bf16 v[124:127], a[80:83], a[4:7], v[124:127]
ds_read_b64_tr_b16 a[70:71], v16 offset:10880
v_mfma_f32_16x16x32_bf16 v[128:131], a[80:83], a[8:11], v[128:131]
s_add_u32 m0, s26, 61440
v_mfma_f32_16x16x32_bf16 v[128:131], a[84:87], a[24:27], v[128:131]
buffer_load_dwordx4 v13, s[12:15], s27 offen lds
v_mfma_f32_16x16x32_bf16 v[132:135], a[84:87], a[28:31], v[132:135]
v_mfma_f32_16x16x32_bf16 v[132:135], a[80:83], a[12:15], v[132:135]
s_waitcnt lgkmcnt(4)
buffer_load_dwordx4 a[56:59], v7, s[16:19], s28 offen offset:3072 sc1
v_mfma_f32_16x16x32_bf16 v[148:151], a[88:91], a[12:15], v[148:151]
ds_read_b64_tr_b16 a[72:73], v16 offset:14464
v_mfma_f32_16x16x32_bf16 v[148:151], a[92:95], a[28:31], v[148:151]
ds_read_b64_tr_b16 a[74:75], v16 offset:18048
v_mfma_f32_16x16x32_bf16 v[144:147], a[92:95], a[24:27], v[144:147]
ds_read_b64_tr_b16 a[76:77], v16 offset:21632
v_mfma_f32_16x16x32_bf16 v[144:147], a[88:91], a[8:11], v[144:147]
ds_read_b64_tr_b16 a[78:79], v16 offset:25216
v_mfma_f32_16x16x32_bf16 v[140:143], a[88:91], a[4:7], v[140:143]
v_mfma_f32_16x16x32_bf16 v[140:143], a[92:95], a[20:23], v[140:143]
v_mfma_f32_16x16x32_bf16 v[136:139], a[92:95], a[16:19], v[136:139]
v_mfma_f32_16x16x32_bf16 v[136:139], a[88:91], a[0:3], v[136:139]
s_waitcnt lgkmcnt(4)
buffer_load_dwordx4 a[60:63], v8, s[16:19], s28 offen offset:3072 sc1
s_add_u32 s28, s28, 4096
v_mfma_f32_16x16x32_bf16 v[152:155], a[64:67], a[0:3], v[152:155]
ds_read_b64_tr_b16 a[80:81], v16 offset:160
v_mfma_f32_16x16x32_bf16 v[152:155], a[68:71], a[16:19], v[152:155]
ds_read_b64_tr_b16 a[82:83], v16 offset:3744
v_mfma_f32_16x16x32_bf16 v[156:159], a[68:71], a[20:23], v[156:159]
ds_read_b64_tr_b16 a[84:85], v16 offset:7328
v_mfma_f32_16x16x32_bf16 v[156:159], a[64:67], a[4:7], v[156:159]
ds_read_b64_tr_b16 a[86:87], v16 offset:10912
v_mfma_f32_16x16x32_bf16 v[160:163], a[64:67], a[8:11], v[160:163]
s_add_u32 m0, s26, 62464
v_mfma_f32_16x16x32_bf16 v[160:163], a[68:71], a[24:27], v[160:163]
buffer_load_dwordx4 v14, s[12:15], s27 offen lds
v_mfma_f32_16x16x32_bf16 v[164:167], a[68:71], a[28:31], v[164:167]
v_mfma_f32_16x16x32_bf16 v[164:167], a[64:67], a[12:15], v[164:167]
s_waitcnt lgkmcnt(4)
v_mfma_f32_16x16x32_bf16 v[180:183], a[72:75], a[12:15], v[180:183]
ds_read_b64_tr_b16 a[88:89], v16 offset:14496
v_mfma_f32_16x16x32_bf16 v[180:183], a[76:79], a[28:31], v[180:183]
ds_read_b64_tr_b16 a[90:91], v16 offset:18080
v_mfma_f32_16x16x32_bf16 v[176:179], a[76:79], a[24:27], v[176:179]
ds_read_b64_tr_b16 a[92:93], v16 offset:21664
v_mfma_f32_16x16x32_bf16 v[176:179], a[72:75], a[8:11], v[176:179]
ds_read_b64_tr_b16 a[94:95], v16 offset:25248
v_mfma_f32_16x16x32_bf16 v[172:175], a[72:75], a[4:7], v[172:175]
v_mfma_f32_16x16x32_bf16 v[172:175], a[76:79], a[20:23], v[172:175]
v_mfma_f32_16x16x32_bf16 v[168:171], a[76:79], a[16:19], v[168:171]
v_mfma_f32_16x16x32_bf16 v[168:171], a[72:75], a[0:3], v[168:171]
s_waitcnt lgkmcnt(4)
v_mfma_f32_16x16x32_bf16 v[184:187], a[80:83], a[0:3], v[184:187]
ds_read_b64_tr_b16 a[64:65], v17 offset:0
v_mfma_f32_16x16x32_bf16 v[184:187], a[84:87], a[16:19], v[184:187]
ds_read_b64_tr_b16 a[66:67], v17 offset:3584
v_mfma_f32_16x16x32_bf16 v[188:191], a[84:87], a[20:23], v[188:191]
ds_read_b64_tr_b16 a[68:69], v17 offset:7168
v_mfma_f32_16x16x32_bf16 v[188:191], a[80:83], a[4:7], v[188:191]
ds_read_b64_tr_b16 a[70:71], v17 offset:10752
v_mfma_f32_16x16x32_bf16 v[192:195], a[80:83], a[8:11], v[192:195]
s_add_u32 m0, s26, 63488
v_mfma_f32_16x16x32_bf16 v[192:195], a[84:87], a[24:27], v[192:195]
buffer_load_dwordx4 v15, s[12:15], s27 offen lds
s_add_u32 s27, s27, 458752
v_mfma_f32_16x16x32_bf16 v[196:199], a[84:87], a[28:31], v[196:199]
v_mfma_f32_16x16x32_bf16 v[196:199], a[80:83], a[12:15], v[196:199]
s_waitcnt lgkmcnt(4)
v_mfma_f32_16x16x32_bf16 v[212:215], a[88:91], a[12:15], v[212:215]
ds_read_b64_tr_b16 a[72:73], v17 offset:14336
v_mfma_f32_16x16x32_bf16 v[212:215], a[92:95], a[28:31], v[212:215]
ds_read_b64_tr_b16 a[74:75], v17 offset:17920
v_mfma_f32_16x16x32_bf16 v[208:211], a[92:95], a[24:27], v[208:211]
ds_read_b64_tr_b16 a[76:77], v17 offset:21504
v_mfma_f32_16x16x32_bf16 v[208:211], a[88:91], a[8:11], v[208:211]
ds_read_b64_tr_b16 a[78:79], v17 offset:25088
v_mfma_f32_16x16x32_bf16 v[204:207], a[88:91], a[4:7], v[204:207]
v_mfma_f32_16x16x32_bf16 v[204:207], a[92:95], a[20:23], v[204:207]
v_mfma_f32_16x16x32_bf16 v[200:203], a[92:95], a[16:19], v[200:203]
v_mfma_f32_16x16x32_bf16 v[200:203], a[88:91], a[0:3], v[200:203]
s_waitcnt lgkmcnt(4)
v_mfma_f32_16x16x32_bf16 v[216:219], a[64:67], a[0:3], v[216:219]
s_waitcnt vmcnt(15)
s_barrier
ds_read_b64_tr_b16 a[80:81], v16 offset:28672
v_mfma_f32_16x16x32_bf16 v[216:219], a[68:71], a[16:19], v[216:219]
ds_read_b64_tr_b16 a[82:83], v16 offset:32256
v_mfma_f32_16x16x32_bf16 v[220:223], a[68:71], a[20:23], v[220:223]
ds_read_b64_tr_b16 a[84:85], v16 offset:35840
v_mfma_f32_16x16x32_bf16 v[220:223], a[64:67], a[4:7], v[220:223]
ds_read_b64_tr_b16 a[86:87], v16 offset:39424
v_mfma_f32_16x16x32_bf16 v[224:227], a[64:67], a[8:11], v[224:227]
v_mfma_f32_16x16x32_bf16 v[224:227], a[68:71], a[24:27], v[224:227]
v_mfma_f32_16x16x32_bf16 v[228:231], a[68:71], a[28:31], v[228:231]
v_mfma_f32_16x16x32_bf16 v[228:231], a[64:67], a[12:15], v[228:231]
s_waitcnt lgkmcnt(4)
v_mfma_f32_16x16x32_bf16 v[244:247], a[72:75], a[12:15], v[244:247]
ds_read_b64_tr_b16 a[88:89], v16 offset:43008
v_mfma_f32_16x16x32_bf16 v[244:247], a[76:79], a[28:31], v[244:247]
ds_read_b64_tr_b16 a[90:91], v16 offset:46592
v_mfma_f32_16x16x32_bf16 v[240:243], a[76:79], a[24:27], v[240:243]
ds_read_b64_tr_b16 a[92:93], v16 offset:50176
v_mfma_f32_16x16x32_bf16 v[240:243], a[72:75], a[8:11], v[240:243]
ds_read_b64_tr_b16 a[94:95], v16 offset:53760
v_mfma_f32_16x16x32_bf16 v[236:239], a[72:75], a[4:7], v[236:239]
v_mfma_f32_16x16x32_bf16 v[236:239], a[76:79], a[20:23], v[236:239]
v_mfma_f32_16x16x32_bf16 v[232:235], a[76:79], a[16:19], v[232:235]
v_mfma_f32_16x16x32_bf16 v[232:235], a[72:75], a[0:3], v[232:235]
s_waitcnt vmcnt(2) lgkmcnt(4)
v_mfma_f32_16x16x32_bf16 v[24:27], a[80:83], a[32:35], v[24:27]
ds_read_b64_tr_b16 a[64:65], v16 offset:28704
v_mfma_f32_16x16x32_bf16 v[24:27], a[84:87], a[48:51], v[24:27]
ds_read_b64_tr_b16 a[66:67], v16 offset:32288
v_mfma_f32_16x16x32_bf16 v[28:31], a[84:87], a[52:55], v[28:31]
ds_read_b64_tr_b16 a[68:69], v16 offset:35872
v_mfma_f32_16x16x32_bf16 v[28:31], a[80:83], a[36:39], v[28:31]
ds_read_b64_tr_b16 a[70:71], v16 offset:39456
v_mfma_f32_16x16x32_bf16 v[32:35], a[80:83], a[40:43], v[32:35]
s_add_u32 m0, s26, 86016
v_mfma_f32_16x16x32_bf16 v[32:35], a[84:87], a[56:59], v[32:35]
buffer_load_dwordx4 v9, s[12:15], s27 offen lds
v_mfma_f32_16x16x32_bf16 v[36:39], a[84:87], a[60:63], v[36:39]
v_mfma_f32_16x16x32_bf16 v[36:39], a[80:83], a[44:47], v[36:39]
s_waitcnt lgkmcnt(4)
buffer_load_dwordx4 a[0:3], v5, s[16:19], s28 offen offset:0 sc1
v_mfma_f32_16x16x32_bf16 v[52:55], a[88:91], a[44:47], v[52:55]
ds_read_b64_tr_b16 a[72:73], v16 offset:43040
v_mfma_f32_16x16x32_bf16 v[52:55], a[92:95], a[60:63], v[52:55]
ds_read_b64_tr_b16 a[74:75], v16 offset:46624
v_mfma_f32_16x16x32_bf16 v[48:51], a[92:95], a[56:59], v[48:51]
ds_read_b64_tr_b16 a[76:77], v16 offset:50208
v_mfma_f32_16x16x32_bf16 v[48:51], a[88:91], a[40:43], v[48:51]
ds_read_b64_tr_b16 a[78:79], v16 offset:53792
v_mfma_f32_16x16x32_bf16 v[44:47], a[88:91], a[36:39], v[44:47]
s_add_u32 m0, s26, 87040
v_mfma_f32_16x16x32_bf16 v[44:47], a[92:95], a[52:55], v[44:47]
buffer_load_dwordx4 v10, s[12:15], s27 offen lds
v_mfma_f32_16x16x32_bf16 v[40:43], a[92:95], a[48:51], v[40:43]
v_mfma_f32_16x16x32_bf16 v[40:43], a[88:91], a[32:35], v[40:43]
s_waitcnt lgkmcnt(4)
buffer_load_dwordx4 a[4:7], v6, s[16:19], s28 offen offset:0 sc1
v_mfma_f32_16x16x32_bf16 v[56:59], a[64:67], a[32:35], v[56:59]
ds_read_b64_tr_b16 a[80:81], v16 offset:28736
v_mfma_f32_16x16x32_bf16 v[56:59], a[68:71], a[48:51], v[56:59]
ds_read_b64_tr_b16 a[82:83], v16 offset:32320
v_mfma_f32_16x16x32_bf16 v[60:63], a[68:71], a[52:55], v[60:63]
ds_read_b64_tr_b16 a[84:85], v16 offset:35904
v_mfma_f32_16x16x32_bf16 v[60:63], a[64:67], a[36:39], v[60:63]
ds_read_b64_tr_b16 a[86:87], v16 offset:39488
v_mfma_f32_16x16x32_bf16 v[64:67], a[64:67], a[40:43], v[64:67]
v_mfma_f32_16x16x32_bf16 v[64:67], a[68:71], a[56:59], v[64:67]
v_mfma_f32_16x16x32_bf16 v[68:71], a[68:71], a[60:63], v[68:71]
v_mfma_f32_16x16x32_bf16 v[68:71], a[64:67], a[44:47], v[68:71]
s_waitcnt lgkmcnt(4)
buffer_load_dwordx4 a[8:11], v7, s[16:19], s28 offen offset:0 sc1
v_mfma_f32_16x16x32_bf16 v[84:87], a[72:75], a[44:47], v[84:87]
ds_read_b64_tr_b16 a[88:89], v16 offset:43072
v_mfma_f32_16x16x32_bf16 v[84:87], a[76:79], a[60:63], v[84:87]
ds_read_b64_tr_b16 a[90:91], v16 offset:46656
v_mfma_f32_16x16x32_bf16 v[80:83], a[76:79], a[56:59], v[80:83]
ds_read_b64_tr_b16 a[92:93], v16 offset:50240
v_mfma_f32_16x16x32_bf16 v[80:83], a[72:75], a[40:43], v[80:83]
ds_read_b64_tr_b16 a[94:95], v16 offset:53824
v_mfma_f32_16x16x32_bf16 v[76:79], a[72:75], a[36:39], v[76:79]
s_add_u32 m0, s26, 88064
v_mfma_f32_16x16x32_bf16 v[76:79], a[76:79], a[52:55], v[76:79]
buffer_load_dwordx4 v11, s[12:15], s27 offen lds
v_mfma_f32_16x16x32_bf16 v[72:75], a[76:79], a[48:51], v[72:75]
v_mfma_f32_16x16x32_bf16 v[72:75], a[72:75], a[32:35], v[72:75]
s_waitcnt lgkmcnt(4)
buffer_load_dwordx4 a[12:15], v8, s[16:19], s28 offen offset:0 sc1
v_mfma_f32_16x16x32_bf16 v[88:91], a[80:83], a[32:35], v[88:91]
ds_read_b64_tr_b16 a[64:65], v16 offset:28768
v_mfma_f32_16x16x32_bf16 v[88:91], a[84:87], a[48:51], v[88:91]
ds_read_b64_tr_b16 a[66:67], v16 offset:32352
v_mfma_f32_16x16x32_bf16 v[92:95], a[84:87], a[52:55], v[92:95]
ds_read_b64_tr_b16 a[68:69], v16 offset:35936
v_mfma_f32_16x16x32_bf16 v[92:95], a[80:83], a[36:39], v[92:95]
ds_read_b64_tr_b16 a[70:71], v16 offset:39520
v_mfma_f32_16x16x32_bf16 v[96:99], a[80:83], a[40:43], v[96:99]
v_mfma_f32_16x16x32_bf16 v[96:99], a[84:87], a[56:59], v[96:99]
v_mfma_f32_16x16x32_bf16 v[100:103], a[84:87], a[60:63], v[100:103]
v_mfma_f32_16x16x32_bf16 v[100:103], a[80:83], a[44:47], v[100:103]
s_waitcnt lgkmcnt(4)
buffer_load_dwordx4 a[16:19], v5, s[16:19], s28 offen offset:1024 sc1
v_mfma_f32_16x16x32_bf16 v[116:119], a[88:91], a[44:47], v[116:119]
ds_read_b64_tr_b16 a[72:73], v16 offset:43104
v_mfma_f32_16x16x32_bf16 v[116:119], a[92:95], a[60:63], v[116:119]
ds_read_b64_tr_b16 a[74:75], v16 offset:46688
v_mfma_f32_16x16x32_bf16 v[112:115], a[92:95], a[56:59], v[112:115]
ds_read_b64_tr_b16 a[76:77], v16 offset:50272
v_mfma_f32_16x16x32_bf16 v[112:115], a[88:91], a[40:43], v[112:115]
ds_read_b64_tr_b16 a[78:79], v16 offset:53856
v_mfma_f32_16x16x32_bf16 v[108:111], a[88:91], a[36:39], v[108:111]
s_add_u32 m0, s26, 89088
v_mfma_f32_16x16x32_bf16 v[108:111], a[92:95], a[52:55], v[108:111]
buffer_load_dwordx4 v12, s[12:15], s27 offen lds
v_mfma_f32_16x16x32_bf16 v[104:107], a[92:95], a[48:51], v[104:107]
v_mfma_f32_16x16x32_bf16 v[104:107], a[88:91], a[32:35], v[104:107]
s_waitcnt lgkmcnt(4)
buffer_load_dwordx4 a[20:23], v6, s[16:19], s28 offen offset:1024 sc1
v_mfma_f32_16x16x32_bf16 v[120:123], a[64:67], a[32:35], v[120:123]
ds_read_b64_tr_b16 a[80:81], v16 offset:28800
v_mfma_f32_16x16x32_bf16 v[120:123], a[68:71], a[48:51], v[120:123]
ds_read_b64_tr_b16 a[82:83], v16 offset:32384
v_mfma_f32_16x16x32_bf16 v[124:127], a[68:71], a[52:55], v[124:127]
ds_read_b64_tr_b16 a[84:85], v16 offset:35968
v_mfma_f32_16x16x32_bf16 v[124:127], a[64:67], a[36:39], v[124:127]
ds_read_b64_tr_b16 a[86:87], v16 offset:39552
v_mfma_f32_16x16x32_bf16 v[128:131], a[64:67], a[40:43], v[128:131]
s_add_u32 m0, s26, 90112
v_mfma_f32_16x16x32_bf16 v[128:131], a[68:71], a[56:59], v[128:131]
buffer_load_dwordx4 v13, s[12:15], s27 offen lds
v_mfma_f32_16x16x32_bf16 v[132:135], a[68:71], a[60:63], v[132:135]
v_mfma_f32_16x16x32_bf16 v[132:135], a[64:67], a[44:47], v[132:135]
s_waitcnt lgkmcnt(4)
buffer_load_dwordx4 a[24:27], v7, s[16:19], s28 offen offset:1024 sc1
v_mfma_f32_16x16x32_bf16 v[148:151], a[72:75], a[44:47], v[148:151]
ds_read_b64_tr_b16 a[88:89], v16 offset:43136
v_mfma_f32_16x16x32_bf16 v[148:151], a[76:79], a[60:63], v[148:151]
ds_read_b64_tr_b16 a[90:91], v16 offset:46720
v_mfma_f32_16x16x32_bf16 v[144:147], a[76:79], a[56:59], v[144:147]
ds_read_b64_tr_b16 a[92:93], v16 offset:50304
v_mfma_f32_16x16x32_bf16 v[144:147], a[72:75], a[40:43], v[144:147]
ds_read_b64_tr_b16 a[94:95], v16 offset:53888
v_mfma_f32_16x16x32_bf16 v[140:143], a[72:75], a[36:39], v[140:143]
v_mfma_f32_16x16x32_bf16 v[140:143], a[76:79], a[52:55], v[140:143]
v_mfma_f32_16x16x32_bf16 v[136:139], a[76:79], a[48:51], v[136:139]
v_mfma_f32_16x16x32_bf16 v[136:139], a[72:75], a[32:35], v[136:139]
s_waitcnt lgkmcnt(4)
buffer_load_dwordx4 a[28:31], v8, s[16:19], s28 offen offset:1024 sc1
v_mfma_f32_16x16x32_bf16 v[152:155], a[80:83], a[32:35], v[152:155]
ds_read_b64_tr_b16 a[64:65], v16 offset:28832
v_mfma_f32_16x16x32_bf16 v[152:155], a[84:87], a[48:51], v[152:155]
ds_read_b64_tr_b16 a[66:67], v16 offset:32416
v_mfma_f32_16x16x32_bf16 v[156:159], a[84:87], a[52:55], v[156:159]
ds_read_b64_tr_b16 a[68:69], v16 offset:36000
v_mfma_f32_16x16x32_bf16 v[156:159], a[80:83], a[36:39], v[156:159]
ds_read_b64_tr_b16 a[70:71], v16 offset:39584
v_mfma_f32_16x16x32_bf16 v[160:163], a[80:83], a[40:43], v[160:163]
s_add_u32 m0, s26, 91136
v_mfma_f32_16x16x32_bf16 v[160:163], a[84:87], a[56:59], v[160:163]
buffer_load_dwordx4 v14, s[12:15], s27 offen lds
v_mfma_f32_16x16x32_bf16 v[164:167], a[84:87], a[60:63], v[164:167]
v_mfma_f32_16x16x32_bf16 v[164:167], a[80:83], a[44:47], v[164:167]
s_waitcnt lgkmcnt(4)
v_mfma_f32_16x16x32_bf16 v[180:183], a[88:91], a[44:47], v[180:183]
ds_read_b64_tr_b16 a[72:73], v16 offset:43168
v_mfma_f32_16x16x32_bf16 v[180:183], a[92:95], a[60:63], v[180:183]
ds_read_b64_tr_b16 a[74:75], v16 offset:46752
v_mfma_f32_16x16x32_bf16 v[176:179], a[92:95], a[56:59], v[176:179]
ds_read_b64_tr_b16 a[76:77], v16 offset:50336
v_mfma_f32_16x16x32_bf16 v[176:179], a[88:91], a[40:43], v[176:179]
ds_read_b64_tr_b16 a[78:79], v16 offset:53920
v_mfma_f32_16x16x32_bf16 v[172:175], a[88:91], a[36:39], v[172:175]
v_mfma_f32_16x16x32_bf16 v[172:175], a[92:95], a[52:55], v[172:175]
v_mfma_f32_16x16x32_bf16 v[168:171], a[92:95], a[48:51], v[168:171]
v_mfma_f32_16x16x32_bf16 v[168:171], a[88:91], a[32:35], v[168:171]
s_waitcnt lgkmcnt(4)
v_mfma_f32_16x16x32_bf16 v[184:187], a[64:67], a[32:35], v[184:187]
ds_read_b64_tr_b16 a[80:81], v17 offset:28672
v_mfma_f32_16x16x32_bf16 v[184:187], a[68:71], a[48:51], v[184:187]
ds_read_b64_tr_b16 a[82:83], v17 offset:32256
v_mfma_f32_16x16x32_bf16 v[188:191], a[68:71], a[52:55], v[188:191]
ds_read_b64_tr_b16 a[84:85], v17 offset:35840
v_mfma_f32_16x16x32_bf16 v[188:191], a[64:67], a[36:39], v[188:191]
ds_read_b64_tr_b16 a[86:87], v17 offset:39424
v_mfma_f32_16x16x32_bf16 v[192:195], a[64:67], a[40:43], v[192:195]
s_add_u32 m0, s26, 92160
v_mfma_f32_16x16x32_bf16 v[192:195], a[68:71], a[56:59], v[192:195]
buffer_load_dwordx4 v15, s[12:15], s27 offen lds
s_add_u32 s27, s27, 458752
v_mfma_f32_16x16x32_bf16 v[196:199], a[68:71], a[60:63], v[196:199]
v_mfma_f32_16x16x32_bf16 v[196:199], a[64:67], a[44:47], v[196:199]
s_waitcnt lgkmcnt(4)
v_mfma_f32_16x16x32_bf16 v[212:215], a[72:75], a[44:47], v[212:215]
ds_read_b64_tr_b16 a[88:89], v17 offset:43008
v_mfma_f32_16x16x32_bf16 v[212:215], a[76:79], a[60:63], v[212:215]
ds_read_b64_tr_b16 a[90:91], v17 offset:46592
v_mfma_f32_16x16x32_bf16 v[208:211], a[76:79], a[56:59], v[208:211]
ds_read_b64_tr_b16 a[92:93], v17 offset:50176
v_mfma_f32_16x16x32_bf16 v[208:211], a[72:75], a[40:43], v[208:211]
ds_read_b64_tr_b16 a[94:95], v17 offset:53760
v_mfma_f32_16x16x32_bf16 v[204:207], a[72:75], a[36:39], v[204:207]
v_mfma_f32_16x16x32_bf16 v[204:207], a[76:79], a[52:55], v[204:207]
v_mfma_f32_16x16x32_bf16 v[200:203], a[76:79], a[48:51], v[200:203]
v_mfma_f32_16x16x32_bf16 v[200:203], a[72:75], a[32:35], v[200:203]
s_waitcnt lgkmcnt(4)
v_mfma_f32_16x16x32_bf16 v[216:219], a[80:83], a[32:35], v[216:219]
s_waitcnt vmcnt(15)
s_barrier
ds_read_b64_tr_b16 a[64:65], v18 offset:0
v_mfma_f32_16x16x32_bf16 v[216:219], a[84:87], a[48:51], v[216:219]
ds_read_b64_tr_b16 a[66:67], v18 offset:3584
v_mfma_f32_16x16x32_bf16 v[220:223], a[84:87], a[52:55], v[220:223]
ds_read_b64_tr_b16 a[68:69], v18 offset:7168
v_mfma_f32_16x16x32_bf16 v[220:223], a[80:83], a[36:39], v[220:223]
ds_read_b64_tr_b16 a[70:71], v18 offset:10752
v_mfma_f32_16x16x32_bf16 v[224:227], a[80:83], a[40:43], v[224:227]
v_mfma_f32_16x16x32_bf16 v[224:227], a[84:87], a[56:59], v[224:227]
v_mfma_f32_16x16x32_bf16 v[228:231], a[84:87], a[60:63], v[228:231]
v_mfma_f32_16x16x32_bf16 v[228:231], a[80:83], a[44:47], v[228:231]
s_waitcnt lgkmcnt(4)
v_mfma_f32_16x16x32_bf16 v[244:247], a[88:91], a[44:47], v[244:247]
ds_read_b64_tr_b16 a[72:73], v18 offset:14336
v_mfma_f32_16x16x32_bf16 v[244:247], a[92:95], a[60:63], v[244:247]
ds_read_b64_tr_b16 a[74:75], v18 offset:17920
v_mfma_f32_16x16x32_bf16 v[240:243], a[92:95], a[56:59], v[240:243]
ds_read_b64_tr_b16 a[76:77], v18 offset:21504
v_mfma_f32_16x16x32_bf16 v[240:243], a[88:91], a[40:43], v[240:243]
ds_read_b64_tr_b16 a[78:79], v18 offset:25088
v_mfma_f32_16x16x32_bf16 v[236:239], a[88:91], a[36:39], v[236:239]
v_mfma_f32_16x16x32_bf16 v[236:239], a[92:95], a[52:55], v[236:239]
v_mfma_f32_16x16x32_bf16 v[232:235], a[92:95], a[48:51], v[232:235]
v_mfma_f32_16x16x32_bf16 v[232:235], a[88:91], a[32:35], v[232:235]
s_waitcnt vmcnt(2) lgkmcnt(4)
v_mfma_f32_16x16x32_bf16 v[24:27], a[64:67], a[0:3], v[24:27]
ds_read_b64_tr_b16 a[80:81], v18 offset:32
v_mfma_f32_16x16x32_bf16 v[24:27], a[68:71], a[16:19], v[24:27]
ds_read_b64_tr_b16 a[82:83], v18 offset:3616
v_mfma_f32_16x16x32_bf16 v[28:31], a[68:71], a[20:23], v[28:31]
ds_read_b64_tr_b16 a[84:85], v18 offset:7200
v_mfma_f32_16x16x32_bf16 v[28:31], a[64:67], a[4:7], v[28:31]
ds_read_b64_tr_b16 a[86:87], v18 offset:10784
v_mfma_f32_16x16x32_bf16 v[32:35], a[64:67], a[8:11], v[32:35]
v_mfma_f32_16x16x32_bf16 v[32:35], a[68:71], a[24:27], v[32:35]
v_mfma_f32_16x16x32_bf16 v[36:39], a[68:71], a[28:31], v[36:39]
v_mfma_f32_16x16x32_bf16 v[36:39], a[64:67], a[12:15], v[36:39]
s_waitcnt lgkmcnt(4)
buffer_load_dwordx4 a[32:35], v5, s[16:19], s28 offen offset:2048 sc1
v_mfma_f32_16x16x32_bf16 v[52:55], a[72:75], a[12:15], v[52:55]
ds_read_b64_tr_b16 a[88:89], v18 offset:14368
v_mfma_f32_16x16x32_bf16 v[52:55], a[76:79], a[28:31], v[52:55]
ds_read_b64_tr_b16 a[90:91], v18 offset:17952
v_mfma_f32_16x16x32_bf16 v[48:51], a[76:79], a[24:27], v[48:51]
ds_read_b64_tr_b16 a[92:93], v18 offset:21536
v_mfma_f32_16x16x32_bf16 v[48:51], a[72:75], a[8:11], v[48:51]
ds_read_b64_tr_b16 a[94:95], v18 offset:25120
v_mfma_f32_16x16x32_bf16 v[44:47], a[72:75], a[4:7], v[44:47]
v_mfma_f32_16x16x32_bf16 v[44:47], a[76:79], a[20:23], v[44:47]
v_mfma_f32_16x16x32_bf16 v[40:43], a[76:79], a[16:19], v[40:43]
v_mfma_f32_16x16x32_bf16 v[40:43], a[72:75], a[0:3], v[40:43]
s_waitcnt lgkmcnt(4)
buffer_load_dwordx4 a[36:39], v6, s[16:19], s28 offen offset:2048 sc1
v_mfma_f32_16x16x32_bf16 v[56:59], a[80:83], a[0:3], v[56:59]
ds_read_b64_tr_b16 a[64:65], v18 offset:64
v_mfma_f32_16x16x32_bf16 v[56:59], a[84:87], a[16:19], v[56:59]
ds_read_b64_tr_b16 a[66:67], v18 offset:3648
v_mfma_f32_16x16x32_bf16 v[60:63], a[84:87], a[20:23], v[60:63]
ds_read_b64_tr_b16 a[68:69], v18 offset:7232
v_mfma_f32_16x16x32_bf16 v[60:63], a[80:83], a[4:7], v[60:63]
ds_read_b64_tr_b16 a[70:71], v18 offset:10816
v_mfma_f32_16x16x32_bf16 v[64:67], a[80:83], a[8:11], v[64:67]
v_mfma_f32_16x16x32_bf16 v[64:67], a[84:87], a[24:27], v[64:67]
v_mfma_f32_16x16x32_bf16 v[68:71], a[84:87], a[28:31], v[68:71]
v_mfma_f32_16x16x32_bf16 v[68:71], a[80:83], a[12:15], v[68:71]
s_waitcnt lgkmcnt(4)
buffer_load_dwordx4 a[40:43], v7, s[16:19], s28 offen offset:2048 sc1
v_mfma_f32_16x16x32_bf16 v[84:87], a[88:91], a[12:15], v[84:87]
ds_read_b64_tr_b16 a[72:73], v18 offset:14400
v_mfma_f32_16x16x32_bf16 v[84:87], a[92:95], a[28:31], v[84:87]
ds_read_b64_tr_b16 a[74:75], v18 offset:17984
v_mfma_f32_16x16x32_bf16 v[80:83], a[92:95], a[24:27], v[80:83]
ds_read_b64_tr_b16 a[76:77], v18 offset:21568
v_mfma_f32_16x16x32_bf16 v[80:83], a[88:91], a[8:11], v[80:83]
ds_read_b64_tr_b16 a[78:79], v18 offset:25152
v_mfma_f32_16x16x32_bf16 v[76:79], a[88:91], a[4:7], v[76:79]
v_mfma_f32_16x16x32_bf16 v[76:79], a[92:95], a[20:23], v[76:79]
v_mfma_f32_16x16x32_bf16 v[72:75], a[92:95], a[16:19], v[72:75]
v_mfma_f32_16x16x32_bf16 v[72:75], a[88:91], a[0:3], v[72:75]
s_waitcnt lgkmcnt(4)
buffer_load_dwordx4 a[44:47], v8, s[16:19], s28 offen offset:2048 sc1
v_mfma_f32_16x16x32_bf16 v[88:91], a[64:67], a[0:3], v[88:91]
ds_read_b64_tr_b16 a[80:81], v18 offset:96
v_mfma_f32_16x16x32_bf16 v[88:91], a[68:71], a[16:19], v[88:91]
ds_read_b64_tr_b16 a[82:83], v18 offset:3680
v_mfma_f32_16x16x32_bf16 v[92:95], a[68:71], a[20:23], v[92:95]
ds_read_b64_tr_b16 a[84:85], v18 offset:7264
v_mfma_f32_16x16x32_bf16 v[92:95], a[64:67], a[4:7], v[92:95]
ds_read_b64_tr_b16 a[86:87], v18 offset:10848
v_mfma_f32_16x16x32_bf16 v[96:99], a[64:67], a[8:11], v[96:99]
v_mfma_f32_16x16x32_bf16 v[96:99], a[68:71], a[24:27], v[96:99]
v_mfma_f32_16x16x32_bf16 v[100:103], a[68:71], a[28:31], v[100:103]
v_mfma_f32_16x16x32_bf16 v[100:103], a[64:67], a[12:15], v[100:103]
s_waitcnt lgkmcnt(4)
buffer_load_dwordx4 a[48:51], v5, s[16:19], s28 offen offset:3072 sc1
v_mfma_f32_16x16x32_bf16 v[116:119], a[72:75], a[12:15], v[116:119]
ds_read_b64_tr_b16 a[88:89], v18 offset:14432
v_mfma_f32_16x16x32_bf16 v[116:119], a[76:79], a[28:31], v[116:119]
ds_read_b64_tr_b16 a[90:91], v18 offset:18016
v_mfma_f32_16x16x32_bf16 v[112:115], a[76:79], a[24:27], v[112:115]
ds_read_b64_tr_b16 a[92:93], v18 offset:21600
v_mfma_f32_16x16x32_bf16 v[112:115], a[72:75], a[8:11], v[112:115]
ds_read_b64_tr_b16 a[94:95], v18 offset:25184
v_mfma_f32_16x16x32_bf16 v[108:111], a[72:75], a[4:7], v[108:111]
v_mfma_f32_16x16x32_bf16 v[108:111], a[76:79], a[20:23], v[108:111]
v_mfma_f32_16x16x32_bf16 v[104:107], a[76:79], a[16:19], v[104:107]
v_mfma_f32_16x16x32_bf16 v[104:107], a[72:75], a[0:3], v[104:107]
s_waitcnt lgkmcnt(4)
buffer_load_dwordx4 a[52:55], v6, s[16:19], s28 offen offset:3072 sc1
v_mfma_f32_16x16x32_bf16 v[120:123], a[80:83], a[0:3], v[120:123]
ds_read_b64_tr_b16 a[64:65], v18 offset:128
v_mfma_f32_16x16x32_bf16 v[120:123], a[84:87], a[16:19], v[120:123]
ds_read_b64_tr_b16 a[66:67], v18 offset:3712
v_mfma_f32_16x16x32_bf16 v[124:127], a[84:87], a[20:23], v[124:127]
ds_read_b64_tr_b16 a[68:69], v18 offset:7296
v_mfma_f32_16x16x32_bf16 v[124:127], a[80:83], a[4:7], v[124:127]
ds_read_b64_tr_b16 a[70:71], v18 offset:10880
v_mfma_f32_16x16x32_bf16 v[128:131], a[80:83], a[8:11], v[128:131]
v_mfma_f32_16x16x32_bf16 v[128:131], a[84:87], a[24:27], v[128:131]
v_mfma_f32_16x16x32_bf16 v[132:135], a[84:87], a[28:31], v[132:135]
v_mfma_f32_16x16x32_bf16 v[132:135], a[80:83], a[12:15], v[132:135]
s_waitcnt lgkmcnt(4)
buffer_load_dwordx4 a[56:59], v7, s[16:19], s28 offen offset:3072 sc1
v_mfma_f32_16x16x32_bf16 v[148:151], a[88:91], a[12:15], v[148:151]
ds_read_b64_tr_b16 a[72:73], v18 offset:14464
v_mfma_f32_16x16x32_bf16 v[148:151], a[92:95], a[28:31], v[148:151]
ds_read_b64_tr_b16 a[74:75], v18 offset:18048
v_mfma_f32_16x16x32_bf16 v[144:147], a[92:95], a[24:27], v[144:147]
ds_read_b64_tr_b16 a[76:77], v18 offset:21632
v_mfma_f32_16x16x32_bf16 v[144:147], a[88:91], a[8:11], v[144:147]
ds_read_b64_tr_b16 a[78:79], v18 offset:25216
v_mfma_f32_16x16x32_bf16 v[140:143], a[88:91], a[4:7], v[140:143]
v_mfma_f32_16x16x32_bf16 v[140:143], a[92:95], a[20:23], v[140:143]
v_mfma_f32_16x16x32_bf16 v[136:139], a[92:95], a[16:19], v[136:139]
v_mfma_f32_16x16x32_bf16 v[136:139], a[88:91], a[0:3], v[136:139]
s_waitcnt lgkmcnt(4)
buffer_load_dwordx4 a[60:63], v8, s[16:19], s28 offen offset:3072 sc1
s_add_u32 s28, s28, 4096
v_mfma_f32_16x16x32_bf16 v[152:155], a[64:67], a[0:3], v[152:155]
ds_read_b64_tr_b16 a[80:81], v18 offset:160
v_mfma_f32_16x16x32_bf16 v[152:155], a[68:71], a[16:19], v[152:155]
ds_read_b64_tr_b16 a[82:83], v18 offset:3744
v_mfma_f32_16x16x32_bf16 v[156:159], a[68:71], a[20:23], v[156:159]
ds_read_b64_tr_b16 a[84:85], v18 offset:7328
v_mfma_f32_16x16x32_bf16 v[156:159], a[64:67], a[4:7], v[156:159]
ds_read_b64_tr_b16 a[86:87], v18 offset:10912
v_mfma_f32_16x16x32_bf16 v[160:163], a[64:67], a[8:11], v[160:163]
v_mfma_f32_16x16x32_bf16 v[160:163], a[68:71], a[24:27], v[160:163]
v_mfma_f32_16x16x32_bf16 v[164:167], a[68:71], a[28:31], v[164:167]
v_mfma_f32_16x16x32_bf16 v[164:167], a[64:67], a[12:15], v[164:167]
s_waitcnt lgkmcnt(4)
v_mfma_f32_16x16x32_bf16 v[180:183], a[72:75], a[12:15], v[180:183]
ds_read_b64_tr_b16 a[88:89], v18 offset:14496
v_mfma_f32_16x16x32_bf16 v[180:183], a[76:79], a[28:31], v[180:183]
ds_read_b64_tr_b16 a[90:91], v18 offset:18080
v_mfma_f32_16x16x32_bf16 v[176:179], a[76:79], a[24:27], v[176:179]
ds_read_b64_tr_b16 a[92:93], v18 offset:21664
v_mfma_f32_16x16x32_bf16 v[176:179], a[72:75], a[8:11], v[176:179]
ds_read_b64_tr_b16 a[94:95], v18 offset:25248
v_mfma_f32_16x16x32_bf16 v[172:175], a[72:75], a[4:7], v[172:175]
v_mfma_f32_16x16x32_bf16 v[172:175], a[76:79], a[20:23], v[172:175]
v_mfma_f32_16x16x32_bf16 v[168:171], a[76:79], a[16:19], v[168:171]
v_mfma_f32_16x16x32_bf16 v[168:171], a[72:75], a[0:3], v[168:171]
s_waitcnt lgkmcnt(4)
v_mfma_f32_16x16x32_bf16 v[184:187], a[80:83], a[0:3], v[184:187]
ds_read_b64_tr_b16 a[64:65], v19 offset:0
v_mfma_f32_16x16x32_bf16 v[184:187], a[84:87], a[16:19], v[184:187]
ds_read_b64_tr_b16 a[66:67], v19 offset:3584
v_mfma_f32_16x16x32_bf16 v[188:191], a[84:87], a[20:23], v[188:191]
ds_read_b64_tr_b16 a[68:69], v19 offset:7168
v_mfma_f32_16x16x32_bf16 v[188:191], a[80:83], a[4:7], v[188:191]
ds_read_b64_tr_b16 a[70:71], v19 offset:10752
v_mfma_f32_16x16x32_bf16 v[192:195], a[80:83], a[8:11], v[192:195]
v_mfma_f32_16x16x32_bf16 v[192:195], a[84:87], a[24:27], v[192:195]
v_mfma_f32_16x16x32_bf16 v[196:199], a[84:87], a[28:31], v[196:199]
v_mfma_f32_16x16x32_bf16 v[196:199], a[80:83], a[12:15], v[196:199]
s_waitcnt lgkmcnt(4)
v_mfma_f32_16x16x32_bf16 v[212:215], a[88:91], a[12:15], v[212:215]
ds_read_b64_tr_b16 a[72:73], v19 offset:14336
v_mfma_f32_16x16x32_bf16 v[212:215], a[92:95], a[28:31], v[212:215]
ds_read_b64_tr_b16 a[74:75], v19 offset:17920
v_mfma_f32_16x16x32_bf16 v[208:211], a[92:95], a[24:27], v[208:211]
ds_read_b64_tr_b16 a[76:77], v19 offset:21504
v_mfma_f32_16x16x32_bf16 v[208:211], a[88:91], a[8:11], v[208:211]
ds_read_b64_tr_b16 a[78:79], v19 offset:25088
v_mfma_f32_16x16x32_bf16 v[204:207], a[88:91], a[4:7], v[204:207]
v_mfma_f32_16x16x32_bf16 v[204:207], a[92:95], a[20:23], v[204:207]
v_mfma_f32_16x16x32_bf16 v[200:203], a[92:95], a[16:19], v[200:203]
v_mfma_f32_16x16x32_bf16 v[200:203], a[88:91], a[0:3], v[200:203]
s_waitcnt lgkmcnt(4)
v_mfma_f32_16x16x32_bf16 v[216:219], a[64:67], a[0:3], v[216:219]
s_waitcnt vmcnt(8)
s_barrier
ds_read_b64_tr_b16 a[80:81], v18 offset:28672
v_mfma_f32_16x16x32_bf16 v[216:219], a[68:71], a[16:19], v[216:219]
ds_read_b64_tr_b16 a[82:83], v18 offset:32256
v_mfma_f32_16x16x32_bf16 v[220:223], a[68:71], a[20:23], v[220:223]
ds_read_b64_tr_b16 a[84:85], v18 offset:35840
v_mfma_f32_16x16x32_bf16 v[220:223], a[64:67], a[4:7], v[220:223]
ds_read_b64_tr_b16 a[86:87], v18 offset:39424
v_mfma_f32_16x16x32_bf16 v[224:227], a[64:67], a[8:11], v[224:227]
v_mfma_f32_16x16x32_bf16 v[224:227], a[68:71], a[24:27], v[224:227]
v_mfma_f32_16x16x32_bf16 v[228:231], a[68:71], a[28:31], v[228:231]
v_mfma_f32_16x16x32_bf16 v[228:231], a[64:67], a[12:15], v[228:231]
s_waitcnt lgkmcnt(4)
v_mfma_f32_16x16x32_bf16 v[244:247], a[72:75], a[12:15], v[244:247]
ds_read_b64_tr_b16 a[88:89], v18 offset:43008
v_mfma_f32_16x16x32_bf16 v[244:247], a[76:79], a[28:31], v[244:247]
ds_read_b64_tr_b16 a[90:91], v18 offset:46592
v_mfma_f32_16x16x32_bf16 v[240:243], a[76:79], a[24:27], v[240:243]
ds_read_b64_tr_b16 a[92:93], v18 offset:50176
v_mfma_f32_16x16x32_bf16 v[240:243], a[72:75], a[8:11], v[240:243]
ds_read_b64_tr_b16 a[94:95], v18 offset:53760
v_mfma_f32_16x16x32_bf16 v[236:239], a[72:75], a[4:7], v[236:239]
v_mfma_f32_16x16x32_bf16 v[236:239], a[76:79], a[20:23], v[236:239]
v_mfma_f32_16x16x32_bf16 v[232:235], a[76:79], a[16:19], v[232:235]
v_mfma_f32_16x16x32_bf16 v[232:235], a[72:75], a[0:3], v[232:235]
s_waitcnt vmcnt(0) lgkmcnt(4)
v_mfma_f32_16x16x32_bf16 v[24:27], a[80:83], a[32:35], v[24:27]
ds_read_b64_tr_b16 a[64:65], v18 offset:28704
v_mfma_f32_16x16x32_bf16 v[24:27], a[84:87], a[48:51], v[24:27]
ds_read_b64_tr_b16 a[66:67], v18 offset:32288
v_mfma_f32_16x16x32_bf16 v[28:31], a[84:87], a[52:55], v[28:31]
ds_read_b64_tr_b16 a[68:69], v18 offset:35872
v_mfma_f32_16x16x32_bf16 v[28:31], a[80:83], a[36:39], v[28:31]
ds_read_b64_tr_b16 a[70:71], v18 offset:39456
v_mfma_f32_16x16x32_bf16 v[32:35], a[80:83], a[40:43], v[32:35]
v_mfma_f32_16x16x32_bf16 v[32:35], a[84:87], a[56:59], v[32:35]
v_mfma_f32_16x16x32_bf16 v[36:39], a[84:87], a[60:63], v[36:39]
v_mfma_f32_16x16x32_bf16 v[36:39], a[80:83], a[44:47], v[36:39]
s_waitcnt lgkmcnt(4)
v_mfma_f32_16x16x32_bf16 v[52:55], a[88:91], a[44:47], v[52:55]
ds_read_b64_tr_b16 a[72:73], v18 offset:43040
v_mfma_f32_16x16x32_bf16 v[52:55], a[92:95], a[60:63], v[52:55]
ds_read_b64_tr_b16 a[74:75], v18 offset:46624
v_mfma_f32_16x16x32_bf16 v[48:51], a[92:95], a[56:59], v[48:51]
ds_read_b64_tr_b16 a[76:77], v18 offset:50208
v_mfma_f32_16x16x32_bf16 v[48:51], a[88:91], a[40:43], v[48:51]
ds_read_b64_tr_b16 a[78:79], v18 offset:53792
v_mfma_f32_16x16x32_bf16 v[44:47], a[88:91], a[36:39], v[44:47]
v_mfma_f32_16x16x32_bf16 v[44:47], a[92:95], a[52:55], v[44:47]
v_mfma_f32_16x16x32_bf16 v[40:43], a[92:95], a[48:51], v[40:43]
v_mfma_f32_16x16x32_bf16 v[40:43], a[88:91], a[32:35], v[40:43]
s_waitcnt lgkmcnt(4)
v_mfma_f32_16x16x32_bf16 v[56:59], a[64:67], a[32:35], v[56:59]
ds_read_b64_tr_b16 a[80:81], v18 offset:28736
v_mfma_f32_16x16x32_bf16 v[56:59], a[68:71], a[48:51], v[56:59]
ds_read_b64_tr_b16 a[82:83], v18 offset:32320
v_mfma_f32_16x16x32_bf16 v[60:63], a[68:71], a[52:55], v[60:63]
ds_read_b64_tr_b16 a[84:85], v18 offset:35904
v_mfma_f32_16x16x32_bf16 v[60:63], a[64:67], a[36:39], v[60:63]
ds_read_b64_tr_b16 a[86:87], v18 offset:39488
v_mfma_f32_16x16x32_bf16 v[64:67], a[64:67], a[40:43], v[64:67]
v_mfma_f32_16x16x32_bf16 v[64:67], a[68:71], a[56:59], v[64:67]
v_mfma_f32_16x16x32_bf16 v[68:71], a[68:71], a[60:63], v[68:71]
v_mfma_f32_16x16x32_bf16 v[68:71], a[64:67], a[44:47], v[68:71]
s_waitcnt lgkmcnt(4)
v_mfma_f32_16x16x32_bf16 v[84:87], a[72:75], a[44:47], v[84:87]
ds_read_b64_tr_b16 a[88:89], v18 offset:43072
v_mfma_f32_16x16x32_bf16 v[84:87], a[76:79], a[60:63], v[84:87]
ds_read_b64_tr_b16 a[90:91], v18 offset:46656
v_mfma_f32_16x16x32_bf16 v[80:83], a[76:79], a[56:59], v[80:83]
ds_read_b64_tr_b16 a[92:93], v18 offset:50240
v_mfma_f32_16x16x32_bf16 v[80:83], a[72:75], a[40:43], v[80:83]
ds_read_b64_tr_b16 a[94:95], v18 offset:53824
v_mfma_f32_16x16x32_bf16 v[76:79], a[72:75], a[36:39], v[76:79]
v_mfma_f32_16x16x32_bf16 v[76:79], a[76:79], a[52:55], v[76:79]
v_mfma_f32_16x16x32_bf16 v[72:75], a[76:79], a[48:51], v[72:75]
v_mfma_f32_16x16x32_bf16 v[72:75], a[72:75], a[32:35], v[72:75]
s_waitcnt lgkmcnt(4)
v_mfma_f32_16x16x32_bf16 v[88:91], a[80:83], a[32:35], v[88:91]
ds_read_b64_tr_b16 a[64:65], v18 offset:28768
v_mfma_f32_16x16x32_bf16 v[88:91], a[84:87], a[48:51], v[88:91]
ds_read_b64_tr_b16 a[66:67], v18 offset:32352
v_mfma_f32_16x16x32_bf16 v[92:95], a[84:87], a[52:55], v[92:95]
ds_read_b64_tr_b16 a[68:69], v18 offset:35936
v_mfma_f32_16x16x32_bf16 v[92:95], a[80:83], a[36:39], v[92:95]
ds_read_b64_tr_b16 a[70:71], v18 offset:39520
v_mfma_f32_16x16x32_bf16 v[96:99], a[80:83], a[40:43], v[96:99]
v_mfma_f32_16x16x32_bf16 v[96:99], a[84:87], a[56:59], v[96:99]
v_mfma_f32_16x16x32_bf16 v[100:103], a[84:87], a[60:63], v[100:103]
v_mfma_f32_16x16x32_bf16 v[100:103], a[80:83], a[44:47], v[100:103]
s_waitcnt lgkmcnt(4)
v_mfma_f32_16x16x32_bf16 v[116:119], a[88:91], a[44:47], v[116:119]
ds_read_b64_tr_b16 a[72:73], v18 offset:43104
v_mfma_f32_16x16x32_bf16 v[116:119], a[92:95], a[60:63], v[116:119]
ds_read_b64_tr_b16 a[74:75], v18 offset:46688
v_mfma_f32_16x16x32_bf16 v[112:115], a[92:95], a[56:59], v[112:115]
ds_read_b64_tr_b16 a[76:77], v18 offset:50272
v_mfma_f32_16x16x32_bf16 v[112:115], a[88:91], a[40:43], v[112:115]
ds_read_b64_tr_b16 a[78:79], v18 offset:53856
v_mfma_f32_16x16x32_bf16 v[108:111], a[88:91], a[36:39], v[108:111]
v_mfma_f32_16x16x32_bf16 v[108:111], a[92:95], a[52:55], v[108:111]
v_mfma_f32_16x16x32_bf16 v[104:107], a[92:95], a[48:51], v[104:107]
v_mfma_f32_16x16x32_bf16 v[104:107], a[88:91], a[32:35], v[104:107]
s_waitcnt lgkmcnt(4)
v_mfma_f32_16x16x32_bf16 v[120:123], a[64:67], a[32:35], v[120:123]
ds_read_b64_tr_b16 a[80:81], v18 offset:28800
v_mfma_f32_16x16x32_bf16 v[120:123], a[68:71], a[48:51], v[120:123]
ds_read_b64_tr_b16 a[82:83], v18 offset:32384
v_mfma_f32_16x16x32_bf16 v[124:127], a[68:71], a[52:55], v[124:127]
ds_read_b64_tr_b16 a[84:85], v18 offset:35968
v_mfma_f32_16x16x32_bf16 v[124:127], a[64:67], a[36:39], v[124:127]
ds_read_b64_tr_b16 a[86:87], v18 offset:39552
v_mfma_f32_16x16x32_bf16 v[128:131], a[64:67], a[40:43], v[128:131]
v_mfma_f32_16x16x32_bf16 v[128:131], a[68:71], a[56:59], v[128:131]
v_mfma_f32_16x16x32_bf16 v[132:135], a[68:71], a[60:63], v[132:135]
v_mfma_f32_16x16x32_bf16 v[132:135], a[64:67], a[44:47], v[132:135]
s_waitcnt lgkmcnt(4)
v_mfma_f32_16x16x32_bf16 v[148:151], a[72:75], a[44:47], v[148:151]
ds_read_b64_tr_b16 a[88:89], v18 offset:43136
v_mfma_f32_16x16x32_bf16 v[148:151], a[76:79], a[60:63], v[148:151]
ds_read_b64_tr_b16 a[90:91], v18 offset:46720
v_mfma_f32_16x16x32_bf16 v[144:147], a[76:79], a[56:59], v[144:147]
ds_read_b64_tr_b16 a[92:93], v18 offset:50304
v_mfma_f32_16x16x32_bf16 v[144:147], a[72:75], a[40:43], v[144:147]
ds_read_b64_tr_b16 a[94:95], v18 offset:53888
v_mfma_f32_16x16x32_bf16 v[140:143], a[72:75], a[36:39], v[140:143]
v_mfma_f32_16x16x32_bf16 v[140:143], a[76:79], a[52:55], v[140:143]
v_mfma_f32_16x16x32_bf16 v[136:139], a[76:79], a[48:51], v[136:139]
v_mfma_f32_16x16x32_bf16 v[136:139], a[72:75], a[32:35], v[136:139]
s_waitcnt lgkmcnt(4)
v_mfma_f32_16x16x32_bf16 v[152:155], a[80:83], a[32:35], v[152:155]
ds_read_b64_tr_b16 a[64:65], v18 offset:28832
v_mfma_f32_16x16x32_bf16 v[152:155], a[84:87], a[48:51], v[152:155]
ds_read_b64_tr_b16 a[66:67], v18 offset:32416
v_mfma_f32_16x16x32_bf16 v[156:159], a[84:87], a[52:55], v[156:159]
ds_read_b64_tr_b16 a[68:69], v18 offset:36000
v_mfma_f32_16x16x32_bf16 v[156:159], a[80:83], a[36:39], v[156:159]
ds_read_b64_tr_b16 a[70:71], v18 offset:39584
v_mfma_f32_16x16x32_bf16 v[160:163], a[80:83], a[40:43], v[160:163]
v_mfma_f32_16x16x32_bf16 v[160:163], a[84:87], a[56:59], v[160:163]
v_mfma_f32_16x16x32_bf16 v[164:167], a[84:87], a[60:63], v[164:167]
v_mfma_f32_16x16x32_bf16 v[164:167], a[80:83], a[44:47], v[164:167]
s_waitcnt lgkmcnt(4)
v_mfma_f32_16x16x32_bf16 v[180:183], a[88:91], a[44:47], v[180:183]
ds_read_b64_tr_b16 a[72:73], v18 offset:43168
v_mfma_f32_16x16x32_bf16 v[180:183], a[92:95], a[60:63], v[180:183]
ds_read_b64_tr_b16 a[74:75], v18 offset:46752
v_mfma_f32_16x16x32_bf16 v[176:179], a[92:95], a[56:59], v[176:179]
ds_read_b64_tr_b16 a[76:77], v18 offset:50336
v_mfma_f32_16x16x32_bf16 v[176:179], a[88:91], a[40:43], v[176:179]
ds_read_b64_tr_b16 a[78:79], v18 offset:53920
v_mfma_f32_16x16x32_bf16 v[172:175], a[88:91], a[36:39], v[172:175]
v_mfma_f32_16x16x32_bf16 v[172:175], a[92:95], a[52:55], v[172:175]
v_mfma_f32_16x16x32_bf16 v[168:171], a[92:95], a[48:51], v[168:171]
v_mfma_f32_16x16x32_bf16 v[168:171], a[88:91], a[32:35], v[168:171]
s_waitcnt lgkmcnt(4)
v_mfma_f32_16x16x32_bf16 v[184:187], a[64:67], a[32:35], v[184:187]
ds_read_b64_tr_b16 a[80:81], v19 offset:28672
v_mfma_f32_16x16x32_bf16 v[184:187], a[68:71], a[48:51], v[184:187]
ds_read_b64_tr_b16 a[82:83], v19 offset:32256
v_mfma_f32_16x16x32_bf16 v[188:191], a[68:71], a[52:55], v[188:191]
ds_read_b64_tr_b16 a[84:85], v19 offset:35840
v_mfma_f32_16x16x32_bf16 v[188:191], a[64:67], a[36:39], v[188:191]
ds_read_b64_tr_b16 a[86:87], v19 offset:39424
v_mfma_f32_16x16x32_bf16 v[192:195], a[64:67], a[40:43], v[192:195]
v_mfma_f32_16x16x32_bf16 v[192:195], a[68:71], a[56:59], v[192:195]
v_mfma_f32_16x16x32_bf16 v[196:199], a[68:71], a[60:63], v[196:199]
v_mfma_f32_16x16x32_bf16 v[196:199], a[64:67], a[44:47], v[196:199]
s_waitcnt lgkmcnt(4)
v_mfma_f32_16x16x32_bf16 v[212:215], a[72:75], a[44:47], v[212:215]
ds_read_b64_tr_b16 a[88:89], v19 offset:43008
v_mfma_f32_16x16x32_bf16 v[212:215], a[76:79], a[60:63], v[212:215]
ds_read_b64_tr_b16 a[90:91], v19 offset:46592
v_mfma_f32_16x16x32_bf16 v[208:211], a[76:79], a[56:59], v[208:211]
ds_read_b64_tr_b16 a[92:93], v19 offset:50176
v_mfma_f32_16x16x32_bf16 v[208:211], a[72:75], a[40:43], v[208:211]
ds_read_b64_tr_b16 a[94:95], v19 offset:53760
v_mfma_f32_16x16x32_bf16 v[204:207], a[72:75], a[36:39], v[204:207]
v_mfma_f32_16x16x32_bf16 v[204:207], a[76:79], a[52:55], v[204:207]
v_mfma_f32_16x16x32_bf16 v[200:203], a[76:79], a[48:51], v[200:203]
v_mfma_f32_16x16x32_bf16 v[200:203], a[72:75], a[32:35], v[200:203]
s_waitcnt lgkmcnt(4)
v_mfma_f32_16x16x32_bf16 v[216:219], a[80:83], a[32:35], v[216:219]
v_mfma_f32_16x16x32_bf16 v[216:219], a[84:87], a[48:51], v[216:219]
v_mfma_f32_16x16x32_bf16 v[220:223], a[84:87], a[52:55], v[220:223]
v_mfma_f32_16x16x32_bf16 v[220:223], a[80:83], a[36:39], v[220:223]
v_mfma_f32_16x16x32_bf16 v[224:227], a[80:83], a[40:43], v[224:227]
v_mfma_f32_16x16x32_bf16 v[224:227], a[84:87], a[56:59], v[224:227]
v_mfma_f32_16x16x32_bf16 v[228:231], a[84:87], a[60:63], v[228:231]
v_mfma_f32_16x16x32_bf16 v[228:231], a[80:83], a[44:47], v[228:231]
s_waitcnt lgkmcnt(0)
v_mfma_f32_16x16x32_bf16 v[244:247], a[88:91], a[44:47], v[244:247]
v_mfma_f32_16x16x32_bf16 v[244:247], a[92:95], a[60:63], v[244:247]
v_mfma_f32_16x16x32_bf16 v[240:243], a[92:95], a[56:59], v[240:243]
v_mfma_f32_16x16x32_bf16 v[240:243], a[88:91], a[40:43], v[240:243]
v_mfma_f32_16x16x32_bf16 v[236:239], a[88:91], a[36:39], v[236:239]
v_mfma_f32_16x16x32_bf16 v[236:239], a[92:95], a[52:55], v[236:239]
v_mfma_f32_16x16x32_bf16 v[232:235], a[92:95], a[48:51], v[232:235]
v_mfma_f32_16x16x32_bf16 v[232:235], a[88:91], a[32:35], v[232:235]
s_nop 7
s_mul_i32 s24, s22, 7
s_add_u32 s25, s24, s23
s_lshr_b32 s25, s25, 1
s_lshl_b32 s25, s25, 10
s_mul_i32 s37, s30, 114688
s_add_u32 s37, s37, 33619968
s_cmp_eq_u32 s23, 0
s_cselect_b32 s38, 6, 0
s_add_u32 s38, s38, s24
s_lshr_b32 s38, s38, 1
s_lshl_b32 s38, s38, 10
s_lshl_b32 s24, s23, 9
s_add_u32 s38, s38, s24
s_add_u32 s38, s38, s37
s_add_u32 s37, s37, s25
v_lshlrev_b32 v3, 3, v1
v_mov_b32 v6, 1.0
v_mov_b32 v7, 1.0
v_exp_f32 v24, -v24
v_exp_f32 v25, -v25
v_exp_f32 v26, -v26
v_exp_f32 v27, -v27
v_exp_f32 v56, -v56
v_exp_f32 v57, -v57
v_exp_f32 v58, -v58
v_exp_f32 v59, -v59
v_add_f32 v24, 1.0, v24
v_add_f32 v25, 1.0, v25
v_add_f32 v26, 1.0, v26
v_add_f32 v27, 1.0, v27
v_add_f32 v56, 1.0, v56
v_add_f32 v57, 1.0, v57
v_add_f32 v58, 1.0, v58
v_add_f32 v59, 1.0, v59
v_rcp_f32 v24, v24
v_rcp_f32 v25, v25
v_rcp_f32 v26, v26
v_rcp_f32 v27, v27
v_rcp_f32 v56, v56
v_rcp_f32 v57, v57
v_rcp_f32 v58, v58
v_rcp_f32 v59, v59
v_mul_f32 v24, v24, v40
v_mul_f32 v25, v25, v41
v_mul_f32 v26, v26, v42
v_mul_f32 v27, v27, v43
v_mul_f32 v56, v56, v72
v_mul_f32 v57, v57, v73
v_mul_f32 v58, v58, v74
v_mul_f32 v59, v59, v75
v_cvt_pk_bf16_f32 v40, v24, v25
v_cvt_pk_bf16_f32 v41, v26, v27
v_cvt_pk_bf16_f32 v42, v56, v57
v_cvt_pk_bf16_f32 v43, v58, v59
buffer_store_dwordx4 v[40:43], v2, s[16:19], s37 offen offset:0 sc1
v_exp_f32 v88, -v88
v_exp_f32 v89, -v89
v_exp_f32 v90, -v90
v_exp_f32 v91, -v91
v_exp_f32 v120, -v120
v_exp_f32 v121, -v121
v_exp_f32 v122, -v122
v_exp_f32 v123, -v123
v_add_f32 v88, 1.0, v88
v_add_f32 v89, 1.0, v89
v_add_f32 v90, 1.0, v90
v_add_f32 v91, 1.0, v91
v_add_f32 v120, 1.0, v120
v_add_f32 v121, 1.0, v121
v_add_f32 v122, 1.0, v122
v_add_f32 v123, 1.0, v123
v_rcp_f32 v88, v88
v_rcp_f32 v89, v89
v_rcp_f32 v90, v90
v_rcp_f32 v91, v91
v_rcp_f32 v120, v120
v_rcp_f32 v121, v121
v_rcp_f32 v122, v122
v_rcp_f32 v123, v123
v_mul_f32 v88, v88, v104
v_mul_f32 v89, v89, v105
v_mul_f32 v90, v90, v106
v_mul_f32 v91, v91, v107
v_mul_f32 v120, v120, v136
v_mul_f32 v121, v121, v137
v_mul_f32 v122, v122, v138
v_mul_f32 v123, v123, v139
v_cvt_pk_bf16_f32 v104, v88, v89
v_cvt_pk_bf16_f32 v105, v90, v91
v_cvt_pk_bf16_f32 v106, v120, v121
v_cvt_pk_bf16_f32 v107, v122, v123
buffer_store_dwordx4 v[104:107], v2, s[16:19], s37 offen offset:1024 sc1
v_exp_f32 v152, -v152
v_exp_f32 v153, -v153
v_exp_f32 v154, -v154
v_exp_f32 v155, -v155
v_exp_f32 v184, -v184
v_exp_f32 v185, -v185
v_exp_f32 v186, -v186
v_exp_f32 v187, -v187
v_add_f32 v152, 1.0, v152
v_add_f32 v153, 1.0, v153
v_add_f32 v154, 1.0, v154
v_add_f32 v155, 1.0, v155
v_add_f32 v184, 1.0, v184
v_add_f32 v185, 1.0, v185
v_add_f32 v186, 1.0, v186
v_add_f32 v187, 1.0, v187
v_rcp_f32 v152, v152
v_rcp_f32 v153, v153
v_rcp_f32 v154, v154
v_rcp_f32 v155, v155
v_rcp_f32 v184, v184
v_rcp_f32 v185, v185
v_rcp_f32 v186, v186
v_rcp_f32 v187, v187
v_mul_f32 v152, v152, v168
v_mul_f32 v153, v153, v169
v_mul_f32 v154, v154, v170
v_mul_f32 v155, v155, v171
v_mul_f32 v184, v184, v200
v_mul_f32 v185, v185, v201
v_mul_f32 v186, v186, v202
v_mul_f32 v187, v187, v203
v_cvt_pk_bf16_f32 v168, v152, v153
v_cvt_pk_bf16_f32 v169, v154, v155
v_cvt_pk_bf16_f32 v170, v184, v185
v_cvt_pk_bf16_f32 v171, v186, v187
buffer_store_dwordx4 v[168:171], v2, s[16:19], s37 offen offset:2048 sc1
v_exp_f32 v216, -v216
v_exp_f32 v217, -v217
v_exp_f32 v218, -v218
v_exp_f32 v219, -v219
v_add_f32 v216, 1.0, v216
v_add_f32 v217, 1.0, v217
v_add_f32 v218, 1.0, v218
v_add_f32 v219, 1.0, v219
v_rcp_f32 v216, v216
v_rcp_f32 v217, v217
v_rcp_f32 v218, v218
v_rcp_f32 v219, v219
v_mul_f32 v216, v216, v232
v_mul_f32 v217, v217, v233
v_mul_f32 v218, v218, v234
v_mul_f32 v219, v219, v235
v_cvt_pk_bf16_f32 v232, v216, v217
v_cvt_pk_bf16_f32 v233, v218, v219
buffer_store_dwordx2 v[232:233], v3, s[16:19], s38 offen sc1
s_add_u32 s37, s37, 114688
s_add_u32 s38, s38, 114688
v_exp_f32 v28, -v28
v_exp_f32 v29, -v29
v_exp_f32 v30, -v30
v_exp_f32 v31, -v31
v_exp_f32 v60, -v60
v_exp_f32 v61, -v61
v_exp_f32 v62, -v62
v_exp_f32 v63, -v63
v_add_f32 v28, 1.0, v28
v_add_f32 v29, 1.0, v29
v_add_f32 v30, 1.0, v30
v_add_f32 v31, 1.0, v31
v_add_f32 v60, 1.0, v60
v_add_f32 v61, 1.0, v61
v_add_f32 v62, 1.0, v62
v_add_f32 v63, 1.0, v63
v_rcp_f32 v28, v28
v_rcp_f32 v29, v29
v_rcp_f32 v30, v30
v_rcp_f32 v31, v31
v_rcp_f32 v60, v60
v_rcp_f32 v61, v61
v_rcp_f32 v62, v62
v_rcp_f32 v63, v63
v_mul_f32 v28, v28, v44
v_mul_f32 v29, v29, v45
v_mul_f32 v30, v30, v46
v_mul_f32 v31, v31, v47
v_mul_f32 v60, v60, v76
v_mul_f32 v61, v61, v77
v_mul_f32 v62, v62, v78
v_mul_f32 v63, v63, v79
v_cvt_pk_bf16_f32 v44, v28, v29
v_cvt_pk_bf16_f32 v45, v30, v31
v_cvt_pk_bf16_f32 v46, v60, v61
v_cvt_pk_bf16_f32 v47, v62, v63
buffer_store_dwordx4 v[44:47], v2, s[16:19], s37 offen offset:0 sc1
v_exp_f32 v92, -v92
v_exp_f32 v93, -v93
v_exp_f32 v94, -v94
v_exp_f32 v95, -v95
v_exp_f32 v124, -v124
v_exp_f32 v125, -v125
v_exp_f32 v126, -v126
v_exp_f32 v127, -v127
v_add_f32 v92, 1.0, v92
v_add_f32 v93, 1.0, v93
v_add_f32 v94, 1.0, v94
v_add_f32 v95, 1.0, v95
v_add_f32 v124, 1.0, v124
v_add_f32 v125, 1.0, v125
v_add_f32 v126, 1.0, v126
v_add_f32 v127, 1.0, v127
v_rcp_f32 v92, v92
v_rcp_f32 v93, v93
v_rcp_f32 v94, v94
v_rcp_f32 v95, v95
v_rcp_f32 v124, v124
v_rcp_f32 v125, v125
v_rcp_f32 v126, v126
v_rcp_f32 v127, v127
v_mul_f32 v92, v92, v108
v_mul_f32 v93, v93, v109
v_mul_f32 v94, v94, v110
v_mul_f32 v95, v95, v111
v_mul_f32 v124, v124, v140
v_mul_f32 v125, v125, v141
v_mul_f32 v126, v126, v142
v_mul_f32 v127, v127, v143
v_cvt_pk_bf16_f32 v108, v92, v93
v_cvt_pk_bf16_f32 v109, v94, v95
v_cvt_pk_bf16_f32 v110, v124, v125
v_cvt_pk_bf16_f32 v111, v126, v127
buffer_store_dwordx4 v[108:111], v2, s[16:19], s37 offen offset:1024 sc1
v_exp_f32 v156, -v156
v_exp_f32 v157, -v157
v_exp_f32 v158, -v158
v_exp_f32 v159, -v159
v_exp_f32 v188, -v188
v_exp_f32 v189, -v189
v_exp_f32 v190, -v190
v_exp_f32 v191, -v191
v_add_f32 v156, 1.0, v156
v_add_f32 v157, 1.0, v157
v_add_f32 v158, 1.0, v158
v_add_f32 v159, 1.0, v159
v_add_f32 v188, 1.0, v188
v_add_f32 v189, 1.0, v189
v_add_f32 v190, 1.0, v190
v_add_f32 v191, 1.0, v191
v_rcp_f32 v156, v156
v_rcp_f32 v157, v157
v_rcp_f32 v158, v158
v_rcp_f32 v159, v159
v_rcp_f32 v188, v188
v_rcp_f32 v189, v189
v_rcp_f32 v190, v190
v_rcp_f32 v191, v191
v_mul_f32 v156, v156, v172
v_mul_f32 v157, v157, v173
v_mul_f32 v158, v158, v174
v_mul_f32 v159, v159, v175
v_mul_f32 v188, v188, v204
v_mul_f32 v189, v189, v205
v_mul_f32 v190, v190, v206
v_mul_f32 v191, v191, v207
v_cvt_pk_bf16_f32 v172, v156, v157
v_cvt_pk_bf16_f32 v173, v158, v159
v_cvt_pk_bf16_f32 v174, v188, v189
v_cvt_pk_bf16_f32 v175, v190, v191
buffer_store_dwordx4 v[172:175], v2, s[16:19], s37 offen offset:2048 sc1
v_exp_f32 v220, -v220
v_exp_f32 v221, -v221
v_exp_f32 v222, -v222
v_exp_f32 v223, -v223
v_add_f32 v220, 1.0, v220
v_add_f32 v221, 1.0, v221
v_add_f32 v222, 1.0, v222
v_add_f32 v223, 1.0, v223
v_rcp_f32 v220, v220
v_rcp_f32 v221, v221
v_rcp_f32 v222, v222
v_rcp_f32 v223, v223
v_mul_f32 v220, v220, v236
v_mul_f32 v221, v221, v237
v_mul_f32 v222, v222, v238
v_mul_f32 v223, v223, v239
v_cvt_pk_bf16_f32 v236, v220, v221
v_cvt_pk_bf16_f32 v237, v222, v223
buffer_store_dwordx2 v[236:237], v3, s[16:19], s38 offen sc1
s_add_u32 s37, s37, 114688
s_add_u32 s38, s38, 114688
v_exp_f32 v32, -v32
v_exp_f32 v33, -v33
v_exp_f32 v34, -v34
v_exp_f32 v35, -v35
v_exp_f32 v64, -v64
v_exp_f32 v65, -v65
v_exp_f32 v66, -v66
v_exp_f32 v67, -v67
v_add_f32 v32, 1.0, v32
v_add_f32 v33, 1.0, v33
v_add_f32 v34, 1.0, v34
v_add_f32 v35, 1.0, v35
v_add_f32 v64, 1.0, v64
v_add_f32 v65, 1.0, v65
v_add_f32 v66, 1.0, v66
v_add_f32 v67, 1.0, v67
v_rcp_f32 v32, v32
v_rcp_f32 v33, v33
v_rcp_f32 v34, v34
v_rcp_f32 v35, v35
v_rcp_f32 v64, v64
v_rcp_f32 v65, v65
v_rcp_f32 v66, v66
v_rcp_f32 v67, v67
v_mul_f32 v32, v32, v48
v_mul_f32 v33, v33, v49
v_mul_f32 v34, v34, v50
v_mul_f32 v35, v35, v51
v_mul_f32 v64, v64, v80
v_mul_f32 v65, v65, v81
v_mul_f32 v66, v66, v82
v_mul_f32 v67, v67, v83
v_cvt_pk_bf16_f32 v48, v32, v33
v_cvt_pk_bf16_f32 v49, v34, v35
v_cvt_pk_bf16_f32 v50, v64, v65
v_cvt_pk_bf16_f32 v51, v66, v67
buffer_store_dwordx4 v[48:51], v2, s[16:19], s37 offen offset:0 sc1
v_exp_f32 v96, -v96
v_exp_f32 v97, -v97
v_exp_f32 v98, -v98
v_exp_f32 v99, -v99
v_exp_f32 v128, -v128
v_exp_f32 v129, -v129
v_exp_f32 v130, -v130
v_exp_f32 v131, -v131
v_add_f32 v96, 1.0, v96
v_add_f32 v97, 1.0, v97
v_add_f32 v98, 1.0, v98
v_add_f32 v99, 1.0, v99
v_add_f32 v128, 1.0, v128
v_add_f32 v129, 1.0, v129
v_add_f32 v130, 1.0, v130
v_add_f32 v131, 1.0, v131
v_rcp_f32 v96, v96
v_rcp_f32 v97, v97
v_rcp_f32 v98, v98
v_rcp_f32 v99, v99
v_rcp_f32 v128, v128
v_rcp_f32 v129, v129
v_rcp_f32 v130, v130
v_rcp_f32 v131, v131
v_mul_f32 v96, v96, v112
v_mul_f32 v97, v97, v113
v_mul_f32 v98, v98, v114
v_mul_f32 v99, v99, v115
v_mul_f32 v128, v128, v144
v_mul_f32 v129, v129, v145
v_mul_f32 v130, v130, v146
v_mul_f32 v131, v131, v147
v_cvt_pk_bf16_f32 v112, v96, v97
v_cvt_pk_bf16_f32 v113, v98, v99
v_cvt_pk_bf16_f32 v114, v128, v129
v_cvt_pk_bf16_f32 v115, v130, v131
buffer_store_dwordx4 v[112:115], v2, s[16:19], s37 offen offset:1024 sc1
v_exp_f32 v160, -v160
v_exp_f32 v161, -v161
v_exp_f32 v162, -v162
v_exp_f32 v163, -v163
v_exp_f32 v192, -v192
v_exp_f32 v193, -v193
v_exp_f32 v194, -v194
v_exp_f32 v195, -v195
v_add_f32 v160, 1.0, v160
v_add_f32 v161, 1.0, v161
v_add_f32 v162, 1.0, v162
v_add_f32 v163, 1.0, v163
v_add_f32 v192, 1.0, v192
v_add_f32 v193, 1.0, v193
v_add_f32 v194, 1.0, v194
v_add_f32 v195, 1.0, v195
v_rcp_f32 v160, v160
v_rcp_f32 v161, v161
v_rcp_f32 v162, v162
v_rcp_f32 v163, v163
v_rcp_f32 v192, v192
v_rcp_f32 v193, v193
v_rcp_f32 v194, v194
v_rcp_f32 v195, v195
v_mul_f32 v160, v160, v176
v_mul_f32 v161, v161, v177
v_mul_f32 v162, v162, v178
v_mul_f32 v163, v163, v179
v_mul_f32 v192, v192, v208
v_mul_f32 v193, v193, v209
v_mul_f32 v194, v194, v210
v_mul_f32 v195, v195, v211
v_cvt_pk_bf16_f32 v176, v160, v161
v_cvt_pk_bf16_f32 v177, v162, v163
v_cvt_pk_bf16_f32 v178, v192, v193
v_cvt_pk_bf16_f32 v179, v194, v195
buffer_store_dwordx4 v[176:179], v2, s[16:19], s37 offen offset:2048 sc1
v_exp_f32 v224, -v224
v_exp_f32 v225, -v225
v_exp_f32 v226, -v226
v_exp_f32 v227, -v227
v_add_f32 v224, 1.0, v224
v_add_f32 v225, 1.0, v225
v_add_f32 v226, 1.0, v226
v_add_f32 v227, 1.0, v227
v_rcp_f32 v224, v224
v_rcp_f32 v225, v225
v_rcp_f32 v226, v226
v_rcp_f32 v227, v227
v_mul_f32 v224, v224, v240
v_mul_f32 v225, v225, v241
v_mul_f32 v226, v226, v242
v_mul_f32 v227, v227, v243
v_cvt_pk_bf16_f32 v240, v224, v225
v_cvt_pk_bf16_f32 v241, v226, v227
buffer_store_dwordx2 v[240:241], v3, s[16:19], s38 offen sc1
s_add_u32 s37, s37, 114688
s_add_u32 s38, s38, 114688
v_exp_f32 v36, -v36
v_exp_f32 v37, -v37
v_exp_f32 v38, -v38
v_exp_f32 v39, -v39
v_exp_f32 v68, -v68
v_exp_f32 v69, -v69
v_exp_f32 v70, -v70
v_exp_f32 v71, -v71
v_add_f32 v36, 1.0, v36
v_add_f32 v37, 1.0, v37
v_add_f32 v38, 1.0, v38
v_add_f32 v39, 1.0, v39
v_add_f32 v68, 1.0, v68
v_add_f32 v69, 1.0, v69
v_add_f32 v70, 1.0, v70
v_add_f32 v71, 1.0, v71
v_rcp_f32 v36, v36
v_rcp_f32 v37, v37
v_rcp_f32 v38, v38
v_rcp_f32 v39, v39
v_rcp_f32 v68, v68
v_rcp_f32 v69, v69
v_rcp_f32 v70, v70
v_rcp_f32 v71, v71
v_mul_f32 v36, v36, v52
v_mul_f32 v37, v37, v53
v_mul_f32 v38, v38, v54
v_mul_f32 v39, v39, v55
v_mul_f32 v68, v68, v84
v_mul_f32 v69, v69, v85
v_mul_f32 v70, v70, v86
v_mul_f32 v71, v71, v87
v_cvt_pk_bf16_f32 v52, v36, v37
v_cvt_pk_bf16_f32 v53, v38, v39
v_cvt_pk_bf16_f32 v54, v68, v69
v_cvt_pk_bf16_f32 v55, v70, v71
buffer_store_dwordx4 v[52:55], v2, s[16:19], s37 offen offset:0 sc1
v_exp_f32 v100, -v100
v_exp_f32 v101, -v101
v_exp_f32 v102, -v102
v_exp_f32 v103, -v103
v_exp_f32 v132, -v132
v_exp_f32 v133, -v133
v_exp_f32 v134, -v134
v_exp_f32 v135, -v135
v_add_f32 v100, 1.0, v100
v_add_f32 v101, 1.0, v101
v_add_f32 v102, 1.0, v102
v_add_f32 v103, 1.0, v103
v_add_f32 v132, 1.0, v132
v_add_f32 v133, 1.0, v133
v_add_f32 v134, 1.0, v134
v_add_f32 v135, 1.0, v135
v_rcp_f32 v100, v100
v_rcp_f32 v101, v101
v_rcp_f32 v102, v102
v_rcp_f32 v103, v103
v_rcp_f32 v132, v132
v_rcp_f32 v133, v133
v_rcp_f32 v134, v134
v_rcp_f32 v135, v135
v_mul_f32 v100, v100, v116
v_mul_f32 v101, v101, v117
v_mul_f32 v102, v102, v118
v_mul_f32 v103, v103, v119
v_mul_f32 v132, v132, v148
v_mul_f32 v133, v133, v149
v_mul_f32 v134, v134, v150
v_mul_f32 v135, v135, v151
v_cvt_pk_bf16_f32 v116, v100, v101
v_cvt_pk_bf16_f32 v117, v102, v103
v_cvt_pk_bf16_f32 v118, v132, v133
v_cvt_pk_bf16_f32 v119, v134, v135
buffer_store_dwordx4 v[116:119], v2, s[16:19], s37 offen offset:1024 sc1
v_exp_f32 v164, -v164
v_exp_f32 v165, -v165
v_exp_f32 v166, -v166
v_exp_f32 v167, -v167
v_exp_f32 v196, -v196
v_exp_f32 v197, -v197
v_exp_f32 v198, -v198
v_exp_f32 v199, -v199
v_add_f32 v164, 1.0, v164
v_add_f32 v165, 1.0, v165
v_add_f32 v166, 1.0, v166
v_add_f32 v167, 1.0, v167
v_add_f32 v196, 1.0, v196
v_add_f32 v197, 1.0, v197
v_add_f32 v198, 1.0, v198
v_add_f32 v199, 1.0, v199
v_rcp_f32 v164, v164
v_rcp_f32 v165, v165
v_rcp_f32 v166, v166
v_rcp_f32 v167, v167
v_rcp_f32 v196, v196
v_rcp_f32 v197, v197
v_rcp_f32 v198, v198
v_rcp_f32 v199, v199
v_mul_f32 v164, v164, v180
v_mul_f32 v165, v165, v181
v_mul_f32 v166, v166, v182
v_mul_f32 v167, v167, v183
v_mul_f32 v196, v196, v212
v_mul_f32 v197, v197, v213
v_mul_f32 v198, v198, v214
v_mul_f32 v199, v199, v215
v_cvt_pk_bf16_f32 v180, v164, v165
v_cvt_pk_bf16_f32 v181, v166, v167
v_cvt_pk_bf16_f32 v182, v196, v197
v_cvt_pk_bf16_f32 v183, v198, v199
buffer_store_dwordx4 v[180:183], v2, s[16:19], s37 offen offset:2048 sc1
v_exp_f32 v228, -v228
v_exp_f32 v229, -v229
v_exp_f32 v230, -v230
v_exp_f32 v231, -v231
v_add_f32 v228, 1.0, v228
v_add_f32 v229, 1.0, v229
v_add_f32 v230, 1.0, v230
v_add_f32 v231, 1.0, v231
v_rcp_f32 v228, v228
v_rcp_f32 v229, v229
v_rcp_f32 v230, v230
v_rcp_f32 v231, v231
v_mul_f32 v228, v228, v244
v_mul_f32 v229, v229, v245
v_mul_f32 v230, v230, v246
v_mul_f32 v231, v231, v247
v_cvt_pk_bf16_f32 v244, v228, v229
v_cvt_pk_bf16_f32 v245, v230, v231
buffer_store_dwordx2 v[244:245], v3, s[16:19], s38 offen sc1
s_lshl_b32 s3, s21, 5
s_add_u32 s3, s3, s22
L_phase_dn:
s_barrier
s_load_dwordx2 s[4:5], s[0:1], 64
s_load_dwordx2 s[6:7], s[0:1], 104
s_load_dwordx2 s[8:9], s[0:1], 88
v_lshrrev_b32 v2, 6, v0
v_and_b32 v1, 63, v0
v_readfirstlane_b32 s24, v2
v_lshlrev_b32 v2, 4, v1
s_and_b32 s28, s2, 7
s_lshr_b32 s29, s2, 3
s_and_b32 s27, s28, 1
s_lshr_b32 s25, s28, 1
s_lshl_b32 s25, s25, 2
s_lshr_b32 s26, s29, 3
s_add_u32 s25, s25, s26
s_and_b32 s26, s29, 7
s_lshl_b32 s28, s24, 15
v_lshrrev_b32 v3, 4, v1
v_add_u32 v3, 0, v3
v_and_b32 v4, 7, v3
v_lshlrev_b32 v4, 1, v4
v_and_b32 v9, 15, v1
v_xor_b32 v4, v4, v9
v_lshlrev_b32 v3, 11, v3
v_lshl_add_u32 v3, v4, 4, v3
v_add_u32 v9, s28, v3
v_lshrrev_b32 v3, 4, v1
v_add_u32 v3, 4, v3
v_and_b32 v4, 7, v3
v_lshlrev_b32 v4, 1, v4
v_and_b32 v10, 15, v1
v_xor_b32 v4, v4, v10
v_lshlrev_b32 v3, 11, v3
v_lshl_add_u32 v3, v4, 4, v3
v_add_u32 v10, s28, v3
v_lshrrev_b32 v3, 4, v1
v_add_u32 v3, 8, v3
v_and_b32 v4, 7, v3
v_lshlrev_b32 v4, 1, v4
v_and_b32 v11, 15, v1
v_xor_b32 v4, v4, v11
v_lshlrev_b32 v3, 11, v3
v_lshl_add_u32 v3, v4, 4, v3
v_add_u32 v11, s28, v3
v_lshrrev_b32 v3, 4, v1
v_add_u32 v3, 12, v3
v_and_b32 v4, 7, v3
v_lshlrev_b32 v4, 1, v4
v_and_b32 v12, 15, v1
v_xor_b32 v4, v4, v12
v_lshlrev_b32 v3, 11, v3
v_lshl_add_u32 v3, v4, 4, v3
v_add_u32 v12, s28, v3
v_add_u32 v5, 0, v2
v_add_u32 v6, 114688, v2
v_lshlrev_b32 v7, 3, v1
v_add_u32 v8, 114688, v7
s_waitcnt lgkmcnt(0)
s_mov_b32 s12, s4
s_and_b32 s13, s5, 0xffff
s_mov_b32 s14, 0x700000
s_mov_b32 s15, 0x20000
s_mov_b32 s16, s6
s_and_b32 s17, s7, 0xffff
s_mov_b32 s18, 0x10000000
s_mov_b32 s19, 0x20000
s_mov_b32 s20, s8
s_and_b32 s21, s9, 0xffff
s_mov_b32 s22, 0x400000
s_mov_b32 s23, 0x20000
s_lshl_b32 s31, s24, 12
s_lshl_b32 s32, s26, 8
s_mul_i32 s28, s27, 3670016
s_add_u32 s32, s32, s28
s_lshl_b32 s30, s25, 3
s_lshl_b32 s28, s24, 1
s_add_u32 s30, s30, s28
s_mul_i32 s33, s30, 114688
s_mul_i32 s28, s27, 57344
s_add_u32 s33, s33, s28
s_add_u32 s33, s33, 33619968
s_waitcnt vmcnt(0)
s_barrier
s_lshl_b32 s28, s3, 7
s_add_u32 s28, s28, 57180160
s_cmp_lg_u32 s24, 0
s_cbranch_scc1 L_dnp_pubd
v_mov_b32 v3, 0
v_mov_b32 v4, 1
s_mov_b64 exec, 1
buffer_store_dword v4, v3, s[16:19], s28 offen sc1
s_mov_b64 exec, -1
L_dnp_pubd:
s_add_u32 m0, s31, 0
s_nop 0
buffer_load_dwordx4 v9, s[12:15], s32 offen lds
s_add_u32 m0, s31, 1024
s_nop 0
buffer_load_dwordx4 v10, s[12:15], s32 offen lds
s_add_u32 m0, s31, 2048
s_nop 0
buffer_load_dwordx4 v11, s[12:15], s32 offen lds
s_add_u32 m0, s31, 3072
s_nop 0
buffer_load_dwordx4 v12, s[12:15], s32 offen lds
s_add_u32 s32, s32, 131072
s_add_u32 m0, s31, 16384
s_nop 0
buffer_load_dwordx4 v9, s[12:15], s32 offen lds
s_add_u32 m0, s31, 17408
s_nop 0
buffer_load_dwordx4 v10, s[12:15], s32 offen lds
s_add_u32 m0, s31, 18432
s_nop 0
buffer_load_dwordx4 v11, s[12:15], s32 offen lds
s_add_u32 m0, s31, 19456
s_nop 0
buffer_load_dwordx4 v12, s[12:15], s32 offen lds
s_add_u32 s32, s32, 131072
s_add_u32 m0, s31, 32768
s_nop 0
buffer_load_dwordx4 v9, s[12:15], s32 offen lds
s_add_u32 m0, s31, 33792
s_nop 0
buffer_load_dwordx4 v10, s[12:15], s32 offen lds
s_add_u32 m0, s31, 34816
s_nop 0
buffer_load_dwordx4 v11, s[12:15], s32 offen lds
s_add_u32 m0, s31, 35840
s_nop 0
buffer_load_dwordx4 v12, s[12:15], s32 offen lds
s_add_u32 s32, s32, 131072
s_lshl_b32 s38, s27, 3
v_bfe_u32 v3, v1, 1, 1
v_add_u32 v3, 0, v3
v_xor_b32 v3, s38, v3
v_bfe_u32 v4, v1, 2, 3
v_lshlrev_b32 v4, 1, v4
v_xor_b32 v3, v3, v4
v_lshrrev_b32 v4, 2, v1
v_lshlrev_b32 v4, 8, v4
v_lshl_add_u32 v3, v3, 4, v4
v_and_b32 v4, 1, v1
v_lshl_add_u32 v13, v4, 3, v3
v_add_u32 v21, 0x10000, v13
v_bfe_u32 v3, v1, 1, 1
v_add_u32 v3, 2, v3
v_xor_b32 v3, s38, v3
v_bfe_u32 v4, v1, 2, 3
v_lshlrev_b32 v4, 1, v4
v_xor_b32 v3, v3, v4
v_lshrrev_b32 v4, 2, v1
v_lshlrev_b32 v4, 8, v4
v_lshl_add_u32 v3, v3, 4, v4
v_and_b32 v4, 1, v1
v_lshl_add_u32 v14, v4, 3, v3
v_add_u32 v22, 0x10000, v14
v_bfe_u32 v3, v1, 1, 1
v_add_u32 v3, 4, v3
v_xor_b32 v3, s38, v3
v_bfe_u32 v4, v1, 2, 3
v_lshlrev_b32 v4, 1, v4
v_xor_b32 v3, v3, v4
v_lshrrev_b32 v4, 2, v1
v_lshlrev_b32 v4, 8, v4
v_lshl_add_u32 v3, v3, 4, v4
v_and_b32 v4, 1, v1
v_lshl_add_u32 v15, v4, 3, v3
v_add_u32 v23, 0x10000, v15
v_bfe_u32 v3, v1, 1, 1
v_add_u32 v3, 6, v3
v_xor_b32 v3, s38, v3
v_bfe_u32 v4, v1, 2, 3
v_lshlrev_b32 v4, 1, v4
v_xor_b32 v3, v3, v4
v_lshrrev_b32 v4, 2, v1
v_lshlrev_b32 v4, 8, v4
v_lshl_add_u32 v3, v3, 4, v4
v_and_b32 v4, 1, v1
v_lshl_add_u32 v16, v4, 3, v3
v_add_u32 v24, 0x10000, v16
v_bfe_u32 v3, v1, 1, 1
v_add_u32 v3, 8, v3
v_xor_b32 v3, s38, v3
v_bfe_u32 v4, v1, 2, 3
v_lshlrev_b32 v4, 1, v4
v_xor_b32 v3, v3, v4
v_lshrrev_b32 v4, 2, v1
v_lshlrev_b32 v4, 8, v4
v_lshl_add_u32 v3, v3, 4, v4
v_and_b32 v4, 1, v1
v_lshl_add_u32 v17, v4, 3, v3
v_add_u32 v25, 0x10000, v17
v_bfe_u32 v3, v1, 1, 1
v_add_u32 v3, 10, v3
v_xor_b32 v3, s38, v3
v_bfe_u32 v4, v1, 2, 3
v_lshlrev_b32 v4, 1, v4
v_xor_b32 v3, v3, v4
v_lshrrev_b32 v4, 2, v1
v_lshlrev_b32 v4, 8, v4
v_lshl_add_u32 v3, v3, 4, v4
v_and_b32 v4, 1, v1
v_lshl_add_u32 v18, v4, 3, v3
v_add_u32 v26, 0x10000, v18
v_bfe_u32 v3, v1, 1, 1
v_add_u32 v3, 12, v3
v_xor_b32 v3, s38, v3
v_bfe_u32 v4, v1, 2, 3
v_lshlrev_b32 v4, 1, v4
v_xor_b32 v3, v3, v4
v_lshrrev_b32 v4, 2, v1
v_lshlrev_b32 v4, 8, v4
v_lshl_add_u32 v3, v3, 4, v4
v_and_b32 v4, 1, v1
v_lshl_add_u32 v19, v4, 3, v3
v_add_u32 v27, 0x10000, v19
v_bfe_u32 v3, v1, 1, 1
v_add_u32 v3, 14, v3
v_xor_b32 v3, s38, v3
v_bfe_u32 v4, v1, 2, 3
v_lshlrev_b32 v4, 1, v4
v_xor_b32 v3, v3, v4
v_lshrrev_b32 v4, 2, v1
v_lshlrev_b32 v4, 8, v4
v_lshl_add_u32 v3, v3, 4, v4
v_and_b32 v4, 1, v1
v_lshl_add_u32 v20, v4, 3, v3
v_add_u32 v28, 0x10000, v20
v_mov_b32 v32, 0
v_mov_b32 v33, 0
v_mov_b32 v34, 0
v_mov_b32 v35, 0
v_mov_b32 v36, 0
v_mov_b32 v37, 0
v_mov_b32 v38, 0
v_mov_b32 v39, 0
v_mov_b32 v40, 0
v_mov_b32 v41, 0
v_mov_b32 v42, 0
v_mov_b32 v43, 0
v_mov_b32 v44, 0
v_mov_b32 v45, 0
v_mov_b32 v46, 0
v_mov_b32 v47, 0
v_mov_b32 v48, 0
v_mov_b32 v49, 0
v_mov_b32 v50, 0
v_mov_b32 v51, 0
v_mov_b32 v52, 0
v_mov_b32 v53, 0
v_mov_b32 v54, 0
v_mov_b32 v55, 0
v_mov_b32 v56, 0
v_mov_b32 v57, 0
v_mov_b32 v58, 0
v_mov_b32 v59, 0
v_mov_b32 v60, 0
v_mov_b32 v61, 0
v_mov_b32 v62, 0
v_mov_b32 v63, 0
v_mov_b32 v64, 0
v_mov_b32 v65, 0
v_mov_b32 v66, 0
v_mov_b32 v67, 0
v_mov_b32 v68, 0
v_mov_b32 v69, 0
v_mov_b32 v70, 0
v_mov_b32 v71, 0
v_mov_b32 v72, 0
v_mov_b32 v73, 0
v_mov_b32 v74, 0
v_mov_b32 v75, 0
v_mov_b32 v76, 0
v_mov_b32 v77, 0
v_mov_b32 v78, 0
v_mov_b32 v79, 0
v_mov_b32 v80, 0
v_mov_b32 v81, 0
v_mov_b32 v82, 0
v_mov_b32 v83, 0
v_mov_b32 v84, 0
v_mov_b32 v85, 0
v_mov_b32 v86, 0
v_mov_b32 v87, 0
v_mov_b32 v88, 0
v_mov_b32 v89, 0
v_mov_b32 v90, 0
v_mov_b32 v91, 0
v_mov_b32 v92, 0
v_mov_b32 v93, 0
v_mov_b32 v94, 0
v_mov_b32 v95, 0
s_lshr_b32 s28, s25, 1
s_lshl_b32 s28, s28, 5
s_lshl_b32 s29, s27, 4
s_add_u32 s28, s28, s29
s_lshl_b32 s28, s28, 7
s_add_u32 s28, s28, 57180160
v_and_b32 v3, 15, v1
v_lshlrev_b32 v3, 7, v3
s_mov_b32 s29, 0x200000
L_dnw_aw:
buffer_load_dword v4, v3, s[16:19], s28 offen sc1
s_waitcnt vmcnt(0)
v_cmp_eq_u32 vcc, 0, v4
s_sub_u32 s29, s29, 1
s_cmp_eq_u32 s29, 0
s_cbranch_scc1 L_dnw_awd
s_cmp_lg_u64 vcc, 0
s_cbranch_scc1 L_dnw_aw
L_dnw_awd:
buffer_load_dwordx4 a[0:3], v5, s[16:19], s33 offen offset:0 sc1
s_nop 0
buffer_load_dwordx4 a[4:7], v6, s[16:19], s33 offen offset:0 sc1
buffer_load_dwordx4 a[8:11], v5, s[16:19], s33 offen offset:1024 sc1
buffer_load_dwordx4 a[12:15], v6, s[16:19], s33 offen offset:1024 sc1
buffer_load_dwordx4 a[16:19], v5, s[16:19], s33 offen offset:2048 sc1
buffer_load_dwordx4 a[20:23], v6, s[16:19], s33 offen offset:2048 sc1
buffer_load_dwordx2 a[24:25], v7, s[16:19], s33 offen offset:3072 sc1
buffer_load_dwordx2 a[26:27], v7, s[16:19], s33 offen offset:3584 sc1
buffer_load_dwordx2 a[28:29], v8, s[16:19], s33 offen offset:3072 sc1
buffer_load_dwordx2 a[30:31], v8, s[16:19], s33 offen offset:3584 sc1
s_add_u32 s33, s33, 4096
buffer_load_dwordx4 a[32:35], v5, s[16:19], s33 offen offset:0 sc1
buffer_load_dwordx4 a[36:39], v6, s[16:19], s33 offen offset:0 sc1
buffer_load_dwordx4 a[40:43], v5, s[16:19], s33 offen offset:1024 sc1
buffer_load_dwordx4 a[44:47], v6, s[16:19], s33 offen offset:1024 sc1
s_waitcnt lgkmcnt(0)
s_barrier
ds_read_b64_tr_b16 a[112:113], v13 offset:0
ds_read_b64_tr_b16 a[114:115], v13 offset:4096
ds_read_b64_tr_b16 a[116:117], v13 offset:8192
ds_read_b64_tr_b16 a[118:119], v13 offset:12288
ds_read_b64_tr_b16 a[120:121], v14 offset:0
ds_read_b64_tr_b16 a[122:123], v14 offset:4096
ds_read_b64_tr_b16 a[124:125], v14 offset:8192
ds_read_b64_tr_b16 a[126:127], v14 offset:12288
ds_read_b64_tr_b16 a[128:129], v15 offset:0
ds_read_b64_tr_b16 a[130:131], v15 offset:4096
ds_read_b64_tr_b16 a[132:133], v15 offset:8192
ds_read_b64_tr_b16 a[134:135], v15 offset:12288
s_waitcnt vmcnt(10) lgkmcnt(8)
s_mov_b32 s34, 1
L_dn_loop:
v_mfma_f32_16x16x32_bf16 v[32:35], a[112:115], a[0:3], v[32:35]
ds_read_b64_tr_b16 a[136:137], v16 offset:0
v_mfma_f32_16x16x32_bf16 v[32:35], a[116:119], a[8:11], v[32:35]
s_add_u32 m0, s31, 49152
ds_read_b64_tr_b16 a[138:139], v16 offset:4096
v_mfma_f32_16x16x32_bf16 v[36:39], a[116:119], a[12:15], v[36:39]
ds_read_b64_tr_b16 a[140:141], v16 offset:8192
buffer_load_dwordx4 v9, s[12:15], s32 offen lds
v_mfma_f32_16x16x32_bf16 v[36:39], a[112:115], a[4:7], v[36:39]
s_waitcnt lgkmcnt(7)
ds_read_b64_tr_b16 a[142:143], v16 offset:12288
buffer_load_dwordx4 a[48:51], v5, s[16:19], s33 offen offset:2048 sc1
v_mfma_f32_16x16x32_bf16 v[44:47], a[120:123], a[4:7], v[44:47]
ds_read_b64_tr_b16 a[112:113], v17 offset:0
v_mfma_f32_16x16x32_bf16 v[44:47], a[124:127], a[12:15], v[44:47]
s_add_u32 m0, s31, 50176
ds_read_b64_tr_b16 a[114:115], v17 offset:4096
v_mfma_f32_16x16x32_bf16 v[40:43], a[124:127], a[8:11], v[40:43]
ds_read_b64_tr_b16 a[116:117], v17 offset:8192
buffer_load_dwordx4 v10, s[12:15], s32 offen lds
v_mfma_f32_16x16x32_bf16 v[40:43], a[120:123], a[0:3], v[40:43]
s_waitcnt lgkmcnt(7)
ds_read_b64_tr_b16 a[118:119], v17 offset:12288
buffer_load_dwordx4 a[52:55], v6, s[16:19], s33 offen offset:2048 sc1
v_mfma_f32_16x16x32_bf16 v[48:51], a[128:131], a[0:3], v[48:51]
ds_read_b64_tr_b16 a[120:121], v18 offset:0
v_mfma_f32_16x16x32_bf16 v[48:51], a[132:135], a[8:11], v[48:51]
s_add_u32 m0, s31, 51200
ds_read_b64_tr_b16 a[122:123], v18 offset:4096
v_mfma_f32_16x16x32_bf16 v[52:55], a[132:135], a[12:15], v[52:55]
ds_read_b64_tr_b16 a[124:125], v18 offset:8192
buffer_load_dwordx4 v11, s[12:15], s32 offen lds
v_mfma_f32_16x16x32_bf16 v[52:55], a[128:131], a[4:7], v[52:55]
s_waitcnt lgkmcnt(7)
ds_read_b64_tr_b16 a[126:127], v18 offset:12288
buffer_load_dwordx4 a[56:59], v5, s[16:19], s33 offen offset:3072 sc1
v_mfma_f32_16x16x32_bf16 v[60:63], a[136:139], a[4:7], v[60:63]
ds_read_b64_tr_b16 a[128:129], v19 offset:0
v_mfma_f32_16x16x32_bf16 v[60:63], a[140:143], a[12:15], v[60:63]
s_add_u32 m0, s31, 52224
ds_read_b64_tr_b16 a[130:131], v19 offset:4096
v_mfma_f32_16x16x32_bf16 v[56:59], a[140:143], a[8:11], v[56:59]
ds_read_b64_tr_b16 a[132:133], v19 offset:8192
buffer_load_dwordx4 v12, s[12:15], s32 offen lds
s_add_u32 s32, s32, 131072
v_mfma_f32_16x16x32_bf16 v[56:59], a[136:139], a[0:3], v[56:59]
s_waitcnt lgkmcnt(7)
ds_read_b64_tr_b16 a[134:135], v19 offset:12288
buffer_load_dwordx4 a[60:63], v6, s[16:19], s33 offen offset:3072 sc1
s_add_u32 s33, s33, 4096
v_mfma_f32_16x16x32_bf16 v[64:67], a[112:115], a[0:3], v[64:67]
ds_read_b64_tr_b16 a[136:137], v20 offset:0
v_mfma_f32_16x16x32_bf16 v[64:67], a[116:119], a[8:11], v[64:67]
ds_read_b64_tr_b16 a[138:139], v20 offset:4096
v_mfma_f32_16x16x32_bf16 v[68:71], a[116:119], a[12:15], v[68:71]
ds_read_b64_tr_b16 a[140:141], v20 offset:8192
v_mfma_f32_16x16x32_bf16 v[68:71], a[112:115], a[4:7], v[68:71]
s_waitcnt lgkmcnt(7)
ds_read_b64_tr_b16 a[142:143], v20 offset:12288
v_mfma_f32_16x16x32_bf16 v[76:79], a[120:123], a[4:7], v[76:79]
s_barrier
ds_read_b64_tr_b16 a[112:113], v13 offset:16384
v_mfma_f32_16x16x32_bf16 v[76:79], a[124:127], a[12:15], v[76:79]
ds_read_b64_tr_b16 a[114:115], v13 offset:20480
v_mfma_f32_16x16x32_bf16 v[72:75], a[124:127], a[8:11], v[72:75]
ds_read_b64_tr_b16 a[116:117], v13 offset:24576
v_mfma_f32_16x16x32_bf16 v[72:75], a[120:123], a[0:3], v[72:75]
s_waitcnt lgkmcnt(7)
ds_read_b64_tr_b16 a[118:119], v13 offset:28672
v_mfma_f32_16x16x32_bf16 v[80:83], a[128:131], a[0:3], v[80:83]
ds_read_b64_tr_b16 a[120:121], v14 offset:16384
v_mfma_f32_16x16x32_bf16 v[80:83], a[132:135], a[8:11], v[80:83]
ds_read_b64_tr_b16 a[122:123], v14 offset:20480
v_mfma_f32_16x16x32_bf16 v[84:87], a[132:135], a[12:15], v[84:87]
ds_read_b64_tr_b16 a[124:125], v14 offset:24576
v_mfma_f32_16x16x32_bf16 v[84:87], a[128:131], a[4:7], v[84:87]
s_waitcnt lgkmcnt(7)
ds_read_b64_tr_b16 a[126:127], v14 offset:28672
v_mfma_f32_16x16x32_bf16 v[92:95], a[136:139], a[4:7], v[92:95]
ds_read_b64_tr_b16 a[128:129], v15 offset:16384
v_mfma_f32_16x16x32_bf16 v[92:95], a[140:143], a[12:15], v[92:95]
ds_read_b64_tr_b16 a[130:131], v15 offset:20480
v_mfma_f32_16x16x32_bf16 v[88:91], a[140:143], a[8:11], v[88:91]
ds_read_b64_tr_b16 a[132:133], v15 offset:24576
v_mfma_f32_16x16x32_bf16 v[88:91], a[136:139], a[0:3], v[88:91]
s_waitcnt vmcnt(12) lgkmcnt(7)
ds_read_b64_tr_b16 a[134:135], v15 offset:28672
v_mfma_f32_16x16x32_bf16 v[32:35], a[112:115], a[16:19], v[32:35]
ds_read_b64_tr_b16 a[136:137], v16 offset:16384
v_mfma_f32_16x16x32_bf16 v[32:35], a[116:119], a[24:27], v[32:35]
s_add_u32 m0, s31, 65536
ds_read_b64_tr_b16 a[138:139], v16 offset:20480
v_mfma_f32_16x16x32_bf16 v[36:39], a[116:119], a[28:31], v[36:39]
ds_read_b64_tr_b16 a[140:141], v16 offset:24576
buffer_load_dwordx4 v9, s[12:15], s32 offen lds
v_mfma_f32_16x16x32_bf16 v[36:39], a[112:115], a[20:23], v[36:39]
s_waitcnt lgkmcnt(7)
ds_read_b64_tr_b16 a[142:143], v16 offset:28672
buffer_load_dwordx4 a[64:67], v5, s[16:19], s33 offen offset:0 sc1
v_mfma_f32_16x16x32_bf16 v[44:47], a[120:123], a[20:23], v[44:47]
ds_read_b64_tr_b16 a[112:113], v17 offset:16384
v_mfma_f32_16x16x32_bf16 v[44:47], a[124:127], a[28:31], v[44:47]
s_add_u32 m0, s31, 66560
ds_read_b64_tr_b16 a[114:115], v17 offset:20480
v_mfma_f32_16x16x32_bf16 v[40:43], a[124:127], a[24:27], v[40:43]
ds_read_b64_tr_b16 a[116:117], v17 offset:24576
buffer_load_dwordx4 v10, s[12:15], s32 offen lds
v_mfma_f32_16x16x32_bf16 v[40:43], a[120:123], a[16:19], v[40:43]
s_waitcnt lgkmcnt(7)
ds_read_b64_tr_b16 a[118:119], v17 offset:28672
buffer_load_dwordx4 a[68:71], v6, s[16:19], s33 offen offset:0 sc1
v_mfma_f32_16x16x32_bf16 v[48:51], a[128:131], a[16:19], v[48:51]
ds_read_b64_tr_b16 a[120:121], v18 offset:16384
v_mfma_f32_16x16x32_bf16 v[48:51], a[132:135], a[24:27], v[48:51]
s_add_u32 m0, s31, 67584
ds_read_b64_tr_b16 a[122:123], v18 offset:20480
v_mfma_f32_16x16x32_bf16 v[52:55], a[132:135], a[28:31], v[52:55]
ds_read_b64_tr_b16 a[124:125], v18 offset:24576
buffer_load_dwordx4 v11, s[12:15], s32 offen lds
v_mfma_f32_16x16x32_bf16 v[52:55], a[128:131], a[20:23], v[52:55]
s_waitcnt lgkmcnt(7)
ds_read_b64_tr_b16 a[126:127], v18 offset:28672
buffer_load_dwordx4 a[72:75], v5, s[16:19], s33 offen offset:1024 sc1
v_mfma_f32_16x16x32_bf16 v[60:63], a[136:139], a[20:23], v[60:63]
ds_read_b64_tr_b16 a[128:129], v19 offset:16384
v_mfma_f32_16x16x32_bf16 v[60:63], a[140:143], a[28:31], v[60:63]
s_add_u32 m0, s31, 68608
ds_read_b64_tr_b16 a[130:131], v19 offset:20480
v_mfma_f32_16x16x32_bf16 v[56:59], a[140:143], a[24:27], v[56:59]
ds_read_b64_tr_b16 a[132:133], v19 offset:24576
buffer_load_dwordx4 v12, s[12:15], s32 offen lds
s_add_u32 s32, s32, 131072
v_mfma_f32_16x16x32_bf16 v[56:59], a[136:139], a[16:19], v[56:59]
s_waitcnt lgkmcnt(7)
ds_read_b64_tr_b16 a[134:135], v19 offset:28672
buffer_load_dwordx4 a[76:79], v6, s[16:19], s33 offen offset:1024 sc1
v_mfma_f32_16x16x32_bf16 v[64:67], a[112:115], a[16:19], v[64:67]
ds_read_b64_tr_b16 a[136:137], v20 offset:16384
v_mfma_f32_16x16x32_bf16 v[64:67], a[116:119], a[24:27], v[64:67]
ds_read_b64_tr_b16 a[138:139], v20 offset:20480
v_mfma_f32_16x16x32_bf16 v[68:71], a[116:119], a[28:31], v[68:71]
ds_read_b64_tr_b16 a[140:141], v20 offset:24576
v_mfma_f32_16x16x32_bf16 v[68:71], a[112:115], a[20:23], v[68:71]
s_waitcnt lgkmcnt(7)
ds_read_b64_tr_b16 a[142:143], v20 offset:28672
v_mfma_f32_16x16x32_bf16 v[76:79], a[120:123], a[20:23], v[76:79]
s_barrier
ds_read_b64_tr_b16 a[112:113], v13 offset:32768
v_mfma_f32_16x16x32_bf16 v[76:79], a[124:127], a[28:31], v[76:79]
ds_read_b64_tr_b16 a[114:115], v13 offset:36864
v_mfma_f32_16x16x32_bf16 v[72:75], a[124:127], a[24:27], v[72:75]
ds_read_b64_tr_b16 a[116:117], v13 offset:40960
v_mfma_f32_16x16x32_bf16 v[72:75], a[120:123], a[16:19], v[72:75]
s_waitcnt lgkmcnt(7)
ds_read_b64_tr_b16 a[118:119], v13 offset:45056
v_mfma_f32_16x16x32_bf16 v[80:83], a[128:131], a[16:19], v[80:83]
ds_read_b64_tr_b16 a[120:121], v14 offset:32768
v_mfma_f32_16x16x32_bf16 v[80:83], a[132:135], a[24:27], v[80:83]
ds_read_b64_tr_b16 a[122:123], v14 offset:36864
v_mfma_f32_16x16x32_bf16 v[84:87], a[132:135], a[28:31], v[84:87]
ds_read_b64_tr_b16 a[124:125], v14 offset:40960
v_mfma_f32_16x16x32_bf16 v[84:87], a[128:131], a[20:23], v[84:87]
s_waitcnt lgkmcnt(7)
ds_read_b64_tr_b16 a[126:127], v14 offset:45056
v_mfma_f32_16x16x32_bf16 v[92:95], a[136:139], a[20:23], v[92:95]
ds_read_b64_tr_b16 a[128:129], v15 offset:32768
v_mfma_f32_16x16x32_bf16 v[92:95], a[140:143], a[28:31], v[92:95]
ds_read_b64_tr_b16 a[130:131], v15 offset:36864
v_mfma_f32_16x16x32_bf16 v[88:91], a[140:143], a[24:27], v[88:91]
ds_read_b64_tr_b16 a[132:133], v15 offset:40960
v_mfma_f32_16x16x32_bf16 v[88:91], a[136:139], a[16:19], v[88:91]
s_waitcnt vmcnt(16) lgkmcnt(7)
ds_read_b64_tr_b16 a[134:135], v15 offset:45056
v_mfma_f32_16x16x32_bf16 v[32:35], a[112:115], a[32:35], v[32:35]
ds_read_b64_tr_b16 a[136:137], v16 offset:32768
v_mfma_f32_16x16x32_bf16 v[32:35], a[116:119], a[40:43], v[32:35]
s_add_u32 m0, s31, 81920
ds_read_b64_tr_b16 a[138:139], v16 offset:36864
v_mfma_f32_16x16x32_bf16 v[36:39], a[116:119], a[44:47], v[36:39]
ds_read_b64_tr_b16 a[140:141], v16 offset:40960
buffer_load_dwordx4 v9, s[12:15], s32 offen lds
v_mfma_f32_16x16x32_bf16 v[36:39], a[112:115], a[36:39], v[36:39]
s_waitcnt lgkmcnt(7)
ds_read_b64_tr_b16 a[142:143], v16 offset:45056
buffer_load_dwordx2 a[80:81], v7, s[16:19], s33 offen offset:2048 sc1
buffer_load_dwordx2 a[82:83], v7, s[16:19], s33 offen offset:2560 sc1
v_mfma_f32_16x16x32_bf16 v[44:47], a[120:123], a[36:39], v[44:47]
ds_read_b64_tr_b16 a[112:113], v17 offset:32768
v_mfma_f32_16x16x32_bf16 v[44:47], a[124:127], a[44:47], v[44:47]
s_add_u32 m0, s31, 82944
ds_read_b64_tr_b16 a[114:115], v17 offset:36864
v_mfma_f32_16x16x32_bf16 v[40:43], a[124:127], a[40:43], v[40:43]
ds_read_b64_tr_b16 a[116:117], v17 offset:40960
buffer_load_dwordx4 v10, s[12:15], s32 offen lds
v_mfma_f32_16x16x32_bf16 v[40:43], a[120:123], a[32:35], v[40:43]
s_waitcnt lgkmcnt(7)
ds_read_b64_tr_b16 a[118:119], v17 offset:45056
buffer_load_dwordx2 a[84:85], v8, s[16:19], s33 offen offset:2048 sc1
buffer_load_dwordx2 a[86:87], v8, s[16:19], s33 offen offset:2560 sc1
v_mfma_f32_16x16x32_bf16 v[48:51], a[128:131], a[32:35], v[48:51]
ds_read_b64_tr_b16 a[120:121], v18 offset:32768
v_mfma_f32_16x16x32_bf16 v[48:51], a[132:135], a[40:43], v[48:51]
s_add_u32 m0, s31, 83968
ds_read_b64_tr_b16 a[122:123], v18 offset:36864
v_mfma_f32_16x16x32_bf16 v[52:55], a[132:135], a[44:47], v[52:55]
ds_read_b64_tr_b16 a[124:125], v18 offset:40960
buffer_load_dwordx4 v11, s[12:15], s32 offen lds
v_mfma_f32_16x16x32_bf16 v[52:55], a[128:131], a[36:39], v[52:55]
s_waitcnt lgkmcnt(7)
ds_read_b64_tr_b16 a[126:127], v18 offset:45056
buffer_load_dwordx4 a[88:91], v5, s[16:19], s33 offen offset:3072 sc1
v_mfma_f32_16x16x32_bf16 v[60:63], a[136:139], a[36:39], v[60:63]
ds_read_b64_tr_b16 a[128:129], v19 offset:32768
v_mfma_f32_16x16x32_bf16 v[60:63], a[140:143], a[44:47], v[60:63]
s_add_u32 m0, s31, 84992
ds_read_b64_tr_b16 a[130:131], v19 offset:36864
v_mfma_f32_16x16x32_bf16 v[56:59], a[140:143], a[40:43], v[56:59]
ds_read_b64_tr_b16 a[132:133], v19 offset:40960
buffer_load_dwordx4 v12, s[12:15], s32 offen lds
s_add_u32 s32, s32, 131072
v_mfma_f32_16x16x32_bf16 v[56:59], a[136:139], a[32:35], v[56:59]
s_waitcnt lgkmcnt(7)
ds_read_b64_tr_b16 a[134:135], v19 offset:45056
buffer_load_dwordx4 a[92:95], v6, s[16:19], s33 offen offset:3072 sc1
s_add_u32 s33, s33, 4096
v_mfma_f32_16x16x32_bf16 v[64:67], a[112:115], a[32:35], v[64:67]
ds_read_b64_tr_b16 a[136:137], v20 offset:32768
v_mfma_f32_16x16x32_bf16 v[64:67], a[116:119], a[40:43], v[64:67]
ds_read_b64_tr_b16 a[138:139], v20 offset:36864
v_mfma_f32_16x16x32_bf16 v[68:71], a[116:119], a[44:47], v[68:71]
ds_read_b64_tr_b16 a[140:141], v20 offset:40960
v_mfma_f32_16x16x32_bf16 v[68:71], a[112:115], a[36:39], v[68:71]
s_waitcnt lgkmcnt(7)
ds_read_b64_tr_b16 a[142:143], v20 offset:45056
v_mfma_f32_16x16x32_bf16 v[76:79], a[120:123], a[36:39], v[76:79]
s_waitcnt vmcnt(19)
s_barrier
ds_read_b64_tr_b16 a[112:113], v13 offset:49152
v_mfma_f32_16x16x32_bf16 v[76:79], a[124:127], a[44:47], v[76:79]
ds_read_b64_tr_b16 a[114:115], v13 offset:53248
v_mfma_f32_16x16x32_bf16 v[72:75], a[124:127], a[40:43], v[72:75]
ds_read_b64_tr_b16 a[116:117], v13 offset:57344
v_mfma_f32_16x16x32_bf16 v[72:75], a[120:123], a[32:35], v[72:75]
s_waitcnt lgkmcnt(7)
ds_read_b64_tr_b16 a[118:119], v13 offset:61440
v_mfma_f32_16x16x32_bf16 v[80:83], a[128:131], a[32:35], v[80:83]
ds_read_b64_tr_b16 a[120:121], v14 offset:49152
v_mfma_f32_16x16x32_bf16 v[80:83], a[132:135], a[40:43], v[80:83]
ds_read_b64_tr_b16 a[122:123], v14 offset:53248
v_mfma_f32_16x16x32_bf16 v[84:87], a[132:135], a[44:47], v[84:87]
ds_read_b64_tr_b16 a[124:125], v14 offset:57344
v_mfma_f32_16x16x32_bf16 v[84:87], a[128:131], a[36:39], v[84:87]
s_waitcnt lgkmcnt(7)
ds_read_b64_tr_b16 a[126:127], v14 offset:61440
v_mfma_f32_16x16x32_bf16 v[92:95], a[136:139], a[36:39], v[92:95]
ds_read_b64_tr_b16 a[128:129], v15 offset:49152
v_mfma_f32_16x16x32_bf16 v[92:95], a[140:143], a[44:47], v[92:95]
ds_read_b64_tr_b16 a[130:131], v15 offset:53248
v_mfma_f32_16x16x32_bf16 v[88:91], a[140:143], a[40:43], v[88:91]
ds_read_b64_tr_b16 a[132:133], v15 offset:57344
v_mfma_f32_16x16x32_bf16 v[88:91], a[136:139], a[32:35], v[88:91]
s_waitcnt vmcnt(18) lgkmcnt(7)
ds_read_b64_tr_b16 a[134:135], v15 offset:61440
v_mfma_f32_16x16x32_bf16 v[32:35], a[112:115], a[48:51], v[32:35]
ds_read_b64_tr_b16 a[136:137], v16 offset:49152
v_mfma_f32_16x16x32_bf16 v[32:35], a[116:119], a[56:59], v[32:35]
s_add_u32 m0, s31, 98304
ds_read_b64_tr_b16 a[138:139], v16 offset:53248
v_mfma_f32_16x16x32_bf16 v[36:39], a[116:119], a[60:63], v[36:39]
ds_read_b64_tr_b16 a[140:141], v16 offset:57344
buffer_load_dwordx4 v9, s[12:15], s32 offen lds
v_mfma_f32_16x16x32_bf16 v[36:39], a[112:115], a[52:55], v[36:39]
s_waitcnt lgkmcnt(7)
ds_read_b64_tr_b16 a[142:143], v16 offset:61440
buffer_load_dwordx4 a[96:99], v5, s[16:19], s33 offen offset:0 sc1
v_mfma_f32_16x16x32_bf16 v[44:47], a[120:123], a[52:55], v[44:47]
ds_read_b64_tr_b16 a[112:113], v17 offset:49152
v_mfma_f32_16x16x32_bf16 v[44:47], a[124:127], a[60:63], v[44:47]
s_add_u32 m0, s31, 99328
ds_read_b64_tr_b16 a[114:115], v17 offset:53248
v_mfma_f32_16x16x32_bf16 v[40:43], a[124:127], a[56:59], v[40:43]
ds_read_b64_tr_b16 a[116:117], v17 offset:57344
buffer_load_dwordx4 v10, s[12:15], s32 offen lds
v_mfma_f32_16x16x32_bf16 v[40:43], a[120:123], a[48:51], v[40:43]
s_waitcnt lgkmcnt(7)
ds_read_b64_tr_b16 a[118:119], v17 offset:61440
buffer_load_dwordx4 a[100:103], v6, s[16:19], s33 offen offset:0 sc1
v_mfma_f32_16x16x32_bf16 v[48:51], a[128:131], a[48:51], v[48:51]
ds_read_b64_tr_b16 a[120:121], v18 offset:49152
v_mfma_f32_16x16x32_bf16 v[48:51], a[132:135], a[56:59], v[48:51]
s_add_u32 m0, s31, 100352
ds_read_b64_tr_b16 a[122:123], v18 offset:53248
v_mfma_f32_16x16x32_bf16 v[52:55], a[132:135], a[60:63], v[52:55]
ds_read_b64_tr_b16 a[124:125], v18 offset:57344
buffer_load_dwordx4 v11, s[12:15], s32 offen lds
v_mfma_f32_16x16x32_bf16 v[52:55], a[128:131], a[52:55], v[52:55]
s_waitcnt lgkmcnt(7)
ds_read_b64_tr_b16 a[126:127], v18 offset:61440
buffer_load_dwordx4 a[104:107], v5, s[16:19], s33 offen offset:1024 sc1
v_mfma_f32_16x16x32_bf16 v[60:63], a[136:139], a[52:55], v[60:63]
ds_read_b64_tr_b16 a[128:129], v19 offset:49152
v_mfma_f32_16x16x32_bf16 v[60:63], a[140:143], a[60:63], v[60:63]
s_add_u32 m0, s31, 101376
ds_read_b64_tr_b16 a[130:131], v19 offset:53248
v_mfma_f32_16x16x32_bf16 v[56:59], a[140:143], a[56:59], v[56:59]
ds_read_b64_tr_b16 a[132:133], v19 offset:57344
buffer_load_dwordx4 v12, s[12:15], s32 offen lds
s_add_u32 s32, s32, 131072
v_mfma_f32_16x16x32_bf16 v[56:59], a[136:139], a[48:51], v[56:59]
s_waitcnt lgkmcnt(7)
ds_read_b64_tr_b16 a[134:135], v19 offset:61440
buffer_load_dwordx4 a[108:111], v6, s[16:19], s33 offen offset:1024 sc1
v_mfma_f32_16x16x32_bf16 v[64:67], a[112:115], a[48:51], v[64:67]
ds_read_b64_tr_b16 a[136:137], v20 offset:49152
v_mfma_f32_16x16x32_bf16 v[64:67], a[116:119], a[56:59], v[64:67]
ds_read_b64_tr_b16 a[138:139], v20 offset:53248
v_mfma_f32_16x16x32_bf16 v[68:71], a[116:119], a[60:63], v[68:71]
ds_read_b64_tr_b16 a[140:141], v20 offset:57344
v_mfma_f32_16x16x32_bf16 v[68:71], a[112:115], a[52:55], v[68:71]
s_waitcnt lgkmcnt(7)
ds_read_b64_tr_b16 a[142:143], v20 offset:61440
v_mfma_f32_16x16x32_bf16 v[76:79], a[120:123], a[52:55], v[76:79]
s_waitcnt vmcnt(19)
s_barrier
ds_read_b64_tr_b16 a[112:113], v21 offset:0
v_mfma_f32_16x16x32_bf16 v[76:79], a[124:127], a[60:63], v[76:79]
ds_read_b64_tr_b16 a[114:115], v21 offset:4096
v_mfma_f32_16x16x32_bf16 v[72:75], a[124:127], a[56:59], v[72:75]
ds_read_b64_tr_b16 a[116:117], v21 offset:8192
v_mfma_f32_16x16x32_bf16 v[72:75], a[120:123], a[48:51], v[72:75]
s_waitcnt lgkmcnt(7)
ds_read_b64_tr_b16 a[118:119], v21 offset:12288
v_mfma_f32_16x16x32_bf16 v[80:83], a[128:131], a[48:51], v[80:83]
ds_read_b64_tr_b16 a[120:121], v22 offset:0
v_mfma_f32_16x16x32_bf16 v[80:83], a[132:135], a[56:59], v[80:83]
ds_read_b64_tr_b16 a[122:123], v22 offset:4096
v_mfma_f32_16x16x32_bf16 v[84:87], a[132:135], a[60:63], v[84:87]
ds_read_b64_tr_b16 a[124:125], v22 offset:8192
v_mfma_f32_16x16x32_bf16 v[84:87], a[128:131], a[52:55], v[84:87]
s_waitcnt lgkmcnt(7)
ds_read_b64_tr_b16 a[126:127], v22 offset:12288
v_mfma_f32_16x16x32_bf16 v[92:95], a[136:139], a[52:55], v[92:95]
ds_read_b64_tr_b16 a[128:129], v23 offset:0
v_mfma_f32_16x16x32_bf16 v[92:95], a[140:143], a[60:63], v[92:95]
ds_read_b64_tr_b16 a[130:131], v23 offset:4096
v_mfma_f32_16x16x32_bf16 v[88:91], a[140:143], a[56:59], v[88:91]
ds_read_b64_tr_b16 a[132:133], v23 offset:8192
v_mfma_f32_16x16x32_bf16 v[88:91], a[136:139], a[48:51], v[88:91]
s_waitcnt vmcnt(18) lgkmcnt(7)
ds_read_b64_tr_b16 a[134:135], v23 offset:12288
v_mfma_f32_16x16x32_bf16 v[32:35], a[112:115], a[64:67], v[32:35]
ds_read_b64_tr_b16 a[136:137], v24 offset:0
v_mfma_f32_16x16x32_bf16 v[32:35], a[116:119], a[72:75], v[32:35]
s_add_u32 m0, s31, 0
ds_read_b64_tr_b16 a[138:139], v24 offset:4096
v_mfma_f32_16x16x32_bf16 v[36:39], a[116:119], a[76:79], v[36:39]
ds_read_b64_tr_b16 a[140:141], v24 offset:8192
buffer_load_dwordx4 v9, s[12:15], s32 offen lds
v_mfma_f32_16x16x32_bf16 v[36:39], a[112:115], a[68:71], v[36:39]
s_waitcnt lgkmcnt(7)
ds_read_b64_tr_b16 a[142:143], v24 offset:12288
buffer_load_dwordx4 a[0:3], v5, s[16:19], s33 offen offset:2048 sc1
v_mfma_f32_16x16x32_bf16 v[44:47], a[120:123], a[68:71], v[44:47]
ds_read_b64_tr_b16 a[112:113], v25 offset:0
v_mfma_f32_16x16x32_bf16 v[44:47], a[124:127], a[76:79], v[44:47]
s_add_u32 m0, s31, 1024
ds_read_b64_tr_b16 a[114:115], v25 offset:4096
v_mfma_f32_16x16x32_bf16 v[40:43], a[124:127], a[72:75], v[40:43]
ds_read_b64_tr_b16 a[116:117], v25 offset:8192
buffer_load_dwordx4 v10, s[12:15], s32 offen lds
v_mfma_f32_16x16x32_bf16 v[40:43], a[120:123], a[64:67], v[40:43]
s_waitcnt lgkmcnt(7)
ds_read_b64_tr_b16 a[118:119], v25 offset:12288
buffer_load_dwordx4 a[4:7], v6, s[16:19], s33 offen offset:2048 sc1
v_mfma_f32_16x16x32_bf16 v[48:51], a[128:131], a[64:67], v[48:51]
ds_read_b64_tr_b16 a[120:121], v26 offset:0
v_mfma_f32_16x16x32_bf16 v[48:51], a[132:135], a[72:75], v[48:51]
s_add_u32 m0, s31, 2048
ds_read_b64_tr_b16 a[122:123], v26 offset:4096
v_mfma_f32_16x16x32_bf16 v[52:55], a[132:135], a[76:79], v[52:55]
ds_read_b64_tr_b16 a[124:125], v26 offset:8192
buffer_load_dwordx4 v11, s[12:15], s32 offen lds
v_mfma_f32_16x16x32_bf16 v[52:55], a[128:131], a[68:71], v[52:55]
s_waitcnt lgkmcnt(7)
ds_read_b64_tr_b16 a[126:127], v26 offset:12288
buffer_load_dwordx4 a[8:11], v5, s[16:19], s33 offen offset:3072 sc1
v_mfma_f32_16x16x32_bf16 v[60:63], a[136:139], a[68:71], v[60:63]
ds_read_b64_tr_b16 a[128:129], v27 offset:0
v_mfma_f32_16x16x32_bf16 v[60:63], a[140:143], a[76:79], v[60:63]
s_add_u32 m0, s31, 3072
ds_read_b64_tr_b16 a[130:131], v27 offset:4096
v_mfma_f32_16x16x32_bf16 v[56:59], a[140:143], a[72:75], v[56:59]
ds_read_b64_tr_b16 a[132:133], v27 offset:8192
buffer_load_dwordx4 v12, s[12:15], s32 offen lds
s_add_u32 s32, s32, 131072
v_mfma_f32_16x16x32_bf16 v[56:59], a[136:139], a[64:67], v[56:59]
s_waitcnt lgkmcnt(7)
ds_read_b64_tr_b16 a[134:135], v27 offset:12288
buffer_load_dwordx4 a[12:15], v6, s[16:19], s33 offen offset:3072 sc1
s_add_u32 s33, s33, 4096
v_mfma_f32_16x16x32_bf16 v[64:67], a[112:115], a[64:67], v[64:67]
ds_read_b64_tr_b16 a[136:137], v28 offset:0
v_mfma_f32_16x16x32_bf16 v[64:67], a[116:119], a[72:75], v[64:67]
ds_read_b64_tr_b16 a[138:139], v28 offset:4096
v_mfma_f32_16x16x32_bf16 v[68:71], a[116:119], a[76:79], v[68:71]
ds_read_b64_tr_b16 a[140:141], v28 offset:8192
v_mfma_f32_16x16x32_bf16 v[68:71], a[112:115], a[68:71], v[68:71]
s_waitcnt lgkmcnt(7)
ds_read_b64_tr_b16 a[142:143], v28 offset:12288
v_mfma_f32_16x16x32_bf16 v[76:79], a[120:123], a[68:71], v[76:79]
s_waitcnt vmcnt(17)
s_barrier
ds_read_b64_tr_b16 a[112:113], v21 offset:16384
v_mfma_f32_16x16x32_bf16 v[76:79], a[124:127], a[76:79], v[76:79]
ds_read_b64_tr_b16 a[114:115], v21 offset:20480
v_mfma_f32_16x16x32_bf16 v[72:75], a[124:127], a[72:75], v[72:75]
ds_read_b64_tr_b16 a[116:117], v21 offset:24576
v_mfma_f32_16x16x32_bf16 v[72:75], a[120:123], a[64:67], v[72:75]
s_waitcnt lgkmcnt(7)
ds_read_b64_tr_b16 a[118:119], v21 offset:28672
v_mfma_f32_16x16x32_bf16 v[80:83], a[128:131], a[64:67], v[80:83]
ds_read_b64_tr_b16 a[120:121], v22 offset:16384
v_mfma_f32_16x16x32_bf16 v[80:83], a[132:135], a[72:75], v[80:83]
ds_read_b64_tr_b16 a[122:123], v22 offset:20480
v_mfma_f32_16x16x32_bf16 v[84:87], a[132:135], a[76:79], v[84:87]
ds_read_b64_tr_b16 a[124:125], v22 offset:24576
v_mfma_f32_16x16x32_bf16 v[84:87], a[128:131], a[68:71], v[84:87]
s_waitcnt lgkmcnt(7)
ds_read_b64_tr_b16 a[126:127], v22 offset:28672
v_mfma_f32_16x16x32_bf16 v[92:95], a[136:139], a[68:71], v[92:95]
ds_read_b64_tr_b16 a[128:129], v23 offset:16384
v_mfma_f32_16x16x32_bf16 v[92:95], a[140:143], a[76:79], v[92:95]
ds_read_b64_tr_b16 a[130:131], v23 offset:20480
v_mfma_f32_16x16x32_bf16 v[88:91], a[140:143], a[72:75], v[88:91]
ds_read_b64_tr_b16 a[132:133], v23 offset:24576
v_mfma_f32_16x16x32_bf16 v[88:91], a[136:139], a[64:67], v[88:91]
s_waitcnt vmcnt(16) lgkmcnt(7)
ds_read_b64_tr_b16 a[134:135], v23 offset:28672
v_mfma_f32_16x16x32_bf16 v[32:35], a[112:115], a[80:83], v[32:35]
ds_read_b64_tr_b16 a[136:137], v24 offset:16384
v_mfma_f32_16x16x32_bf16 v[32:35], a[116:119], a[88:91], v[32:35]
s_add_u32 m0, s31, 16384
ds_read_b64_tr_b16 a[138:139], v24 offset:20480
v_mfma_f32_16x16x32_bf16 v[36:39], a[116:119], a[92:95], v[36:39]
ds_read_b64_tr_b16 a[140:141], v24 offset:24576
buffer_load_dwordx4 v9, s[12:15], s32 offen lds
v_mfma_f32_16x16x32_bf16 v[36:39], a[112:115], a[84:87], v[36:39]
s_waitcnt lgkmcnt(7)
ds_read_b64_tr_b16 a[142:143], v24 offset:28672
buffer_load_dwordx4 a[16:19], v5, s[16:19], s33 offen offset:0 sc1
v_mfma_f32_16x16x32_bf16 v[44:47], a[120:123], a[84:87], v[44:47]
ds_read_b64_tr_b16 a[112:113], v25 offset:16384
v_mfma_f32_16x16x32_bf16 v[44:47], a[124:127], a[92:95], v[44:47]
s_add_u32 m0, s31, 17408
ds_read_b64_tr_b16 a[114:115], v25 offset:20480
v_mfma_f32_16x16x32_bf16 v[40:43], a[124:127], a[88:91], v[40:43]
ds_read_b64_tr_b16 a[116:117], v25 offset:24576
buffer_load_dwordx4 v10, s[12:15], s32 offen lds
v_mfma_f32_16x16x32_bf16 v[40:43], a[120:123], a[80:83], v[40:43]
s_waitcnt lgkmcnt(7)
ds_read_b64_tr_b16 a[118:119], v25 offset:28672
buffer_load_dwordx4 a[20:23], v6, s[16:19], s33 offen offset:0 sc1
v_mfma_f32_16x16x32_bf16 v[48:51], a[128:131], a[80:83], v[48:51]
ds_read_b64_tr_b16 a[120:121], v26 offset:16384
v_mfma_f32_16x16x32_bf16 v[48:51], a[132:135], a[88:91], v[48:51]
s_add_u32 m0, s31, 18432
ds_read_b64_tr_b16 a[122:123], v26 offset:20480
v_mfma_f32_16x16x32_bf16 v[52:55], a[132:135], a[92:95], v[52:55]
ds_read_b64_tr_b16 a[124:125], v26 offset:24576
buffer_load_dwordx4 v11, s[12:15], s32 offen lds
v_mfma_f32_16x16x32_bf16 v[52:55], a[128:131], a[84:87], v[52:55]
s_waitcnt lgkmcnt(7)
ds_read_b64_tr_b16 a[126:127], v26 offset:28672
buffer_load_dwordx2 a[24:25], v7, s[16:19], s33 offen offset:1024 sc1
buffer_load_dwordx2 a[26:27], v7, s[16:19], s33 offen offset:1536 sc1
v_mfma_f32_16x16x32_bf16 v[60:63], a[136:139], a[84:87], v[60:63]
ds_read_b64_tr_b16 a[128:129], v27 offset:16384
v_mfma_f32_16x16x32_bf16 v[60:63], a[140:143], a[92:95], v[60:63]
s_add_u32 m0, s31, 19456
ds_read_b64_tr_b16 a[130:131], v27 offset:20480
v_mfma_f32_16x16x32_bf16 v[56:59], a[140:143], a[88:91], v[56:59]
ds_read_b64_tr_b16 a[132:133], v27 offset:24576
buffer_load_dwordx4 v12, s[12:15], s32 offen lds
s_add_u32 s32, s32, 131072
v_mfma_f32_16x16x32_bf16 v[56:59], a[136:139], a[80:83], v[56:59]
s_waitcnt lgkmcnt(7)
ds_read_b64_tr_b16 a[134:135], v27 offset:28672
buffer_load_dwordx2 a[28:29], v8, s[16:19], s33 offen offset:1024 sc1
buffer_load_dwordx2 a[30:31], v8, s[16:19], s33 offen offset:1536 sc1
v_mfma_f32_16x16x32_bf16 v[64:67], a[112:115], a[80:83], v[64:67]
ds_read_b64_tr_b16 a[136:137], v28 offset:16384
v_mfma_f32_16x16x32_bf16 v[64:67], a[116:119], a[88:91], v[64:67]
ds_read_b64_tr_b16 a[138:139], v28 offset:20480
v_mfma_f32_16x16x32_bf16 v[68:71], a[116:119], a[92:95], v[68:71]
ds_read_b64_tr_b16 a[140:141], v28 offset:24576
v_mfma_f32_16x16x32_bf16 v[68:71], a[112:115], a[84:87], v[68:71]
s_waitcnt lgkmcnt(7)
ds_read_b64_tr_b16 a[142:143], v28 offset:28672
v_mfma_f32_16x16x32_bf16 v[76:79], a[120:123], a[84:87], v[76:79]
s_waitcnt vmcnt(19)
s_barrier
ds_read_b64_tr_b16 a[112:113], v21 offset:32768
v_mfma_f32_16x16x32_bf16 v[76:79], a[124:127], a[92:95], v[76:79]
ds_read_b64_tr_b16 a[114:115], v21 offset:36864
v_mfma_f32_16x16x32_bf16 v[72:75], a[124:127], a[88:91], v[72:75]
ds_read_b64_tr_b16 a[116:117], v21 offset:40960
v_mfma_f32_16x16x32_bf16 v[72:75], a[120:123], a[80:83], v[72:75]
s_waitcnt lgkmcnt(7)
ds_read_b64_tr_b16 a[118:119], v21 offset:45056
v_mfma_f32_16x16x32_bf16 v[80:83], a[128:131], a[80:83], v[80:83]
ds_read_b64_tr_b16 a[120:121], v22 offset:32768
v_mfma_f32_16x16x32_bf16 v[80:83], a[132:135], a[88:91], v[80:83]
ds_read_b64_tr_b16 a[122:123], v22 offset:36864
v_mfma_f32_16x16x32_bf16 v[84:87], a[132:135], a[92:95], v[84:87]
ds_read_b64_tr_b16 a[124:125], v22 offset:40960
v_mfma_f32_16x16x32_bf16 v[84:87], a[128:131], a[84:87], v[84:87]
s_waitcnt lgkmcnt(7)
ds_read_b64_tr_b16 a[126:127], v22 offset:45056
v_mfma_f32_16x16x32_bf16 v[92:95], a[136:139], a[84:87], v[92:95]
ds_read_b64_tr_b16 a[128:129], v23 offset:32768
v_mfma_f32_16x16x32_bf16 v[92:95], a[140:143], a[92:95], v[92:95]
ds_read_b64_tr_b16 a[130:131], v23 offset:36864
v_mfma_f32_16x16x32_bf16 v[88:91], a[140:143], a[88:91], v[88:91]
ds_read_b64_tr_b16 a[132:133], v23 offset:40960
v_mfma_f32_16x16x32_bf16 v[88:91], a[136:139], a[80:83], v[88:91]
s_waitcnt vmcnt(18) lgkmcnt(7)
ds_read_b64_tr_b16 a[134:135], v23 offset:45056
v_mfma_f32_16x16x32_bf16 v[32:35], a[112:115], a[96:99], v[32:35]
ds_read_b64_tr_b16 a[136:137], v24 offset:32768
v_mfma_f32_16x16x32_bf16 v[32:35], a[116:119], a[104:107], v[32:35]
s_add_u32 m0, s31, 32768
ds_read_b64_tr_b16 a[138:139], v24 offset:36864
v_mfma_f32_16x16x32_bf16 v[36:39], a[116:119], a[108:111], v[36:39]
ds_read_b64_tr_b16 a[140:141], v24 offset:40960
buffer_load_dwordx4 v9, s[12:15], s32 offen lds
v_mfma_f32_16x16x32_bf16 v[36:39], a[112:115], a[100:103], v[36:39]
s_waitcnt lgkmcnt(7)
ds_read_b64_tr_b16 a[142:143], v24 offset:45056
buffer_load_dwordx4 a[32:35], v5, s[16:19], s33 offen offset:2048 sc1
v_mfma_f32_16x16x32_bf16 v[44:47], a[120:123], a[100:103], v[44:47]
ds_read_b64_tr_b16 a[112:113], v25 offset:32768
v_mfma_f32_16x16x32_bf16 v[44:47], a[124:127], a[108:111], v[44:47]
s_add_u32 m0, s31, 33792
ds_read_b64_tr_b16 a[114:115], v25 offset:36864
v_mfma_f32_16x16x32_bf16 v[40:43], a[124:127], a[104:107], v[40:43]
ds_read_b64_tr_b16 a[116:117], v25 offset:40960
buffer_load_dwordx4 v10, s[12:15], s32 offen lds
v_mfma_f32_16x16x32_bf16 v[40:43], a[120:123], a[96:99], v[40:43]
s_waitcnt lgkmcnt(7)
ds_read_b64_tr_b16 a[118:119], v25 offset:45056
buffer_load_dwordx4 a[36:39], v6, s[16:19], s33 offen offset:2048 sc1
v_mfma_f32_16x16x32_bf16 v[48:51], a[128:131], a[96:99], v[48:51]
ds_read_b64_tr_b16 a[120:121], v26 offset:32768
v_mfma_f32_16x16x32_bf16 v[48:51], a[132:135], a[104:107], v[48:51]
s_add_u32 m0, s31, 34816
ds_read_b64_tr_b16 a[122:123], v26 offset:36864
v_mfma_f32_16x16x32_bf16 v[52:55], a[132:135], a[108:111], v[52:55]
ds_read_b64_tr_b16 a[124:125], v26 offset:40960
buffer_load_dwordx4 v11, s[12:15], s32 offen lds
v_mfma_f32_16x16x32_bf16 v[52:55], a[128:131], a[100:103], v[52:55]
s_waitcnt lgkmcnt(7)
ds_read_b64_tr_b16 a[126:127], v26 offset:45056
buffer_load_dwordx4 a[40:43], v5, s[16:19], s33 offen offset:3072 sc1
v_mfma_f32_16x16x32_bf16 v[60:63], a[136:139], a[100:103], v[60:63]
ds_read_b64_tr_b16 a[128:129], v27 offset:32768
v_mfma_f32_16x16x32_bf16 v[60:63], a[140:143], a[108:111], v[60:63]
s_add_u32 m0, s31, 35840
ds_read_b64_tr_b16 a[130:131], v27 offset:36864
v_mfma_f32_16x16x32_bf16 v[56:59], a[140:143], a[104:107], v[56:59]
ds_read_b64_tr_b16 a[132:133], v27 offset:40960
buffer_load_dwordx4 v12, s[12:15], s32 offen lds
s_add_u32 s32, s32, 131072
v_mfma_f32_16x16x32_bf16 v[56:59], a[136:139], a[96:99], v[56:59]
s_waitcnt lgkmcnt(7)
ds_read_b64_tr_b16 a[134:135], v27 offset:45056
buffer_load_dwordx4 a[44:47], v6, s[16:19], s33 offen offset:3072 sc1
s_add_u32 s33, s33, 4096
v_mfma_f32_16x16x32_bf16 v[64:67], a[112:115], a[96:99], v[64:67]
ds_read_b64_tr_b16 a[136:137], v28 offset:32768
v_mfma_f32_16x16x32_bf16 v[64:67], a[116:119], a[104:107], v[64:67]
ds_read_b64_tr_b16 a[138:139], v28 offset:36864
v_mfma_f32_16x16x32_bf16 v[68:71], a[116:119], a[108:111], v[68:71]
ds_read_b64_tr_b16 a[140:141], v28 offset:40960
v_mfma_f32_16x16x32_bf16 v[68:71], a[112:115], a[100:103], v[68:71]
s_waitcnt lgkmcnt(7)
ds_read_b64_tr_b16 a[142:143], v28 offset:45056
v_mfma_f32_16x16x32_bf16 v[76:79], a[120:123], a[100:103], v[76:79]
s_waitcnt vmcnt(19)
s_barrier
ds_read_b64_tr_b16 a[112:113], v13 offset:0
v_mfma_f32_16x16x32_bf16 v[76:79], a[124:127], a[108:111], v[76:79]
ds_read_b64_tr_b16 a[114:115], v13 offset:4096
v_mfma_f32_16x16x32_bf16 v[72:75], a[124:127], a[104:107], v[72:75]
ds_read_b64_tr_b16 a[116:117], v13 offset:8192
v_mfma_f32_16x16x32_bf16 v[72:75], a[120:123], a[96:99], v[72:75]
s_waitcnt lgkmcnt(7)
ds_read_b64_tr_b16 a[118:119], v13 offset:12288
v_mfma_f32_16x16x32_bf16 v[80:83], a[128:131], a[96:99], v[80:83]
ds_read_b64_tr_b16 a[120:121], v14 offset:0
v_mfma_f32_16x16x32_bf16 v[80:83], a[132:135], a[104:107], v[80:83]
ds_read_b64_tr_b16 a[122:123], v14 offset:4096
v_mfma_f32_16x16x32_bf16 v[84:87], a[132:135], a[108:111], v[84:87]
ds_read_b64_tr_b16 a[124:125], v14 offset:8192
v_mfma_f32_16x16x32_bf16 v[84:87], a[128:131], a[100:103], v[84:87]
s_waitcnt lgkmcnt(7)
ds_read_b64_tr_b16 a[126:127], v14 offset:12288
v_mfma_f32_16x16x32_bf16 v[92:95], a[136:139], a[100:103], v[92:95]
ds_read_b64_tr_b16 a[128:129], v15 offset:0
v_mfma_f32_16x16x32_bf16 v[92:95], a[140:143], a[108:111], v[92:95]
ds_read_b64_tr_b16 a[130:131], v15 offset:4096
v_mfma_f32_16x16x32_bf16 v[88:91], a[140:143], a[104:107], v[88:91]
ds_read_b64_tr_b16 a[132:133], v15 offset:8192
v_mfma_f32_16x16x32_bf16 v[88:91], a[136:139], a[96:99], v[88:91]
s_waitcnt vmcnt(18) lgkmcnt(7)
ds_read_b64_tr_b16 a[134:135], v15 offset:12288
v_mfma_f32_16x16x32_bf16 v[32:35], a[112:115], a[0:3], v[32:35]
ds_read_b64_tr_b16 a[136:137], v16 offset:0
v_mfma_f32_16x16x32_bf16 v[32:35], a[116:119], a[8:11], v[32:35]
s_add_u32 m0, s31, 49152
ds_read_b64_tr_b16 a[138:139], v16 offset:4096
v_mfma_f32_16x16x32_bf16 v[36:39], a[116:119], a[12:15], v[36:39]
ds_read_b64_tr_b16 a[140:141], v16 offset:8192
buffer_load_dwordx4 v9, s[12:15], s32 offen lds
v_mfma_f32_16x16x32_bf16 v[36:39], a[112:115], a[4:7], v[36:39]
s_waitcnt lgkmcnt(7)
ds_read_b64_tr_b16 a[142:143], v16 offset:12288
buffer_load_dwordx4 a[48:51], v5, s[16:19], s33 offen offset:0 sc1
v_mfma_f32_16x16x32_bf16 v[44:47], a[120:123], a[4:7], v[44:47]
ds_read_b64_tr_b16 a[112:113], v17 offset:0
v_mfma_f32_16x16x32_bf16 v[44:47], a[124:127], a[12:15], v[44:47]
s_add_u32 m0, s31, 50176
ds_read_b64_tr_b16 a[114:115], v17 offset:4096
v_mfma_f32_16x16x32_bf16 v[40:43], a[124:127], a[8:11], v[40:43]
ds_read_b64_tr_b16 a[116:117], v17 offset:8192
buffer_load_dwordx4 v10, s[12:15], s32 offen lds
v_mfma_f32_16x16x32_bf16 v[40:43], a[120:123], a[0:3], v[40:43]
s_waitcnt lgkmcnt(7)
ds_read_b64_tr_b16 a[118:119], v17 offset:12288
buffer_load_dwordx4 a[52:55], v6, s[16:19], s33 offen offset:0 sc1
v_mfma_f32_16x16x32_bf16 v[48:51], a[128:131], a[0:3], v[48:51]
ds_read_b64_tr_b16 a[120:121], v18 offset:0
v_mfma_f32_16x16x32_bf16 v[48:51], a[132:135], a[8:11], v[48:51]
s_add_u32 m0, s31, 51200
ds_read_b64_tr_b16 a[122:123], v18 offset:4096
v_mfma_f32_16x16x32_bf16 v[52:55], a[132:135], a[12:15], v[52:55]
ds_read_b64_tr_b16 a[124:125], v18 offset:8192
buffer_load_dwordx4 v11, s[12:15], s32 offen lds
v_mfma_f32_16x16x32_bf16 v[52:55], a[128:131], a[4:7], v[52:55]
s_waitcnt lgkmcnt(7)
ds_read_b64_tr_b16 a[126:127], v18 offset:12288
buffer_load_dwordx4 a[56:59], v5, s[16:19], s33 offen offset:1024 sc1
v_mfma_f32_16x16x32_bf16 v[60:63], a[136:139], a[4:7], v[60:63]
ds_read_b64_tr_b16 a[128:129], v19 offset:0
v_mfma_f32_16x16x32_bf16 v[60:63], a[140:143], a[12:15], v[60:63]
s_add_u32 m0, s31, 52224
ds_read_b64_tr_b16 a[130:131], v19 offset:4096
v_mfma_f32_16x16x32_bf16 v[56:59], a[140:143], a[8:11], v[56:59]
ds_read_b64_tr_b16 a[132:133], v19 offset:8192
buffer_load_dwordx4 v12, s[12:15], s32 offen lds
s_add_u32 s32, s32, 131072
v_mfma_f32_16x16x32_bf16 v[56:59], a[136:139], a[0:3], v[56:59]
s_waitcnt lgkmcnt(7)
ds_read_b64_tr_b16 a[134:135], v19 offset:12288
buffer_load_dwordx4 a[60:63], v6, s[16:19], s33 offen offset:1024 sc1
v_mfma_f32_16x16x32_bf16 v[64:67], a[112:115], a[0:3], v[64:67]
ds_read_b64_tr_b16 a[136:137], v20 offset:0
v_mfma_f32_16x16x32_bf16 v[64:67], a[116:119], a[8:11], v[64:67]
ds_read_b64_tr_b16 a[138:139], v20 offset:4096
v_mfma_f32_16x16x32_bf16 v[68:71], a[116:119], a[12:15], v[68:71]
ds_read_b64_tr_b16 a[140:141], v20 offset:8192
v_mfma_f32_16x16x32_bf16 v[68:71], a[112:115], a[4:7], v[68:71]
s_waitcnt lgkmcnt(7)
ds_read_b64_tr_b16 a[142:143], v20 offset:12288
v_mfma_f32_16x16x32_bf16 v[76:79], a[120:123], a[4:7], v[76:79]
s_waitcnt vmcnt(18)
s_barrier
ds_read_b64_tr_b16 a[112:113], v13 offset:16384
v_mfma_f32_16x16x32_bf16 v[76:79], a[124:127], a[12:15], v[76:79]
ds_read_b64_tr_b16 a[114:115], v13 offset:20480
v_mfma_f32_16x16x32_bf16 v[72:75], a[124:127], a[8:11], v[72:75]
ds_read_b64_tr_b16 a[116:117], v13 offset:24576
v_mfma_f32_16x16x32_bf16 v[72:75], a[120:123], a[0:3], v[72:75]
s_waitcnt lgkmcnt(7)
ds_read_b64_tr_b16 a[118:119], v13 offset:28672
v_mfma_f32_16x16x32_bf16 v[80:83], a[128:131], a[0:3], v[80:83]
ds_read_b64_tr_b16 a[120:121], v14 offset:16384
v_mfma_f32_16x16x32_bf16 v[80:83], a[132:135], a[8:11], v[80:83]
ds_read_b64_tr_b16 a[122:123], v14 offset:20480
v_mfma_f32_16x16x32_bf16 v[84:87], a[132:135], a[12:15], v[84:87]
ds_read_b64_tr_b16 a[124:125], v14 offset:24576
v_mfma_f32_16x16x32_bf16 v[84:87], a[128:131], a[4:7], v[84:87]
s_waitcnt lgkmcnt(7)
ds_read_b64_tr_b16 a[126:127], v14 offset:28672
v_mfma_f32_16x16x32_bf16 v[92:95], a[136:139], a[4:7], v[92:95]
ds_read_b64_tr_b16 a[128:129], v15 offset:16384
v_mfma_f32_16x16x32_bf16 v[92:95], a[140:143], a[12:15], v[92:95]
ds_read_b64_tr_b16 a[130:131], v15 offset:20480
v_mfma_f32_16x16x32_bf16 v[88:91], a[140:143], a[8:11], v[88:91]
ds_read_b64_tr_b16 a[132:133], v15 offset:24576
v_mfma_f32_16x16x32_bf16 v[88:91], a[136:139], a[0:3], v[88:91]
s_waitcnt vmcnt(16) lgkmcnt(7)
ds_read_b64_tr_b16 a[134:135], v15 offset:28672
v_mfma_f32_16x16x32_bf16 v[32:35], a[112:115], a[16:19], v[32:35]
ds_read_b64_tr_b16 a[136:137], v16 offset:16384
v_mfma_f32_16x16x32_bf16 v[32:35], a[116:119], a[24:27], v[32:35]
s_add_u32 m0, s31, 65536
ds_read_b64_tr_b16 a[138:139], v16 offset:20480
v_mfma_f32_16x16x32_bf16 v[36:39], a[116:119], a[28:31], v[36:39]
ds_read_b64_tr_b16 a[140:141], v16 offset:24576
buffer_load_dwordx4 v9, s[12:15], s32 offen lds
v_mfma_f32_16x16x32_bf16 v[36:39], a[112:115], a[20:23], v[36:39]
s_waitcnt lgkmcnt(7)
ds_read_b64_tr_b16 a[142:143], v16 offset:28672
buffer_load_dwordx4 a[64:67], v5, s[16:19], s33 offen offset:2048 sc1
v_mfma_f32_16x16x32_bf16 v[44:47], a[120:123], a[20:23], v[44:47]
ds_read_b64_tr_b16 a[112:113], v17 offset:16384
v_mfma_f32_16x16x32_bf16 v[44:47], a[124:127], a[28:31], v[44:47]
s_add_u32 m0, s31, 66560
ds_read_b64_tr_b16 a[114:115], v17 offset:20480
v_mfma_f32_16x16x32_bf16 v[40:43], a[124:127], a[24:27], v[40:43]
ds_read_b64_tr_b16 a[116:117], v17 offset:24576
buffer_load_dwordx4 v10, s[12:15], s32 offen lds
v_mfma_f32_16x16x32_bf16 v[40:43], a[120:123], a[16:19], v[40:43]
s_waitcnt lgkmcnt(7)
ds_read_b64_tr_b16 a[118:119], v17 offset:28672
buffer_load_dwordx4 a[68:71], v6, s[16:19], s33 offen offset:2048 sc1
v_mfma_f32_16x16x32_bf16 v[48:51], a[128:131], a[16:19], v[48:51]
ds_read_b64_tr_b16 a[120:121], v18 offset:16384
v_mfma_f32_16x16x32_bf16 v[48:51], a[132:135], a[24:27], v[48:51]
s_add_u32 m0, s31, 67584
ds_read_b64_tr_b16 a[122:123], v18 offset:20480
v_mfma_f32_16x16x32_bf16 v[52:55], a[132:135], a[28:31], v[52:55]
ds_read_b64_tr_b16 a[124:125], v18 offset:24576
buffer_load_dwordx4 v11, s[12:15], s32 offen lds
v_mfma_f32_16x16x32_bf16 v[52:55], a[128:131], a[20:23], v[52:55]
s_waitcnt lgkmcnt(7)
ds_read_b64_tr_b16 a[126:127], v18 offset:28672
buffer_load_dwordx4 a[72:75], v5, s[16:19], s33 offen offset:3072 sc1
v_mfma_f32_16x16x32_bf16 v[60:63], a[136:139], a[20:23], v[60:63]
ds_read_b64_tr_b16 a[128:129], v19 offset:16384
v_mfma_f32_16x16x32_bf16 v[60:63], a[140:143], a[28:31], v[60:63]
s_add_u32 m0, s31, 68608
ds_read_b64_tr_b16 a[130:131], v19 offset:20480
v_mfma_f32_16x16x32_bf16 v[56:59], a[140:143], a[24:27], v[56:59]
ds_read_b64_tr_b16 a[132:133], v19 offset:24576
buffer_load_dwordx4 v12, s[12:15], s32 offen lds
s_add_u32 s32, s32, 131072
v_mfma_f32_16x16x32_bf16 v[56:59], a[136:139], a[16:19], v[56:59]
s_waitcnt lgkmcnt(7)
ds_read_b64_tr_b16 a[134:135], v19 offset:28672
buffer_load_dwordx4 a[76:79], v6, s[16:19], s33 offen offset:3072 sc1
s_add_u32 s33, s33, 4096
v_mfma_f32_16x16x32_bf16 v[64:67], a[112:115], a[16:19], v[64:67]
ds_read_b64_tr_b16 a[136:137], v20 offset:16384
v_mfma_f32_16x16x32_bf16 v[64:67], a[116:119], a[24:27], v[64:67]
ds_read_b64_tr_b16 a[138:139], v20 offset:20480
v_mfma_f32_16x16x32_bf16 v[68:71], a[116:119], a[28:31], v[68:71]
ds_read_b64_tr_b16 a[140:141], v20 offset:24576
v_mfma_f32_16x16x32_bf16 v[68:71], a[112:115], a[20:23], v[68:71]
s_waitcnt lgkmcnt(7)
ds_read_b64_tr_b16 a[142:143], v20 offset:28672
v_mfma_f32_16x16x32_bf16 v[76:79], a[120:123], a[20:23], v[76:79]
s_waitcnt vmcnt(17)
s_barrier
ds_read_b64_tr_b16 a[112:113], v13 offset:32768
v_mfma_f32_16x16x32_bf16 v[76:79], a[124:127], a[28:31], v[76:79]
ds_read_b64_tr_b16 a[114:115], v13 offset:36864
v_mfma_f32_16x16x32_bf16 v[72:75], a[124:127], a[24:27], v[72:75]
ds_read_b64_tr_b16 a[116:117], v13 offset:40960
v_mfma_f32_16x16x32_bf16 v[72:75], a[120:123], a[16:19], v[72:75]
s_waitcnt lgkmcnt(7)
ds_read_b64_tr_b16 a[118:119], v13 offset:45056
v_mfma_f32_16x16x32_bf16 v[80:83], a[128:131], a[16:19], v[80:83]
ds_read_b64_tr_b16 a[120:121], v14 offset:32768
v_mfma_f32_16x16x32_bf16 v[80:83], a[132:135], a[24:27], v[80:83]
ds_read_b64_tr_b16 a[122:123], v14 offset:36864
v_mfma_f32_16x16x32_bf16 v[84:87], a[132:135], a[28:31], v[84:87]
ds_read_b64_tr_b16 a[124:125], v14 offset:40960
v_mfma_f32_16x16x32_bf16 v[84:87], a[128:131], a[20:23], v[84:87]
s_waitcnt lgkmcnt(7)
ds_read_b64_tr_b16 a[126:127], v14 offset:45056
v_mfma_f32_16x16x32_bf16 v[92:95], a[136:139], a[20:23], v[92:95]
ds_read_b64_tr_b16 a[128:129], v15 offset:32768
v_mfma_f32_16x16x32_bf16 v[92:95], a[140:143], a[28:31], v[92:95]
ds_read_b64_tr_b16 a[130:131], v15 offset:36864
v_mfma_f32_16x16x32_bf16 v[88:91], a[140:143], a[24:27], v[88:91]
ds_read_b64_tr_b16 a[132:133], v15 offset:40960
v_mfma_f32_16x16x32_bf16 v[88:91], a[136:139], a[16:19], v[88:91]
s_waitcnt vmcnt(16) lgkmcnt(7)
ds_read_b64_tr_b16 a[134:135], v15 offset:45056
v_mfma_f32_16x16x32_bf16 v[32:35], a[112:115], a[32:35], v[32:35]
ds_read_b64_tr_b16 a[136:137], v16 offset:32768
v_mfma_f32_16x16x32_bf16 v[32:35], a[116:119], a[40:43], v[32:35]
s_add_u32 m0, s31, 81920
ds_read_b64_tr_b16 a[138:139], v16 offset:36864
v_mfma_f32_16x16x32_bf16 v[36:39], a[116:119], a[44:47], v[36:39]
ds_read_b64_tr_b16 a[140:141], v16 offset:40960
buffer_load_dwordx4 v9, s[12:15], s32 offen lds
v_mfma_f32_16x16x32_bf16 v[36:39], a[112:115], a[36:39], v[36:39]
s_waitcnt lgkmcnt(7)
ds_read_b64_tr_b16 a[142:143], v16 offset:45056
buffer_load_dwordx2 a[80:81], v7, s[16:19], s33 offen offset:0 sc1
buffer_load_dwordx2 a[82:83], v7, s[16:19], s33 offen offset:512 sc1
v_mfma_f32_16x16x32_bf16 v[44:47], a[120:123], a[36:39], v[44:47]
ds_read_b64_tr_b16 a[112:113], v17 offset:32768
v_mfma_f32_16x16x32_bf16 v[44:47], a[124:127], a[44:47], v[44:47]
s_add_u32 m0, s31, 82944
ds_read_b64_tr_b16 a[114:115], v17 offset:36864
v_mfma_f32_16x16x32_bf16 v[40:43], a[124:127], a[40:43], v[40:43]
ds_read_b64_tr_b16 a[116:117], v17 offset:40960
buffer_load_dwordx4 v10, s[12:15], s32 offen lds
v_mfma_f32_16x16x32_bf16 v[40:43], a[120:123], a[32:35], v[40:43]
s_waitcnt lgkmcnt(7)
ds_read_b64_tr_b16 a[118:119], v17 offset:45056
buffer_load_dwordx2 a[84:85], v8, s[16:19], s33 offen offset:0 sc1
buffer_load_dwordx2 a[86:87], v8, s[16:19], s33 offen offset:512 sc1
v_mfma_f32_16x16x32_bf16 v[48:51], a[128:131], a[32:35], v[48:51]
ds_read_b64_tr_b16 a[120:121], v18 offset:32768
v_mfma_f32_16x16x32_bf16 v[48:51], a[132:135], a[40:43], v[48:51]
s_add_u32 m0, s31, 83968
ds_read_b64_tr_b16 a[122:123], v18 offset:36864
v_mfma_f32_16x16x32_bf16 v[52:55], a[132:135], a[44:47], v[52:55]
ds_read_b64_tr_b16 a[124:125], v18 offset:40960
buffer_load_dwordx4 v11, s[12:15], s32 offen lds
v_mfma_f32_16x16x32_bf16 v[52:55], a[128:131], a[36:39], v[52:55]
s_waitcnt lgkmcnt(7)
ds_read_b64_tr_b16 a[126:127], v18 offset:45056
buffer_load_dwordx4 a[88:91], v5, s[16:19], s33 offen offset:1024 sc1
v_mfma_f32_16x16x32_bf16 v[60:63], a[136:139], a[36:39], v[60:63]
ds_read_b64_tr_b16 a[128:129], v19 offset:32768
v_mfma_f32_16x16x32_bf16 v[60:63], a[140:143], a[44:47], v[60:63]
s_add_u32 m0, s31, 84992
ds_read_b64_tr_b16 a[130:131], v19 offset:36864
v_mfma_f32_16x16x32_bf16 v[56:59], a[140:143], a[40:43], v[56:59]
ds_read_b64_tr_b16 a[132:133], v19 offset:40960
buffer_load_dwordx4 v12, s[12:15], s32 offen lds
s_add_u32 s32, s32, 131072
v_mfma_f32_16x16x32_bf16 v[56:59], a[136:139], a[32:35], v[56:59]
s_waitcnt lgkmcnt(7)
ds_read_b64_tr_b16 a[134:135], v19 offset:45056
buffer_load_dwordx4 a[92:95], v6, s[16:19], s33 offen offset:1024 sc1
v_mfma_f32_16x16x32_bf16 v[64:67], a[112:115], a[32:35], v[64:67]
ds_read_b64_tr_b16 a[136:137], v20 offset:32768
v_mfma_f32_16x16x32_bf16 v[64:67], a[116:119], a[40:43], v[64:67]
ds_read_b64_tr_b16 a[138:139], v20 offset:36864
v_mfma_f32_16x16x32_bf16 v[68:71], a[116:119], a[44:47], v[68:71]
ds_read_b64_tr_b16 a[140:141], v20 offset:40960
v_mfma_f32_16x16x32_bf16 v[68:71], a[112:115], a[36:39], v[68:71]
s_waitcnt lgkmcnt(7)
ds_read_b64_tr_b16 a[142:143], v20 offset:45056
v_mfma_f32_16x16x32_bf16 v[76:79], a[120:123], a[36:39], v[76:79]
s_waitcnt vmcnt(19)
s_barrier
ds_read_b64_tr_b16 a[112:113], v13 offset:49152
v_mfma_f32_16x16x32_bf16 v[76:79], a[124:127], a[44:47], v[76:79]
ds_read_b64_tr_b16 a[114:115], v13 offset:53248
v_mfma_f32_16x16x32_bf16 v[72:75], a[124:127], a[40:43], v[72:75]
ds_read_b64_tr_b16 a[116:117], v13 offset:57344
v_mfma_f32_16x16x32_bf16 v[72:75], a[120:123], a[32:35], v[72:75]
s_waitcnt lgkmcnt(7)
ds_read_b64_tr_b16 a[118:119], v13 offset:61440
v_mfma_f32_16x16x32_bf16 v[80:83], a[128:131], a[32:35], v[80:83]
ds_read_b64_tr_b16 a[120:121], v14 offset:49152
v_mfma_f32_16x16x32_bf16 v[80:83], a[132:135], a[40:43], v[80:83]
ds_read_b64_tr_b16 a[122:123], v14 offset:53248
v_mfma_f32_16x16x32_bf16 v[84:87], a[132:135], a[44:47], v[84:87]
ds_read_b64_tr_b16 a[124:125], v14 offset:57344
v_mfma_f32_16x16x32_bf16 v[84:87], a[128:131], a[36:39], v[84:87]
s_waitcnt lgkmcnt(7)
ds_read_b64_tr_b16 a[126:127], v14 offset:61440
v_mfma_f32_16x16x32_bf16 v[92:95], a[136:139], a[36:39], v[92:95]
ds_read_b64_tr_b16 a[128:129], v15 offset:49152
v_mfma_f32_16x16x32_bf16 v[92:95], a[140:143], a[44:47], v[92:95]
ds_read_b64_tr_b16 a[130:131], v15 offset:53248
v_mfma_f32_16x16x32_bf16 v[88:91], a[140:143], a[40:43], v[88:91]
ds_read_b64_tr_b16 a[132:133], v15 offset:57344
v_mfma_f32_16x16x32_bf16 v[88:91], a[136:139], a[32:35], v[88:91]
s_waitcnt vmcnt(18) lgkmcnt(7)
ds_read_b64_tr_b16 a[134:135], v15 offset:61440
v_mfma_f32_16x16x32_bf16 v[32:35], a[112:115], a[48:51], v[32:35]
ds_read_b64_tr_b16 a[136:137], v16 offset:49152
v_mfma_f32_16x16x32_bf16 v[32:35], a[116:119], a[56:59], v[32:35]
s_add_u32 m0, s31, 98304
ds_read_b64_tr_b16 a[138:139], v16 offset:53248
v_mfma_f32_16x16x32_bf16 v[36:39], a[116:119], a[60:63], v[36:39]
ds_read_b64_tr_b16 a[140:141], v16 offset:57344
buffer_load_dwordx4 v9, s[12:15], s32 offen lds
v_mfma_f32_16x16x32_bf16 v[36:39], a[112:115], a[52:55], v[36:39]
s_waitcnt lgkmcnt(7)
ds_read_b64_tr_b16 a[142:143], v16 offset:61440
buffer_load_dwordx4 a[96:99], v5, s[16:19], s33 offen offset:2048 sc1
v_mfma_f32_16x16x32_bf16 v[44:47], a[120:123], a[52:55], v[44:47]
ds_read_b64_tr_b16 a[112:113], v17 offset:49152
v_mfma_f32_16x16x32_bf16 v[44:47], a[124:127], a[60:63], v[44:47]
s_add_u32 m0, s31, 99328
ds_read_b64_tr_b16 a[114:115], v17 offset:53248
v_mfma_f32_16x16x32_bf16 v[40:43], a[124:127], a[56:59], v[40:43]
ds_read_b64_tr_b16 a[116:117], v17 offset:57344
buffer_load_dwordx4 v10, s[12:15], s32 offen lds
v_mfma_f32_16x16x32_bf16 v[40:43], a[120:123], a[48:51], v[40:43]
s_waitcnt lgkmcnt(7)
ds_read_b64_tr_b16 a[118:119], v17 offset:61440
buffer_load_dwordx4 a[100:103], v6, s[16:19], s33 offen offset:2048 sc1
v_mfma_f32_16x16x32_bf16 v[48:51], a[128:131], a[48:51], v[48:51]
ds_read_b64_tr_b16 a[120:121], v18 offset:49152
v_mfma_f32_16x16x32_bf16 v[48:51], a[132:135], a[56:59], v[48:51]
s_add_u32 m0, s31, 100352
ds_read_b64_tr_b16 a[122:123], v18 offset:53248
v_mfma_f32_16x16x32_bf16 v[52:55], a[132:135], a[60:63], v[52:55]
ds_read_b64_tr_b16 a[124:125], v18 offset:57344
buffer_load_dwordx4 v11, s[12:15], s32 offen lds
v_mfma_f32_16x16x32_bf16 v[52:55], a[128:131], a[52:55], v[52:55]
s_waitcnt lgkmcnt(7)
ds_read_b64_tr_b16 a[126:127], v18 offset:61440
buffer_load_dwordx4 a[104:107], v5, s[16:19], s33 offen offset:3072 sc1
v_mfma_f32_16x16x32_bf16 v[60:63], a[136:139], a[52:55], v[60:63]
ds_read_b64_tr_b16 a[128:129], v19 offset:49152
v_mfma_f32_16x16x32_bf16 v[60:63], a[140:143], a[60:63], v[60:63]
s_add_u32 m0, s31, 101376
ds_read_b64_tr_b16 a[130:131], v19 offset:53248
v_mfma_f32_16x16x32_bf16 v[56:59], a[140:143], a[56:59], v[56:59]
ds_read_b64_tr_b16 a[132:133], v19 offset:57344
buffer_load_dwordx4 v12, s[12:15], s32 offen lds
s_add_u32 s32, s32, 131072
v_mfma_f32_16x16x32_bf16 v[56:59], a[136:139], a[48:51], v[56:59]
s_waitcnt lgkmcnt(7)
ds_read_b64_tr_b16 a[134:135], v19 offset:61440
buffer_load_dwordx4 a[108:111], v6, s[16:19], s33 offen offset:3072 sc1
s_add_u32 s33, s33, 4096
v_mfma_f32_16x16x32_bf16 v[64:67], a[112:115], a[48:51], v[64:67]
ds_read_b64_tr_b16 a[136:137], v20 offset:49152
v_mfma_f32_16x16x32_bf16 v[64:67], a[116:119], a[56:59], v[64:67]
ds_read_b64_tr_b16 a[138:139], v20 offset:53248
v_mfma_f32_16x16x32_bf16 v[68:71], a[116:119], a[60:63], v[68:71]
ds_read_b64_tr_b16 a[140:141], v20 offset:57344
v_mfma_f32_16x16x32_bf16 v[68:71], a[112:115], a[52:55], v[68:71]
s_waitcnt lgkmcnt(7)
ds_read_b64_tr_b16 a[142:143], v20 offset:61440
v_mfma_f32_16x16x32_bf16 v[76:79], a[120:123], a[52:55], v[76:79]
s_waitcnt vmcnt(19)
s_barrier
ds_read_b64_tr_b16 a[112:113], v21 offset:0
v_mfma_f32_16x16x32_bf16 v[76:79], a[124:127], a[60:63], v[76:79]
ds_read_b64_tr_b16 a[114:115], v21 offset:4096
v_mfma_f32_16x16x32_bf16 v[72:75], a[124:127], a[56:59], v[72:75]
ds_read_b64_tr_b16 a[116:117], v21 offset:8192
v_mfma_f32_16x16x32_bf16 v[72:75], a[120:123], a[48:51], v[72:75]
s_waitcnt lgkmcnt(7)
ds_read_b64_tr_b16 a[118:119], v21 offset:12288
v_mfma_f32_16x16x32_bf16 v[80:83], a[128:131], a[48:51], v[80:83]
ds_read_b64_tr_b16 a[120:121], v22 offset:0
v_mfma_f32_16x16x32_bf16 v[80:83], a[132:135], a[56:59], v[80:83]
ds_read_b64_tr_b16 a[122:123], v22 offset:4096
v_mfma_f32_16x16x32_bf16 v[84:87], a[132:135], a[60:63], v[84:87]
ds_read_b64_tr_b16 a[124:125], v22 offset:8192
v_mfma_f32_16x16x32_bf16 v[84:87], a[128:131], a[52:55], v[84:87]
s_waitcnt lgkmcnt(7)
ds_read_b64_tr_b16 a[126:127], v22 offset:12288
v_mfma_f32_16x16x32_bf16 v[92:95], a[136:139], a[52:55], v[92:95]
ds_read_b64_tr_b16 a[128:129], v23 offset:0
v_mfma_f32_16x16x32_bf16 v[92:95], a[140:143], a[60:63], v[92:95]
ds_read_b64_tr_b16 a[130:131], v23 offset:4096
v_mfma_f32_16x16x32_bf16 v[88:91], a[140:143], a[56:59], v[88:91]
ds_read_b64_tr_b16 a[132:133], v23 offset:8192
v_mfma_f32_16x16x32_bf16 v[88:91], a[136:139], a[48:51], v[88:91]
s_waitcnt vmcnt(18) lgkmcnt(7)
ds_read_b64_tr_b16 a[134:135], v23 offset:12288
v_mfma_f32_16x16x32_bf16 v[32:35], a[112:115], a[64:67], v[32:35]
ds_read_b64_tr_b16 a[136:137], v24 offset:0
v_mfma_f32_16x16x32_bf16 v[32:35], a[116:119], a[72:75], v[32:35]
s_add_u32 m0, s31, 0
ds_read_b64_tr_b16 a[138:139], v24 offset:4096
v_mfma_f32_16x16x32_bf16 v[36:39], a[116:119], a[76:79], v[36:39]
ds_read_b64_tr_b16 a[140:141], v24 offset:8192
buffer_load_dwordx4 v9, s[12:15], s32 offen lds
v_mfma_f32_16x16x32_bf16 v[36:39], a[112:115], a[68:71], v[36:39]
s_waitcnt lgkmcnt(7)
ds_read_b64_tr_b16 a[142:143], v24 offset:12288
buffer_load_dwordx4 a[0:3], v5, s[16:19], s33 offen offset:0 sc1
v_mfma_f32_16x16x32_bf16 v[44:47], a[120:123], a[68:71], v[44:47]
ds_read_b64_tr_b16 a[112:113], v25 offset:0
v_mfma_f32_16x16x32_bf16 v[44:47], a[124:127], a[76:79], v[44:47]
s_add_u32 m0, s31, 1024
ds_read_b64_tr_b16 a[114:115], v25 offset:4096
v_mfma_f32_16x16x32_bf16 v[40:43], a[124:127], a[72:75], v[40:43]
ds_read_b64_tr_b16 a[116:117], v25 offset:8192
buffer_load_dwordx4 v10, s[12:15], s32 offen lds
v_mfma_f32_16x16x32_bf16 v[40:43], a[120:123], a[64:67], v[40:43]
s_waitcnt lgkmcnt(7)
ds_read_b64_tr_b16 a[118:119], v25 offset:12288
buffer_load_dwordx4 a[4:7], v6, s[16:19], s33 offen offset:0 sc1
v_mfma_f32_16x16x32_bf16 v[48:51], a[128:131], a[64:67], v[48:51]
ds_read_b64_tr_b16 a[120:121], v26 offset:0
v_mfma_f32_16x16x32_bf16 v[48:51], a[132:135], a[72:75], v[48:51]
s_add_u32 m0, s31, 2048
ds_read_b64_tr_b16 a[122:123], v26 offset:4096
v_mfma_f32_16x16x32_bf16 v[52:55], a[132:135], a[76:79], v[52:55]
ds_read_b64_tr_b16 a[124:125], v26 offset:8192
buffer_load_dwordx4 v11, s[12:15], s32 offen lds
v_mfma_f32_16x16x32_bf16 v[52:55], a[128:131], a[68:71], v[52:55]
s_waitcnt lgkmcnt(7)
ds_read_b64_tr_b16 a[126:127], v26 offset:12288
buffer_load_dwordx4 a[8:11], v5, s[16:19], s33 offen offset:1024 sc1
v_mfma_f32_16x16x32_bf16 v[60:63], a[136:139], a[68:71], v[60:63]
ds_read_b64_tr_b16 a[128:129], v27 offset:0
v_mfma_f32_16x16x32_bf16 v[60:63], a[140:143], a[76:79], v[60:63]
s_add_u32 m0, s31, 3072
ds_read_b64_tr_b16 a[130:131], v27 offset:4096
v_mfma_f32_16x16x32_bf16 v[56:59], a[140:143], a[72:75], v[56:59]
ds_read_b64_tr_b16 a[132:133], v27 offset:8192
buffer_load_dwordx4 v12, s[12:15], s32 offen lds
s_add_u32 s32, s32, 131072
v_mfma_f32_16x16x32_bf16 v[56:59], a[136:139], a[64:67], v[56:59]
s_waitcnt lgkmcnt(7)
ds_read_b64_tr_b16 a[134:135], v27 offset:12288
buffer_load_dwordx4 a[12:15], v6, s[16:19], s33 offen offset:1024 sc1
v_mfma_f32_16x16x32_bf16 v[64:67], a[112:115], a[64:67], v[64:67]
ds_read_b64_tr_b16 a[136:137], v28 offset:0
v_mfma_f32_16x16x32_bf16 v[64:67], a[116:119], a[72:75], v[64:67]
ds_read_b64_tr_b16 a[138:139], v28 offset:4096
v_mfma_f32_16x16x32_bf16 v[68:71], a[116:119], a[76:79], v[68:71]
ds_read_b64_tr_b16 a[140:141], v28 offset:8192
v_mfma_f32_16x16x32_bf16 v[68:71], a[112:115], a[68:71], v[68:71]
s_waitcnt lgkmcnt(7)
ds_read_b64_tr_b16 a[142:143], v28 offset:12288
v_mfma_f32_16x16x32_bf16 v[76:79], a[120:123], a[68:71], v[76:79]
s_waitcnt vmcnt(17)
s_barrier
ds_read_b64_tr_b16 a[112:113], v21 offset:16384
v_mfma_f32_16x16x32_bf16 v[76:79], a[124:127], a[76:79], v[76:79]
ds_read_b64_tr_b16 a[114:115], v21 offset:20480
v_mfma_f32_16x16x32_bf16 v[72:75], a[124:127], a[72:75], v[72:75]
ds_read_b64_tr_b16 a[116:117], v21 offset:24576
v_mfma_f32_16x16x32_bf16 v[72:75], a[120:123], a[64:67], v[72:75]
s_waitcnt lgkmcnt(7)
ds_read_b64_tr_b16 a[118:119], v21 offset:28672
v_mfma_f32_16x16x32_bf16 v[80:83], a[128:131], a[64:67], v[80:83]
ds_read_b64_tr_b16 a[120:121], v22 offset:16384
v_mfma_f32_16x16x32_bf16 v[80:83], a[132:135], a[72:75], v[80:83]
ds_read_b64_tr_b16 a[122:123], v22 offset:20480
v_mfma_f32_16x16x32_bf16 v[84:87], a[132:135], a[76:79], v[84:87]
ds_read_b64_tr_b16 a[124:125], v22 offset:24576
v_mfma_f32_16x16x32_bf16 v[84:87], a[128:131], a[68:71], v[84:87]
s_waitcnt lgkmcnt(7)
ds_read_b64_tr_b16 a[126:127], v22 offset:28672
v_mfma_f32_16x16x32_bf16 v[92:95], a[136:139], a[68:71], v[92:95]
ds_read_b64_tr_b16 a[128:129], v23 offset:16384
v_mfma_f32_16x16x32_bf16 v[92:95], a[140:143], a[76:79], v[92:95]
ds_read_b64_tr_b16 a[130:131], v23 offset:20480
v_mfma_f32_16x16x32_bf16 v[88:91], a[140:143], a[72:75], v[88:91]
ds_read_b64_tr_b16 a[132:133], v23 offset:24576
v_mfma_f32_16x16x32_bf16 v[88:91], a[136:139], a[64:67], v[88:91]
s_waitcnt vmcnt(16) lgkmcnt(7)
ds_read_b64_tr_b16 a[134:135], v23 offset:28672
v_mfma_f32_16x16x32_bf16 v[32:35], a[112:115], a[80:83], v[32:35]
ds_read_b64_tr_b16 a[136:137], v24 offset:16384
v_mfma_f32_16x16x32_bf16 v[32:35], a[116:119], a[88:91], v[32:35]
s_add_u32 m0, s31, 16384
ds_read_b64_tr_b16 a[138:139], v24 offset:20480
v_mfma_f32_16x16x32_bf16 v[36:39], a[116:119], a[92:95], v[36:39]
ds_read_b64_tr_b16 a[140:141], v24 offset:24576
buffer_load_dwordx4 v9, s[12:15], s32 offen lds
v_mfma_f32_16x16x32_bf16 v[36:39], a[112:115], a[84:87], v[36:39]
s_waitcnt lgkmcnt(7)
ds_read_b64_tr_b16 a[142:143], v24 offset:28672
buffer_load_dwordx4 a[16:19], v5, s[16:19], s33 offen offset:2048 sc1
v_mfma_f32_16x16x32_bf16 v[44:47], a[120:123], a[84:87], v[44:47]
ds_read_b64_tr_b16 a[112:113], v25 offset:16384
v_mfma_f32_16x16x32_bf16 v[44:47], a[124:127], a[92:95], v[44:47]
s_add_u32 m0, s31, 17408
ds_read_b64_tr_b16 a[114:115], v25 offset:20480
v_mfma_f32_16x16x32_bf16 v[40:43], a[124:127], a[88:91], v[40:43]
ds_read_b64_tr_b16 a[116:117], v25 offset:24576
buffer_load_dwordx4 v10, s[12:15], s32 offen lds
v_mfma_f32_16x16x32_bf16 v[40:43], a[120:123], a[80:83], v[40:43]
s_waitcnt lgkmcnt(7)
ds_read_b64_tr_b16 a[118:119], v25 offset:28672
buffer_load_dwordx4 a[20:23], v6, s[16:19], s33 offen offset:2048 sc1
v_mfma_f32_16x16x32_bf16 v[48:51], a[128:131], a[80:83], v[48:51]
ds_read_b64_tr_b16 a[120:121], v26 offset:16384
v_mfma_f32_16x16x32_bf16 v[48:51], a[132:135], a[88:91], v[48:51]
s_add_u32 m0, s31, 18432
ds_read_b64_tr_b16 a[122:123], v26 offset:20480
v_mfma_f32_16x16x32_bf16 v[52:55], a[132:135], a[92:95], v[52:55]
ds_read_b64_tr_b16 a[124:125], v26 offset:24576
buffer_load_dwordx4 v11, s[12:15], s32 offen lds
v_mfma_f32_16x16x32_bf16 v[52:55], a[128:131], a[84:87], v[52:55]
s_waitcnt lgkmcnt(7)
ds_read_b64_tr_b16 a[126:127], v26 offset:28672
buffer_load_dwordx2 a[24:25], v7, s[16:19], s33 offen offset:3072 sc1
buffer_load_dwordx2 a[26:27], v7, s[16:19], s33 offen offset:3584 sc1
v_mfma_f32_16x16x32_bf16 v[60:63], a[136:139], a[84:87], v[60:63]
ds_read_b64_tr_b16 a[128:129], v27 offset:16384
v_mfma_f32_16x16x32_bf16 v[60:63], a[140:143], a[92:95], v[60:63]
s_add_u32 m0, s31, 19456
ds_read_b64_tr_b16 a[130:131], v27 offset:20480
v_mfma_f32_16x16x32_bf16 v[56:59], a[140:143], a[88:91], v[56:59]
ds_read_b64_tr_b16 a[132:133], v27 offset:24576
buffer_load_dwordx4 v12, s[12:15], s32 offen lds
s_add_u32 s32, s32, 131072
v_mfma_f32_16x16x32_bf16 v[56:59], a[136:139], a[80:83], v[56:59]
s_waitcnt lgkmcnt(7)
ds_read_b64_tr_b16 a[134:135], v27 offset:28672
buffer_load_dwordx2 a[28:29], v8, s[16:19], s33 offen offset:3072 sc1
buffer_load_dwordx2 a[30:31], v8, s[16:19], s33 offen offset:3584 sc1
s_add_u32 s33, s33, 4096
v_mfma_f32_16x16x32_bf16 v[64:67], a[112:115], a[80:83], v[64:67]
ds_read_b64_tr_b16 a[136:137], v28 offset:16384
v_mfma_f32_16x16x32_bf16 v[64:67], a[116:119], a[88:91], v[64:67]
ds_read_b64_tr_b16 a[138:139], v28 offset:20480
v_mfma_f32_16x16x32_bf16 v[68:71], a[116:119], a[92:95], v[68:71]
ds_read_b64_tr_b16 a[140:141], v28 offset:24576
v_mfma_f32_16x16x32_bf16 v[68:71], a[112:115], a[84:87], v[68:71]
s_waitcnt lgkmcnt(7)
ds_read_b64_tr_b16 a[142:143], v28 offset:28672
v_mfma_f32_16x16x32_bf16 v[76:79], a[120:123], a[84:87], v[76:79]
s_waitcnt vmcnt(19)
s_barrier
ds_read_b64_tr_b16 a[112:113], v21 offset:32768
v_mfma_f32_16x16x32_bf16 v[76:79], a[124:127], a[92:95], v[76:79]
ds_read_b64_tr_b16 a[114:115], v21 offset:36864
v_mfma_f32_16x16x32_bf16 v[72:75], a[124:127], a[88:91], v[72:75]
ds_read_b64_tr_b16 a[116:117], v21 offset:40960
v_mfma_f32_16x16x32_bf16 v[72:75], a[120:123], a[80:83], v[72:75]
s_waitcnt lgkmcnt(7)
ds_read_b64_tr_b16 a[118:119], v21 offset:45056
v_mfma_f32_16x16x32_bf16 v[80:83], a[128:131], a[80:83], v[80:83]
ds_read_b64_tr_b16 a[120:121], v22 offset:32768
v_mfma_f32_16x16x32_bf16 v[80:83], a[132:135], a[88:91], v[80:83]
ds_read_b64_tr_b16 a[122:123], v22 offset:36864
v_mfma_f32_16x16x32_bf16 v[84:87], a[132:135], a[92:95], v[84:87]
ds_read_b64_tr_b16 a[124:125], v22 offset:40960
v_mfma_f32_16x16x32_bf16 v[84:87], a[128:131], a[84:87], v[84:87]
s_waitcnt lgkmcnt(7)
ds_read_b64_tr_b16 a[126:127], v22 offset:45056
v_mfma_f32_16x16x32_bf16 v[92:95], a[136:139], a[84:87], v[92:95]
ds_read_b64_tr_b16 a[128:129], v23 offset:32768
v_mfma_f32_16x16x32_bf16 v[92:95], a[140:143], a[92:95], v[92:95]
ds_read_b64_tr_b16 a[130:131], v23 offset:36864
v_mfma_f32_16x16x32_bf16 v[88:91], a[140:143], a[88:91], v[88:91]
ds_read_b64_tr_b16 a[132:133], v23 offset:40960
v_mfma_f32_16x16x32_bf16 v[88:91], a[136:139], a[80:83], v[88:91]
s_waitcnt vmcnt(18) lgkmcnt(7)
ds_read_b64_tr_b16 a[134:135], v23 offset:45056
v_mfma_f32_16x16x32_bf16 v[32:35], a[112:115], a[96:99], v[32:35]
ds_read_b64_tr_b16 a[136:137], v24 offset:32768
v_mfma_f32_16x16x32_bf16 v[32:35], a[116:119], a[104:107], v[32:35]
s_add_u32 m0, s31, 32768
ds_read_b64_tr_b16 a[138:139], v24 offset:36864
v_mfma_f32_16x16x32_bf16 v[36:39], a[116:119], a[108:111], v[36:39]
ds_read_b64_tr_b16 a[140:141], v24 offset:40960
buffer_load_dwordx4 v9, s[12:15], s32 offen lds
v_mfma_f32_16x16x32_bf16 v[36:39], a[112:115], a[100:103], v[36:39]
s_waitcnt lgkmcnt(7)
ds_read_b64_tr_b16 a[142:143], v24 offset:45056
buffer_load_dwordx4 a[32:35], v5, s[16:19], s33 offen offset:0 sc1
v_mfma_f32_16x16x32_bf16 v[44:47], a[120:123], a[100:103], v[44:47]
ds_read_b64_tr_b16 a[112:113], v25 offset:32768
v_mfma_f32_16x16x32_bf16 v[44:47], a[124:127], a[108:111], v[44:47]
s_add_u32 m0, s31, 33792
ds_read_b64_tr_b16 a[114:115], v25 offset:36864
v_mfma_f32_16x16x32_bf16 v[40:43], a[124:127], a[104:107], v[40:43]
ds_read_b64_tr_b16 a[116:117], v25 offset:40960
buffer_load_dwordx4 v10, s[12:15], s32 offen lds
v_mfma_f32_16x16x32_bf16 v[40:43], a[120:123], a[96:99], v[40:43]
s_waitcnt lgkmcnt(7)
ds_read_b64_tr_b16 a[118:119], v25 offset:45056
buffer_load_dwordx4 a[36:39], v6, s[16:19], s33 offen offset:0 sc1
v_mfma_f32_16x16x32_bf16 v[48:51], a[128:131], a[96:99], v[48:51]
ds_read_b64_tr_b16 a[120:121], v26 offset:32768
v_mfma_f32_16x16x32_bf16 v[48:51], a[132:135], a[104:107], v[48:51]
s_add_u32 m0, s31, 34816
ds_read_b64_tr_b16 a[122:123], v26 offset:36864
v_mfma_f32_16x16x32_bf16 v[52:55], a[132:135], a[108:111], v[52:55]
ds_read_b64_tr_b16 a[124:125], v26 offset:40960
buffer_load_dwordx4 v11, s[12:15], s32 offen lds
v_mfma_f32_16x16x32_bf16 v[52:55], a[128:131], a[100:103], v[52:55]
s_waitcnt lgkmcnt(7)
ds_read_b64_tr_b16 a[126:127], v26 offset:45056
buffer_load_dwordx4 a[40:43], v5, s[16:19], s33 offen offset:1024 sc1
v_mfma_f32_16x16x32_bf16 v[60:63], a[136:139], a[100:103], v[60:63]
ds_read_b64_tr_b16 a[128:129], v27 offset:32768
v_mfma_f32_16x16x32_bf16 v[60:63], a[140:143], a[108:111], v[60:63]
s_add_u32 m0, s31, 35840
ds_read_b64_tr_b16 a[130:131], v27 offset:36864
v_mfma_f32_16x16x32_bf16 v[56:59], a[140:143], a[104:107], v[56:59]
ds_read_b64_tr_b16 a[132:133], v27 offset:40960
buffer_load_dwordx4 v12, s[12:15], s32 offen lds
s_add_u32 s32, s32, 131072
v_mfma_f32_16x16x32_bf16 v[56:59], a[136:139], a[96:99], v[56:59]
s_waitcnt lgkmcnt(7)
ds_read_b64_tr_b16 a[134:135], v27 offset:45056
buffer_load_dwordx4 a[44:47], v6, s[16:19], s33 offen offset:1024 sc1
v_mfma_f32_16x16x32_bf16 v[64:67], a[112:115], a[96:99], v[64:67]
ds_read_b64_tr_b16 a[136:137], v28 offset:32768
v_mfma_f32_16x16x32_bf16 v[64:67], a[116:119], a[104:107], v[64:67]
ds_read_b64_tr_b16 a[138:139], v28 offset:36864
v_mfma_f32_16x16x32_bf16 v[68:71], a[116:119], a[108:111], v[68:71]
ds_read_b64_tr_b16 a[140:141], v28 offset:40960
v_mfma_f32_16x16x32_bf16 v[68:71], a[112:115], a[100:103], v[68:71]
s_waitcnt lgkmcnt(7)
ds_read_b64_tr_b16 a[142:143], v28 offset:45056
v_mfma_f32_16x16x32_bf16 v[76:79], a[120:123], a[100:103], v[76:79]
s_waitcnt vmcnt(19)
s_barrier
ds_read_b64_tr_b16 a[112:113], v13 offset:0
v_mfma_f32_16x16x32_bf16 v[76:79], a[124:127], a[108:111], v[76:79]
ds_read_b64_tr_b16 a[114:115], v13 offset:4096
v_mfma_f32_16x16x32_bf16 v[72:75], a[124:127], a[104:107], v[72:75]
ds_read_b64_tr_b16 a[116:117], v13 offset:8192
v_mfma_f32_16x16x32_bf16 v[72:75], a[120:123], a[96:99], v[72:75]
s_waitcnt lgkmcnt(7)
ds_read_b64_tr_b16 a[118:119], v13 offset:12288
v_mfma_f32_16x16x32_bf16 v[80:83], a[128:131], a[96:99], v[80:83]
ds_read_b64_tr_b16 a[120:121], v14 offset:0
v_mfma_f32_16x16x32_bf16 v[80:83], a[132:135], a[104:107], v[80:83]
ds_read_b64_tr_b16 a[122:123], v14 offset:4096
v_mfma_f32_16x16x32_bf16 v[84:87], a[132:135], a[108:111], v[84:87]
ds_read_b64_tr_b16 a[124:125], v14 offset:8192
v_mfma_f32_16x16x32_bf16 v[84:87], a[128:131], a[100:103], v[84:87]
s_waitcnt lgkmcnt(7)
ds_read_b64_tr_b16 a[126:127], v14 offset:12288
v_mfma_f32_16x16x32_bf16 v[92:95], a[136:139], a[100:103], v[92:95]
ds_read_b64_tr_b16 a[128:129], v15 offset:0
v_mfma_f32_16x16x32_bf16 v[92:95], a[140:143], a[108:111], v[92:95]
ds_read_b64_tr_b16 a[130:131], v15 offset:4096
v_mfma_f32_16x16x32_bf16 v[88:91], a[140:143], a[104:107], v[88:91]
ds_read_b64_tr_b16 a[132:133], v15 offset:8192
v_mfma_f32_16x16x32_bf16 v[88:91], a[136:139], a[96:99], v[88:91]
s_waitcnt vmcnt(18) lgkmcnt(7)
ds_read_b64_tr_b16 a[134:135], v15 offset:12288
s_sub_u32 s34, s34, 1
s_cmp_lg_u32 s34, 0
s_cbranch_scc1 L_dn_loop
s_lshl_b32 s37, s26, 1
s_add_u32 s37, s37, s27
v_lshrrev_b32 v3, 4, v1
v_lshlrev_b32 v129, 4, v3
s_lshl_b32 s39, s30, 15
s_lshl_b32 s28, s37, 11
s_add_u32 s39, s39, s28
s_add_u32 s39, s39, 25231360
s_lshl_b32 s40, s37, 8
s_add_u32 s40, s40, 71389184
v_mfma_f32_16x16x32_bf16 v[32:35], a[112:115], a[0:3], v[32:35]
ds_read_b64_tr_b16 a[136:137], v16 offset:0
v_mfma_f32_16x16x32_bf16 v[32:35], a[116:119], a[8:11], v[32:35]
s_add_u32 m0, s31, 49152
ds_read_b64_tr_b16 a[138:139], v16 offset:4096
v_mfma_f32_16x16x32_bf16 v[36:39], a[116:119], a[12:15], v[36:39]
ds_read_b64_tr_b16 a[140:141], v16 offset:8192
buffer_load_dwordx4 v9, s[12:15], s32 offen lds
v_mfma_f32_16x16x32_bf16 v[36:39], a[112:115], a[4:7], v[36:39]
s_waitcnt lgkmcnt(7)
ds_read_b64_tr_b16 a[142:143], v16 offset:12288
buffer_load_dwordx4 a[48:51], v5, s[16:19], s33 offen offset:2048 sc1
v_mfma_f32_16x16x32_bf16 v[44:47], a[120:123], a[4:7], v[44:47]
ds_read_b64_tr_b16 a[112:113], v17 offset:0
v_mfma_f32_16x16x32_bf16 v[44:47], a[124:127], a[12:15], v[44:47]
s_add_u32 m0, s31, 50176
ds_read_b64_tr_b16 a[114:115], v17 offset:4096
v_mfma_f32_16x16x32_bf16 v[40:43], a[124:127], a[8:11], v[40:43]
ds_read_b64_tr_b16 a[116:117], v17 offset:8192
buffer_load_dwordx4 v10, s[12:15], s32 offen lds
v_mfma_f32_16x16x32_bf16 v[40:43], a[120:123], a[0:3], v[40:43]
s_waitcnt lgkmcnt(7)
ds_read_b64_tr_b16 a[118:119], v17 offset:12288
buffer_load_dwordx4 a[52:55], v6, s[16:19], s33 offen offset:2048 sc1
v_mfma_f32_16x16x32_bf16 v[48:51], a[128:131], a[0:3], v[48:51]
ds_read_b64_tr_b16 a[120:121], v18 offset:0
v_mfma_f32_16x16x32_bf16 v[48:51], a[132:135], a[8:11], v[48:51]
s_add_u32 m0, s31, 51200
ds_read_b64_tr_b16 a[122:123], v18 offset:4096
v_mfma_f32_16x16x32_bf16 v[52:55], a[132:135], a[12:15], v[52:55]
ds_read_b64_tr_b16 a[124:125], v18 offset:8192
buffer_load_dwordx4 v11, s[12:15], s32 offen lds
v_mfma_f32_16x16x32_bf16 v[52:55], a[128:131], a[4:7], v[52:55]
s_waitcnt lgkmcnt(7)
ds_read_b64_tr_b16 a[126:127], v18 offset:12288
buffer_load_dwordx4 a[56:59], v5, s[16:19], s33 offen offset:3072 sc1
v_mfma_f32_16x16x32_bf16 v[60:63], a[136:139], a[4:7], v[60:63]
ds_read_b64_tr_b16 a[128:129], v19 offset:0
v_mfma_f32_16x16x32_bf16 v[60:63], a[140:143], a[12:15], v[60:63]
s_add_u32 m0, s31, 52224
ds_read_b64_tr_b16 a[130:131], v19 offset:4096
v_mfma_f32_16x16x32_bf16 v[56:59], a[140:143], a[8:11], v[56:59]
ds_read_b64_tr_b16 a[132:133], v19 offset:8192
buffer_load_dwordx4 v12, s[12:15], s32 offen lds
s_add_u32 s32, s32, 131072
v_mfma_f32_16x16x32_bf16 v[56:59], a[136:139], a[0:3], v[56:59]
s_waitcnt lgkmcnt(7)
ds_read_b64_tr_b16 a[134:135], v19 offset:12288
buffer_load_dwordx4 a[60:63], v6, s[16:19], s33 offen offset:3072 sc1
s_add_u32 s33, s33, 4096
v_mfma_f32_16x16x32_bf16 v[64:67], a[112:115], a[0:3], v[64:67]
ds_read_b64_tr_b16 a[136:137], v20 offset:0
v_mfma_f32_16x16x32_bf16 v[64:67], a[116:119], a[8:11], v[64:67]
ds_read_b64_tr_b16 a[138:139], v20 offset:4096
v_mfma_f32_16x16x32_bf16 v[68:71], a[116:119], a[12:15], v[68:71]
ds_read_b64_tr_b16 a[140:141], v20 offset:8192
buffer_load_dwordx4 v[96:99], v2, s[16:19], s39 offen offset:0 sc1
v_mfma_f32_16x16x32_bf16 v[68:71], a[112:115], a[4:7], v[68:71]
s_waitcnt lgkmcnt(7)
ds_read_b64_tr_b16 a[142:143], v20 offset:12288
v_mfma_f32_16x16x32_bf16 v[76:79], a[120:123], a[4:7], v[76:79]
s_waitcnt vmcnt(19)
s_barrier
ds_read_b64_tr_b16 a[112:113], v13 offset:16384
v_mfma_f32_16x16x32_bf16 v[76:79], a[124:127], a[12:15], v[76:79]
ds_read_b64_tr_b16 a[114:115], v13 offset:20480
v_mfma_f32_16x16x32_bf16 v[72:75], a[124:127], a[8:11], v[72:75]
ds_read_b64_tr_b16 a[116:117], v13 offset:24576
buffer_load_dwordx4 v[100:103], v2, s[16:19], s39 offen offset:1024 sc1
v_mfma_f32_16x16x32_bf16 v[72:75], a[120:123], a[0:3], v[72:75]
s_waitcnt lgkmcnt(7)
ds_read_b64_tr_b16 a[118:119], v13 offset:28672
v_mfma_f32_16x16x32_bf16 v[80:83], a[128:131], a[0:3], v[80:83]
ds_read_b64_tr_b16 a[120:121], v14 offset:16384
v_mfma_f32_16x16x32_bf16 v[80:83], a[132:135], a[8:11], v[80:83]
s_add_u32 s39, s39, 32768
ds_read_b64_tr_b16 a[122:123], v14 offset:20480
v_mfma_f32_16x16x32_bf16 v[84:87], a[132:135], a[12:15], v[84:87]
ds_read_b64_tr_b16 a[124:125], v14 offset:24576
buffer_load_dwordx4 v[104:107], v2, s[16:19], s39 offen offset:0 sc1
v_mfma_f32_16x16x32_bf16 v[84:87], a[128:131], a[4:7], v[84:87]
s_waitcnt lgkmcnt(7)
ds_read_b64_tr_b16 a[126:127], v14 offset:28672
v_mfma_f32_16x16x32_bf16 v[92:95], a[136:139], a[4:7], v[92:95]
ds_read_b64_tr_b16 a[128:129], v15 offset:16384
v_mfma_f32_16x16x32_bf16 v[92:95], a[140:143], a[12:15], v[92:95]
ds_read_b64_tr_b16 a[130:131], v15 offset:20480
v_mfma_f32_16x16x32_bf16 v[88:91], a[140:143], a[8:11], v[88:91]
ds_read_b64_tr_b16 a[132:133], v15 offset:24576
buffer_load_dwordx4 v[108:111], v2, s[16:19], s39 offen offset:1024 sc1
v_mfma_f32_16x16x32_bf16 v[88:91], a[136:139], a[0:3], v[88:91]
s_waitcnt vmcnt(20) lgkmcnt(7)
ds_read_b64_tr_b16 a[134:135], v15 offset:28672
v_mfma_f32_16x16x32_bf16 v[32:35], a[112:115], a[16:19], v[32:35]
ds_read_b64_tr_b16 a[136:137], v16 offset:16384
v_mfma_f32_16x16x32_bf16 v[32:35], a[116:119], a[24:27], v[32:35]
s_add_u32 m0, s31, 65536
ds_read_b64_tr_b16 a[138:139], v16 offset:20480
v_mfma_f32_16x16x32_bf16 v[36:39], a[116:119], a[28:31], v[36:39]
ds_read_b64_tr_b16 a[140:141], v16 offset:24576
buffer_load_dwordx4 v9, s[12:15], s32 offen lds
v_mfma_f32_16x16x32_bf16 v[36:39], a[112:115], a[20:23], v[36:39]
s_waitcnt lgkmcnt(7)
ds_read_b64_tr_b16 a[142:143], v16 offset:28672
buffer_load_dwordx4 a[64:67], v5, s[16:19], s33 offen offset:0 sc1
v_mfma_f32_16x16x32_bf16 v[44:47], a[120:123], a[20:23], v[44:47]
ds_read_b64_tr_b16 a[112:113], v17 offset:16384
v_mfma_f32_16x16x32_bf16 v[44:47], a[124:127], a[28:31], v[44:47]
s_add_u32 m0, s31, 66560
ds_read_b64_tr_b16 a[114:115], v17 offset:20480
v_mfma_f32_16x16x32_bf16 v[40:43], a[124:127], a[24:27], v[40:43]
ds_read_b64_tr_b16 a[116:117], v17 offset:24576
buffer_load_dwordx4 v10, s[12:15], s32 offen lds
v_mfma_f32_16x16x32_bf16 v[40:43], a[120:123], a[16:19], v[40:43]
s_waitcnt lgkmcnt(7)
ds_read_b64_tr_b16 a[118:119], v17 offset:28672
buffer_load_dwordx4 a[68:71], v6, s[16:19], s33 offen offset:0 sc1
v_mfma_f32_16x16x32_bf16 v[48:51], a[128:131], a[16:19], v[48:51]
ds_read_b64_tr_b16 a[120:121], v18 offset:16384
v_mfma_f32_16x16x32_bf16 v[48:51], a[132:135], a[24:27], v[48:51]
s_add_u32 m0, s31, 67584
ds_read_b64_tr_b16 a[122:123], v18 offset:20480
v_mfma_f32_16x16x32_bf16 v[52:55], a[132:135], a[28:31], v[52:55]
ds_read_b64_tr_b16 a[124:125], v18 offset:24576
buffer_load_dwordx4 v11, s[12:15], s32 offen lds
v_mfma_f32_16x16x32_bf16 v[52:55], a[128:131], a[20:23], v[52:55]
s_waitcnt lgkmcnt(7)
ds_read_b64_tr_b16 a[126:127], v18 offset:28672
buffer_load_dwordx4 a[72:75], v5, s[16:19], s33 offen offset:1024 sc1
v_mfma_f32_16x16x32_bf16 v[60:63], a[136:139], a[20:23], v[60:63]
ds_read_b64_tr_b16 a[128:129], v19 offset:16384
v_mfma_f32_16x16x32_bf16 v[60:63], a[140:143], a[28:31], v[60:63]
s_add_u32 m0, s31, 68608
ds_read_b64_tr_b16 a[130:131], v19 offset:20480
v_mfma_f32_16x16x32_bf16 v[56:59], a[140:143], a[24:27], v[56:59]
ds_read_b64_tr_b16 a[132:133], v19 offset:24576
buffer_load_dwordx4 v12, s[12:15], s32 offen lds
s_add_u32 s32, s32, 131072
v_mfma_f32_16x16x32_bf16 v[56:59], a[136:139], a[16:19], v[56:59]
s_waitcnt lgkmcnt(7)
ds_read_b64_tr_b16 a[134:135], v19 offset:28672
buffer_load_dwordx4 a[76:79], v6, s[16:19], s33 offen offset:1024 sc1
v_mfma_f32_16x16x32_bf16 v[64:67], a[112:115], a[16:19], v[64:67]
ds_read_b64_tr_b16 a[136:137], v20 offset:16384
v_mfma_f32_16x16x32_bf16 v[64:67], a[116:119], a[24:27], v[64:67]
ds_read_b64_tr_b16 a[138:139], v20 offset:20480
v_mfma_f32_16x16x32_bf16 v[68:71], a[116:119], a[28:31], v[68:71]
ds_read_b64_tr_b16 a[140:141], v20 offset:24576
buffer_load_dwordx4 v[112:115], v129, s[16:19], s40 offen offset:0
v_mfma_f32_16x16x32_bf16 v[68:71], a[112:115], a[20:23], v[68:71]
s_waitcnt lgkmcnt(7)
ds_read_b64_tr_b16 a[142:143], v20 offset:28672
v_mfma_f32_16x16x32_bf16 v[76:79], a[120:123], a[20:23], v[76:79]
s_waitcnt vmcnt(22)
s_barrier
ds_read_b64_tr_b16 a[112:113], v13 offset:32768
v_mfma_f32_16x16x32_bf16 v[76:79], a[124:127], a[28:31], v[76:79]
ds_read_b64_tr_b16 a[114:115], v13 offset:36864
v_mfma_f32_16x16x32_bf16 v[72:75], a[124:127], a[24:27], v[72:75]
ds_read_b64_tr_b16 a[116:117], v13 offset:40960
buffer_load_dwordx4 v[116:119], v129, s[16:19], s40 offen offset:64
v_mfma_f32_16x16x32_bf16 v[72:75], a[120:123], a[16:19], v[72:75]
s_waitcnt lgkmcnt(7)
ds_read_b64_tr_b16 a[118:119], v13 offset:45056
v_mfma_f32_16x16x32_bf16 v[80:83], a[128:131], a[16:19], v[80:83]
ds_read_b64_tr_b16 a[120:121], v14 offset:32768
v_mfma_f32_16x16x32_bf16 v[80:83], a[132:135], a[24:27], v[80:83]
ds_read_b64_tr_b16 a[122:123], v14 offset:36864
v_mfma_f32_16x16x32_bf16 v[84:87], a[132:135], a[28:31], v[84:87]
ds_read_b64_tr_b16 a[124:125], v14 offset:40960
buffer_load_dwordx4 v[120:123], v129, s[16:19], s40 offen offset:128
v_mfma_f32_16x16x32_bf16 v[84:87], a[128:131], a[20:23], v[84:87]
s_waitcnt lgkmcnt(7)
ds_read_b64_tr_b16 a[126:127], v14 offset:45056
v_mfma_f32_16x16x32_bf16 v[92:95], a[136:139], a[20:23], v[92:95]
ds_read_b64_tr_b16 a[128:129], v15 offset:32768
v_mfma_f32_16x16x32_bf16 v[92:95], a[140:143], a[28:31], v[92:95]
ds_read_b64_tr_b16 a[130:131], v15 offset:36864
v_mfma_f32_16x16x32_bf16 v[88:91], a[140:143], a[24:27], v[88:91]
ds_read_b64_tr_b16 a[132:133], v15 offset:40960
buffer_load_dwordx4 v[124:127], v129, s[16:19], s40 offen offset:192
v_mfma_f32_16x16x32_bf16 v[88:91], a[136:139], a[16:19], v[88:91]
s_waitcnt vmcnt(24) lgkmcnt(7)
ds_read_b64_tr_b16 a[134:135], v15 offset:45056
v_mfma_f32_16x16x32_bf16 v[32:35], a[112:115], a[32:35], v[32:35]
ds_read_b64_tr_b16 a[136:137], v16 offset:32768
v_mfma_f32_16x16x32_bf16 v[32:35], a[116:119], a[40:43], v[32:35]
s_add_u32 m0, s31, 81920
ds_read_b64_tr_b16 a[138:139], v16 offset:36864
v_mfma_f32_16x16x32_bf16 v[36:39], a[116:119], a[44:47], v[36:39]
ds_read_b64_tr_b16 a[140:141], v16 offset:40960
buffer_load_dwordx4 v9, s[12:15], s32 offen lds
v_mfma_f32_16x16x32_bf16 v[36:39], a[112:115], a[36:39], v[36:39]
s_waitcnt lgkmcnt(7)
ds_read_b64_tr_b16 a[142:143], v16 offset:45056
buffer_load_dwordx2 a[80:81], v7, s[16:19], s33 offen offset:2048 sc1
buffer_load_dwordx2 a[82:83], v7, s[16:19], s33 offen offset:2560 sc1
v_mfma_f32_16x16x32_bf16 v[44:47], a[120:123], a[36:39], v[44:47]
ds_read_b64_tr_b16 a[112:113], v17 offset:32768
v_mfma_f32_16x16x32_bf16 v[44:47], a[124:127], a[44:47], v[44:47]
s_add_u32 m0, s31, 82944
ds_read_b64_tr_b16 a[114:115], v17 offset:36864
v_mfma_f32_16x16x32_bf16 v[40:43], a[124:127], a[40:43], v[40:43]
ds_read_b64_tr_b16 a[116:117], v17 offset:40960
buffer_load_dwordx4 v10, s[12:15], s32 offen lds
v_mfma_f32_16x16x32_bf16 v[40:43], a[120:123], a[32:35], v[40:43]
s_waitcnt lgkmcnt(7)
ds_read_b64_tr_b16 a[118:119], v17 offset:45056
buffer_load_dwordx2 a[84:85], v8, s[16:19], s33 offen offset:2048 sc1
buffer_load_dwordx2 a[86:87], v8, s[16:19], s33 offen offset:2560 sc1
v_mfma_f32_16x16x32_bf16 v[48:51], a[128:131], a[32:35], v[48:51]
ds_read_b64_tr_b16 a[120:121], v18 offset:32768
v_mfma_f32_16x16x32_bf16 v[48:51], a[132:135], a[40:43], v[48:51]
s_add_u32 m0, s31, 83968
ds_read_b64_tr_b16 a[122:123], v18 offset:36864
v_mfma_f32_16x16x32_bf16 v[52:55], a[132:135], a[44:47], v[52:55]
ds_read_b64_tr_b16 a[124:125], v18 offset:40960
buffer_load_dwordx4 v11, s[12:15], s32 offen lds
v_mfma_f32_16x16x32_bf16 v[52:55], a[128:131], a[36:39], v[52:55]
s_waitcnt lgkmcnt(7)
ds_read_b64_tr_b16 a[126:127], v18 offset:45056
buffer_load_dwordx4 a[88:91], v5, s[16:19], s33 offen offset:3072 sc1
v_mfma_f32_16x16x32_bf16 v[60:63], a[136:139], a[36:39], v[60:63]
ds_read_b64_tr_b16 a[128:129], v19 offset:32768
v_mfma_f32_16x16x32_bf16 v[60:63], a[140:143], a[44:47], v[60:63]
s_add_u32 m0, s31, 84992
ds_read_b64_tr_b16 a[130:131], v19 offset:36864
v_mfma_f32_16x16x32_bf16 v[56:59], a[140:143], a[40:43], v[56:59]
ds_read_b64_tr_b16 a[132:133], v19 offset:40960
buffer_load_dwordx4 v12, s[12:15], s32 offen lds
s_add_u32 s32, s32, 131072
v_mfma_f32_16x16x32_bf16 v[56:59], a[136:139], a[32:35], v[56:59]
s_waitcnt lgkmcnt(7)
ds_read_b64_tr_b16 a[134:135], v19 offset:45056
buffer_load_dwordx4 a[92:95], v6, s[16:19], s33 offen offset:3072 sc1
s_add_u32 s33, s33, 4096
v_mfma_f32_16x16x32_bf16 v[64:67], a[112:115], a[32:35], v[64:67]
ds_read_b64_tr_b16 a[136:137], v20 offset:32768
v_mfma_f32_16x16x32_bf16 v[64:67], a[116:119], a[40:43], v[64:67]
s_add_u32 s40, s40, 24576
ds_read_b64_tr_b16 a[138:139], v20 offset:36864
v_mfma_f32_16x16x32_bf16 v[68:71], a[116:119], a[44:47], v[68:71]
ds_read_b64_tr_b16 a[140:141], v20 offset:40960
buffer_load_dwordx4 v[164:167], v129, s[16:19], s40 offen offset:0
v_mfma_f32_16x16x32_bf16 v[68:71], a[112:115], a[36:39], v[68:71]
s_waitcnt lgkmcnt(7)
ds_read_b64_tr_b16 a[142:143], v20 offset:45056
v_mfma_f32_16x16x32_bf16 v[76:79], a[120:123], a[36:39], v[76:79]
s_waitcnt vmcnt(28)
s_barrier
ds_read_b64_tr_b16 a[112:113], v13 offset:49152
v_mfma_f32_16x16x32_bf16 v[76:79], a[124:127], a[44:47], v[76:79]
ds_read_b64_tr_b16 a[114:115], v13 offset:53248
v_mfma_f32_16x16x32_bf16 v[72:75], a[124:127], a[40:43], v[72:75]
ds_read_b64_tr_b16 a[116:117], v13 offset:57344
buffer_load_dwordx4 v[168:171], v129, s[16:19], s40 offen offset:64
v_mfma_f32_16x16x32_bf16 v[72:75], a[120:123], a[32:35], v[72:75]
s_waitcnt lgkmcnt(7)
ds_read_b64_tr_b16 a[118:119], v13 offset:61440
v_mfma_f32_16x16x32_bf16 v[80:83], a[128:131], a[32:35], v[80:83]
ds_read_b64_tr_b16 a[120:121], v14 offset:49152
v_mfma_f32_16x16x32_bf16 v[80:83], a[132:135], a[40:43], v[80:83]
ds_read_b64_tr_b16 a[122:123], v14 offset:53248
v_mfma_f32_16x16x32_bf16 v[84:87], a[132:135], a[44:47], v[84:87]
ds_read_b64_tr_b16 a[124:125], v14 offset:57344
buffer_load_dwordx4 v[172:175], v129, s[16:19], s40 offen offset:128
v_mfma_f32_16x16x32_bf16 v[84:87], a[128:131], a[36:39], v[84:87]
s_waitcnt lgkmcnt(7)
ds_read_b64_tr_b16 a[126:127], v14 offset:61440
v_mfma_f32_16x16x32_bf16 v[92:95], a[136:139], a[36:39], v[92:95]
ds_read_b64_tr_b16 a[128:129], v15 offset:49152
v_mfma_f32_16x16x32_bf16 v[92:95], a[140:143], a[44:47], v[92:95]
ds_read_b64_tr_b16 a[130:131], v15 offset:53248
v_mfma_f32_16x16x32_bf16 v[88:91], a[140:143], a[40:43], v[88:91]
ds_read_b64_tr_b16 a[132:133], v15 offset:57344
buffer_load_dwordx4 v[176:179], v129, s[16:19], s40 offen offset:192
v_mfma_f32_16x16x32_bf16 v[88:91], a[136:139], a[32:35], v[88:91]
s_waitcnt vmcnt(30) lgkmcnt(7)
ds_read_b64_tr_b16 a[134:135], v15 offset:61440
v_mfma_f32_16x16x32_bf16 v[32:35], a[112:115], a[48:51], v[32:35]
ds_read_b64_tr_b16 a[136:137], v16 offset:49152
v_mfma_f32_16x16x32_bf16 v[32:35], a[116:119], a[56:59], v[32:35]
s_add_u32 m0, s31, 98304
ds_read_b64_tr_b16 a[138:139], v16 offset:53248
v_mfma_f32_16x16x32_bf16 v[36:39], a[116:119], a[60:63], v[36:39]
ds_read_b64_tr_b16 a[140:141], v16 offset:57344
buffer_load_dwordx4 v9, s[12:15], s32 offen lds
v_mfma_f32_16x16x32_bf16 v[36:39], a[112:115], a[52:55], v[36:39]
s_waitcnt lgkmcnt(7)
ds_read_b64_tr_b16 a[142:143], v16 offset:61440
buffer_load_dwordx4 a[96:99], v5, s[16:19], s33 offen offset:0 sc1
v_mfma_f32_16x16x32_bf16 v[44:47], a[120:123], a[52:55], v[44:47]
ds_read_b64_tr_b16 a[112:113], v17 offset:49152
v_mfma_f32_16x16x32_bf16 v[44:47], a[124:127], a[60:63], v[44:47]
s_add_u32 m0, s31, 99328
ds_read_b64_tr_b16 a[114:115], v17 offset:53248
v_mfma_f32_16x16x32_bf16 v[40:43], a[124:127], a[56:59], v[40:43]
ds_read_b64_tr_b16 a[116:117], v17 offset:57344
buffer_load_dwordx4 v10, s[12:15], s32 offen lds
v_mfma_f32_16x16x32_bf16 v[40:43], a[120:123], a[48:51], v[40:43]
s_waitcnt lgkmcnt(7)
ds_read_b64_tr_b16 a[118:119], v17 offset:61440
buffer_load_dwordx4 a[100:103], v6, s[16:19], s33 offen offset:0 sc1
v_mfma_f32_16x16x32_bf16 v[48:51], a[128:131], a[48:51], v[48:51]
ds_read_b64_tr_b16 a[120:121], v18 offset:49152
v_mfma_f32_16x16x32_bf16 v[48:51], a[132:135], a[56:59], v[48:51]
s_add_u32 m0, s31, 100352
ds_read_b64_tr_b16 a[122:123], v18 offset:53248
v_mfma_f32_16x16x32_bf16 v[52:55], a[132:135], a[60:63], v[52:55]
ds_read_b64_tr_b16 a[124:125], v18 offset:57344
buffer_load_dwordx4 v11, s[12:15], s32 offen lds
v_mfma_f32_16x16x32_bf16 v[52:55], a[128:131], a[52:55], v[52:55]
s_waitcnt lgkmcnt(7)
ds_read_b64_tr_b16 a[126:127], v18 offset:61440
buffer_load_dwordx4 a[104:107], v5, s[16:19], s33 offen offset:1024 sc1
v_mfma_f32_16x16x32_bf16 v[60:63], a[136:139], a[52:55], v[60:63]
ds_read_b64_tr_b16 a[128:129], v19 offset:49152
v_mfma_f32_16x16x32_bf16 v[60:63], a[140:143], a[60:63], v[60:63]
s_add_u32 m0, s31, 101376
ds_read_b64_tr_b16 a[130:131], v19 offset:53248
v_mfma_f32_16x16x32_bf16 v[56:59], a[140:143], a[56:59], v[56:59]
ds_read_b64_tr_b16 a[132:133], v19 offset:57344
buffer_load_dwordx4 v12, s[12:15], s32 offen lds
s_add_u32 s32, s32, 131072
v_mfma_f32_16x16x32_bf16 v[56:59], a[136:139], a[48:51], v[56:59]
s_waitcnt lgkmcnt(7)
ds_read_b64_tr_b16 a[134:135], v19 offset:61440
buffer_load_dwordx4 a[108:111], v6, s[16:19], s33 offen offset:1024 sc1
v_mfma_f32_16x16x32_bf16 v[64:67], a[112:115], a[48:51], v[64:67]
ds_read_b64_tr_b16 a[136:137], v20 offset:49152
v_mfma_f32_16x16x32_bf16 v[64:67], a[116:119], a[56:59], v[64:67]
s_add_u32 s40, s40, 24576
ds_read_b64_tr_b16 a[138:139], v20 offset:53248
v_mfma_f32_16x16x32_bf16 v[68:71], a[116:119], a[60:63], v[68:71]
ds_read_b64_tr_b16 a[140:141], v20 offset:57344
buffer_load_dwordx4 v[180:183], v129, s[16:19], s40 offen offset:0
v_mfma_f32_16x16x32_bf16 v[68:71], a[112:115], a[52:55], v[68:71]
s_waitcnt lgkmcnt(7)
ds_read_b64_tr_b16 a[142:143], v20 offset:61440
v_mfma_f32_16x16x32_bf16 v[76:79], a[120:123], a[52:55], v[76:79]
s_waitcnt vmcnt(28)
s_barrier
ds_read_b64_tr_b16 a[112:113], v21 offset:0
v_mfma_f32_16x16x32_bf16 v[76:79], a[124:127], a[60:63], v[76:79]
ds_read_b64_tr_b16 a[114:115], v21 offset:4096
v_mfma_f32_16x16x32_bf16 v[72:75], a[124:127], a[56:59], v[72:75]
ds_read_b64_tr_b16 a[116:117], v21 offset:8192
buffer_load_dwordx4 v[184:187], v129, s[16:19], s40 offen offset:64
v_mfma_f32_16x16x32_bf16 v[72:75], a[120:123], a[48:51], v[72:75]
s_waitcnt lgkmcnt(7)
ds_read_b64_tr_b16 a[118:119], v21 offset:12288
v_mfma_f32_16x16x32_bf16 v[80:83], a[128:131], a[48:51], v[80:83]
ds_read_b64_tr_b16 a[120:121], v22 offset:0
v_mfma_f32_16x16x32_bf16 v[80:83], a[132:135], a[56:59], v[80:83]
ds_read_b64_tr_b16 a[122:123], v22 offset:4096
v_mfma_f32_16x16x32_bf16 v[84:87], a[132:135], a[60:63], v[84:87]
ds_read_b64_tr_b16 a[124:125], v22 offset:8192
buffer_load_dwordx4 v[188:191], v129, s[16:19], s40 offen offset:128
v_mfma_f32_16x16x32_bf16 v[84:87], a[128:131], a[52:55], v[84:87]
s_waitcnt lgkmcnt(7)
ds_read_b64_tr_b16 a[126:127], v22 offset:12288
v_mfma_f32_16x16x32_bf16 v[92:95], a[136:139], a[52:55], v[92:95]
ds_read_b64_tr_b16 a[128:129], v23 offset:0
v_mfma_f32_16x16x32_bf16 v[92:95], a[140:143], a[60:63], v[92:95]
ds_read_b64_tr_b16 a[130:131], v23 offset:4096
v_mfma_f32_16x16x32_bf16 v[88:91], a[140:143], a[56:59], v[88:91]
ds_read_b64_tr_b16 a[132:133], v23 offset:8192
buffer_load_dwordx4 v[192:195], v129, s[16:19], s40 offen offset:192
v_mfma_f32_16x16x32_bf16 v[88:91], a[136:139], a[48:51], v[88:91]
s_waitcnt vmcnt(30) lgkmcnt(7)
ds_read_b64_tr_b16 a[134:135], v23 offset:12288
v_mfma_f32_16x16x32_bf16 v[32:35], a[112:115], a[64:67], v[32:35]
ds_read_b64_tr_b16 a[136:137], v24 offset:0
v_mfma_f32_16x16x32_bf16 v[32:35], a[116:119], a[72:75], v[32:35]
s_add_u32 m0, s31, 0
ds_read_b64_tr_b16 a[138:139], v24 offset:4096
v_mfma_f32_16x16x32_bf16 v[36:39], a[116:119], a[76:79], v[36:39]
ds_read_b64_tr_b16 a[140:141], v24 offset:8192
buffer_load_dwordx4 v9, s[12:15], s32 offen lds
v_mfma_f32_16x16x32_bf16 v[36:39], a[112:115], a[68:71], v[36:39]
s_waitcnt lgkmcnt(7)
ds_read_b64_tr_b16 a[142:143], v24 offset:12288
buffer_load_dwordx4 a[0:3], v5, s[16:19], s33 offen offset:2048 sc1
v_mfma_f32_16x16x32_bf16 v[44:47], a[120:123], a[68:71], v[44:47]
ds_read_b64_tr_b16 a[112:113], v25 offset:0
v_mfma_f32_16x16x32_bf16 v[44:47], a[124:127], a[76:79], v[44:47]
s_add_u32 m0, s31, 1024
ds_read_b64_tr_b16 a[114:115], v25 offset:4096
v_mfma_f32_16x16x32_bf16 v[40:43], a[124:127], a[72:75], v[40:43]
ds_read_b64_tr_b16 a[116:117], v25 offset:8192
buffer_load_dwordx4 v10, s[12:15], s32 offen lds
v_mfma_f32_16x16x32_bf16 v[40:43], a[120:123], a[64:67], v[40:43]
s_waitcnt lgkmcnt(7)
ds_read_b64_tr_b16 a[118:119], v25 offset:12288
buffer_load_dwordx4 a[4:7], v6, s[16:19], s33 offen offset:2048 sc1
v_mfma_f32_16x16x32_bf16 v[48:51], a[128:131], a[64:67], v[48:51]
ds_read_b64_tr_b16 a[120:121], v26 offset:0
v_mfma_f32_16x16x32_bf16 v[48:51], a[132:135], a[72:75], v[48:51]
s_add_u32 m0, s31, 2048
ds_read_b64_tr_b16 a[122:123], v26 offset:4096
v_mfma_f32_16x16x32_bf16 v[52:55], a[132:135], a[76:79], v[52:55]
ds_read_b64_tr_b16 a[124:125], v26 offset:8192
buffer_load_dwordx4 v11, s[12:15], s32 offen lds
v_mfma_f32_16x16x32_bf16 v[52:55], a[128:131], a[68:71], v[52:55]
s_waitcnt lgkmcnt(7)
ds_read_b64_tr_b16 a[126:127], v26 offset:12288
buffer_load_dwordx4 a[8:11], v5, s[16:19], s33 offen offset:3072 sc1
v_mfma_f32_16x16x32_bf16 v[60:63], a[136:139], a[68:71], v[60:63]
ds_read_b64_tr_b16 a[128:129], v27 offset:0
v_mfma_f32_16x16x32_bf16 v[60:63], a[140:143], a[76:79], v[60:63]
s_add_u32 m0, s31, 3072
ds_read_b64_tr_b16 a[130:131], v27 offset:4096
v_mfma_f32_16x16x32_bf16 v[56:59], a[140:143], a[72:75], v[56:59]
ds_read_b64_tr_b16 a[132:133], v27 offset:8192
buffer_load_dwordx4 v12, s[12:15], s32 offen lds
s_add_u32 s32, s32, 131072
v_mfma_f32_16x16x32_bf16 v[56:59], a[136:139], a[64:67], v[56:59]
s_waitcnt lgkmcnt(7)
ds_read_b64_tr_b16 a[134:135], v27 offset:12288
buffer_load_dwordx4 a[12:15], v6, s[16:19], s33 offen offset:3072 sc1
s_add_u32 s33, s33, 4096
v_mfma_f32_16x16x32_bf16 v[64:67], a[112:115], a[64:67], v[64:67]
ds_read_b64_tr_b16 a[136:137], v28 offset:0
v_mfma_f32_16x16x32_bf16 v[64:67], a[116:119], a[72:75], v[64:67]
s_add_u32 s40, s40, 24576
ds_read_b64_tr_b16 a[138:139], v28 offset:4096
v_mfma_f32_16x16x32_bf16 v[68:71], a[116:119], a[76:79], v[68:71]
ds_read_b64_tr_b16 a[140:141], v28 offset:8192
buffer_load_dwordx4 v[196:199], v129, s[16:19], s40 offen offset:0
v_mfma_f32_16x16x32_bf16 v[68:71], a[112:115], a[68:71], v[68:71]
s_waitcnt lgkmcnt(7)
ds_read_b64_tr_b16 a[142:143], v28 offset:12288
v_mfma_f32_16x16x32_bf16 v[76:79], a[120:123], a[68:71], v[76:79]
s_waitcnt vmcnt(26)
s_barrier
ds_read_b64_tr_b16 a[112:113], v21 offset:16384
v_mfma_f32_16x16x32_bf16 v[76:79], a[124:127], a[76:79], v[76:79]
ds_read_b64_tr_b16 a[114:115], v21 offset:20480
v_mfma_f32_16x16x32_bf16 v[72:75], a[124:127], a[72:75], v[72:75]
ds_read_b64_tr_b16 a[116:117], v21 offset:24576
buffer_load_dwordx4 v[200:203], v129, s[16:19], s40 offen offset:64
v_mfma_f32_16x16x32_bf16 v[72:75], a[120:123], a[64:67], v[72:75]
s_waitcnt lgkmcnt(7)
ds_read_b64_tr_b16 a[118:119], v21 offset:28672
v_mfma_f32_16x16x32_bf16 v[80:83], a[128:131], a[64:67], v[80:83]
ds_read_b64_tr_b16 a[120:121], v22 offset:16384
v_mfma_f32_16x16x32_bf16 v[80:83], a[132:135], a[72:75], v[80:83]
ds_read_b64_tr_b16 a[122:123], v22 offset:20480
v_mfma_f32_16x16x32_bf16 v[84:87], a[132:135], a[76:79], v[84:87]
ds_read_b64_tr_b16 a[124:125], v22 offset:24576
buffer_load_dwordx4 v[204:207], v129, s[16:19], s40 offen offset:128
v_mfma_f32_16x16x32_bf16 v[84:87], a[128:131], a[68:71], v[84:87]
s_waitcnt lgkmcnt(7)
ds_read_b64_tr_b16 a[126:127], v22 offset:28672
v_mfma_f32_16x16x32_bf16 v[92:95], a[136:139], a[68:71], v[92:95]
ds_read_b64_tr_b16 a[128:129], v23 offset:16384
v_mfma_f32_16x16x32_bf16 v[92:95], a[140:143], a[76:79], v[92:95]
ds_read_b64_tr_b16 a[130:131], v23 offset:20480
v_mfma_f32_16x16x32_bf16 v[88:91], a[140:143], a[72:75], v[88:91]
ds_read_b64_tr_b16 a[132:133], v23 offset:24576
buffer_load_dwordx4 v[208:211], v129, s[16:19], s40 offen offset:192
v_mfma_f32_16x16x32_bf16 v[88:91], a[136:139], a[64:67], v[88:91]
s_waitcnt vmcnt(28) lgkmcnt(7)
ds_read_b64_tr_b16 a[134:135], v23 offset:28672
v_mfma_f32_16x16x32_bf16 v[32:35], a[112:115], a[80:83], v[32:35]
ds_read_b64_tr_b16 a[136:137], v24 offset:16384
v_mfma_f32_16x16x32_bf16 v[32:35], a[116:119], a[88:91], v[32:35]
s_add_u32 m0, s31, 16384
ds_read_b64_tr_b16 a[138:139], v24 offset:20480
v_mfma_f32_16x16x32_bf16 v[36:39], a[116:119], a[92:95], v[36:39]
ds_read_b64_tr_b16 a[140:141], v24 offset:24576
buffer_load_dwordx4 v9, s[12:15], s32 offen lds
v_mfma_f32_16x16x32_bf16 v[36:39], a[112:115], a[84:87], v[36:39]
s_waitcnt lgkmcnt(7)
ds_read_b64_tr_b16 a[142:143], v24 offset:28672
buffer_load_dwordx4 a[16:19], v5, s[16:19], s33 offen offset:0 sc1
v_mfma_f32_16x16x32_bf16 v[44:47], a[120:123], a[84:87], v[44:47]
ds_read_b64_tr_b16 a[112:113], v25 offset:16384
v_mfma_f32_16x16x32_bf16 v[44:47], a[124:127], a[92:95], v[44:47]
s_add_u32 m0, s31, 17408
ds_read_b64_tr_b16 a[114:115], v25 offset:20480
v_mfma_f32_16x16x32_bf16 v[40:43], a[124:127], a[88:91], v[40:43]
ds_read_b64_tr_b16 a[116:117], v25 offset:24576
buffer_load_dwordx4 v10, s[12:15], s32 offen lds
v_mfma_f32_16x16x32_bf16 v[40:43], a[120:123], a[80:83], v[40:43]
s_waitcnt lgkmcnt(7)
ds_read_b64_tr_b16 a[118:119], v25 offset:28672
buffer_load_dwordx4 a[20:23], v6, s[16:19], s33 offen offset:0 sc1
v_mfma_f32_16x16x32_bf16 v[48:51], a[128:131], a[80:83], v[48:51]
ds_read_b64_tr_b16 a[120:121], v26 offset:16384
v_mfma_f32_16x16x32_bf16 v[48:51], a[132:135], a[88:91], v[48:51]
s_add_u32 m0, s31, 18432
ds_read_b64_tr_b16 a[122:123], v26 offset:20480
v_mfma_f32_16x16x32_bf16 v[52:55], a[132:135], a[92:95], v[52:55]
ds_read_b64_tr_b16 a[124:125], v26 offset:24576
buffer_load_dwordx4 v11, s[12:15], s32 offen lds
v_mfma_f32_16x16x32_bf16 v[52:55], a[128:131], a[84:87], v[52:55]
s_waitcnt lgkmcnt(7)
ds_read_b64_tr_b16 a[126:127], v26 offset:28672
buffer_load_dwordx2 a[24:25], v7, s[16:19], s33 offen offset:1024 sc1
buffer_load_dwordx2 a[26:27], v7, s[16:19], s33 offen offset:1536 sc1
v_mfma_f32_16x16x32_bf16 v[60:63], a[136:139], a[84:87], v[60:63]
ds_read_b64_tr_b16 a[128:129], v27 offset:16384
v_mfma_f32_16x16x32_bf16 v[60:63], a[140:143], a[92:95], v[60:63]
s_add_u32 m0, s31, 19456
ds_read_b64_tr_b16 a[130:131], v27 offset:20480
v_mfma_f32_16x16x32_bf16 v[56:59], a[140:143], a[88:91], v[56:59]
ds_read_b64_tr_b16 a[132:133], v27 offset:24576
buffer_load_dwordx4 v12, s[12:15], s32 offen lds
s_add_u32 s32, s32, 131072
v_mfma_f32_16x16x32_bf16 v[56:59], a[136:139], a[80:83], v[56:59]
s_waitcnt lgkmcnt(7)
ds_read_b64_tr_b16 a[134:135], v27 offset:28672
buffer_load_dwordx2 a[28:29], v8, s[16:19], s33 offen offset:1024 sc1
buffer_load_dwordx2 a[30:31], v8, s[16:19], s33 offen offset:1536 sc1
v_mfma_f32_16x16x32_bf16 v[64:67], a[112:115], a[80:83], v[64:67]
ds_read_b64_tr_b16 a[136:137], v28 offset:16384
v_mfma_f32_16x16x32_bf16 v[64:67], a[116:119], a[88:91], v[64:67]
ds_read_b64_tr_b16 a[138:139], v28 offset:20480
v_mfma_f32_16x16x32_bf16 v[68:71], a[116:119], a[92:95], v[68:71]
ds_read_b64_tr_b16 a[140:141], v28 offset:24576
v_mfma_f32_16x16x32_bf16 v[68:71], a[112:115], a[84:87], v[68:71]
s_waitcnt lgkmcnt(7)
ds_read_b64_tr_b16 a[142:143], v28 offset:28672
v_mfma_f32_16x16x32_bf16 v[76:79], a[120:123], a[84:87], v[76:79]
s_waitcnt vmcnt(27)
s_barrier
ds_read_b64_tr_b16 a[112:113], v21 offset:32768
v_mfma_f32_16x16x32_bf16 v[76:79], a[124:127], a[92:95], v[76:79]
ds_read_b64_tr_b16 a[114:115], v21 offset:36864
v_mfma_f32_16x16x32_bf16 v[72:75], a[124:127], a[88:91], v[72:75]
ds_read_b64_tr_b16 a[116:117], v21 offset:40960
v_mfma_f32_16x16x32_bf16 v[72:75], a[120:123], a[80:83], v[72:75]
s_waitcnt lgkmcnt(7)
ds_read_b64_tr_b16 a[118:119], v21 offset:45056
v_mfma_f32_16x16x32_bf16 v[80:83], a[128:131], a[80:83], v[80:83]
ds_read_b64_tr_b16 a[120:121], v22 offset:32768
v_mfma_f32_16x16x32_bf16 v[80:83], a[132:135], a[88:91], v[80:83]
ds_read_b64_tr_b16 a[122:123], v22 offset:36864
v_mfma_f32_16x16x32_bf16 v[84:87], a[132:135], a[92:95], v[84:87]
ds_read_b64_tr_b16 a[124:125], v22 offset:40960
v_mfma_f32_16x16x32_bf16 v[84:87], a[128:131], a[84:87], v[84:87]
s_waitcnt lgkmcnt(7)
ds_read_b64_tr_b16 a[126:127], v22 offset:45056
v_mfma_f32_16x16x32_bf16 v[92:95], a[136:139], a[84:87], v[92:95]
ds_read_b64_tr_b16 a[128:129], v23 offset:32768
v_mfma_f32_16x16x32_bf16 v[92:95], a[140:143], a[92:95], v[92:95]
ds_read_b64_tr_b16 a[130:131], v23 offset:36864
v_mfma_f32_16x16x32_bf16 v[88:91], a[140:143], a[88:91], v[88:91]
ds_read_b64_tr_b16 a[132:133], v23 offset:40960
v_mfma_f32_16x16x32_bf16 v[88:91], a[136:139], a[80:83], v[88:91]
s_waitcnt vmcnt(26) lgkmcnt(7)
ds_read_b64_tr_b16 a[134:135], v23 offset:45056
v_mfma_f32_16x16x32_bf16 v[32:35], a[112:115], a[96:99], v[32:35]
ds_read_b64_tr_b16 a[136:137], v24 offset:32768
v_mfma_f32_16x16x32_bf16 v[32:35], a[116:119], a[104:107], v[32:35]
s_add_u32 m0, s31, 32768
ds_read_b64_tr_b16 a[138:139], v24 offset:36864
v_mfma_f32_16x16x32_bf16 v[36:39], a[116:119], a[108:111], v[36:39]
ds_read_b64_tr_b16 a[140:141], v24 offset:40960
buffer_load_dwordx4 v9, s[12:15], s32 offen lds
v_mfma_f32_16x16x32_bf16 v[36:39], a[112:115], a[100:103], v[36:39]
s_waitcnt lgkmcnt(7)
ds_read_b64_tr_b16 a[142:143], v24 offset:45056
buffer_load_dwordx4 a[32:35], v5, s[16:19], s33 offen offset:2048 sc1
v_mfma_f32_16x16x32_bf16 v[44:47], a[120:123], a[100:103], v[44:47]
ds_read_b64_tr_b16 a[112:113], v25 offset:32768
v_mfma_f32_16x16x32_bf16 v[44:47], a[124:127], a[108:111], v[44:47]
s_add_u32 m0, s31, 33792
ds_read_b64_tr_b16 a[114:115], v25 offset:36864
v_mfma_f32_16x16x32_bf16 v[40:43], a[124:127], a[104:107], v[40:43]
ds_read_b64_tr_b16 a[116:117], v25 offset:40960
buffer_load_dwordx4 v10, s[12:15], s32 offen lds
v_mfma_f32_16x16x32_bf16 v[40:43], a[120:123], a[96:99], v[40:43]
s_waitcnt lgkmcnt(7)
ds_read_b64_tr_b16 a[118:119], v25 offset:45056
buffer_load_dwordx4 a[36:39], v6, s[16:19], s33 offen offset:2048 sc1
v_mfma_f32_16x16x32_bf16 v[48:51], a[128:131], a[96:99], v[48:51]
ds_read_b64_tr_b16 a[120:121], v26 offset:32768
v_mfma_f32_16x16x32_bf16 v[48:51], a[132:135], a[104:107], v[48:51]
s_add_u32 m0, s31, 34816
ds_read_b64_tr_b16 a[122:123], v26 offset:36864
v_mfma_f32_16x16x32_bf16 v[52:55], a[132:135], a[108:111], v[52:55]
ds_read_b64_tr_b16 a[124:125], v26 offset:40960
buffer_load_dwordx4 v11, s[12:15], s32 offen lds
v_mfma_f32_16x16x32_bf16 v[52:55], a[128:131], a[100:103], v[52:55]
s_waitcnt lgkmcnt(7)
ds_read_b64_tr_b16 a[126:127], v26 offset:45056
buffer_load_dwordx4 a[40:43], v5, s[16:19], s33 offen offset:3072 sc1
v_mfma_f32_16x16x32_bf16 v[60:63], a[136:139], a[100:103], v[60:63]
ds_read_b64_tr_b16 a[128:129], v27 offset:32768
v_mfma_f32_16x16x32_bf16 v[60:63], a[140:143], a[108:111], v[60:63]
s_add_u32 m0, s31, 35840
ds_read_b64_tr_b16 a[130:131], v27 offset:36864
v_mfma_f32_16x16x32_bf16 v[56:59], a[140:143], a[104:107], v[56:59]
ds_read_b64_tr_b16 a[132:133], v27 offset:40960
buffer_load_dwordx4 v12, s[12:15], s32 offen lds
s_add_u32 s32, s32, 131072
v_mfma_f32_16x16x32_bf16 v[56:59], a[136:139], a[96:99], v[56:59]
s_waitcnt lgkmcnt(7)
ds_read_b64_tr_b16 a[134:135], v27 offset:45056
buffer_load_dwordx4 a[44:47], v6, s[16:19], s33 offen offset:3072 sc1
s_add_u32 s33, s33, 4096
v_mfma_f32_16x16x32_bf16 v[64:67], a[112:115], a[96:99], v[64:67]
ds_read_b64_tr_b16 a[136:137], v28 offset:32768
v_mfma_f32_16x16x32_bf16 v[64:67], a[116:119], a[104:107], v[64:67]
ds_read_b64_tr_b16 a[138:139], v28 offset:36864
v_mfma_f32_16x16x32_bf16 v[68:71], a[116:119], a[108:111], v[68:71]
ds_read_b64_tr_b16 a[140:141], v28 offset:40960
v_mfma_f32_16x16x32_bf16 v[68:71], a[112:115], a[100:103], v[68:71]
s_waitcnt lgkmcnt(7)
ds_read_b64_tr_b16 a[142:143], v28 offset:45056
v_mfma_f32_16x16x32_bf16 v[76:79], a[120:123], a[100:103], v[76:79]
s_waitcnt vmcnt(23)
s_barrier
ds_read_b64_tr_b16 a[112:113], v13 offset:0
v_mfma_f32_16x16x32_bf16 v[76:79], a[124:127], a[108:111], v[76:79]
ds_read_b64_tr_b16 a[114:115], v13 offset:4096
v_mfma_f32_16x16x32_bf16 v[72:75], a[124:127], a[104:107], v[72:75]
ds_read_b64_tr_b16 a[116:117], v13 offset:8192
v_mfma_f32_16x16x32_bf16 v[72:75], a[120:123], a[96:99], v[72:75]
s_waitcnt lgkmcnt(7)
ds_read_b64_tr_b16 a[118:119], v13 offset:12288
v_mfma_f32_16x16x32_bf16 v[80:83], a[128:131], a[96:99], v[80:83]
ds_read_b64_tr_b16 a[120:121], v14 offset:0
v_mfma_f32_16x16x32_bf16 v[80:83], a[132:135], a[104:107], v[80:83]
ds_read_b64_tr_b16 a[122:123], v14 offset:4096
v_mfma_f32_16x16x32_bf16 v[84:87], a[132:135], a[108:111], v[84:87]
ds_read_b64_tr_b16 a[124:125], v14 offset:8192
v_mfma_f32_16x16x32_bf16 v[84:87], a[128:131], a[100:103], v[84:87]
s_waitcnt lgkmcnt(7)
ds_read_b64_tr_b16 a[126:127], v14 offset:12288
v_mfma_f32_16x16x32_bf16 v[92:95], a[136:139], a[100:103], v[92:95]
ds_read_b64_tr_b16 a[128:129], v15 offset:0
v_mfma_f32_16x16x32_bf16 v[92:95], a[140:143], a[108:111], v[92:95]
ds_read_b64_tr_b16 a[130:131], v15 offset:4096
v_mfma_f32_16x16x32_bf16 v[88:91], a[140:143], a[104:107], v[88:91]
ds_read_b64_tr_b16 a[132:133], v15 offset:8192
v_mfma_f32_16x16x32_bf16 v[88:91], a[136:139], a[96:99], v[88:91]
s_waitcnt vmcnt(22) lgkmcnt(7)
ds_read_b64_tr_b16 a[134:135], v15 offset:12288
v_mfma_f32_16x16x32_bf16 v[32:35], a[112:115], a[0:3], v[32:35]
ds_read_b64_tr_b16 a[136:137], v16 offset:0
v_mfma_f32_16x16x32_bf16 v[32:35], a[116:119], a[8:11], v[32:35]
s_add_u32 m0, s31, 49152
ds_read_b64_tr_b16 a[138:139], v16 offset:4096
v_mfma_f32_16x16x32_bf16 v[36:39], a[116:119], a[12:15], v[36:39]
ds_read_b64_tr_b16 a[140:141], v16 offset:8192
buffer_load_dwordx4 v9, s[12:15], s32 offen lds
v_mfma_f32_16x16x32_bf16 v[36:39], a[112:115], a[4:7], v[36:39]
s_waitcnt lgkmcnt(7)
ds_read_b64_tr_b16 a[142:143], v16 offset:12288
buffer_load_dwordx4 a[48:51], v5, s[16:19], s33 offen offset:0 sc1
v_mfma_f32_16x16x32_bf16 v[44:47], a[120:123], a[4:7], v[44:47]
ds_read_b64_tr_b16 a[112:113], v17 offset:0
v_mfma_f32_16x16x32_bf16 v[44:47], a[124:127], a[12:15], v[44:47]
s_add_u32 m0, s31, 50176
ds_read_b64_tr_b16 a[114:115], v17 offset:4096
v_mfma_f32_16x16x32_bf16 v[40:43], a[124:127], a[8:11], v[40:43]
ds_read_b64_tr_b16 a[116:117], v17 offset:8192
buffer_load_dwordx4 v10, s[12:15], s32 offen lds
v_mfma_f32_16x16x32_bf16 v[40:43], a[120:123], a[0:3], v[40:43]
s_waitcnt lgkmcnt(7)
ds_read_b64_tr_b16 a[118:119], v17 offset:12288
buffer_load_dwordx4 a[52:55], v6, s[16:19], s33 offen offset:0 sc1
v_mfma_f32_16x16x32_bf16 v[48:51], a[128:131], a[0:3], v[48:51]
ds_read_b64_tr_b16 a[120:121], v18 offset:0
v_mfma_f32_16x16x32_bf16 v[48:51], a[132:135], a[8:11], v[48:51]
s_add_u32 m0, s31, 51200
ds_read_b64_tr_b16 a[122:123], v18 offset:4096
v_mfma_f32_16x16x32_bf16 v[52:55], a[132:135], a[12:15], v[52:55]
ds_read_b64_tr_b16 a[124:125], v18 offset:8192
buffer_load_dwordx4 v11, s[12:15], s32 offen lds
v_mfma_f32_16x16x32_bf16 v[52:55], a[128:131], a[4:7], v[52:55]
s_waitcnt lgkmcnt(7)
ds_read_b64_tr_b16 a[126:127], v18 offset:12288
buffer_load_dwordx4 a[56:59], v5, s[16:19], s33 offen offset:1024 sc1
v_mfma_f32_16x16x32_bf16 v[60:63], a[136:139], a[4:7], v[60:63]
ds_read_b64_tr_b16 a[128:129], v19 offset:0
v_mfma_f32_16x16x32_bf16 v[60:63], a[140:143], a[12:15], v[60:63]
s_add_u32 m0, s31, 52224
ds_read_b64_tr_b16 a[130:131], v19 offset:4096
v_mfma_f32_16x16x32_bf16 v[56:59], a[140:143], a[8:11], v[56:59]
ds_read_b64_tr_b16 a[132:133], v19 offset:8192
buffer_load_dwordx4 v12, s[12:15], s32 offen lds
s_add_u32 s32, s32, 131072
v_mfma_f32_16x16x32_bf16 v[56:59], a[136:139], a[0:3], v[56:59]
s_waitcnt lgkmcnt(7)
ds_read_b64_tr_b16 a[134:135], v19 offset:12288
buffer_load_dwordx4 a[60:63], v6, s[16:19], s33 offen offset:1024 sc1
v_mfma_f32_16x16x32_bf16 v[64:67], a[112:115], a[0:3], v[64:67]
ds_read_b64_tr_b16 a[136:137], v20 offset:0
v_mfma_f32_16x16x32_bf16 v[64:67], a[116:119], a[8:11], v[64:67]
ds_read_b64_tr_b16 a[138:139], v20 offset:4096
v_mfma_f32_16x16x32_bf16 v[68:71], a[116:119], a[12:15], v[68:71]
ds_read_b64_tr_b16 a[140:141], v20 offset:8192
v_mfma_f32_16x16x32_bf16 v[68:71], a[112:115], a[4:7], v[68:71]
s_waitcnt lgkmcnt(7)
ds_read_b64_tr_b16 a[142:143], v20 offset:12288
v_mfma_f32_16x16x32_bf16 v[76:79], a[120:123], a[4:7], v[76:79]
s_waitcnt vmcnt(18)
s_barrier
ds_read_b64_tr_b16 a[112:113], v13 offset:16384
v_mfma_f32_16x16x32_bf16 v[76:79], a[124:127], a[12:15], v[76:79]
ds_read_b64_tr_b16 a[114:115], v13 offset:20480
v_mfma_f32_16x16x32_bf16 v[72:75], a[124:127], a[8:11], v[72:75]
ds_read_b64_tr_b16 a[116:117], v13 offset:24576
v_mfma_f32_16x16x32_bf16 v[72:75], a[120:123], a[0:3], v[72:75]
s_waitcnt lgkmcnt(7)
ds_read_b64_tr_b16 a[118:119], v13 offset:28672
v_mfma_f32_16x16x32_bf16 v[80:83], a[128:131], a[0:3], v[80:83]
ds_read_b64_tr_b16 a[120:121], v14 offset:16384
v_mfma_f32_16x16x32_bf16 v[80:83], a[132:135], a[8:11], v[80:83]
ds_read_b64_tr_b16 a[122:123], v14 offset:20480
v_mfma_f32_16x16x32_bf16 v[84:87], a[132:135], a[12:15], v[84:87]
ds_read_b64_tr_b16 a[124:125], v14 offset:24576
v_mfma_f32_16x16x32_bf16 v[84:87], a[128:131], a[4:7], v[84:87]
s_waitcnt lgkmcnt(7)
ds_read_b64_tr_b16 a[126:127], v14 offset:28672
v_mfma_f32_16x16x32_bf16 v[92:95], a[136:139], a[4:7], v[92:95]
ds_read_b64_tr_b16 a[128:129], v15 offset:16384
v_mfma_f32_16x16x32_bf16 v[92:95], a[140:143], a[12:15], v[92:95]
ds_read_b64_tr_b16 a[130:131], v15 offset:20480
v_mfma_f32_16x16x32_bf16 v[88:91], a[140:143], a[8:11], v[88:91]
ds_read_b64_tr_b16 a[132:133], v15 offset:24576
v_mfma_f32_16x16x32_bf16 v[88:91], a[136:139], a[0:3], v[88:91]
s_waitcnt vmcnt(16) lgkmcnt(7)
ds_read_b64_tr_b16 a[134:135], v15 offset:28672
v_mfma_f32_16x16x32_bf16 v[32:35], a[112:115], a[16:19], v[32:35]
ds_read_b64_tr_b16 a[136:137], v16 offset:16384
v_mfma_f32_16x16x32_bf16 v[32:35], a[116:119], a[24:27], v[32:35]
s_add_u32 m0, s31, 65536
ds_read_b64_tr_b16 a[138:139], v16 offset:20480
v_mfma_f32_16x16x32_bf16 v[36:39], a[116:119], a[28:31], v[36:39]
ds_read_b64_tr_b16 a[140:141], v16 offset:24576
buffer_load_dwordx4 v9, s[12:15], s32 offen lds
v_mfma_f32_16x16x32_bf16 v[36:39], a[112:115], a[20:23], v[36:39]
s_waitcnt lgkmcnt(7)
ds_read_b64_tr_b16 a[142:143], v16 offset:28672
buffer_load_dwordx4 a[64:67], v5, s[16:19], s33 offen offset:2048 sc1
v_mfma_f32_16x16x32_bf16 v[44:47], a[120:123], a[20:23], v[44:47]
ds_read_b64_tr_b16 a[112:113], v17 offset:16384
v_mfma_f32_16x16x32_bf16 v[44:47], a[124:127], a[28:31], v[44:47]
s_add_u32 m0, s31, 66560
ds_read_b64_tr_b16 a[114:115], v17 offset:20480
v_mfma_f32_16x16x32_bf16 v[40:43], a[124:127], a[24:27], v[40:43]
ds_read_b64_tr_b16 a[116:117], v17 offset:24576
buffer_load_dwordx4 v10, s[12:15], s32 offen lds
v_mfma_f32_16x16x32_bf16 v[40:43], a[120:123], a[16:19], v[40:43]
s_waitcnt lgkmcnt(7)
ds_read_b64_tr_b16 a[118:119], v17 offset:28672
buffer_load_dwordx4 a[68:71], v6, s[16:19], s33 offen offset:2048 sc1
v_mfma_f32_16x16x32_bf16 v[48:51], a[128:131], a[16:19], v[48:51]
ds_read_b64_tr_b16 a[120:121], v18 offset:16384
v_mfma_f32_16x16x32_bf16 v[48:51], a[132:135], a[24:27], v[48:51]
s_add_u32 m0, s31, 67584
ds_read_b64_tr_b16 a[122:123], v18 offset:20480
v_mfma_f32_16x16x32_bf16 v[52:55], a[132:135], a[28:31], v[52:55]
ds_read_b64_tr_b16 a[124:125], v18 offset:24576
buffer_load_dwordx4 v11, s[12:15], s32 offen lds
v_mfma_f32_16x16x32_bf16 v[52:55], a[128:131], a[20:23], v[52:55]
s_waitcnt lgkmcnt(7)
ds_read_b64_tr_b16 a[126:127], v18 offset:28672
buffer_load_dwordx4 a[72:75], v5, s[16:19], s33 offen offset:3072 sc1
v_mfma_f32_16x16x32_bf16 v[60:63], a[136:139], a[20:23], v[60:63]
ds_read_b64_tr_b16 a[128:129], v19 offset:16384
v_mfma_f32_16x16x32_bf16 v[60:63], a[140:143], a[28:31], v[60:63]
s_add_u32 m0, s31, 68608
ds_read_b64_tr_b16 a[130:131], v19 offset:20480
v_mfma_f32_16x16x32_bf16 v[56:59], a[140:143], a[24:27], v[56:59]
ds_read_b64_tr_b16 a[132:133], v19 offset:24576
buffer_load_dwordx4 v12, s[12:15], s32 offen lds
s_add_u32 s32, s32, 131072
v_mfma_f32_16x16x32_bf16 v[56:59], a[136:139], a[16:19], v[56:59]
s_waitcnt lgkmcnt(7)
ds_read_b64_tr_b16 a[134:135], v19 offset:28672
buffer_load_dwordx4 a[76:79], v6, s[16:19], s33 offen offset:3072 sc1
s_add_u32 s33, s33, 4096
v_mfma_f32_16x16x32_bf16 v[64:67], a[112:115], a[16:19], v[64:67]
ds_read_b64_tr_b16 a[136:137], v20 offset:16384
v_mfma_f32_16x16x32_bf16 v[64:67], a[116:119], a[24:27], v[64:67]
ds_read_b64_tr_b16 a[138:139], v20 offset:20480
v_mfma_f32_16x16x32_bf16 v[68:71], a[116:119], a[28:31], v[68:71]
ds_read_b64_tr_b16 a[140:141], v20 offset:24576
v_mfma_f32_16x16x32_bf16 v[68:71], a[112:115], a[20:23], v[68:71]
s_waitcnt lgkmcnt(7)
ds_read_b64_tr_b16 a[142:143], v20 offset:28672
v_mfma_f32_16x16x32_bf16 v[76:79], a[120:123], a[20:23], v[76:79]
s_waitcnt vmcnt(17)
s_barrier
ds_read_b64_tr_b16 a[112:113], v13 offset:32768
v_mfma_f32_16x16x32_bf16 v[76:79], a[124:127], a[28:31], v[76:79]
ds_read_b64_tr_b16 a[114:115], v13 offset:36864
v_mfma_f32_16x16x32_bf16 v[72:75], a[124:127], a[24:27], v[72:75]
ds_read_b64_tr_b16 a[116:117], v13 offset:40960
v_mfma_f32_16x16x32_bf16 v[72:75], a[120:123], a[16:19], v[72:75]
s_waitcnt lgkmcnt(7)
ds_read_b64_tr_b16 a[118:119], v13 offset:45056
v_mfma_f32_16x16x32_bf16 v[80:83], a[128:131], a[16:19], v[80:83]
ds_read_b64_tr_b16 a[120:121], v14 offset:32768
v_mfma_f32_16x16x32_bf16 v[80:83], a[132:135], a[24:27], v[80:83]
ds_read_b64_tr_b16 a[122:123], v14 offset:36864
v_mfma_f32_16x16x32_bf16 v[84:87], a[132:135], a[28:31], v[84:87]
ds_read_b64_tr_b16 a[124:125], v14 offset:40960
v_mfma_f32_16x16x32_bf16 v[84:87], a[128:131], a[20:23], v[84:87]
s_waitcnt lgkmcnt(7)
ds_read_b64_tr_b16 a[126:127], v14 offset:45056
v_mfma_f32_16x16x32_bf16 v[92:95], a[136:139], a[20:23], v[92:95]
ds_read_b64_tr_b16 a[128:129], v15 offset:32768
v_mfma_f32_16x16x32_bf16 v[92:95], a[140:143], a[28:31], v[92:95]
ds_read_b64_tr_b16 a[130:131], v15 offset:36864
v_mfma_f32_16x16x32_bf16 v[88:91], a[140:143], a[24:27], v[88:91]
ds_read_b64_tr_b16 a[132:133], v15 offset:40960
v_mfma_f32_16x16x32_bf16 v[88:91], a[136:139], a[16:19], v[88:91]
s_waitcnt vmcnt(16) lgkmcnt(7)
ds_read_b64_tr_b16 a[134:135], v15 offset:45056
v_mfma_f32_16x16x32_bf16 v[32:35], a[112:115], a[32:35], v[32:35]
ds_read_b64_tr_b16 a[136:137], v16 offset:32768
v_mfma_f32_16x16x32_bf16 v[32:35], a[116:119], a[40:43], v[32:35]
s_add_u32 m0, s31, 81920
ds_read_b64_tr_b16 a[138:139], v16 offset:36864
v_mfma_f32_16x16x32_bf16 v[36:39], a[116:119], a[44:47], v[36:39]
ds_read_b64_tr_b16 a[140:141], v16 offset:40960
buffer_load_dwordx4 v9, s[12:15], s32 offen lds
v_mfma_f32_16x16x32_bf16 v[36:39], a[112:115], a[36:39], v[36:39]
s_waitcnt lgkmcnt(7)
ds_read_b64_tr_b16 a[142:143], v16 offset:45056
buffer_load_dwordx2 a[80:81], v7, s[16:19], s33 offen offset:0 sc1
buffer_load_dwordx2 a[82:83], v7, s[16:19], s33 offen offset:512 sc1
v_mfma_f32_16x16x32_bf16 v[44:47], a[120:123], a[36:39], v[44:47]
ds_read_b64_tr_b16 a[112:113], v17 offset:32768
v_mfma_f32_16x16x32_bf16 v[44:47], a[124:127], a[44:47], v[44:47]
s_add_u32 m0, s31, 82944
ds_read_b64_tr_b16 a[114:115], v17 offset:36864
v_mfma_f32_16x16x32_bf16 v[40:43], a[124:127], a[40:43], v[40:43]
ds_read_b64_tr_b16 a[116:117], v17 offset:40960
buffer_load_dwordx4 v10, s[12:15], s32 offen lds
v_mfma_f32_16x16x32_bf16 v[40:43], a[120:123], a[32:35], v[40:43]
s_waitcnt lgkmcnt(7)
ds_read_b64_tr_b16 a[118:119], v17 offset:45056
buffer_load_dwordx2 a[84:85], v8, s[16:19], s33 offen offset:0 sc1
buffer_load_dwordx2 a[86:87], v8, s[16:19], s33 offen offset:512 sc1
v_mfma_f32_16x16x32_bf16 v[48:51], a[128:131], a[32:35], v[48:51]
ds_read_b64_tr_b16 a[120:121], v18 offset:32768
v_mfma_f32_16x16x32_bf16 v[48:51], a[132:135], a[40:43], v[48:51]
s_add_u32 m0, s31, 83968
ds_read_b64_tr_b16 a[122:123], v18 offset:36864
v_mfma_f32_16x16x32_bf16 v[52:55], a[132:135], a[44:47], v[52:55]
ds_read_b64_tr_b16 a[124:125], v18 offset:40960
buffer_load_dwordx4 v11, s[12:15], s32 offen lds
v_mfma_f32_16x16x32_bf16 v[52:55], a[128:131], a[36:39], v[52:55]
s_waitcnt lgkmcnt(7)
ds_read_b64_tr_b16 a[126:127], v18 offset:45056
buffer_load_dwordx4 a[88:91], v5, s[16:19], s33 offen offset:1024 sc1
v_mfma_f32_16x16x32_bf16 v[60:63], a[136:139], a[36:39], v[60:63]
ds_read_b64_tr_b16 a[128:129], v19 offset:32768
v_mfma_f32_16x16x32_bf16 v[60:63], a[140:143], a[44:47], v[60:63]
s_add_u32 m0, s31, 84992
ds_read_b64_tr_b16 a[130:131], v19 offset:36864
v_mfma_f32_16x16x32_bf16 v[56:59], a[140:143], a[40:43], v[56:59]
ds_read_b64_tr_b16 a[132:133], v19 offset:40960
buffer_load_dwordx4 v12, s[12:15], s32 offen lds
s_add_u32 s32, s32, 131072
v_mfma_f32_16x16x32_bf16 v[56:59], a[136:139], a[32:35], v[56:59]
s_waitcnt lgkmcnt(7)
ds_read_b64_tr_b16 a[134:135], v19 offset:45056
buffer_load_dwordx4 a[92:95], v6, s[16:19], s33 offen offset:1024 sc1
v_mfma_f32_16x16x32_bf16 v[64:67], a[112:115], a[32:35], v[64:67]
ds_read_b64_tr_b16 a[136:137], v20 offset:32768
v_mfma_f32_16x16x32_bf16 v[64:67], a[116:119], a[40:43], v[64:67]
ds_read_b64_tr_b16 a[138:139], v20 offset:36864
v_mfma_f32_16x16x32_bf16 v[68:71], a[116:119], a[44:47], v[68:71]
ds_read_b64_tr_b16 a[140:141], v20 offset:40960
v_mfma_f32_16x16x32_bf16 v[68:71], a[112:115], a[36:39], v[68:71]
s_waitcnt lgkmcnt(7)
ds_read_b64_tr_b16 a[142:143], v20 offset:45056
v_mfma_f32_16x16x32_bf16 v[76:79], a[120:123], a[36:39], v[76:79]
s_waitcnt vmcnt(19)
s_barrier
ds_read_b64_tr_b16 a[112:113], v13 offset:49152
v_mfma_f32_16x16x32_bf16 v[76:79], a[124:127], a[44:47], v[76:79]
ds_read_b64_tr_b16 a[114:115], v13 offset:53248
v_mfma_f32_16x16x32_bf16 v[72:75], a[124:127], a[40:43], v[72:75]
ds_read_b64_tr_b16 a[116:117], v13 offset:57344
v_mfma_f32_16x16x32_bf16 v[72:75], a[120:123], a[32:35], v[72:75]
s_waitcnt lgkmcnt(7)
ds_read_b64_tr_b16 a[118:119], v13 offset:61440
v_mfma_f32_16x16x32_bf16 v[80:83], a[128:131], a[32:35], v[80:83]
ds_read_b64_tr_b16 a[120:121], v14 offset:49152
v_mfma_f32_16x16x32_bf16 v[80:83], a[132:135], a[40:43], v[80:83]
ds_read_b64_tr_b16 a[122:123], v14 offset:53248
v_mfma_f32_16x16x32_bf16 v[84:87], a[132:135], a[44:47], v[84:87]
ds_read_b64_tr_b16 a[124:125], v14 offset:57344
v_mfma_f32_16x16x32_bf16 v[84:87], a[128:131], a[36:39], v[84:87]
s_waitcnt lgkmcnt(7)
ds_read_b64_tr_b16 a[126:127], v14 offset:61440
v_mfma_f32_16x16x32_bf16 v[92:95], a[136:139], a[36:39], v[92:95]
ds_read_b64_tr_b16 a[128:129], v15 offset:49152
v_mfma_f32_16x16x32_bf16 v[92:95], a[140:143], a[44:47], v[92:95]
ds_read_b64_tr_b16 a[130:131], v15 offset:53248
v_mfma_f32_16x16x32_bf16 v[88:91], a[140:143], a[40:43], v[88:91]
ds_read_b64_tr_b16 a[132:133], v15 offset:57344
v_mfma_f32_16x16x32_bf16 v[88:91], a[136:139], a[32:35], v[88:91]
s_waitcnt vmcnt(18) lgkmcnt(7)
ds_read_b64_tr_b16 a[134:135], v15 offset:61440
v_mfma_f32_16x16x32_bf16 v[32:35], a[112:115], a[48:51], v[32:35]
ds_read_b64_tr_b16 a[136:137], v16 offset:49152
v_mfma_f32_16x16x32_bf16 v[32:35], a[116:119], a[56:59], v[32:35]
s_add_u32 m0, s31, 98304
ds_read_b64_tr_b16 a[138:139], v16 offset:53248
v_mfma_f32_16x16x32_bf16 v[36:39], a[116:119], a[60:63], v[36:39]
ds_read_b64_tr_b16 a[140:141], v16 offset:57344
buffer_load_dwordx4 v9, s[12:15], s32 offen lds
v_mfma_f32_16x16x32_bf16 v[36:39], a[112:115], a[52:55], v[36:39]
s_waitcnt lgkmcnt(7)
ds_read_b64_tr_b16 a[142:143], v16 offset:61440
buffer_load_dwordx4 a[96:99], v5, s[16:19], s33 offen offset:2048 sc1
v_mfma_f32_16x16x32_bf16 v[44:47], a[120:123], a[52:55], v[44:47]
ds_read_b64_tr_b16 a[112:113], v17 offset:49152
v_mfma_f32_16x16x32_bf16 v[44:47], a[124:127], a[60:63], v[44:47]
s_add_u32 m0, s31, 99328
ds_read_b64_tr_b16 a[114:115], v17 offset:53248
v_mfma_f32_16x16x32_bf16 v[40:43], a[124:127], a[56:59], v[40:43]
ds_read_b64_tr_b16 a[116:117], v17 offset:57344
buffer_load_dwordx4 v10, s[12:15], s32 offen lds
v_mfma_f32_16x16x32_bf16 v[40:43], a[120:123], a[48:51], v[40:43]
s_waitcnt lgkmcnt(7)
ds_read_b64_tr_b16 a[118:119], v17 offset:61440
buffer_load_dwordx4 a[100:103], v6, s[16:19], s33 offen offset:2048 sc1
v_mfma_f32_16x16x32_bf16 v[48:51], a[128:131], a[48:51], v[48:51]
ds_read_b64_tr_b16 a[120:121], v18 offset:49152
v_mfma_f32_16x16x32_bf16 v[48:51], a[132:135], a[56:59], v[48:51]
s_add_u32 m0, s31, 100352
ds_read_b64_tr_b16 a[122:123], v18 offset:53248
v_mfma_f32_16x16x32_bf16 v[52:55], a[132:135], a[60:63], v[52:55]
ds_read_b64_tr_b16 a[124:125], v18 offset:57344
buffer_load_dwordx4 v11, s[12:15], s32 offen lds
v_mfma_f32_16x16x32_bf16 v[52:55], a[128:131], a[52:55], v[52:55]
s_waitcnt lgkmcnt(7)
ds_read_b64_tr_b16 a[126:127], v18 offset:61440
buffer_load_dwordx4 a[104:107], v5, s[16:19], s33 offen offset:3072 sc1
v_mfma_f32_16x16x32_bf16 v[60:63], a[136:139], a[52:55], v[60:63]
ds_read_b64_tr_b16 a[128:129], v19 offset:49152
v_mfma_f32_16x16x32_bf16 v[60:63], a[140:143], a[60:63], v[60:63]
s_add_u32 m0, s31, 101376
ds_read_b64_tr_b16 a[130:131], v19 offset:53248
v_mfma_f32_16x16x32_bf16 v[56:59], a[140:143], a[56:59], v[56:59]
ds_read_b64_tr_b16 a[132:133], v19 offset:57344
buffer_load_dwordx4 v12, s[12:15], s32 offen lds
s_add_u32 s32, s32, 131072
v_mfma_f32_16x16x32_bf16 v[56:59], a[136:139], a[48:51], v[56:59]
s_waitcnt lgkmcnt(7)
ds_read_b64_tr_b16 a[134:135], v19 offset:61440
buffer_load_dwordx4 a[108:111], v6, s[16:19], s33 offen offset:3072 sc1
s_add_u32 s33, s33, 4096
v_mfma_f32_16x16x32_bf16 v[64:67], a[112:115], a[48:51], v[64:67]
ds_read_b64_tr_b16 a[136:137], v20 offset:49152
v_mfma_f32_16x16x32_bf16 v[64:67], a[116:119], a[56:59], v[64:67]
ds_read_b64_tr_b16 a[138:139], v20 offset:53248
v_mfma_f32_16x16x32_bf16 v[68:71], a[116:119], a[60:63], v[68:71]
ds_read_b64_tr_b16 a[140:141], v20 offset:57344
v_mfma_f32_16x16x32_bf16 v[68:71], a[112:115], a[52:55], v[68:71]
s_waitcnt lgkmcnt(7)
ds_read_b64_tr_b16 a[142:143], v20 offset:61440
v_mfma_f32_16x16x32_bf16 v[76:79], a[120:123], a[52:55], v[76:79]
s_waitcnt vmcnt(19)
s_barrier
ds_read_b64_tr_b16 a[112:113], v21 offset:0
v_mfma_f32_16x16x32_bf16 v[76:79], a[124:127], a[60:63], v[76:79]
ds_read_b64_tr_b16 a[114:115], v21 offset:4096
v_mfma_f32_16x16x32_bf16 v[72:75], a[124:127], a[56:59], v[72:75]
ds_read_b64_tr_b16 a[116:117], v21 offset:8192
v_mfma_f32_16x16x32_bf16 v[72:75], a[120:123], a[48:51], v[72:75]
s_waitcnt lgkmcnt(7)
ds_read_b64_tr_b16 a[118:119], v21 offset:12288
v_mfma_f32_16x16x32_bf16 v[80:83], a[128:131], a[48:51], v[80:83]
ds_read_b64_tr_b16 a[120:121], v22 offset:0
v_mfma_f32_16x16x32_bf16 v[80:83], a[132:135], a[56:59], v[80:83]
ds_read_b64_tr_b16 a[122:123], v22 offset:4096
v_mfma_f32_16x16x32_bf16 v[84:87], a[132:135], a[60:63], v[84:87]
ds_read_b64_tr_b16 a[124:125], v22 offset:8192
v_mfma_f32_16x16x32_bf16 v[84:87], a[128:131], a[52:55], v[84:87]
s_waitcnt lgkmcnt(7)
ds_read_b64_tr_b16 a[126:127], v22 offset:12288
v_mfma_f32_16x16x32_bf16 v[92:95], a[136:139], a[52:55], v[92:95]
ds_read_b64_tr_b16 a[128:129], v23 offset:0
v_mfma_f32_16x16x32_bf16 v[92:95], a[140:143], a[60:63], v[92:95]
ds_read_b64_tr_b16 a[130:131], v23 offset:4096
v_mfma_f32_16x16x32_bf16 v[88:91], a[140:143], a[56:59], v[88:91]
ds_read_b64_tr_b16 a[132:133], v23 offset:8192
v_mfma_f32_16x16x32_bf16 v[88:91], a[136:139], a[48:51], v[88:91]
s_waitcnt vmcnt(18) lgkmcnt(7)
ds_read_b64_tr_b16 a[134:135], v23 offset:12288
v_mfma_f32_16x16x32_bf16 v[32:35], a[112:115], a[64:67], v[32:35]
ds_read_b64_tr_b16 a[136:137], v24 offset:0
v_mfma_f32_16x16x32_bf16 v[32:35], a[116:119], a[72:75], v[32:35]
ds_read_b64_tr_b16 a[138:139], v24 offset:4096
v_mfma_f32_16x16x32_bf16 v[36:39], a[116:119], a[76:79], v[36:39]
ds_read_b64_tr_b16 a[140:141], v24 offset:8192
v_mfma_f32_16x16x32_bf16 v[36:39], a[112:115], a[68:71], v[36:39]
s_waitcnt lgkmcnt(7)
ds_read_b64_tr_b16 a[142:143], v24 offset:12288
v_mfma_f32_16x16x32_bf16 v[44:47], a[120:123], a[68:71], v[44:47]
ds_read_b64_tr_b16 a[112:113], v25 offset:0
v_mfma_f32_16x16x32_bf16 v[44:47], a[124:127], a[76:79], v[44:47]
ds_read_b64_tr_b16 a[114:115], v25 offset:4096
v_mfma_f32_16x16x32_bf16 v[40:43], a[124:127], a[72:75], v[40:43]
ds_read_b64_tr_b16 a[116:117], v25 offset:8192
v_mfma_f32_16x16x32_bf16 v[40:43], a[120:123], a[64:67], v[40:43]
s_waitcnt lgkmcnt(7)
ds_read_b64_tr_b16 a[118:119], v25 offset:12288
v_mfma_f32_16x16x32_bf16 v[48:51], a[128:131], a[64:67], v[48:51]
ds_read_b64_tr_b16 a[120:121], v26 offset:0
v_mfma_f32_16x16x32_bf16 v[48:51], a[132:135], a[72:75], v[48:51]
ds_read_b64_tr_b16 a[122:123], v26 offset:4096
v_mfma_f32_16x16x32_bf16 v[52:55], a[132:135], a[76:79], v[52:55]
ds_read_b64_tr_b16 a[124:125], v26 offset:8192
v_mfma_f32_16x16x32_bf16 v[52:55], a[128:131], a[68:71], v[52:55]
s_waitcnt lgkmcnt(7)
ds_read_b64_tr_b16 a[126:127], v26 offset:12288
v_mfma_f32_16x16x32_bf16 v[60:63], a[136:139], a[68:71], v[60:63]
ds_read_b64_tr_b16 a[128:129], v27 offset:0
v_mfma_f32_16x16x32_bf16 v[60:63], a[140:143], a[76:79], v[60:63]
ds_read_b64_tr_b16 a[130:131], v27 offset:4096
v_mfma_f32_16x16x32_bf16 v[56:59], a[140:143], a[72:75], v[56:59]
ds_read_b64_tr_b16 a[132:133], v27 offset:8192
v_mfma_f32_16x16x32_bf16 v[56:59], a[136:139], a[64:67], v[56:59]
s_waitcnt lgkmcnt(7)
ds_read_b64_tr_b16 a[134:135], v27 offset:12288
v_mfma_f32_16x16x32_bf16 v[64:67], a[112:115], a[64:67], v[64:67]
ds_read_b64_tr_b16 a[136:137], v28 offset:0
v_mfma_f32_16x16x32_bf16 v[64:67], a[116:119], a[72:75], v[64:67]
ds_read_b64_tr_b16 a[138:139], v28 offset:4096
v_mfma_f32_16x16x32_bf16 v[68:71], a[116:119], a[76:79], v[68:71]
ds_read_b64_tr_b16 a[140:141], v28 offset:8192
v_mfma_f32_16x16x32_bf16 v[68:71], a[112:115], a[68:71], v[68:71]
s_waitcnt lgkmcnt(7)
ds_read_b64_tr_b16 a[142:143], v28 offset:12288
v_mfma_f32_16x16x32_bf16 v[76:79], a[120:123], a[68:71], v[76:79]
s_waitcnt vmcnt(9)
s_barrier
ds_read_b64_tr_b16 a[112:113], v21 offset:16384
v_mfma_f32_16x16x32_bf16 v[76:79], a[124:127], a[76:79], v[76:79]
ds_read_b64_tr_b16 a[114:115], v21 offset:20480
v_mfma_f32_16x16x32_bf16 v[72:75], a[124:127], a[72:75], v[72:75]
ds_read_b64_tr_b16 a[116:117], v21 offset:24576
v_mfma_f32_16x16x32_bf16 v[72:75], a[120:123], a[64:67], v[72:75]
s_waitcnt lgkmcnt(7)
ds_read_b64_tr_b16 a[118:119], v21 offset:28672
v_mfma_f32_16x16x32_bf16 v[80:83], a[128:131], a[64:67], v[80:83]
ds_read_b64_tr_b16 a[120:121], v22 offset:16384
v_mfma_f32_16x16x32_bf16 v[80:83], a[132:135], a[72:75], v[80:83]
ds_read_b64_tr_b16 a[122:123], v22 offset:20480
v_mfma_f32_16x16x32_bf16 v[84:87], a[132:135], a[76:79], v[84:87]
ds_read_b64_tr_b16 a[124:125], v22 offset:24576
v_mfma_f32_16x16x32_bf16 v[84:87], a[128:131], a[68:71], v[84:87]
s_waitcnt lgkmcnt(7)
ds_read_b64_tr_b16 a[126:127], v22 offset:28672
v_mfma_f32_16x16x32_bf16 v[92:95], a[136:139], a[68:71], v[92:95]
ds_read_b64_tr_b16 a[128:129], v23 offset:16384
v_mfma_f32_16x16x32_bf16 v[92:95], a[140:143], a[76:79], v[92:95]
ds_read_b64_tr_b16 a[130:131], v23 offset:20480
v_mfma_f32_16x16x32_bf16 v[88:91], a[140:143], a[72:75], v[88:91]
ds_read_b64_tr_b16 a[132:133], v23 offset:24576
v_mfma_f32_16x16x32_bf16 v[88:91], a[136:139], a[64:67], v[88:91]
s_waitcnt vmcnt(8) lgkmcnt(7)
ds_read_b64_tr_b16 a[134:135], v23 offset:28672
v_mfma_f32_16x16x32_bf16 v[32:35], a[112:115], a[80:83], v[32:35]
ds_read_b64_tr_b16 a[136:137], v24 offset:16384
v_mfma_f32_16x16x32_bf16 v[32:35], a[116:119], a[88:91], v[32:35]
ds_read_b64_tr_b16 a[138:139], v24 offset:20480
v_mfma_f32_16x16x32_bf16 v[36:39], a[116:119], a[92:95], v[36:39]
ds_read_b64_tr_b16 a[140:141], v24 offset:24576
v_mfma_f32_16x16x32_bf16 v[36:39], a[112:115], a[84:87], v[36:39]
s_waitcnt lgkmcnt(7)
ds_read_b64_tr_b16 a[142:143], v24 offset:28672
v_mfma_f32_16x16x32_bf16 v[44:47], a[120:123], a[84:87], v[44:47]
ds_read_b64_tr_b16 a[112:113], v25 offset:16384
v_mfma_f32_16x16x32_bf16 v[44:47], a[124:127], a[92:95], v[44:47]
ds_read_b64_tr_b16 a[114:115], v25 offset:20480
v_mfma_f32_16x16x32_bf16 v[40:43], a[124:127], a[88:91], v[40:43]
ds_read_b64_tr_b16 a[116:117], v25 offset:24576
v_mfma_f32_16x16x32_bf16 v[40:43], a[120:123], a[80:83], v[40:43]
s_waitcnt lgkmcnt(7)
ds_read_b64_tr_b16 a[118:119], v25 offset:28672
v_mfma_f32_16x16x32_bf16 v[48:51], a[128:131], a[80:83], v[48:51]
ds_read_b64_tr_b16 a[120:121], v26 offset:16384
v_mfma_f32_16x16x32_bf16 v[48:51], a[132:135], a[88:91], v[48:51]
ds_read_b64_tr_b16 a[122:123], v26 offset:20480
v_mfma_f32_16x16x32_bf16 v[52:55], a[132:135], a[92:95], v[52:55]
ds_read_b64_tr_b16 a[124:125], v26 offset:24576
v_mfma_f32_16x16x32_bf16 v[52:55], a[128:131], a[84:87], v[52:55]
s_waitcnt lgkmcnt(7)
ds_read_b64_tr_b16 a[126:127], v26 offset:28672
v_mfma_f32_16x16x32_bf16 v[60:63], a[136:139], a[84:87], v[60:63]
ds_read_b64_tr_b16 a[128:129], v27 offset:16384
v_mfma_f32_16x16x32_bf16 v[60:63], a[140:143], a[92:95], v[60:63]
ds_read_b64_tr_b16 a[130:131], v27 offset:20480
v_mfma_f32_16x16x32_bf16 v[56:59], a[140:143], a[88:91], v[56:59]
ds_read_b64_tr_b16 a[132:133], v27 offset:24576
v_mfma_f32_16x16x32_bf16 v[56:59], a[136:139], a[80:83], v[56:59]
s_waitcnt lgkmcnt(7)
ds_read_b64_tr_b16 a[134:135], v27 offset:28672
v_mfma_f32_16x16x32_bf16 v[64:67], a[112:115], a[80:83], v[64:67]
ds_read_b64_tr_b16 a[136:137], v28 offset:16384
v_mfma_f32_16x16x32_bf16 v[64:67], a[116:119], a[88:91], v[64:67]
ds_read_b64_tr_b16 a[138:139], v28 offset:20480
v_mfma_f32_16x16x32_bf16 v[68:71], a[116:119], a[92:95], v[68:71]
ds_read_b64_tr_b16 a[140:141], v28 offset:24576
v_mfma_f32_16x16x32_bf16 v[68:71], a[112:115], a[84:87], v[68:71]
s_waitcnt lgkmcnt(7)
ds_read_b64_tr_b16 a[142:143], v28 offset:28672
v_mfma_f32_16x16x32_bf16 v[76:79], a[120:123], a[84:87], v[76:79]
s_waitcnt vmcnt(1)
s_barrier
ds_read_b64_tr_b16 a[112:113], v21 offset:32768
v_mfma_f32_16x16x32_bf16 v[76:79], a[124:127], a[92:95], v[76:79]
ds_read_b64_tr_b16 a[114:115], v21 offset:36864
v_mfma_f32_16x16x32_bf16 v[72:75], a[124:127], a[88:91], v[72:75]
ds_read_b64_tr_b16 a[116:117], v21 offset:40960
v_mfma_f32_16x16x32_bf16 v[72:75], a[120:123], a[80:83], v[72:75]
s_waitcnt lgkmcnt(7)
ds_read_b64_tr_b16 a[118:119], v21 offset:45056
v_mfma_f32_16x16x32_bf16 v[80:83], a[128:131], a[80:83], v[80:83]
ds_read_b64_tr_b16 a[120:121], v22 offset:32768
v_mfma_f32_16x16x32_bf16 v[80:83], a[132:135], a[88:91], v[80:83]
ds_read_b64_tr_b16 a[122:123], v22 offset:36864
v_mfma_f32_16x16x32_bf16 v[84:87], a[132:135], a[92:95], v[84:87]
ds_read_b64_tr_b16 a[124:125], v22 offset:40960
v_mfma_f32_16x16x32_bf16 v[84:87], a[128:131], a[84:87], v[84:87]
s_waitcnt lgkmcnt(7)
ds_read_b64_tr_b16 a[126:127], v22 offset:45056
v_mfma_f32_16x16x32_bf16 v[92:95], a[136:139], a[84:87], v[92:95]
ds_read_b64_tr_b16 a[128:129], v23 offset:32768
v_mfma_f32_16x16x32_bf16 v[92:95], a[140:143], a[92:95], v[92:95]
ds_read_b64_tr_b16 a[130:131], v23 offset:36864
v_mfma_f32_16x16x32_bf16 v[88:91], a[140:143], a[88:91], v[88:91]
ds_read_b64_tr_b16 a[132:133], v23 offset:40960
v_mfma_f32_16x16x32_bf16 v[88:91], a[136:139], a[80:83], v[88:91]
s_waitcnt vmcnt(0) lgkmcnt(7)
ds_read_b64_tr_b16 a[134:135], v23 offset:45056
v_mfma_f32_16x16x32_bf16 v[32:35], a[112:115], a[96:99], v[32:35]
ds_read_b64_tr_b16 a[136:137], v24 offset:32768
v_mfma_f32_16x16x32_bf16 v[32:35], a[116:119], a[104:107], v[32:35]
ds_read_b64_tr_b16 a[138:139], v24 offset:36864
v_mfma_f32_16x16x32_bf16 v[36:39], a[116:119], a[108:111], v[36:39]
ds_read_b64_tr_b16 a[140:141], v24 offset:40960
v_mfma_f32_16x16x32_bf16 v[36:39], a[112:115], a[100:103], v[36:39]
s_waitcnt lgkmcnt(7)
ds_read_b64_tr_b16 a[142:143], v24 offset:45056
v_mfma_f32_16x16x32_bf16 v[44:47], a[120:123], a[100:103], v[44:47]
ds_read_b64_tr_b16 a[112:113], v25 offset:32768
v_mfma_f32_16x16x32_bf16 v[44:47], a[124:127], a[108:111], v[44:47]
ds_read_b64_tr_b16 a[114:115], v25 offset:36864
v_mfma_f32_16x16x32_bf16 v[40:43], a[124:127], a[104:107], v[40:43]
ds_read_b64_tr_b16 a[116:117], v25 offset:40960
v_mfma_f32_16x16x32_bf16 v[40:43], a[120:123], a[96:99], v[40:43]
s_waitcnt lgkmcnt(7)
ds_read_b64_tr_b16 a[118:119], v25 offset:45056
v_mfma_f32_16x16x32_bf16 v[48:51], a[128:131], a[96:99], v[48:51]
ds_read_b64_tr_b16 a[120:121], v26 offset:32768
v_mfma_f32_16x16x32_bf16 v[48:51], a[132:135], a[104:107], v[48:51]
ds_read_b64_tr_b16 a[122:123], v26 offset:36864
v_mfma_f32_16x16x32_bf16 v[52:55], a[132:135], a[108:111], v[52:55]
ds_read_b64_tr_b16 a[124:125], v26 offset:40960
v_mfma_f32_16x16x32_bf16 v[52:55], a[128:131], a[100:103], v[52:55]
s_waitcnt lgkmcnt(7)
ds_read_b64_tr_b16 a[126:127], v26 offset:45056
v_mfma_f32_16x16x32_bf16 v[60:63], a[136:139], a[100:103], v[60:63]
ds_read_b64_tr_b16 a[128:129], v27 offset:32768
v_mfma_f32_16x16x32_bf16 v[60:63], a[140:143], a[108:111], v[60:63]
ds_read_b64_tr_b16 a[130:131], v27 offset:36864
v_mfma_f32_16x16x32_bf16 v[56:59], a[140:143], a[104:107], v[56:59]
ds_read_b64_tr_b16 a[132:133], v27 offset:40960
v_mfma_f32_16x16x32_bf16 v[56:59], a[136:139], a[96:99], v[56:59]
s_waitcnt lgkmcnt(7)
ds_read_b64_tr_b16 a[134:135], v27 offset:45056
v_mfma_f32_16x16x32_bf16 v[64:67], a[112:115], a[96:99], v[64:67]
ds_read_b64_tr_b16 a[136:137], v28 offset:32768
v_mfma_f32_16x16x32_bf16 v[64:67], a[116:119], a[104:107], v[64:67]
ds_read_b64_tr_b16 a[138:139], v28 offset:36864
v_mfma_f32_16x16x32_bf16 v[68:71], a[116:119], a[108:111], v[68:71]
ds_read_b64_tr_b16 a[140:141], v28 offset:40960
v_mfma_f32_16x16x32_bf16 v[68:71], a[112:115], a[100:103], v[68:71]
s_waitcnt lgkmcnt(7)
ds_read_b64_tr_b16 a[142:143], v28 offset:45056
v_mfma_f32_16x16x32_bf16 v[76:79], a[120:123], a[100:103], v[76:79]
v_mfma_f32_16x16x32_bf16 v[76:79], a[124:127], a[108:111], v[76:79]
v_mfma_f32_16x16x32_bf16 v[72:75], a[124:127], a[104:107], v[72:75]
v_mfma_f32_16x16x32_bf16 v[72:75], a[120:123], a[96:99], v[72:75]
s_waitcnt lgkmcnt(4)
v_mfma_f32_16x16x32_bf16 v[80:83], a[128:131], a[96:99], v[80:83]
v_mfma_f32_16x16x32_bf16 v[80:83], a[132:135], a[104:107], v[80:83]
v_mfma_f32_16x16x32_bf16 v[84:87], a[132:135], a[108:111], v[84:87]
v_mfma_f32_16x16x32_bf16 v[84:87], a[128:131], a[100:103], v[84:87]
s_waitcnt lgkmcnt(0)
v_mfma_f32_16x16x32_bf16 v[92:95], a[136:139], a[100:103], v[92:95]
v_mfma_f32_16x16x32_bf16 v[92:95], a[140:143], a[108:111], v[92:95]
v_mfma_f32_16x16x32_bf16 v[88:91], a[140:143], a[104:107], v[88:91]
v_mfma_f32_16x16x32_bf16 v[88:91], a[136:139], a[96:99], v[88:91]
s_nop 7
s_lshl_b32 s35, s2, 2
s_add_u32 s35, s35, s24
s_lshl_b32 s36, s35, 7
s_lshl_b32 s35, s35, 12
s_add_u32 s35, s35, 57409536
v_cvt_pk_bf16_f32 v148, v64, v65
v_cvt_pk_bf16_f32 v149, v66, v67
v_cvt_pk_bf16_f32 v150, v72, v73
v_cvt_pk_bf16_f32 v151, v74, v75
v_cvt_pk_bf16_f32 v152, v80, v81
v_cvt_pk_bf16_f32 v153, v82, v83
v_cvt_pk_bf16_f32 v154, v88, v89
v_cvt_pk_bf16_f32 v155, v90, v91
v_cvt_pk_bf16_f32 v156, v68, v69
v_cvt_pk_bf16_f32 v157, v70, v71
v_cvt_pk_bf16_f32 v158, v76, v77
v_cvt_pk_bf16_f32 v159, v78, v79
v_cvt_pk_bf16_f32 v160, v84, v85
v_cvt_pk_bf16_f32 v161, v86, v87
v_cvt_pk_bf16_f32 v162, v92, v93
v_cvt_pk_bf16_f32 v163, v94, v95
s_add_u32 s36, s36, 56819712
buffer_store_dwordx4 v[148:151], v2, s[16:19], s35 offen offset:0 sc1
buffer_store_dwordx4 v[152:155], v2, s[16:19], s35 offen offset:1024 sc1
buffer_store_dwordx4 v[156:159], v2, s[16:19], s35 offen offset:2048 sc1
buffer_store_dwordx4 v[160:163], v2, s[16:19], s35 offen offset:3072 sc1
s_waitcnt vmcnt(0)
v_mov_b32 v3, 0
v_mov_b32 v4, 1
s_mov_b64 exec, 1
buffer_store_dword v4, v3, s[16:19], s36 offen sc1
s_mov_b64 exec, -1
v_add_f32 v112, v112, v164
v_add_f32 v180, v180, v196
v_add_f32 v113, v113, v165
v_add_f32 v181, v181, v197
v_add_f32 v114, v114, v166
v_add_f32 v182, v182, v198
v_add_f32 v115, v115, v167
v_add_f32 v183, v183, v199
v_add_f32 v116, v116, v168
v_add_f32 v184, v184, v200
v_add_f32 v117, v117, v169
v_add_f32 v185, v185, v201
v_add_f32 v118, v118, v170
v_add_f32 v186, v186, v202
v_add_f32 v119, v119, v171
v_add_f32 v187, v187, v203
v_add_f32 v120, v120, v172
v_add_f32 v188, v188, v204
v_add_f32 v121, v121, v173
v_add_f32 v189, v189, v205
v_add_f32 v122, v122, v174
v_add_f32 v190, v190, v206
v_add_f32 v123, v123, v175
v_add_f32 v191, v191, v207
v_add_f32 v124, v124, v176
v_add_f32 v192, v192, v208
v_add_f32 v125, v125, v177
v_add_f32 v193, v193, v209
v_add_f32 v126, v126, v178
v_add_f32 v194, v194, v210
v_add_f32 v127, v127, v179
v_add_f32 v195, v195, v211
v_add_f32 v112, v112, v180
v_add_f32 v113, v113, v181
v_add_f32 v114, v114, v182
v_add_f32 v115, v115, v183
v_add_f32 v116, v116, v184
v_add_f32 v117, v117, v185
v_add_f32 v118, v118, v186
v_add_f32 v119, v119, v187
v_add_f32 v120, v120, v188
v_add_f32 v121, v121, v189
v_add_f32 v122, v122, v190
v_add_f32 v123, v123, v191
v_add_f32 v124, v124, v192
v_add_f32 v125, v125, v193
v_add_f32 v126, v126, v194
v_add_f32 v127, v127, v195
v_cvt_pk_bf16_f32 v164, v112, v113
v_lshlrev_b32 v112, 16, v164
v_and_b32 v113, 0xffff0000, v164
v_cvt_pk_bf16_f32 v166, v114, v115
v_lshlrev_b32 v114, 16, v166
v_and_b32 v115, 0xffff0000, v166
v_cvt_pk_bf16_f32 v168, v116, v117
v_lshlrev_b32 v116, 16, v168
v_and_b32 v117, 0xffff0000, v168
v_cvt_pk_bf16_f32 v170, v118, v119
v_lshlrev_b32 v118, 16, v170
v_and_b32 v119, 0xffff0000, v170
v_cvt_pk_bf16_f32 v172, v120, v121
v_lshlrev_b32 v120, 16, v172
v_and_b32 v121, 0xffff0000, v172
v_cvt_pk_bf16_f32 v174, v122, v123
v_lshlrev_b32 v122, 16, v174
v_and_b32 v123, 0xffff0000, v174
v_cvt_pk_bf16_f32 v176, v124, v125
v_lshlrev_b32 v124, 16, v176
v_and_b32 v125, 0xffff0000, v176
v_cvt_pk_bf16_f32 v178, v126, v127
v_lshlrev_b32 v126, 16, v178
v_and_b32 v127, 0xffff0000, v178
v_mul_f32 v112, 0x3f317218, v112
v_mul_f32 v113, 0x3f317218, v113
v_mul_f32 v114, 0x3f317218, v114
v_mul_f32 v115, 0x3f317218, v115
v_mul_f32 v116, 0x3f317218, v116
v_mul_f32 v117, 0x3f317218, v117
v_mul_f32 v118, 0x3f317218, v118
v_mul_f32 v119, 0x3f317218, v119
v_mul_f32 v120, 0x3f317218, v120
v_mul_f32 v121, 0x3f317218, v121
v_mul_f32 v122, 0x3f317218, v122
v_mul_f32 v123, 0x3f317218, v123
v_mul_f32 v124, 0x3f317218, v124
v_mul_f32 v125, 0x3f317218, v125
v_mul_f32 v126, 0x3f317218, v126
v_mul_f32 v127, 0x3f317218, v127
v_lshlrev_b32 v214, 16, v96
v_and_b32 v215, 0xffff0000, v96
v_fma_f32 v32, v32, v112, v214
v_fma_f32 v33, v33, v113, v215
v_lshlrev_b32 v214, 16, v97
v_and_b32 v215, 0xffff0000, v97
v_fma_f32 v34, v34, v114, v214
v_fma_f32 v35, v35, v115, v215
v_lshlrev_b32 v214, 16, v98
v_and_b32 v215, 0xffff0000, v98
v_fma_f32 v40, v40, v116, v214
v_fma_f32 v41, v41, v117, v215
v_lshlrev_b32 v214, 16, v99
v_and_b32 v215, 0xffff0000, v99
v_fma_f32 v42, v42, v118, v214
v_fma_f32 v43, v43, v119, v215
v_lshlrev_b32 v214, 16, v100
v_and_b32 v215, 0xffff0000, v100
v_fma_f32 v48, v48, v120, v214
v_fma_f32 v49, v49, v121, v215
v_lshlrev_b32 v214, 16, v101
v_and_b32 v215, 0xffff0000, v101
v_fma_f32 v50, v50, v122, v214
v_fma_f32 v51, v51, v123, v215
v_lshlrev_b32 v214, 16, v102
v_and_b32 v215, 0xffff0000, v102
v_fma_f32 v56, v56, v124, v214
v_fma_f32 v57, v57, v125, v215
v_lshlrev_b32 v214, 16, v103
v_and_b32 v215, 0xffff0000, v103
v_fma_f32 v58, v58, v126, v214
v_fma_f32 v59, v59, v127, v215
v_lshlrev_b32 v214, 16, v104
v_and_b32 v215, 0xffff0000, v104
v_fma_f32 v36, v36, v112, v214
v_fma_f32 v37, v37, v113, v215
v_lshlrev_b32 v214, 16, v105
v_and_b32 v215, 0xffff0000, v105
v_fma_f32 v38, v38, v114, v214
v_fma_f32 v39, v39, v115, v215
v_lshlrev_b32 v214, 16, v106
v_and_b32 v215, 0xffff0000, v106
v_fma_f32 v44, v44, v116, v214
v_fma_f32 v45, v45, v117, v215
v_lshlrev_b32 v214, 16, v107
v_and_b32 v215, 0xffff0000, v107
v_fma_f32 v46, v46, v118, v214
v_fma_f32 v47, v47, v119, v215
v_lshlrev_b32 v214, 16, v108
v_and_b32 v215, 0xffff0000, v108
v_fma_f32 v52, v52, v120, v214
v_fma_f32 v53, v53, v121, v215
v_lshlrev_b32 v214, 16, v109
v_and_b32 v215, 0xffff0000, v109
v_fma_f32 v54, v54, v122, v214
v_fma_f32 v55, v55, v123, v215
v_lshlrev_b32 v214, 16, v110
v_and_b32 v215, 0xffff0000, v110
v_fma_f32 v60, v60, v124, v214
v_fma_f32 v61, v61, v125, v215
v_lshlrev_b32 v214, 16, v111
v_and_b32 v215, 0xffff0000, v111
v_fma_f32 v62, v62, v126, v214
v_fma_f32 v63, v63, v127, v215
v_mov_b32 v3, 0
s_xor_b32 s36, s2, 1
s_lshl_b32 s36, s36, 2
s_add_u32 s36, s36, s24
s_lshl_b32 s35, s36, 12
s_add_u32 s35, s35, 57409536
s_lshl_b32 s36, s36, 7
s_add_u32 s36, s36, 56819712
s_mov_b32 s29, 0x200000
L_dnx_aw:
buffer_load_dword v4, v3, s[16:19], s36 offen sc1
s_waitcnt vmcnt(0)
v_cmp_eq_u32 vcc, 0, v4
s_sub_u32 s29, s29, 1
s_cmp_eq_u32 s29, 0
s_cbranch_scc1 L_dnx_awd
s_cmp_lg_u64 vcc, 0
s_cbranch_scc1 L_dnx_aw
L_dnx_awd:
buffer_load_dwordx4 v[132:135], v2, s[16:19], s35 offen offset:0 sc1
buffer_load_dwordx4 v[136:139], v2, s[16:19], s35 offen offset:1024 sc1
buffer_load_dwordx4 v[140:143], v2, s[16:19], s35 offen offset:2048 sc1
buffer_load_dwordx4 v[144:147], v2, s[16:19], s35 offen offset:3072 sc1
s_waitcnt vmcnt(2)
v_lshlrev_b32 v212, 16, v132
v_and_b32 v213, 0xffff0000, v132
v_fmac_f32 v32, v212, v112
v_fmac_f32 v33, v213, v113
v_lshlrev_b32 v212, 16, v133
v_and_b32 v213, 0xffff0000, v133
v_fmac_f32 v34, v212, v114
v_fmac_f32 v35, v213, v115
v_cvt_pk_bf16_f32 v96, v32, v33
v_cvt_pk_bf16_f32 v97, v34, v35
v_lshlrev_b32 v212, 16, v134
v_and_b32 v213, 0xffff0000, v134
v_fmac_f32 v40, v212, v116
v_fmac_f32 v41, v213, v117
v_lshlrev_b32 v212, 16, v135
v_and_b32 v213, 0xffff0000, v135
v_fmac_f32 v42, v212, v118
v_fmac_f32 v43, v213, v119
v_cvt_pk_bf16_f32 v98, v40, v41
v_cvt_pk_bf16_f32 v99, v42, v43
v_lshlrev_b32 v212, 16, v136
v_and_b32 v213, 0xffff0000, v136
v_fmac_f32 v48, v212, v120
v_fmac_f32 v49, v213, v121
v_lshlrev_b32 v212, 16, v137
v_and_b32 v213, 0xffff0000, v137
v_fmac_f32 v50, v212, v122
v_fmac_f32 v51, v213, v123
v_cvt_pk_bf16_f32 v100, v48, v49
v_cvt_pk_bf16_f32 v101, v50, v51
v_lshlrev_b32 v212, 16, v138
v_and_b32 v213, 0xffff0000, v138
v_fmac_f32 v56, v212, v124
v_fmac_f32 v57, v213, v125
v_lshlrev_b32 v212, 16, v139
v_and_b32 v213, 0xffff0000, v139
v_fmac_f32 v58, v212, v126
v_fmac_f32 v59, v213, v127
v_cvt_pk_bf16_f32 v102, v56, v57
v_cvt_pk_bf16_f32 v103, v58, v59
v_and_b32 v3, 15, v1
v_mul_u32_u24 v3, 144, v3
v_lshrrev_b32 v4, 4, v1
v_lshl_add_u32 v3, v4, 3, v3
s_mul_i32 s28, s24, 4608
s_add_u32 s28, s28, 114688
v_add_u32 v3, s28, v3
ds_write_b64 v3, v[96:97] offset:0
ds_write_b64 v3, v[98:99] offset:32
ds_write_b64 v3, v[100:101] offset:64
ds_write_b64 v3, v[102:103] offset:96
s_waitcnt vmcnt(0)
v_lshlrev_b32 v212, 16, v140
v_and_b32 v213, 0xffff0000, v140
v_fmac_f32 v36, v212, v112
v_fmac_f32 v37, v213, v113
v_lshlrev_b32 v212, 16, v141
v_and_b32 v213, 0xffff0000, v141
v_fmac_f32 v38, v212, v114
v_fmac_f32 v39, v213, v115
v_cvt_pk_bf16_f32 v104, v36, v37
v_cvt_pk_bf16_f32 v105, v38, v39
v_lshlrev_b32 v212, 16, v142
v_and_b32 v213, 0xffff0000, v142
v_fmac_f32 v44, v212, v116
v_fmac_f32 v45, v213, v117
v_lshlrev_b32 v212, 16, v143
v_and_b32 v213, 0xffff0000, v143
v_fmac_f32 v46, v212, v118
v_fmac_f32 v47, v213, v119
v_cvt_pk_bf16_f32 v106, v44, v45
v_cvt_pk_bf16_f32 v107, v46, v47
v_lshlrev_b32 v212, 16, v144
v_and_b32 v213, 0xffff0000, v144
v_fmac_f32 v52, v212, v120
v_fmac_f32 v53, v213, v121
v_lshlrev_b32 v212, 16, v145
v_and_b32 v213, 0xffff0000, v145
v_fmac_f32 v54, v212, v122
v_fmac_f32 v55, v213, v123
v_cvt_pk_bf16_f32 v108, v52, v53
v_cvt_pk_bf16_f32 v109, v54, v55
v_lshlrev_b32 v212, 16, v146
v_and_b32 v213, 0xffff0000, v146
v_fmac_f32 v60, v212, v124
v_fmac_f32 v61, v213, v125
v_lshlrev_b32 v212, 16, v147
v_and_b32 v213, 0xffff0000, v147
v_fmac_f32 v62, v212, v126
v_fmac_f32 v63, v213, v127
v_cvt_pk_bf16_f32 v110, v60, v61
v_cvt_pk_bf16_f32 v111, v62, v63
ds_write_b64 v3, v[104:105] offset:2304
ds_write_b64 v3, v[106:107] offset:2336
ds_write_b64 v3, v[108:109] offset:2368
ds_write_b64 v3, v[110:111] offset:2400
v_lshrrev_b32 v128, 3, v1
v_and_b32 v4, 7, v1
v_mul_u32_u24 v3, 144, v128
v_lshl_add_u32 v3, v4, 4, v3
v_add_u32 v3, s28, v3
v_lshlrev_b32 v128, 11, v128
v_lshl_add_u32 v128, v4, 4, v128
s_lshl_b32 s35, s30, 15
s_lshl_b32 s29, s37, 7
s_add_u32 s35, s35, s29
s_waitcnt lgkmcnt(0)
ds_read_b128 v[132:135], v3 offset:0
ds_read_b128 v[136:139], v3 offset:1152
ds_read_b128 v[140:143], v3 offset:2304
ds_read_b128 v[144:147], v3 offset:3456
s_waitcnt lgkmcnt(3)
buffer_store_dwordx4 v[132:135], v128, s[20:23], s35 offen
s_add_u32 s35, s35, 16384
s_waitcnt lgkmcnt(2)
buffer_store_dwordx4 v[136:139], v128, s[20:23], s35 offen
s_add_u32 s35, s35, 16384
s_waitcnt lgkmcnt(1)
buffer_store_dwordx4 v[140:143], v128, s[20:23], s35 offen
s_add_u32 s35, s35, 16384
s_waitcnt lgkmcnt(0)
buffer_store_dwordx4 v[144:147], v128, s[20:23], s35 offen
L_main_end:
s_endpgm
L_at_fallback:
s_waitcnt vmcnt(0)
s_barrier
v_mov_b32 v192, 0xff800000
v_mov_b32 v193, 0xff800000
v_mov_b32 v194, 0xff800000
v_mov_b32 v195, 0xff800000
s_lshl_b32 s41, s32, 19
s_lshl_b32 s34, s30, 12
s_add_u32 s41, s41, s34
s_add_u32 s41, s41, 65536
s_mov_b32 m0, s34
s_mov_b32 s46, 32
L_at_fbloop:
buffer_load_dwordx4 v2, s[8:11], s41 offen offset:0 lds
buffer_load_dwordx4 v2, s[8:11], s41 offen offset:1024 lds
buffer_load_dwordx4 v2, s[8:11], s41 offen offset:2048 lds
buffer_load_dwordx4 v2, s[8:11], s41 offen offset:3072 lds
s_waitcnt vmcnt(0)
s_barrier
ds_read_b128 a[128:131], v2 offset:0
ds_read_b128 a[132:135], v2 offset:1024
ds_read_b128 a[136:139], v2 offset:2048
ds_read_b128 a[140:143], v2 offset:3072
s_waitcnt lgkmcnt(0)
v_mfma_f32_16x16x32_bf16 v[76:79], a[128:131], v[12:15], 0
v_mfma_f32_16x16x32_bf16 v[80:83], a[128:131], v[28:31], 0
v_mfma_f32_16x16x32_bf16 v[84:87], a[128:131], v[44:47], 0
v_mfma_f32_16x16x32_bf16 v[88:91], a[128:131], v[60:63], 0
v_mfma_f32_16x16x32_bf16 v[76:79], a[132:135], v[16:19], v[76:79]
v_mfma_f32_16x16x32_bf16 v[80:83], a[132:135], v[32:35], v[80:83]
v_mfma_f32_16x16x32_bf16 v[84:87], a[132:135], v[48:51], v[84:87]
v_mfma_f32_16x16x32_bf16 v[88:91], a[132:135], v[64:67], v[88:91]
v_mfma_f32_16x16x32_bf16 v[76:79], a[136:139], v[20:23], v[76:79]
v_mfma_f32_16x16x32_bf16 v[80:83], a[136:139], v[36:39], v[80:83]
v_mfma_f32_16x16x32_bf16 v[84:87], a[136:139], v[52:55], v[84:87]
v_mfma_f32_16x16x32_bf16 v[88:91], a[136:139], v[68:71], v[88:91]
v_mfma_f32_16x16x32_bf16 v[76:79], a[140:143], v[24:27], v[76:79]
v_mfma_f32_16x16x32_bf16 v[80:83], a[140:143], v[40:43], v[80:83]
v_mfma_f32_16x16x32_bf16 v[84:87], a[140:143], v[56:59], v[84:87]
v_mfma_f32_16x16x32_bf16 v[88:91], a[140:143], v[72:75], v[88:91]
s_nop 7
v_max3_f32 v192, v192, v76, v77
v_max3_f32 v192, v192, v78, v79
v_max3_f32 v193, v193, v80, v81
v_max3_f32 v193, v193, v82, v83
v_max3_f32 v194, v194, v84, v85
v_max3_f32 v194, v194, v86, v87
v_max3_f32 v195, v195, v88, v89
v_max3_f32 v195, v195, v90, v91
ds_read_b128 a[128:131], v2 offset:4096
ds_read_b128 a[132:135], v2 offset:5120
ds_read_b128 a[136:139], v2 offset:6144
ds_read_b128 a[140:143], v2 offset:7168
s_waitcnt lgkmcnt(0)
v_mfma_f32_16x16x32_bf16 v[76:79], a[128:131], v[12:15], 0
v_mfma_f32_16x16x32_bf16 v[80:83], a[128:131], v[28:31], 0
v_mfma_f32_16x16x32_bf16 v[84:87], a[128:131], v[44:47], 0
v_mfma_f32_16x16x32_bf16 v[88:91], a[128:131], v[60:63], 0
v_mfma_f32_16x16x32_bf16 v[76:79], a[132:135], v[16:19], v[76:79]
v_mfma_f32_16x16x32_bf16 v[80:83], a[132:135], v[32:35], v[80:83]
v_mfma_f32_16x16x32_bf16 v[84:87], a[132:135], v[48:51], v[84:87]
v_mfma_f32_16x16x32_bf16 v[88:91], a[132:135], v[64:67], v[88:91]
v_mfma_f32_16x16x32_bf16 v[76:79], a[136:139], v[20:23], v[76:79]
v_mfma_f32_16x16x32_bf16 v[80:83], a[136:139], v[36:39], v[80:83]
v_mfma_f32_16x16x32_bf16 v[84:87], a[136:139], v[52:55], v[84:87]
v_mfma_f32_16x16x32_bf16 v[88:91], a[136:139], v[68:71], v[88:91]
v_mfma_f32_16x16x32_bf16 v[76:79], a[140:143], v[24:27], v[76:79]
v_mfma_f32_16x16x32_bf16 v[80:83], a[140:143], v[40:43], v[80:83]
v_mfma_f32_16x16x32_bf16 v[84:87], a[140:143], v[56:59], v[84:87]
v_mfma_f32_16x16x32_bf16 v[88:91], a[140:143], v[72:75], v[88:91]
s_nop 7
v_max3_f32 v192, v192, v76, v77
v_max3_f32 v192, v192, v78, v79
v_max3_f32 v193, v193, v80, v81
v_max3_f32 v193, v193, v82, v83
v_max3_f32 v194, v194, v84, v85
v_max3_f32 v194, v194, v86, v87
v_max3_f32 v195, v195, v88, v89
v_max3_f32 v195, v195, v90, v91
ds_read_b128 a[128:131], v2 offset:8192
ds_read_b128 a[132:135], v2 offset:9216
ds_read_b128 a[136:139], v2 offset:10240
ds_read_b128 a[140:143], v2 offset:11264
s_waitcnt lgkmcnt(0)
v_mfma_f32_16x16x32_bf16 v[76:79], a[128:131], v[12:15], 0
v_mfma_f32_16x16x32_bf16 v[80:83], a[128:131], v[28:31], 0
v_mfma_f32_16x16x32_bf16 v[84:87], a[128:131], v[44:47], 0
v_mfma_f32_16x16x32_bf16 v[88:91], a[128:131], v[60:63], 0
v_mfma_f32_16x16x32_bf16 v[76:79], a[132:135], v[16:19], v[76:79]
v_mfma_f32_16x16x32_bf16 v[80:83], a[132:135], v[32:35], v[80:83]
v_mfma_f32_16x16x32_bf16 v[84:87], a[132:135], v[48:51], v[84:87]
v_mfma_f32_16x16x32_bf16 v[88:91], a[132:135], v[64:67], v[88:91]
v_mfma_f32_16x16x32_bf16 v[76:79], a[136:139], v[20:23], v[76:79]
v_mfma_f32_16x16x32_bf16 v[80:83], a[136:139], v[36:39], v[80:83]
v_mfma_f32_16x16x32_bf16 v[84:87], a[136:139], v[52:55], v[84:87]
v_mfma_f32_16x16x32_bf16 v[88:91], a[136:139], v[68:71], v[88:91]
v_mfma_f32_16x16x32_bf16 v[76:79], a[140:143], v[24:27], v[76:79]
v_mfma_f32_16x16x32_bf16 v[80:83], a[140:143], v[40:43], v[80:83]
v_mfma_f32_16x16x32_bf16 v[84:87], a[140:143], v[56:59], v[84:87]
v_mfma_f32_16x16x32_bf16 v[88:91], a[140:143], v[72:75], v[88:91]
s_nop 7
v_max3_f32 v192, v192, v76, v77
v_max3_f32 v192, v192, v78, v79
v_max3_f32 v193, v193, v80, v81
v_max3_f32 v193, v193, v82, v83
v_max3_f32 v194, v194, v84, v85
v_max3_f32 v194, v194, v86, v87
v_max3_f32 v195, v195, v88, v89
v_max3_f32 v195, v195, v90, v91
ds_read_b128 a[128:131], v2 offset:12288
ds_read_b128 a[132:135], v2 offset:13312
ds_read_b128 a[136:139], v2 offset:14336
ds_read_b128 a[140:143], v2 offset:15360
s_waitcnt lgkmcnt(0)
v_mfma_f32_16x16x32_bf16 v[76:79], a[128:131], v[12:15], 0
v_mfma_f32_16x16x32_bf16 v[80:83], a[128:131], v[28:31], 0
v_mfma_f32_16x16x32_bf16 v[84:87], a[128:131], v[44:47], 0
v_mfma_f32_16x16x32_bf16 v[88:91], a[128:131], v[60:63], 0
v_mfma_f32_16x16x32_bf16 v[76:79], a[132:135], v[16:19], v[76:79]
v_mfma_f32_16x16x32_bf16 v[80:83], a[132:135], v[32:35], v[80:83]
v_mfma_f32_16x16x32_bf16 v[84:87], a[132:135], v[48:51], v[84:87]
v_mfma_f32_16x16x32_bf16 v[88:91], a[132:135], v[64:67], v[88:91]
v_mfma_f32_16x16x32_bf16 v[76:79], a[136:139], v[20:23], v[76:79]
v_mfma_f32_16x16x32_bf16 v[80:83], a[136:139], v[36:39], v[80:83]
v_mfma_f32_16x16x32_bf16 v[84:87], a[136:139], v[52:55], v[84:87]
v_mfma_f32_16x16x32_bf16 v[88:91], a[136:139], v[68:71], v[88:91]
v_mfma_f32_16x16x32_bf16 v[76:79], a[140:143], v[24:27], v[76:79]
v_mfma_f32_16x16x32_bf16 v[80:83], a[140:143], v[40:43], v[80:83]
v_mfma_f32_16x16x32_bf16 v[84:87], a[140:143], v[56:59], v[84:87]
v_mfma_f32_16x16x32_bf16 v[88:91], a[140:143], v[72:75], v[88:91]
s_nop 7
v_max3_f32 v192, v192, v76, v77
v_max3_f32 v192, v192, v78, v79
v_max3_f32 v193, v193, v80, v81
v_max3_f32 v193, v193, v82, v83
v_max3_f32 v194, v194, v84, v85
v_max3_f32 v194, v194, v86, v87
v_max3_f32 v195, v195, v88, v89
v_max3_f32 v195, v195, v90, v91
s_barrier
s_add_u32 s41, s41, 16384
s_sub_u32 s46, s46, 1
s_cmp_lg_u32 s46, 0
s_cbranch_scc1 L_at_fbloop
v_mov_b32 v200, v192
s_nop 1
v_permlane32_swap_b32 v192, v200
v_max_f32 v192, v192, v200
v_mov_b32 v200, v192
s_nop 1
v_permlane16_swap_b32 v192, v200
v_max_f32 v192, v192, v200
v_mov_b32 v200, v193
s_nop 1
v_permlane32_swap_b32 v193, v200
v_max_f32 v193, v193, v200
v_mov_b32 v200, v193
s_nop 1
v_permlane16_swap_b32 v193, v200
v_max_f32 v193, v193, v200
v_mov_b32 v200, v194
s_nop 1
v_permlane32_swap_b32 v194, v200
v_max_f32 v194, v194, v200
v_mov_b32 v200, v194
s_nop 1
v_permlane16_swap_b32 v194, v200
v_max_f32 v194, v194, v200
v_mov_b32 v200, v195
s_nop 1
v_permlane32_swap_b32 v195, v200
v_max_f32 v195, v195, v200
v_mov_b32 v200, v195
s_nop 1
v_permlane16_swap_b32 v195, v200
v_max_f32 v195, v195, v200
v_sub_f32 v172, 0, v192
v_sub_f32 v173, 0, v192
v_sub_f32 v174, 0, v192
v_sub_f32 v175, 0, v192
v_sub_f32 v176, 0, v193
v_sub_f32 v177, 0, v193
v_sub_f32 v178, 0, v193
v_sub_f32 v179, 0, v193
v_sub_f32 v180, 0, v194
v_sub_f32 v181, 0, v194
v_sub_f32 v182, 0, v194
v_sub_f32 v183, 0, v194
v_sub_f32 v184, 0, v195
v_sub_f32 v185, 0, v195
v_sub_f32 v186, 0, v195
v_sub_f32 v187, 0, v195
s_mov_b32 s45, 1
s_mov_b32 s41, s47
s_lshl_b32 s43, s30, 13
s_mov_b32 m0, s43
s_nop 0
buffer_load_dwordx4 v2, s[8:11], s41 offen offset:0 lds
buffer_load_dwordx4 v2, s[8:11], s41 offen offset:1024 lds
buffer_load_dwordx4 v2, s[8:11], s41 offen offset:2048 lds
buffer_load_dwordx4 v2, s[8:11], s41 offen offset:3072 lds
s_add_u32 m0, s43, 4096
s_add_u32 s42, s41, 4096
s_nop 0
buffer_load_dwordx4 v2, s[8:11], s42 offen offset:0 lds
buffer_load_dwordx4 v2, s[8:11], s42 offen offset:1024 lds
buffer_load_dwordx4 v2, s[8:11], s42 offen offset:2048 lds
buffer_load_dwordx4 v2, s[8:11], s42 offen offset:3072 lds
s_add_u32 s41, s41, 16384
s_add_u32 s43, s43, 32768
s_and_b32 s43, s43, 0x1ffff
s_mov_b32 m0, s43
s_nop 0
buffer_load_dwordx4 v2, s[8:11], s41 offen offset:0 lds
buffer_load_dwordx4 v2, s[8:11], s41 offen offset:1024 lds
buffer_load_dwordx4 v2, s[8:11], s41 offen offset:2048 lds
buffer_load_dwordx4 v2, s[8:11], s41 offen offset:3072 lds
s_add_u32 m0, s43, 4096
s_add_u32 s42, s41, 4096
s_nop 0
buffer_load_dwordx4 v2, s[8:11], s42 offen offset:0 lds
buffer_load_dwordx4 v2, s[8:11], s42 offen offset:1024 lds
buffer_load_dwordx4 v2, s[8:11], s42 offen offset:2048 lds
buffer_load_dwordx4 v2, s[8:11], s42 offen offset:3072 lds
s_add_u32 s41, s41, 16384
s_add_u32 s43, s43, 32768
s_and_b32 s43, s43, 0x1ffff
v_accvgpr_write_b32 a0, 0
v_accvgpr_write_b32 a1, 0
v_accvgpr_write_b32 a2, 0
v_accvgpr_write_b32 a3, 0
v_accvgpr_write_b32 a4, 0
v_accvgpr_write_b32 a5, 0
v_accvgpr_write_b32 a6, 0
v_accvgpr_write_b32 a7, 0
v_accvgpr_write_b32 a8, 0
v_accvgpr_write_b32 a9, 0
v_accvgpr_write_b32 a10, 0
v_accvgpr_write_b32 a11, 0
v_accvgpr_write_b32 a12, 0
v_accvgpr_write_b32 a13, 0
v_accvgpr_write_b32 a14, 0
v_accvgpr_write_b32 a15, 0
v_accvgpr_write_b32 a16, 0
v_accvgpr_write_b32 a17, 0
v_accvgpr_write_b32 a18, 0
v_accvgpr_write_b32 a19, 0
v_accvgpr_write_b32 a20, 0
v_accvgpr_write_b32 a21, 0
v_accvgpr_write_b32 a22, 0
v_accvgpr_write_b32 a23, 0
v_accvgpr_write_b32 a24, 0
v_accvgpr_write_b32 a25, 0
v_accvgpr_write_b32 a26, 0
v_accvgpr_write_b32 a27, 0
v_accvgpr_write_b32 a28, 0
v_accvgpr_write_b32 a29, 0
v_accvgpr_write_b32 a30, 0
v_accvgpr_write_b32 a31, 0
v_accvgpr_write_b32 a32, 0
v_accvgpr_write_b32 a33, 0
v_accvgpr_write_b32 a34, 0
v_accvgpr_write_b32 a35, 0
v_accvgpr_write_b32 a36, 0
v_accvgpr_write_b32 a37, 0
v_accvgpr_write_b32 a38, 0
v_accvgpr_write_b32 a39, 0
v_accvgpr_write_b32 a40, 0
v_accvgpr_write_b32 a41, 0
v_accvgpr_write_b32 a42, 0
v_accvgpr_write_b32 a43, 0
v_accvgpr_write_b32 a44, 0
v_accvgpr_write_b32 a45, 0
v_accvgpr_write_b32 a46, 0
v_accvgpr_write_b32 a47, 0
v_accvgpr_write_b32 a48, 0
v_accvgpr_write_b32 a49, 0
v_accvgpr_write_b32 a50, 0
v_accvgpr_write_b32 a51, 0
v_accvgpr_write_b32 a52, 0
v_accvgpr_write_b32 a53, 0
v_accvgpr_write_b32 a54, 0
v_accvgpr_write_b32 a55, 0
v_accvgpr_write_b32 a56, 0
v_accvgpr_write_b32 a57, 0
v_accvgpr_write_b32 a58, 0
v_accvgpr_write_b32 a59, 0
v_accvgpr_write_b32 a60, 0
v_accvgpr_write_b32 a61, 0
v_accvgpr_write_b32 a62, 0
v_accvgpr_write_b32 a63, 0
v_accvgpr_write_b32 a64, 0
v_accvgpr_write_b32 a65, 0
v_accvgpr_write_b32 a66, 0
v_accvgpr_write_b32 a67, 0
v_accvgpr_write_b32 a68, 0
v_accvgpr_write_b32 a69, 0
v_accvgpr_write_b32 a70, 0
v_accvgpr_write_b32 a71, 0
v_accvgpr_write_b32 a72, 0
v_accvgpr_write_b32 a73, 0
v_accvgpr_write_b32 a74, 0
v_accvgpr_write_b32 a75, 0
v_accvgpr_write_b32 a76, 0
v_accvgpr_write_b32 a77, 0
v_accvgpr_write_b32 a78, 0
v_accvgpr_write_b32 a79, 0
v_accvgpr_write_b32 a80, 0
v_accvgpr_write_b32 a81, 0
v_accvgpr_write_b32 a82, 0
v_accvgpr_write_b32 a83, 0
v_accvgpr_write_b32 a84, 0
v_accvgpr_write_b32 a85, 0
v_accvgpr_write_b32 a86, 0
v_accvgpr_write_b32 a87, 0
v_accvgpr_write_b32 a88, 0
v_accvgpr_write_b32 a89, 0
v_accvgpr_write_b32 a90, 0
v_accvgpr_write_b32 a91, 0
v_accvgpr_write_b32 a92, 0
v_accvgpr_write_b32 a93, 0
v_accvgpr_write_b32 a94, 0
v_accvgpr_write_b32 a95, 0
v_accvgpr_write_b32 a96, 0
v_accvgpr_write_b32 a97, 0
v_accvgpr_write_b32 a98, 0
v_accvgpr_write_b32 a99, 0
v_accvgpr_write_b32 a100, 0
v_accvgpr_write_b32 a101, 0
v_accvgpr_write_b32 a102, 0
v_accvgpr_write_b32 a103, 0
v_accvgpr_write_b32 a104, 0
v_accvgpr_write_b32 a105, 0
v_accvgpr_write_b32 a106, 0
v_accvgpr_write_b32 a107, 0
v_accvgpr_write_b32 a108, 0
v_accvgpr_write_b32 a109, 0
v_accvgpr_write_b32 a110, 0
v_accvgpr_write_b32 a111, 0
v_accvgpr_write_b32 a112, 0
v_accvgpr_write_b32 a113, 0
v_accvgpr_write_b32 a114, 0
v_accvgpr_write_b32 a115, 0
v_accvgpr_write_b32 a116, 0
v_accvgpr_write_b32 a117, 0
v_accvgpr_write_b32 a118, 0
v_accvgpr_write_b32 a119, 0
v_accvgpr_write_b32 a120, 0
v_accvgpr_write_b32 a121, 0
v_accvgpr_write_b32 a122, 0
v_accvgpr_write_b32 a123, 0
v_accvgpr_write_b32 a124, 0
v_accvgpr_write_b32 a125, 0
v_accvgpr_write_b32 a126, 0
v_accvgpr_write_b32 a127, 0
v_mov_b32 v188, 0
v_mov_b32 v189, 0
v_mov_b32 v190, 0
v_mov_b32 v191, 0
v_accvgpr_write_b32 a176, 0
v_accvgpr_write_b32 a177, 0
v_accvgpr_write_b32 a178, 0
v_accvgpr_write_b32 a179, 0
s_waitcnt vmcnt(0)
s_branch L_at_go
.section .rodata,"a"
.p2align 6
.amdhsa_kernel k_main_kernel
  .amdhsa_next_free_vgpr 512
  .amdhsa_next_free_sgpr 102
  .amdhsa_accum_offset 256
  .amdhsa_group_segment_fixed_size 0
  .amdhsa_kernarg_size 112
  .amdhsa_user_sgpr_count 2
  .amdhsa_user_sgpr_kernarg_segment_ptr 1
  .amdhsa_system_sgpr_workgroup_id_x 1
.end_amdhsa_kernel
```
